```python
import torch

def _softmax(x, axis=-1):
    return torch.softmax(x, dim=axis)
def _gelu(x):
    return torch.nn.functional.gelu(x, approximate="tanh")
def _silu(x):
    return torch.nn.functional.silu(x)
def _sigmoid(x):
    return torch.sigmoid(x)
def _layernorm(x, axis=-1, eps=1e-5):
    m = x.mean(dim=axis, keepdim=True)
    v = x.var(dim=axis, keepdim=True, unbiased=False)
    return (x - m) / torch.sqrt(v + eps)
def _scatter_add(tgt, idx, src, axis=0):
    return tgt.clone().index_add_(axis, idx, src)
def _segment_sum(src, seg, n):
    out = torch.zeros((n,) + src.shape[1:], dtype=src.dtype)
    return out.index_add_(0, seg, src)
def _pad(x, pw):
    flat = tuple(v for pair in reversed(pw) for v in pair)
    return torch.nn.functional.pad(x, flat)

kernel_name = 'concat_heads__mha_block_cached__gqa_block_cached__near_ridge'

def setup_inputs():

    _w = (lambda a: (lambda t: t.to(torch.bfloat16) if t.is_floating_point() else t)(torch.as_tensor(a)))
    def _A_setup():
        B, Sq, D = 8, 288, 512
        H, Sk, Dh = 32, 1024, 128
        return {
            "x": _w((lambda *s: torch.randn(*s, dtype=torch.bfloat16) * 0.8)(B, Sq, D)),
            "k_cache": _w((lambda *s: torch.randn(*s, dtype=torch.bfloat16) * 0.8)(B, H, Sk, Dh)),
            "v_cache": _w((lambda *s: torch.randn(*s, dtype=torch.bfloat16) * 0.05)(B, H, Sk, Dh)),
            "wq": _w((lambda *s: torch.randn(*s, dtype=torch.bfloat16) * 0.8)(D, H * Dh) * (D ** -0.5)),
            "wo": _w((lambda *s: torch.randn(*s, dtype=torch.bfloat16) * 0.05)(H * Dh, D) * ((H * Dh) ** -0.5)),
        }
    _A_in = _A_setup()

    def _B_setup():
        B, Sq, D = 8, 288, 512
        Hq, Hkv, Sk, Dh = 32, 32, 1024, 128
        assert Hq % Hkv == 0, (Hq, Hkv)
        return {
            "x": _w((lambda *s: torch.randn(*s, dtype=torch.bfloat16) * 0.8)(B, Sq, D)),
            "k_cache": _w((lambda *s: torch.randn(*s, dtype=torch.bfloat16) * 0.8)(B, Hkv, Sk, Dh)),
            "v_cache": _w((lambda *s: torch.randn(*s, dtype=torch.bfloat16) * 0.05)(B, Hkv, Sk, Dh)),
            "wq": _w((lambda *s: torch.randn(*s, dtype=torch.bfloat16) * 0.8)(D, Hq * Dh) * (D ** -0.5)),
            "wo": _w((lambda *s: torch.randn(*s, dtype=torch.bfloat16) * 0.05)(Hq * Dh, D) * ((Hq * Dh) ** -0.5)),
        }
    _B_in = _B_setup()

    return {
        "A_x": _A_in["x"],
        "A_k_cache": _A_in["k_cache"],
        "A_v_cache": _A_in["v_cache"],
        "A_wq": _A_in["wq"],
        "A_wo": _A_in["wo"],
        "B_x": _B_in["x"],
        "B_k_cache": _B_in["k_cache"],
        "B_v_cache": _B_in["v_cache"],
        "B_wq": _B_in["wq"],
        "B_wo": _B_in["wo"],
    }

def reference(A_x, A_k_cache, A_v_cache, A_wq, A_wo, B_x, B_k_cache, B_v_cache, B_wq, B_wo):
    def _A_ref(x, k_cache, v_cache, wq, wo):
        B, Sq, D = x.shape
        H, Dh = 32, 128
        q = (lambda x, *d: x.permute(*d))((x @ wq).reshape(B, Sq, H, Dh), 0, 2, 1, 3)
        scores = torch.einsum("bhqd,bhkd->bhqk", q, k_cache) * (Dh ** -0.5)
        p = _softmax(scores, axis=-1)
        o = torch.einsum("bhqk,bhkd->bhqd", p, v_cache)
        return (lambda x, *d: x.permute(*d))(o, 0, 2, 1, 3).reshape(B, Sq, H * Dh) @ wo

    def _B_ref(x, k_cache, v_cache, wq, wo):
        B, Sq, D = x.shape
        Hq, Dh = 32, 128
        Hkv = k_cache.shape[1]
        rep = Hq // Hkv
        q = (lambda x, *d: x.permute(*d))((x @ wq).reshape(B, Sq, Hq, Dh), 0, 2, 1, 3)
        k = (lambda x, n, axis: torch.repeat_interleave(x, n, dim=axis))(k_cache, rep, axis=1)
        v = (lambda x, n, axis: torch.repeat_interleave(x, n, dim=axis))(v_cache, rep, axis=1)
        scores = torch.einsum("bhqd,bhkd->bhqk", q, k) * (Dh ** -0.5)
        p = _softmax(scores, axis=-1)
        o = torch.einsum("bhqk,bhkd->bhqd", p, v)
        return (lambda x, *d: x.permute(*d))(o, 0, 2, 1, 3).reshape(B, Sq, Hq * Dh) @ wo

    a = _A_ref(A_x, A_k_cache, A_v_cache, A_wq, A_wo)
    b = _B_ref(B_x, B_k_cache, B_v_cache, B_wq, B_wo)
    return torch.concatenate([a, b], axis=-1)
```

```asm
; @launch grid=(256,1,1) block=(256,1,1) lds=163840
.amdgcn_target "amdgcn-amd-amdhsa--gfx950"
.text
.globl concat_heads__mha_block_cached__gqa_block_cached__near_ridge_kernel
.p2align 8
.type concat_heads__mha_block_cached__gqa_block_cached__near_ridge_kernel,@function
concat_heads__mha_block_cached__gqa_block_cached__near_ridge_kernel:
    s_cmp_ge_u32 s2, 256
    s_cbranch_scc1 K1_exit
    s_mov_b32 s75, 0
K1_again:
    s_load_dwordx4 s[4:7], s[0:1], 88
    s_load_dwordx8 s[44:51], s[0:1], 0
    s_load_dwordx8 s[52:59], s[0:1], 40
    s_load_dwordx2 s[92:93], s[0:1], 32
    s_load_dwordx4 s[64:67], s[0:1], 72
    s_getreg_b32 s42, hwreg(HW_REG_XCC_ID, 0, 3)
    v_mov_b32 v236, v0
    v_and_b32 v232, 63, v0
    v_lshrrev_b32 v1, 6, v0
    v_lshlrev_b32 v233, 4, v232
    v_readfirstlane_b32 s36, v1
    s_or_b32 s70, s36, s75
    s_cmp_lg_u32 s70, 0
    s_cbranch_scc1 K1_tk2
    s_mov_b32 s60, s42
    s_mov_b32 s62, 8
    v_mov_b32 v10, 1
    s_lshl_b32 s61, s60, 5
    v_mov_b32 v9, s61
    s_waitcnt lgkmcnt(0)
    s_mov_b64 exec, 1
    global_atomic_add v11, v9, v10, s[4:5] sc0
    s_mov_b64 exec, -1
K1_tk2:
    s_getpc_b64 s[94:95]
    v_lshlrev_b32 v12, 7, v0
    s_waitcnt lgkmcnt(0)
    v_lshrrev_b32 v1, 4, v232
    v_and_b32 v2, 15, v232
    v_bfe_u32 v6, v232, 2, 2
    v_and_b32 v8, 3, v232
    v_xor_b32 v3, v1, v2
    v_lshlrev_b32 v3, 4, v3
    v_lshl_add_u32 v220, v1, 8, v3
    s_lshl_b32 s71, s36, 6
    v_xor_b32 v220, s71, v220
    s_and_b32 s71, s36, 1
    s_lshl_b32 s71, s71, 7
    v_lshl_add_u32 v4, v2, 8, v3
    v_xor_b32 v4, s71, v4
    v_xor_b32 v208, 0, v4
    v_xor_b32 v209, 64, v4
    v_xor_b32 v210, 128, v4
    v_xor_b32 v211, 192, v4
    global_load_dword v238, v12, s[94:95]
    v_lshlrev_b32 v3, 1, v1
    v_xor_b32 v3, v3, v2
    v_lshlrev_b32 v3, 4, v3
    v_lshl_add_u32 v224, v1, 8, v3
    v_lshrrev_b32 v3, 2, v232
    v_and_b32 v4, 7, v3
    v_lshlrev_b32 v4, 5, v4
    v_lshl_add_u32 v4, v3, 8, v4
    v_lshl_add_u32 v4, v8, 3, v4
    v_xor_b32 v212, 0, v4
    v_xor_b32 v213, 32, v4
    v_xor_b32 v214, 64, v4
    v_xor_b32 v215, 96, v4
    v_xor_b32 v216, 128, v4
    v_xor_b32 v217, 160, v4
    v_xor_b32 v218, 192, v4
    v_xor_b32 v219, 224, v4
    v_mov_b32 v235, v4
    v_lshl_add_u32 v3, v1, 3, v6
    v_lshlrev_b32 v3, 9, v3
    v_lshl_add_u32 v3, v6, 6, v3
    v_lshl_add_u32 v3, v8, 4, v3
    v_xor_b32 v3, s71, v3
    v_xor_b32 v241, 0, v3
    v_xor_b32 v242, 64, v3
    v_xor_b32 v243, 128, v3
    v_xor_b32 v244, 192, v3
    v_lshrrev_b32 v3, 1, v2
    v_xor_b32 v3, v3, v1
    v_lshlrev_b32 v3, 4, v3
    v_lshl_add_u32 v3, v2, 7, v3
    s_lshl_b32 s72, s36, 13
    s_add_u32 s72, s72, 32768
    s_lshr_b32 s73, s36, 1
    s_lshl_b32 s73, s73, 11
    s_add_u32 s73, s73, 65536
    v_xor_b32 v4, 0, v3
    v_add_u32 v245, s72, v4
    v_add_u32 v247, s73, v4
    v_xor_b32 v4, 64, v3
    v_add_u32 v246, s72, v4
    v_add_u32 v248, s73, v4
    v_lshrrev_b32 v7, 5, v232
    v_and_b32 v3, 31, v232
    v_lshlrev_b32 v4, 2, v7
    v_xor_b32 v3, v3, v4
    v_lshlrev_b32 v3, 4, v3
    v_lshl_add_u32 v3, v7, 13, v3
    v_xor_b32 v4, 0, v3
    v_add_u32 v200, 0, v4
    v_xor_b32 v4, 128, v3
    v_add_u32 v201, 15360, v4
    v_xor_b32 v4, 0, v3
    v_add_u32 v202, 30720, v4
    v_xor_b32 v4, 128, v3
    v_add_u32 v203, 46080, v4
    v_lshrrev_b32 v5, 3, v232
    v_and_b32 v7, 7, v232
    v_xor_b32 v3, v7, v1
    v_lshlrev_b32 v3, 4, v3
    v_lshl_add_u32 v3, v5, 10, v3
    v_xor_b32 v4, 0, v3
    v_add_u32 v204, 0, v4
    v_xor_b32 v4, 64, v3
    v_add_u32 v205, 7168, v4
    v_xor_b32 v4, 0, v3
    v_add_u32 v206, 14336, v4
    v_xor_b32 v4, 64, v3
    v_add_u32 v207, 21504, v4
    s_lshr_b32 s72, s71, 1
    v_xor_b32 v4, s72, v3
    s_lshl_b32 s72, s36, 13
    s_add_u32 s72, s72, 262144
    v_add_u32 v240, s72, v4
    v_and_b32 v4, 255, v224
    v_lshl_add_u32 v234, v1, 10, v4
    v_xor_b32 v224, s71, v224
    v_cmp_eq_u32 vcc, 0, v8
    v_mov_b32 v4, 0x3f803f80
    s_nop 0
    v_cndmask_b32 v228, 0, v4, vcc
    v_mov_b32 v229, v228
    v_mov_b32 v230, v228
    v_mov_b32 v231, v228
    v_lshrrev_b32 v3, 2, v232
    v_lshlrev_b32 v4, 7, v8
    v_lshl_add_u32 v253, v3, 13, v4
    s_lshl_b32 s80, s36, 17
    s_lshl_b32 s81, s36, 16
    s_lshl_b32 s82, s36, 13
    s_add_u32 s83, s82, 32768
    s_lshl_b32 s84, s36, 10
    s_add_u32 s84, s84, 65536
    v_mov_b32 v1, 139264
    s_cmp_lg_u32 s70, 0
    s_cbranch_scc1 K1_tk3
    s_waitcnt vmcnt(1)
K1_tk0:
    v_readfirstlane_b32 s63, v11
    s_cmp_lt_u32 s63, 32
    s_cbranch_scc1 K1_tk1
    s_sub_u32 s62, s62, 1
    s_cmp_eq_u32 s62, 0
    s_cbranch_scc1 K1_tk1
    s_add_u32 s60, s60, 1
    s_and_b32 s60, s60, 7
    s_lshl_b32 s61, s60, 5
    v_mov_b32 v9, s61
    s_mov_b64 exec, 1
    global_atomic_add v11, v9, v10, s[4:5] sc0
    s_mov_b64 exec, -1
    s_waitcnt vmcnt(0)
    s_branch K1_tk0
K1_tk1:
    s_and_b32 s63, s63, 31
    s_add_u32 s61, s61, s63
    v_mov_b32 v3, s61
    ds_write_b32 v1, v3
K1_tk3:
    s_waitcnt lgkmcnt(0)
    s_barrier
    ds_read_b32 v3, v1
    s_waitcnt lgkmcnt(0)
    v_readfirstlane_b32 s73, v3
    s_sub_u32 s72, s75, 1
    s_cmp_lg_u32 s75, 0
    s_cselect_b32 s73, s72, s73
    s_and_b32 s73, s73, 255
    s_lshr_b32 s78, s73, 4
    s_and_b32 s77, s73, 15
    s_cmp_ge_u32 s78, 8
    s_cselect_b64 s[44:45], s[52:53], s[44:45]
    s_cselect_b64 s[46:47], s[54:55], s[46:47]
    s_cselect_b64 s[48:49], s[56:57], s[48:49]
    s_cselect_b64 s[50:51], s[58:59], s[50:51]
    s_cselect_b64 s[92:93], s[64:65], s[92:93]
    s_and_b32 s62, s78, 7
    s_mul_i32 s71, s62, 294912
    s_add_u32 s44, s44, s71
    s_addc_u32 s45, s45, 0
    s_mov_b32 s8, s44
    s_and_b32 s9, s45, 0xffff
    s_mov_b32 s10, 294912
    s_mov_b32 s11, 0x20000
    s_lshl_b32 s71, s77, 9
    s_add_u32 s50, s50, s71
    s_addc_u32 s51, s51, 0
    s_mov_b32 s12, s50
    s_and_b32 s13, s51, 0xffff
    s_mov_b32 s14, 4186624
    s_mov_b32 s15, 0x20000
    s_add_u32 m0, s82, 0
    s_add_u32 s60, s80, 0
    buffer_load_dwordx4 v200, s[12:15], s60 offen offset:0  lds
    buffer_load_dwordx4 v201, s[12:15], s60 offen offset:1024  lds
    buffer_load_dwordx4 v202, s[12:15], s60 offen offset:2048  lds
    buffer_load_dwordx4 v203, s[12:15], s60 offen offset:3072  lds
    s_add_u32 m0, s82, 4096
    s_add_u32 s60, s80, 65536
    buffer_load_dwordx4 v200, s[12:15], s60 offen offset:0  lds
    buffer_load_dwordx4 v201, s[12:15], s60 offen offset:1024  lds
    buffer_load_dwordx4 v202, s[12:15], s60 offen offset:2048  lds
    buffer_load_dwordx4 v203, s[12:15], s60 offen offset:3072  lds
    s_add_u32 m0, s83, 0
    s_add_u32 s60, s81, 0
    buffer_load_dwordx4 v204, s[8:11], s60 offen offset:0 nt lds
    buffer_load_dwordx4 v205, s[8:11], s60 offen offset:1024 nt lds
    buffer_load_dwordx4 v206, s[8:11], s60 offen offset:2048 nt lds
    buffer_load_dwordx4 v207, s[8:11], s60 offen offset:3072 nt lds
    s_add_u32 m0, s83, 4096
    s_add_u32 s60, s81, 32768
    buffer_load_dwordx4 v204, s[8:11], s60 offen offset:0 nt lds
    buffer_load_dwordx4 v205, s[8:11], s60 offen offset:1024 nt lds
    buffer_load_dwordx4 v206, s[8:11], s60 offen offset:2048 nt lds
    buffer_load_dwordx4 v207, s[8:11], s60 offen offset:3072 nt lds
    s_add_u32 m0, s84, 0
    s_mov_b32 s60, 0
    buffer_load_dwordx4 v240, s[8:11], s60 offen nt lds
    s_add_u32 m0, s82, 69632
    s_add_u32 s60, s80, 524288
    buffer_load_dwordx4 v200, s[12:15], s60 offen offset:0  lds
    buffer_load_dwordx4 v201, s[12:15], s60 offen offset:1024  lds
    buffer_load_dwordx4 v202, s[12:15], s60 offen offset:2048  lds
    buffer_load_dwordx4 v203, s[12:15], s60 offen offset:3072  lds
    s_add_u32 m0, s82, 73728
    s_add_u32 s60, s80, 589824
    buffer_load_dwordx4 v200, s[12:15], s60 offen offset:0  lds
    buffer_load_dwordx4 v201, s[12:15], s60 offen offset:1024  lds
    buffer_load_dwordx4 v202, s[12:15], s60 offen offset:2048  lds
    buffer_load_dwordx4 v203, s[12:15], s60 offen offset:3072  lds
    s_mul_i32 s71, s77, 18
    s_mul_i32 s72, s36, 5
    s_add_u32 s71, s71, s72
    v_add_u32 v1, s71, v232
    v_lshlrev_b32 v1, 10, v1
    v_cmp_gt_u32 vcc, 5, v232
    v_mov_b32 v2, 0x1000000
    s_nop 0
    v_cndmask_b32 v226, v2, v1, vcc
    s_and_b32 s71, s78, 1
    v_bfe_u32 v1, v232, 2, 1
    v_cmp_eq_u32 vcc, s71, v1
    s_nop 1
    v_cndmask_b32 v253, v2, v253, vcc
    s_getpc_b64 s[94:95]
K1_pc:
    s_sub_u32 s94, s94, K1_pc-concat_heads__mha_block_cached__gqa_block_cached__near_ridge_kernel
    s_subb_u32 s95, s95, 0
    s_and_b32 s71, s73, 31
    s_lshl_b32 s71, s71, 2
    s_add_u32 s71, s71, s36
    s_lshl_b32 s71, s71, 10
    v_add_u32 v237, s71, v233
    v_min_u32 v237, K1_exit-concat_heads__mha_block_cached__gqa_block_cached__near_ridge_kernel-16, v237
    global_load_dword v238, v237, s[94:95]
    s_mov_b32 s88, s66
    s_and_b32 s89, s67, 0xffff
    s_mov_b32 s90, 4718592
    s_mov_b32 s91, 0x20000
    s_lshl_b32 s71, s62, 23
    s_lshl_b32 s72, s77, 19
    s_add_u32 s71, s71, s72
    s_add_u32 s46, s46, s71
    s_addc_u32 s47, s47, 0
    s_mov_b32 s20, s46
    s_and_b32 s21, s47, 0xffff
    s_mov_b32 s22, 524288
    s_mov_b32 s23, 0x20000
    s_add_u32 s48, s48, s71
    s_addc_u32 s49, s49, 0
    s_mov_b32 s24, s48
    s_and_b32 s25, s49, 0xffff
    s_mov_b32 s26, 524288
    s_mov_b32 s27, 0x20000
    s_mov_b32 s66, s6
    s_mov_b32 s67, s7
    s_mul_i32 s71, s78, 2359296
    s_add_u32 s6, s6, s71
    s_addc_u32 s7, s7, 0
    s_mov_b32 s28, s6
    s_and_b32 s29, s7, 0xffff
    s_mov_b32 s30, 2359296
    s_mov_b32 s31, 0x20000
    s_mov_b32 s64, s92
    s_mov_b32 s65, s93
    s_and_b32 s71, s73, 127
    s_lshl_b32 s71, s71, 2
    s_add_u32 s71, s71, s36
    s_lshl_b32 s71, s71, 13
    s_add_u32 s64, s64, s71
    s_addc_u32 s65, s65, 0
    s_mov_b32 s16, s64
    s_and_b32 s17, s65, 0xffff
    s_mov_b32 s18, 8192
    s_mov_b32 s19, 0x20000
    s_and_b32 s71, s73, 6
    s_lshl_b32 s71, s71, 7
    s_add_u32 s92, s92, s71
    s_addc_u32 s93, s93, 0
    s_mov_b32 s32, s92
    s_and_b32 s33, s93, 0xffff
    s_mov_b32 s34, 4193536
    s_mov_b32 s35, 0x20000
    s_mov_b32 s48, s4
    s_mov_b32 s49, s5
    s_and_b32 s71, s73, 254
    s_mul_i32 s71, s71, 40960
    s_add_u32 s71, s71, 41943040
    s_add_u32 s66, s66, s71
    s_addc_u32 s67, s67, 0
    s_mov_b32 s4, s66
    s_and_b32 s5, s67, 0xffff
    s_mov_b32 s6, 81920
    s_mov_b32 s7, 0x20000
    s_and_b32 s71, s73, 1
    s_mul_i32 s71, s71, 40960
    s_lshl_b32 s72, s36, 2
    s_add_u32 s71, s71, s72
    s_add_u32 s71, s71, 36864
    v_mov_b32 v1, 0
    s_mov_b64 exec, 1
    buffer_store_dword v1, v1, s[4:7], s71 offen sc1
    s_mov_b64 exec, -1
    s_and_b32 s50, s73, 31
    s_lshl_b32 s70, s77, 13
    s_bfe_u32 s71, s50, 0x10003
    s_mul_i32 s71, s71, 1179648
    s_lshl_b32 s72, s36, 14
    s_add_u32 s71, s71, s72
    s_and_b32 s72, s50, 1
    s_lshl_b32 s72, s72, 16
    s_add_u32 s71, s71, s72
    s_add_u32 s51, s71, 0
    s_add_u32 s52, s71, 131072
    s_add_u32 s53, s71, 262144
    s_add_u32 s54, s71, 393216
    s_add_u32 s55, s71, 524288
    s_add_u32 s56, s71, 655360
    s_add_u32 s57, s71, 786432
    s_add_u32 s58, s71, 917504
    s_add_u32 s59, s71, 1048576
    s_lshr_b32 s71, s78, 1
    s_lshl_b32 s71, s71, 5
    s_and_b32 s72, s78, 1
    s_lshl_b32 s72, s72, 3
    s_add_u32 s71, s71, s72
    v_mov_b32 v239, s71
    s_lshl_b32 s47, s36, 12
    s_lshl_b32 s3, s36, 10
    s_mov_b32 s37, s3
    s_add_u32 s85, s37, 8192
    s_mov_b32 s45, 0xfffe8000
    s_mov_b32 s46, 0x8000
    s_mov_b32 s74, 0x18000
    s_mov_b32 s44, s45
    s_lshr_b32 s86, s73, 5
    s_add_u32 s86, s86, s73
    s_and_b32 s86, s86, 31
    s_lshl_b32 s86, s86, 13
    s_lshl_b32 s67, s36, 11
    s_mov_b32 s41, 0
    s_mov_b32 s43, 0x4f800000
    s_waitcnt vmcnt(10)
    s_barrier
    ds_read_b128 a[120:123], v245 offset:0
    ds_read_b128 a[124:127], v245 offset:2048
    ds_read_b128 a[128:131], v245 offset:4096
    ds_read_b128 a[132:135], v245 offset:6144
    ds_read_b128 a[136:139], v247
    ds_read_b64_tr_b16 a[88:89], v241 offset:0
    ds_read_b64_tr_b16 a[90:91], v241 offset:2048
    ds_read_b64_tr_b16 a[92:93], v241 offset:8
    ds_read_b64_tr_b16 a[94:95], v241 offset:2056
    ds_read_b64_tr_b16 a[96:97], v242 offset:0
    ds_read_b64_tr_b16 a[98:99], v242 offset:2048
    ds_read_b64_tr_b16 a[100:101], v242 offset:8
    ds_read_b64_tr_b16 a[102:103], v242 offset:2056
    v_add_u32 v245, 69632, v245
    v_add_u32 v247, 69632, v247
    s_waitcnt lgkmcnt(0)
    v_mfma_f32_16x16x32_bf16 v[16:19], a[88:91], a[120:123], 0
    ds_read_b64_tr_b16 a[104:105], v243 offset:0
    ds_read_b64_tr_b16 a[106:107], v243 offset:2048
    v_mfma_f32_16x16x32_bf16 v[48:51], a[88:91], a[124:127], 0
    ds_read_b64_tr_b16 a[108:109], v243 offset:8
    ds_read_b64_tr_b16 a[110:111], v243 offset:2056
    v_mfma_f32_16x16x32_bf16 a[0:3], a[88:91], a[128:131], 0
    s_add_u32 m0, s83, 69632
    ds_read_b64_tr_b16 a[112:113], v244 offset:0
    ds_read_b64_tr_b16 a[114:115], v244 offset:2048
    v_mfma_f32_16x16x32_bf16 a[32:35], a[88:91], a[132:135], 0
    s_add_u32 s60, s81, 128
    ds_read_b64_tr_b16 a[116:117], v244 offset:8
    ds_read_b64_tr_b16 a[118:119], v244 offset:2056
    v_mfma_f32_16x16x32_bf16 v[0:3], a[88:91], a[136:139], 0
    ds_read_b64_tr_b16 a[88:89], v241 offset:256
    ds_read_b64_tr_b16 a[90:91], v241 offset:2304
    v_mfma_f32_16x16x32_bf16 v[20:23], a[92:95], a[120:123], 0
    ds_read_b128 a[140:143], v246 offset:0
    ds_read_b128 a[144:147], v246 offset:2048
    v_mfma_f32_16x16x32_bf16 v[52:55], a[92:95], a[124:127], 0
    ds_read_b128 a[148:151], v246 offset:4096
    ds_read_b128 a[152:155], v246 offset:6144
    v_mfma_f32_16x16x32_bf16 a[4:7], a[92:95], a[128:131], 0
    ds_read_b128 a[156:159], v248
    v_add_u32 v246, 69632, v246
    v_mfma_f32_16x16x32_bf16 a[36:39], a[92:95], a[132:135], 0
    buffer_load_dwordx4 v204, s[8:11], s60 offen offset:0 nt lds
    v_add_u32 v248, 69632, v248
    v_mfma_f32_16x16x32_bf16 v[4:7], a[92:95], a[136:139], 0
    ds_read_b64_tr_b16 a[92:93], v241 offset:264
    ds_read_b64_tr_b16 a[94:95], v241 offset:2312
    v_mfma_f32_16x16x32_bf16 v[24:27], a[96:99], a[120:123], 0
    buffer_load_dwordx4 v205, s[8:11], s60 offen offset:1024 nt lds
    v_mfma_f32_16x16x32_bf16 v[56:59], a[96:99], a[124:127], 0
    v_mfma_f32_16x16x32_bf16 a[8:11], a[96:99], a[128:131], 0
    v_mfma_f32_16x16x32_bf16 a[40:43], a[96:99], a[132:135], 0
    v_mfma_f32_16x16x32_bf16 v[8:11], a[96:99], a[136:139], 0
    ds_read_b64_tr_b16 a[96:97], v242 offset:256
    ds_read_b64_tr_b16 a[98:99], v242 offset:2304
    v_mfma_f32_16x16x32_bf16 v[28:31], a[100:103], a[120:123], 0
    buffer_load_dwordx4 v206, s[8:11], s60 offen offset:2048 nt lds
    v_mfma_f32_16x16x32_bf16 v[60:63], a[100:103], a[124:127], 0
    v_mfma_f32_16x16x32_bf16 a[12:15], a[100:103], a[128:131], 0
    v_mfma_f32_16x16x32_bf16 a[44:47], a[100:103], a[132:135], 0
    v_mfma_f32_16x16x32_bf16 v[12:15], a[100:103], a[136:139], 0
    s_waitcnt lgkmcnt(2)
    ds_read_b64_tr_b16 a[100:101], v242 offset:264
    ds_read_b64_tr_b16 a[102:103], v242 offset:2312
    v_mfma_f32_16x16x32_bf16 v[32:35], a[104:107], a[120:123], 0
    buffer_load_dwordx4 v207, s[8:11], s60 offen offset:3072 nt lds
    v_mfma_f32_16x16x32_bf16 v[64:67], a[104:107], a[124:127], 0
    s_add_u32 m0, s83, 73728
    s_add_u32 s60, s81, 32896
    v_mfma_f32_16x16x32_bf16 a[16:19], a[104:107], a[128:131], 0
    v_mfma_f32_16x16x32_bf16 a[48:51], a[104:107], a[132:135], 0
    ds_read_b64_tr_b16 a[104:105], v243 offset:256
    ds_read_b64_tr_b16 a[106:107], v243 offset:2304
    v_mfma_f32_16x16x32_bf16 v[36:39], a[108:111], a[120:123], 0
    v_mfma_f32_16x16x32_bf16 v[68:71], a[108:111], a[124:127], 0
    v_mfma_f32_16x16x32_bf16 a[20:23], a[108:111], a[128:131], 0
    buffer_load_dwordx4 v204, s[8:11], s60 offen offset:0 nt lds
    v_mfma_f32_16x16x32_bf16 a[52:55], a[108:111], a[132:135], 0
    ds_read_b64_tr_b16 a[108:109], v243 offset:264
    ds_read_b64_tr_b16 a[110:111], v243 offset:2312
    v_mfma_f32_16x16x32_bf16 v[40:43], a[112:115], a[120:123], 0
    v_mfma_f32_16x16x32_bf16 v[72:75], a[112:115], a[124:127], 0
    v_mfma_f32_16x16x32_bf16 a[24:27], a[112:115], a[128:131], 0
    v_mfma_f32_16x16x32_bf16 a[56:59], a[112:115], a[132:135], 0
    ds_read_b64_tr_b16 a[112:113], v244 offset:256
    ds_read_b64_tr_b16 a[114:115], v244 offset:2304
    v_mfma_f32_16x16x32_bf16 v[44:47], a[116:119], a[120:123], 0
    buffer_load_dwordx4 v205, s[8:11], s60 offen offset:1024 nt lds
    v_mfma_f32_16x16x32_bf16 v[76:79], a[116:119], a[124:127], 0
    v_mfma_f32_16x16x32_bf16 a[28:31], a[116:119], a[128:131], 0
    v_mfma_f32_16x16x32_bf16 a[60:63], a[116:119], a[132:135], 0
    ds_read_b64_tr_b16 a[116:117], v244 offset:264
    ds_read_b64_tr_b16 a[118:119], v244 offset:2312
    v_mfma_f32_16x16x32_bf16 v[80:83], a[88:91], a[120:123], 0
    v_mfma_f32_16x16x32_bf16 v[112:115], a[88:91], a[124:127], 0
    v_mfma_f32_16x16x32_bf16 v[144:147], a[88:91], a[128:131], 0
    buffer_load_dwordx4 v206, s[8:11], s60 offen offset:2048 nt lds
    v_mfma_f32_16x16x32_bf16 v[168:171], a[88:91], a[132:135], 0
    v_mfma_f32_16x16x32_bf16 v[152:155], a[88:91], a[136:139], 0
    ds_read_b64_tr_b16 a[88:89], v241 offset:16384
    ds_read_b64_tr_b16 a[90:91], v241 offset:18432
    v_mfma_f32_16x16x32_bf16 v[84:87], a[92:95], a[120:123], 0
    v_mfma_f32_16x16x32_bf16 v[116:119], a[92:95], a[124:127], 0
    v_mfma_f32_16x16x32_bf16 v[148:151], a[92:95], a[128:131], 0
    v_mfma_f32_16x16x32_bf16 v[172:175], a[92:95], a[132:135], 0
    buffer_load_dwordx4 v207, s[8:11], s60 offen offset:3072 nt lds
    v_mfma_f32_16x16x32_bf16 v[156:159], a[92:95], a[136:139], 0
    s_waitcnt lgkmcnt(2)
    ds_read_b64_tr_b16 a[92:93], v241 offset:16392
    ds_read_b64_tr_b16 a[94:95], v241 offset:18440
    v_mfma_f32_16x16x32_bf16 v[88:91], a[96:99], a[120:123], 0
    s_add_u32 m0, s84, 69632
    s_mov_b32 s60, 128
    v_mfma_f32_16x16x32_bf16 v[120:123], a[96:99], a[124:127], 0
    v_mfma_f32_16x16x32_bf16 a[64:67], a[96:99], a[128:131], 0
    v_mfma_f32_16x16x32_bf16 v[176:179], a[96:99], a[132:135], 0
    v_mfma_f32_16x16x32_bf16 v[160:163], a[96:99], a[136:139], 0
    ds_read_b64_tr_b16 a[96:97], v242 offset:16384
    ds_read_b64_tr_b16 a[98:99], v242 offset:18432
    v_mfma_f32_16x16x32_bf16 v[92:95], a[100:103], a[120:123], 0
    buffer_load_dwordx4 v240, s[8:11], s60 offen nt lds
    v_mfma_f32_16x16x32_bf16 v[124:127], a[100:103], a[124:127], 0
    s_add_u32 s60, s80, 1048576
    v_mfma_f32_16x16x32_bf16 a[68:71], a[100:103], a[128:131], 0
    v_mfma_f32_16x16x32_bf16 v[180:183], a[100:103], a[132:135], 0
    v_mfma_f32_16x16x32_bf16 v[164:167], a[100:103], a[136:139], 0
    ds_read_b64_tr_b16 a[100:101], v242 offset:16392
    ds_read_b64_tr_b16 a[102:103], v242 offset:18440
    v_mfma_f32_16x16x32_bf16 v[96:99], a[104:107], a[120:123], 0
    buffer_load_dword v238, v253, s[12:15], s60 offen
    v_mfma_f32_16x16x32_bf16 v[128:131], a[104:107], a[124:127], 0
    v_mfma_f32_16x16x32_bf16 a[72:75], a[104:107], a[128:131], 0
    v_mfma_f32_16x16x32_bf16 v[184:187], a[104:107], a[132:135], 0
    ds_read_b64_tr_b16 a[104:105], v243 offset:16384
    ds_read_b64_tr_b16 a[106:107], v243 offset:18432
    v_mfma_f32_16x16x32_bf16 v[100:103], a[108:111], a[120:123], 0
    v_mfma_f32_16x16x32_bf16 v[132:135], a[108:111], a[124:127], 0
    v_mfma_f32_16x16x32_bf16 a[76:79], a[108:111], a[128:131], 0
    buffer_load_dword v238, v226, s[8:11], 0 offen offset:256 nt
    v_mfma_f32_16x16x32_bf16 v[188:191], a[108:111], a[132:135], 0
    ds_read_b64_tr_b16 a[108:109], v243 offset:16392
    ds_read_b64_tr_b16 a[110:111], v243 offset:18440
    v_mfma_f32_16x16x32_bf16 v[104:107], a[112:115], a[120:123], 0
    v_mfma_f32_16x16x32_bf16 v[136:139], a[112:115], a[124:127], 0
    v_mfma_f32_16x16x32_bf16 a[80:83], a[112:115], a[128:131], 0
    v_mfma_f32_16x16x32_bf16 v[192:195], a[112:115], a[132:135], 0
    ds_read_b64_tr_b16 a[112:113], v244 offset:16384
    ds_read_b64_tr_b16 a[114:115], v244 offset:18432
    v_mfma_f32_16x16x32_bf16 v[108:111], a[116:119], a[120:123], 0
    v_mfma_f32_16x16x32_bf16 v[140:143], a[116:119], a[124:127], 0
    v_mfma_f32_16x16x32_bf16 a[84:87], a[116:119], a[128:131], 0
    v_mfma_f32_16x16x32_bf16 v[196:199], a[116:119], a[132:135], 0
    s_waitcnt lgkmcnt(2)
    ds_read_b64_tr_b16 a[116:117], v244 offset:16392
    ds_read_b64_tr_b16 a[118:119], v244 offset:18440
    v_mfma_f32_16x16x32_bf16 v[16:19], a[88:91], a[140:143], v[16:19]
    v_mfma_f32_16x16x32_bf16 v[48:51], a[88:91], a[144:147], v[48:51]
    v_mfma_f32_16x16x32_bf16 a[0:3], a[88:91], a[148:151], a[0:3]
    v_mfma_f32_16x16x32_bf16 a[32:35], a[88:91], a[152:155], a[32:35]
    v_mfma_f32_16x16x32_bf16 v[0:3], a[88:91], a[156:159], v[0:3]
    ds_read_b64_tr_b16 a[88:89], v241 offset:16640
    ds_read_b64_tr_b16 a[90:91], v241 offset:18688
    v_mfma_f32_16x16x32_bf16 v[20:23], a[92:95], a[140:143], v[20:23]
    v_mfma_f32_16x16x32_bf16 v[52:55], a[92:95], a[144:147], v[52:55]
    v_mfma_f32_16x16x32_bf16 a[4:7], a[92:95], a[148:151], a[4:7]
    v_mfma_f32_16x16x32_bf16 a[36:39], a[92:95], a[152:155], a[36:39]
    v_mfma_f32_16x16x32_bf16 v[4:7], a[92:95], a[156:159], v[4:7]
    ds_read_b64_tr_b16 a[92:93], v241 offset:16648
    ds_read_b64_tr_b16 a[94:95], v241 offset:18696
    v_mfma_f32_16x16x32_bf16 v[24:27], a[96:99], a[140:143], v[24:27]
    v_add_u32 v241, 69632, v241
    v_mfma_f32_16x16x32_bf16 v[56:59], a[96:99], a[144:147], v[56:59]
    v_mfma_f32_16x16x32_bf16 a[8:11], a[96:99], a[148:151], a[8:11]
    v_mfma_f32_16x16x32_bf16 a[40:43], a[96:99], a[152:155], a[40:43]
    v_mfma_f32_16x16x32_bf16 v[8:11], a[96:99], a[156:159], v[8:11]
    ds_read_b64_tr_b16 a[96:97], v242 offset:16640
    ds_read_b64_tr_b16 a[98:99], v242 offset:18688
    v_mfma_f32_16x16x32_bf16 v[28:31], a[100:103], a[140:143], v[28:31]
    v_mfma_f32_16x16x32_bf16 v[60:63], a[100:103], a[144:147], v[60:63]
    v_mfma_f32_16x16x32_bf16 a[12:15], a[100:103], a[148:151], a[12:15]
    v_mfma_f32_16x16x32_bf16 a[44:47], a[100:103], a[152:155], a[44:47]
    v_mfma_f32_16x16x32_bf16 v[12:15], a[100:103], a[156:159], v[12:15]
    ds_read_b64_tr_b16 a[100:101], v242 offset:16648
    ds_read_b64_tr_b16 a[102:103], v242 offset:18696
    v_mfma_f32_16x16x32_bf16 v[32:35], a[104:107], a[140:143], v[32:35]
    v_add_u32 v242, 69632, v242
    v_mfma_f32_16x16x32_bf16 v[64:67], a[104:107], a[144:147], v[64:67]
    v_mfma_f32_16x16x32_bf16 a[16:19], a[104:107], a[148:151], a[16:19]
    v_mfma_f32_16x16x32_bf16 a[48:51], a[104:107], a[152:155], a[48:51]
    ds_read_b64_tr_b16 a[104:105], v243 offset:16640
    ds_read_b64_tr_b16 a[106:107], v243 offset:18688
    v_mfma_f32_16x16x32_bf16 v[36:39], a[108:111], a[140:143], v[36:39]
    v_mfma_f32_16x16x32_bf16 v[68:71], a[108:111], a[144:147], v[68:71]
    v_mfma_f32_16x16x32_bf16 a[20:23], a[108:111], a[148:151], a[20:23]
    v_mfma_f32_16x16x32_bf16 a[52:55], a[108:111], a[152:155], a[52:55]
    s_waitcnt lgkmcnt(2)
    ds_read_b64_tr_b16 a[108:109], v243 offset:16648
    ds_read_b64_tr_b16 a[110:111], v243 offset:18696
    v_mfma_f32_16x16x32_bf16 v[40:43], a[112:115], a[140:143], v[40:43]
    v_add_u32 v243, 69632, v243
    v_mfma_f32_16x16x32_bf16 v[72:75], a[112:115], a[144:147], v[72:75]
    v_mfma_f32_16x16x32_bf16 a[24:27], a[112:115], a[148:151], a[24:27]
    v_mfma_f32_16x16x32_bf16 a[56:59], a[112:115], a[152:155], a[56:59]
    ds_read_b64_tr_b16 a[112:113], v244 offset:16640
    ds_read_b64_tr_b16 a[114:115], v244 offset:18688
    v_mfma_f32_16x16x32_bf16 v[44:47], a[116:119], a[140:143], v[44:47]
    v_mfma_f32_16x16x32_bf16 v[76:79], a[116:119], a[144:147], v[76:79]
    v_mfma_f32_16x16x32_bf16 a[28:31], a[116:119], a[148:151], a[28:31]
    v_mfma_f32_16x16x32_bf16 a[60:63], a[116:119], a[152:155], a[60:63]
    ds_read_b64_tr_b16 a[116:117], v244 offset:16648
    ds_read_b64_tr_b16 a[118:119], v244 offset:18696
    v_mfma_f32_16x16x32_bf16 v[80:83], a[88:91], a[140:143], v[80:83]
    v_add_u32 v244, 69632, v244
    v_mfma_f32_16x16x32_bf16 v[112:115], a[88:91], a[144:147], v[112:115]
    v_mfma_f32_16x16x32_bf16 v[144:147], a[88:91], a[148:151], v[144:147]
    v_mfma_f32_16x16x32_bf16 v[168:171], a[88:91], a[152:155], v[168:171]
    v_mfma_f32_16x16x32_bf16 v[152:155], a[88:91], a[156:159], v[152:155]
    v_mfma_f32_16x16x32_bf16 v[84:87], a[92:95], a[140:143], v[84:87]
    v_mfma_f32_16x16x32_bf16 v[116:119], a[92:95], a[144:147], v[116:119]
    v_mfma_f32_16x16x32_bf16 v[148:151], a[92:95], a[148:151], v[148:151]
    v_mfma_f32_16x16x32_bf16 v[172:175], a[92:95], a[152:155], v[172:175]
    v_mfma_f32_16x16x32_bf16 v[156:159], a[92:95], a[156:159], v[156:159]
    v_mfma_f32_16x16x32_bf16 v[88:91], a[96:99], a[140:143], v[88:91]
    s_waitcnt vmcnt(2) lgkmcnt(0)
    s_barrier
    v_mfma_f32_16x16x32_bf16 v[120:123], a[96:99], a[144:147], v[120:123]
    s_add_u32 m0, s82, 0
    ds_read_b64_tr_b16 a[88:89], v241 offset:0
    ds_read_b64_tr_b16 a[90:91], v241 offset:2048
    v_mfma_f32_16x16x32_bf16 a[64:67], a[96:99], a[148:151], a[64:67]
    s_add_u32 s60, s80, 1048576
    ds_read_b128 a[120:123], v245 offset:0
    ds_read_b128 a[124:127], v245 offset:2048
    v_mfma_f32_16x16x32_bf16 v[176:179], a[96:99], a[152:155], v[176:179]
    ds_read_b128 a[128:131], v245 offset:4096
    ds_read_b128 a[132:135], v245 offset:6144
    v_mfma_f32_16x16x32_bf16 v[160:163], a[96:99], a[156:159], v[160:163]
    ds_read_b128 a[136:139], v247
    ds_read_b64_tr_b16 a[92:93], v241 offset:8
    v_mfma_f32_16x16x32_bf16 v[92:95], a[100:103], a[140:143], v[92:95]
    ds_read_b64_tr_b16 a[94:95], v241 offset:2056
    ds_read_b64_tr_b16 a[96:97], v242 offset:0
    v_mfma_f32_16x16x32_bf16 v[124:127], a[100:103], a[144:147], v[124:127]
    ds_read_b64_tr_b16 a[98:99], v242 offset:2048
    v_subrev_u32 v245, 69632, v245
    v_mfma_f32_16x16x32_bf16 a[68:71], a[100:103], a[148:151], a[68:71]
    v_subrev_u32 v247, 69632, v247
    v_mfma_f32_16x16x32_bf16 v[180:183], a[100:103], a[152:155], v[180:183]
    buffer_load_dwordx4 v200, s[12:15], s60 offen offset:0  lds
    v_mfma_f32_16x16x32_bf16 v[164:167], a[100:103], a[156:159], v[164:167]
    ds_read_b64_tr_b16 a[100:101], v242 offset:8
    ds_read_b64_tr_b16 a[102:103], v242 offset:2056
    v_mfma_f32_16x16x32_bf16 v[96:99], a[104:107], a[140:143], v[96:99]
    buffer_load_dwordx4 v201, s[12:15], s60 offen offset:1024  lds
    v_mfma_f32_16x16x32_bf16 v[128:131], a[104:107], a[144:147], v[128:131]
    buffer_load_dwordx4 v202, s[12:15], s60 offen offset:2048  lds
    v_mfma_f32_16x16x32_bf16 a[72:75], a[104:107], a[148:151], a[72:75]
    v_mfma_f32_16x16x32_bf16 v[184:187], a[104:107], a[152:155], v[184:187]
    ds_read_b64_tr_b16 a[104:105], v243 offset:0
    ds_read_b64_tr_b16 a[106:107], v243 offset:2048
    v_mfma_f32_16x16x32_bf16 v[100:103], a[108:111], a[140:143], v[100:103]
    v_mfma_f32_16x16x32_bf16 v[132:135], a[108:111], a[144:147], v[132:135]
    v_mfma_f32_16x16x32_bf16 a[76:79], a[108:111], a[148:151], a[76:79]
    buffer_load_dwordx4 v203, s[12:15], s60 offen offset:3072  lds
    v_mfma_f32_16x16x32_bf16 v[188:191], a[108:111], a[152:155], v[188:191]
    s_add_u32 m0, s82, 4096
    ds_read_b64_tr_b16 a[108:109], v243 offset:8
    ds_read_b64_tr_b16 a[110:111], v243 offset:2056
    v_mfma_f32_16x16x32_bf16 v[104:107], a[112:115], a[140:143], v[104:107]
    s_add_u32 s60, s80, 1114112
    v_mfma_f32_16x16x32_bf16 v[136:139], a[112:115], a[144:147], v[136:139]
    v_mfma_f32_16x16x32_bf16 a[80:83], a[112:115], a[148:151], a[80:83]
    v_mfma_f32_16x16x32_bf16 v[192:195], a[112:115], a[152:155], v[192:195]
    ds_read_b64_tr_b16 a[112:113], v244 offset:0
    ds_read_b64_tr_b16 a[114:115], v244 offset:2048
    v_mfma_f32_16x16x32_bf16 v[108:111], a[116:119], a[140:143], v[108:111]
    buffer_load_dwordx4 v200, s[12:15], s60 offen offset:0  lds
    v_mfma_f32_16x16x32_bf16 v[140:143], a[116:119], a[144:147], v[140:143]
    v_mfma_f32_16x16x32_bf16 a[84:87], a[116:119], a[148:151], a[84:87]
    v_mfma_f32_16x16x32_bf16 v[196:199], a[116:119], a[152:155], v[196:199]
    s_waitcnt lgkmcnt(2)
    ds_read_b64_tr_b16 a[116:117], v244 offset:8
    ds_read_b64_tr_b16 a[118:119], v244 offset:2056
    v_mfma_f32_16x16x32_bf16 v[16:19], a[88:91], a[120:123], v[16:19]
    ds_read_b128 a[140:143], v246 offset:0
    ds_read_b128 a[144:147], v246 offset:2048
    v_mfma_f32_16x16x32_bf16 v[48:51], a[88:91], a[124:127], v[48:51]
    ds_read_b128 a[148:151], v246 offset:4096
    ds_read_b128 a[152:155], v246 offset:6144
    v_mfma_f32_16x16x32_bf16 a[0:3], a[88:91], a[128:131], a[0:3]
    ds_read_b128 a[156:159], v248
    v_subrev_u32 v246, 69632, v246
    v_mfma_f32_16x16x32_bf16 a[32:35], a[88:91], a[132:135], a[32:35]
    v_subrev_u32 v248, 69632, v248
    v_mfma_f32_16x16x32_bf16 v[0:3], a[88:91], a[136:139], v[0:3]
    ds_read_b64_tr_b16 a[88:89], v241 offset:256
    ds_read_b64_tr_b16 a[90:91], v241 offset:2304
    v_mfma_f32_16x16x32_bf16 v[20:23], a[92:95], a[120:123], v[20:23]
    buffer_load_dwordx4 v201, s[12:15], s60 offen offset:1024  lds
    v_mfma_f32_16x16x32_bf16 v[52:55], a[92:95], a[124:127], v[52:55]
    buffer_load_dwordx4 v202, s[12:15], s60 offen offset:2048  lds
    v_mfma_f32_16x16x32_bf16 a[4:7], a[92:95], a[128:131], a[4:7]
    v_mfma_f32_16x16x32_bf16 a[36:39], a[92:95], a[132:135], a[36:39]
    v_mfma_f32_16x16x32_bf16 v[4:7], a[92:95], a[136:139], v[4:7]
    ds_read_b64_tr_b16 a[92:93], v241 offset:264
    ds_read_b64_tr_b16 a[94:95], v241 offset:2312
    v_mfma_f32_16x16x32_bf16 v[24:27], a[96:99], a[120:123], v[24:27]
    buffer_load_dwordx4 v203, s[12:15], s60 offen offset:3072  lds
    v_mfma_f32_16x16x32_bf16 v[56:59], a[96:99], a[124:127], v[56:59]
    s_add_u32 m0, s83, 0
    s_add_u32 s60, s81, 256
    v_mfma_f32_16x16x32_bf16 a[8:11], a[96:99], a[128:131], a[8:11]
    v_mfma_f32_16x16x32_bf16 a[40:43], a[96:99], a[132:135], a[40:43]
    v_mfma_f32_16x16x32_bf16 v[8:11], a[96:99], a[136:139], v[8:11]
    ds_read_b64_tr_b16 a[96:97], v242 offset:256
    ds_read_b64_tr_b16 a[98:99], v242 offset:2304
    v_mfma_f32_16x16x32_bf16 v[28:31], a[100:103], a[120:123], v[28:31]
    buffer_load_dwordx4 v204, s[8:11], s60 offen offset:0 nt lds
    v_mfma_f32_16x16x32_bf16 v[60:63], a[100:103], a[124:127], v[60:63]
    v_mfma_f32_16x16x32_bf16 a[12:15], a[100:103], a[128:131], a[12:15]
    v_mfma_f32_16x16x32_bf16 a[44:47], a[100:103], a[132:135], a[44:47]
    v_mfma_f32_16x16x32_bf16 v[12:15], a[100:103], a[136:139], v[12:15]
    ds_read_b64_tr_b16 a[100:101], v242 offset:264
    ds_read_b64_tr_b16 a[102:103], v242 offset:2312
    v_mfma_f32_16x16x32_bf16 v[32:35], a[104:107], a[120:123], v[32:35]
    buffer_load_dwordx4 v205, s[8:11], s60 offen offset:1024 nt lds
    v_mfma_f32_16x16x32_bf16 v[64:67], a[104:107], a[124:127], v[64:67]
    v_mfma_f32_16x16x32_bf16 a[16:19], a[104:107], a[128:131], a[16:19]
    v_mfma_f32_16x16x32_bf16 a[48:51], a[104:107], a[132:135], a[48:51]
    ds_read_b64_tr_b16 a[104:105], v243 offset:256
    ds_read_b64_tr_b16 a[106:107], v243 offset:2304
    v_mfma_f32_16x16x32_bf16 v[36:39], a[108:111], a[120:123], v[36:39]
    v_mfma_f32_16x16x32_bf16 v[68:71], a[108:111], a[124:127], v[68:71]
    buffer_load_dwordx4 v206, s[8:11], s60 offen offset:2048 nt lds
    v_mfma_f32_16x16x32_bf16 a[20:23], a[108:111], a[128:131], a[20:23]
    v_mfma_f32_16x16x32_bf16 a[52:55], a[108:111], a[132:135], a[52:55]
    s_waitcnt lgkmcnt(2)
    ds_read_b64_tr_b16 a[108:109], v243 offset:264
    ds_read_b64_tr_b16 a[110:111], v243 offset:2312
    v_mfma_f32_16x16x32_bf16 v[40:43], a[112:115], a[120:123], v[40:43]
    v_mfma_f32_16x16x32_bf16 v[72:75], a[112:115], a[124:127], v[72:75]
    v_mfma_f32_16x16x32_bf16 a[24:27], a[112:115], a[128:131], a[24:27]
    buffer_load_dwordx4 v207, s[8:11], s60 offen offset:3072 nt lds
    v_mfma_f32_16x16x32_bf16 a[56:59], a[112:115], a[132:135], a[56:59]
    s_add_u32 m0, s83, 4096
    ds_read_b64_tr_b16 a[112:113], v244 offset:256
    ds_read_b64_tr_b16 a[114:115], v244 offset:2304
    v_mfma_f32_16x16x32_bf16 v[44:47], a[116:119], a[120:123], v[44:47]
    s_add_u32 s60, s81, 33024
    v_mfma_f32_16x16x32_bf16 v[76:79], a[116:119], a[124:127], v[76:79]
    v_mfma_f32_16x16x32_bf16 a[28:31], a[116:119], a[128:131], a[28:31]
    v_mfma_f32_16x16x32_bf16 a[60:63], a[116:119], a[132:135], a[60:63]
    ds_read_b64_tr_b16 a[116:117], v244 offset:264
    ds_read_b64_tr_b16 a[118:119], v244 offset:2312
    v_mfma_f32_16x16x32_bf16 v[80:83], a[88:91], a[120:123], v[80:83]
    buffer_load_dwordx4 v204, s[8:11], s60 offen offset:0 nt lds
    v_mfma_f32_16x16x32_bf16 v[112:115], a[88:91], a[124:127], v[112:115]
    v_mfma_f32_16x16x32_bf16 v[144:147], a[88:91], a[128:131], v[144:147]
    v_mfma_f32_16x16x32_bf16 v[168:171], a[88:91], a[132:135], v[168:171]
    v_mfma_f32_16x16x32_bf16 v[152:155], a[88:91], a[136:139], v[152:155]
    ds_read_b64_tr_b16 a[88:89], v241 offset:16384
    ds_read_b64_tr_b16 a[90:91], v241 offset:18432
    v_mfma_f32_16x16x32_bf16 v[84:87], a[92:95], a[120:123], v[84:87]
    buffer_load_dwordx4 v205, s[8:11], s60 offen offset:1024 nt lds
    v_mfma_f32_16x16x32_bf16 v[116:119], a[92:95], a[124:127], v[116:119]
    v_mfma_f32_16x16x32_bf16 v[148:151], a[92:95], a[128:131], v[148:151]
    v_mfma_f32_16x16x32_bf16 v[172:175], a[92:95], a[132:135], v[172:175]
    v_mfma_f32_16x16x32_bf16 v[156:159], a[92:95], a[136:139], v[156:159]
    ds_read_b64_tr_b16 a[92:93], v241 offset:16392
    ds_read_b64_tr_b16 a[94:95], v241 offset:18440
    v_mfma_f32_16x16x32_bf16 v[88:91], a[96:99], a[120:123], v[88:91]
    buffer_load_dwordx4 v206, s[8:11], s60 offen offset:2048 nt lds
    v_mfma_f32_16x16x32_bf16 v[120:123], a[96:99], a[124:127], v[120:123]
    v_mfma_f32_16x16x32_bf16 a[64:67], a[96:99], a[128:131], a[64:67]
    v_mfma_f32_16x16x32_bf16 v[176:179], a[96:99], a[132:135], v[176:179]
    v_mfma_f32_16x16x32_bf16 v[160:163], a[96:99], a[136:139], v[160:163]
    ds_read_b64_tr_b16 a[96:97], v242 offset:16384
    ds_read_b64_tr_b16 a[98:99], v242 offset:18432
    v_mfma_f32_16x16x32_bf16 v[92:95], a[100:103], a[120:123], v[92:95]
    buffer_load_dwordx4 v207, s[8:11], s60 offen offset:3072 nt lds
    v_mfma_f32_16x16x32_bf16 v[124:127], a[100:103], a[124:127], v[124:127]
    s_add_u32 m0, s84, 0
    s_mov_b32 s60, 256
    v_mfma_f32_16x16x32_bf16 a[68:71], a[100:103], a[128:131], a[68:71]
    v_mfma_f32_16x16x32_bf16 v[180:183], a[100:103], a[132:135], v[180:183]
    v_mfma_f32_16x16x32_bf16 v[164:167], a[100:103], a[136:139], v[164:167]
    s_waitcnt lgkmcnt(2)
    ds_read_b64_tr_b16 a[100:101], v242 offset:16392
    ds_read_b64_tr_b16 a[102:103], v242 offset:18440
    v_mfma_f32_16x16x32_bf16 v[96:99], a[104:107], a[120:123], v[96:99]
    buffer_load_dwordx4 v240, s[8:11], s60 offen nt lds
    v_mfma_f32_16x16x32_bf16 v[128:131], a[104:107], a[124:127], v[128:131]
    s_add_u32 s60, s80, 1572864
    v_mfma_f32_16x16x32_bf16 a[72:75], a[104:107], a[128:131], a[72:75]
    v_mfma_f32_16x16x32_bf16 v[184:187], a[104:107], a[132:135], v[184:187]
    ds_read_b64_tr_b16 a[104:105], v243 offset:16384
    ds_read_b64_tr_b16 a[106:107], v243 offset:18432
    v_mfma_f32_16x16x32_bf16 v[100:103], a[108:111], a[120:123], v[100:103]
    buffer_load_dword v238, v253, s[12:15], s60 offen
    v_mfma_f32_16x16x32_bf16 v[132:135], a[108:111], a[124:127], v[132:135]
    v_mfma_f32_16x16x32_bf16 a[76:79], a[108:111], a[128:131], a[76:79]
    v_mfma_f32_16x16x32_bf16 v[188:191], a[108:111], a[132:135], v[188:191]
    ds_read_b64_tr_b16 a[108:109], v243 offset:16392
    ds_read_b64_tr_b16 a[110:111], v243 offset:18440
    v_mfma_f32_16x16x32_bf16 v[104:107], a[112:115], a[120:123], v[104:107]
    v_mfma_f32_16x16x32_bf16 v[136:139], a[112:115], a[124:127], v[136:139]
    buffer_load_dword v238, v226, s[8:11], 0 offen offset:384 nt
    v_mfma_f32_16x16x32_bf16 a[80:83], a[112:115], a[128:131], a[80:83]
    v_mfma_f32_16x16x32_bf16 v[192:195], a[112:115], a[132:135], v[192:195]
    ds_read_b64_tr_b16 a[112:113], v244 offset:16384
    ds_read_b64_tr_b16 a[114:115], v244 offset:18432
    v_mfma_f32_16x16x32_bf16 v[108:111], a[116:119], a[120:123], v[108:111]
    v_mfma_f32_16x16x32_bf16 v[140:143], a[116:119], a[124:127], v[140:143]
    v_mfma_f32_16x16x32_bf16 a[84:87], a[116:119], a[128:131], a[84:87]
    v_mfma_f32_16x16x32_bf16 v[196:199], a[116:119], a[132:135], v[196:199]
    ds_read_b64_tr_b16 a[116:117], v244 offset:16392
    ds_read_b64_tr_b16 a[118:119], v244 offset:18440
    v_mfma_f32_16x16x32_bf16 v[16:19], a[88:91], a[140:143], v[16:19]
    v_mfma_f32_16x16x32_bf16 v[48:51], a[88:91], a[144:147], v[48:51]
    v_mfma_f32_16x16x32_bf16 a[0:3], a[88:91], a[148:151], a[0:3]
    v_mfma_f32_16x16x32_bf16 a[32:35], a[88:91], a[152:155], a[32:35]
    v_mfma_f32_16x16x32_bf16 v[0:3], a[88:91], a[156:159], v[0:3]
    ds_read_b64_tr_b16 a[88:89], v241 offset:16640
    ds_read_b64_tr_b16 a[90:91], v241 offset:18688
    v_mfma_f32_16x16x32_bf16 v[20:23], a[92:95], a[140:143], v[20:23]
    v_mfma_f32_16x16x32_bf16 v[52:55], a[92:95], a[144:147], v[52:55]
    v_mfma_f32_16x16x32_bf16 a[4:7], a[92:95], a[148:151], a[4:7]
    v_mfma_f32_16x16x32_bf16 a[36:39], a[92:95], a[152:155], a[36:39]
    v_mfma_f32_16x16x32_bf16 v[4:7], a[92:95], a[156:159], v[4:7]
    s_waitcnt lgkmcnt(2)
    ds_read_b64_tr_b16 a[92:93], v241 offset:16648
    ds_read_b64_tr_b16 a[94:95], v241 offset:18696
    v_mfma_f32_16x16x32_bf16 v[24:27], a[96:99], a[140:143], v[24:27]
    v_subrev_u32 v241, 69632, v241
    v_mfma_f32_16x16x32_bf16 v[56:59], a[96:99], a[144:147], v[56:59]
    v_mfma_f32_16x16x32_bf16 a[8:11], a[96:99], a[148:151], a[8:11]
    v_mfma_f32_16x16x32_bf16 a[40:43], a[96:99], a[152:155], a[40:43]
    v_mfma_f32_16x16x32_bf16 v[8:11], a[96:99], a[156:159], v[8:11]
    ds_read_b64_tr_b16 a[96:97], v242 offset:16640
    ds_read_b64_tr_b16 a[98:99], v242 offset:18688
    v_mfma_f32_16x16x32_bf16 v[28:31], a[100:103], a[140:143], v[28:31]
    v_mfma_f32_16x16x32_bf16 v[60:63], a[100:103], a[144:147], v[60:63]
    v_mfma_f32_16x16x32_bf16 a[12:15], a[100:103], a[148:151], a[12:15]
    v_mfma_f32_16x16x32_bf16 a[44:47], a[100:103], a[152:155], a[44:47]
    v_mfma_f32_16x16x32_bf16 v[12:15], a[100:103], a[156:159], v[12:15]
    ds_read_b64_tr_b16 a[100:101], v242 offset:16648
    ds_read_b64_tr_b16 a[102:103], v242 offset:18696
    v_mfma_f32_16x16x32_bf16 v[32:35], a[104:107], a[140:143], v[32:35]
    v_subrev_u32 v242, 69632, v242
    v_mfma_f32_16x16x32_bf16 v[64:67], a[104:107], a[144:147], v[64:67]
    v_mfma_f32_16x16x32_bf16 a[16:19], a[104:107], a[148:151], a[16:19]
    v_mfma_f32_16x16x32_bf16 a[48:51], a[104:107], a[152:155], a[48:51]
    ds_read_b64_tr_b16 a[104:105], v243 offset:16640
    ds_read_b64_tr_b16 a[106:107], v243 offset:18688
    v_mfma_f32_16x16x32_bf16 v[36:39], a[108:111], a[140:143], v[36:39]
    v_mfma_f32_16x16x32_bf16 v[68:71], a[108:111], a[144:147], v[68:71]
    v_mfma_f32_16x16x32_bf16 a[20:23], a[108:111], a[148:151], a[20:23]
    v_mfma_f32_16x16x32_bf16 a[52:55], a[108:111], a[152:155], a[52:55]
    ds_read_b64_tr_b16 a[108:109], v243 offset:16648
    ds_read_b64_tr_b16 a[110:111], v243 offset:18696
    v_mfma_f32_16x16x32_bf16 v[40:43], a[112:115], a[140:143], v[40:43]
    v_subrev_u32 v243, 69632, v243
    v_mfma_f32_16x16x32_bf16 v[72:75], a[112:115], a[144:147], v[72:75]
    v_mfma_f32_16x16x32_bf16 a[24:27], a[112:115], a[148:151], a[24:27]
    v_mfma_f32_16x16x32_bf16 a[56:59], a[112:115], a[152:155], a[56:59]
    ds_read_b64_tr_b16 a[112:113], v244 offset:16640
    ds_read_b64_tr_b16 a[114:115], v244 offset:18688
    v_mfma_f32_16x16x32_bf16 v[44:47], a[116:119], a[140:143], v[44:47]
    v_mfma_f32_16x16x32_bf16 v[76:79], a[116:119], a[144:147], v[76:79]
    v_mfma_f32_16x16x32_bf16 a[28:31], a[116:119], a[148:151], a[28:31]
    v_mfma_f32_16x16x32_bf16 a[60:63], a[116:119], a[152:155], a[60:63]
    s_waitcnt lgkmcnt(2)
    ds_read_b64_tr_b16 a[116:117], v244 offset:16648
    ds_read_b64_tr_b16 a[118:119], v244 offset:18696
    v_mfma_f32_16x16x32_bf16 v[80:83], a[88:91], a[140:143], v[80:83]
    v_subrev_u32 v244, 69632, v244
    v_mfma_f32_16x16x32_bf16 v[112:115], a[88:91], a[144:147], v[112:115]
    v_mfma_f32_16x16x32_bf16 v[144:147], a[88:91], a[148:151], v[144:147]
    v_mfma_f32_16x16x32_bf16 v[168:171], a[88:91], a[152:155], v[168:171]
    v_mfma_f32_16x16x32_bf16 v[152:155], a[88:91], a[156:159], v[152:155]
    v_mfma_f32_16x16x32_bf16 v[84:87], a[92:95], a[140:143], v[84:87]
    v_mfma_f32_16x16x32_bf16 v[116:119], a[92:95], a[144:147], v[116:119]
    v_mfma_f32_16x16x32_bf16 v[148:151], a[92:95], a[148:151], v[148:151]
    v_mfma_f32_16x16x32_bf16 v[172:175], a[92:95], a[152:155], v[172:175]
    v_mfma_f32_16x16x32_bf16 v[156:159], a[92:95], a[156:159], v[156:159]
    v_mfma_f32_16x16x32_bf16 v[88:91], a[96:99], a[140:143], v[88:91]
    s_waitcnt vmcnt(2) lgkmcnt(0)
    s_barrier
    v_mfma_f32_16x16x32_bf16 v[120:123], a[96:99], a[144:147], v[120:123]
    s_add_u32 m0, s82, 69632
    ds_read_b64_tr_b16 a[88:89], v241 offset:0
    ds_read_b64_tr_b16 a[90:91], v241 offset:2048
    v_mfma_f32_16x16x32_bf16 a[64:67], a[96:99], a[148:151], a[64:67]
    s_add_u32 s60, s80, 1572864
    ds_read_b128 a[120:123], v245 offset:0
    ds_read_b128 a[124:127], v245 offset:2048
    v_mfma_f32_16x16x32_bf16 v[176:179], a[96:99], a[152:155], v[176:179]
    ds_read_b128 a[128:131], v245 offset:4096
    ds_read_b128 a[132:135], v245 offset:6144
    v_mfma_f32_16x16x32_bf16 v[160:163], a[96:99], a[156:159], v[160:163]
    ds_read_b128 a[136:139], v247
    ds_read_b64_tr_b16 a[92:93], v241 offset:8
    v_mfma_f32_16x16x32_bf16 v[92:95], a[100:103], a[140:143], v[92:95]
    ds_read_b64_tr_b16 a[94:95], v241 offset:2056
    ds_read_b64_tr_b16 a[96:97], v242 offset:0
    v_mfma_f32_16x16x32_bf16 v[124:127], a[100:103], a[144:147], v[124:127]
    ds_read_b64_tr_b16 a[98:99], v242 offset:2048
    v_add_u32 v245, 69632, v245
    v_mfma_f32_16x16x32_bf16 a[68:71], a[100:103], a[148:151], a[68:71]
    v_add_u32 v247, 69632, v247
    v_mfma_f32_16x16x32_bf16 v[180:183], a[100:103], a[152:155], v[180:183]
    buffer_load_dwordx4 v200, s[12:15], s60 offen offset:0  lds
    v_mfma_f32_16x16x32_bf16 v[164:167], a[100:103], a[156:159], v[164:167]
    ds_read_b64_tr_b16 a[100:101], v242 offset:8
    ds_read_b64_tr_b16 a[102:103], v242 offset:2056
    v_mfma_f32_16x16x32_bf16 v[96:99], a[104:107], a[140:143], v[96:99]
    buffer_load_dwordx4 v201, s[12:15], s60 offen offset:1024  lds
    v_mfma_f32_16x16x32_bf16 v[128:131], a[104:107], a[144:147], v[128:131]
    buffer_load_dwordx4 v202, s[12:15], s60 offen offset:2048  lds
    v_mfma_f32_16x16x32_bf16 a[72:75], a[104:107], a[148:151], a[72:75]
    v_mfma_f32_16x16x32_bf16 v[184:187], a[104:107], a[152:155], v[184:187]
    ds_read_b64_tr_b16 a[104:105], v243 offset:0
    ds_read_b64_tr_b16 a[106:107], v243 offset:2048
    v_mfma_f32_16x16x32_bf16 v[100:103], a[108:111], a[140:143], v[100:103]
    v_mfma_f32_16x16x32_bf16 v[132:135], a[108:111], a[144:147], v[132:135]
    v_mfma_f32_16x16x32_bf16 a[76:79], a[108:111], a[148:151], a[76:79]
    buffer_load_dwordx4 v203, s[12:15], s60 offen offset:3072  lds
    v_mfma_f32_16x16x32_bf16 v[188:191], a[108:111], a[152:155], v[188:191]
    s_add_u32 m0, s82, 73728
    ds_read_b64_tr_b16 a[108:109], v243 offset:8
    ds_read_b64_tr_b16 a[110:111], v243 offset:2056
    v_mfma_f32_16x16x32_bf16 v[104:107], a[112:115], a[140:143], v[104:107]
    s_add_u32 s60, s80, 1638400
    v_mfma_f32_16x16x32_bf16 v[136:139], a[112:115], a[144:147], v[136:139]
    v_mfma_f32_16x16x32_bf16 a[80:83], a[112:115], a[148:151], a[80:83]
    v_mfma_f32_16x16x32_bf16 v[192:195], a[112:115], a[152:155], v[192:195]
    ds_read_b64_tr_b16 a[112:113], v244 offset:0
    ds_read_b64_tr_b16 a[114:115], v244 offset:2048
    v_mfma_f32_16x16x32_bf16 v[108:111], a[116:119], a[140:143], v[108:111]
    buffer_load_dwordx4 v200, s[12:15], s60 offen offset:0  lds
    v_mfma_f32_16x16x32_bf16 v[140:143], a[116:119], a[144:147], v[140:143]
    v_mfma_f32_16x16x32_bf16 a[84:87], a[116:119], a[148:151], a[84:87]
    v_mfma_f32_16x16x32_bf16 v[196:199], a[116:119], a[152:155], v[196:199]
    s_waitcnt lgkmcnt(2)
    ds_read_b64_tr_b16 a[116:117], v244 offset:8
    ds_read_b64_tr_b16 a[118:119], v244 offset:2056
    v_mfma_f32_16x16x32_bf16 v[16:19], a[88:91], a[120:123], v[16:19]
    ds_read_b128 a[140:143], v246 offset:0
    ds_read_b128 a[144:147], v246 offset:2048
    v_mfma_f32_16x16x32_bf16 v[48:51], a[88:91], a[124:127], v[48:51]
    ds_read_b128 a[148:151], v246 offset:4096
    ds_read_b128 a[152:155], v246 offset:6144
    v_mfma_f32_16x16x32_bf16 a[0:3], a[88:91], a[128:131], a[0:3]
    ds_read_b128 a[156:159], v248
    v_add_u32 v246, 69632, v246
    v_mfma_f32_16x16x32_bf16 a[32:35], a[88:91], a[132:135], a[32:35]
    v_add_u32 v248, 69632, v248
    v_mfma_f32_16x16x32_bf16 v[0:3], a[88:91], a[136:139], v[0:3]
    ds_read_b64_tr_b16 a[88:89], v241 offset:256
    ds_read_b64_tr_b16 a[90:91], v241 offset:2304
    v_mfma_f32_16x16x32_bf16 v[20:23], a[92:95], a[120:123], v[20:23]
    buffer_load_dwordx4 v201, s[12:15], s60 offen offset:1024  lds
    v_mfma_f32_16x16x32_bf16 v[52:55], a[92:95], a[124:127], v[52:55]
    buffer_load_dwordx4 v202, s[12:15], s60 offen offset:2048  lds
    v_mfma_f32_16x16x32_bf16 a[4:7], a[92:95], a[128:131], a[4:7]
    v_mfma_f32_16x16x32_bf16 a[36:39], a[92:95], a[132:135], a[36:39]
    v_mfma_f32_16x16x32_bf16 v[4:7], a[92:95], a[136:139], v[4:7]
    ds_read_b64_tr_b16 a[92:93], v241 offset:264
    ds_read_b64_tr_b16 a[94:95], v241 offset:2312
    v_mfma_f32_16x16x32_bf16 v[24:27], a[96:99], a[120:123], v[24:27]
    buffer_load_dwordx4 v203, s[12:15], s60 offen offset:3072  lds
    v_mfma_f32_16x16x32_bf16 v[56:59], a[96:99], a[124:127], v[56:59]
    s_add_u32 m0, s83, 69632
    s_add_u32 s60, s81, 384
    v_mfma_f32_16x16x32_bf16 a[8:11], a[96:99], a[128:131], a[8:11]
    v_mfma_f32_16x16x32_bf16 a[40:43], a[96:99], a[132:135], a[40:43]
    v_mfma_f32_16x16x32_bf16 v[8:11], a[96:99], a[136:139], v[8:11]
    ds_read_b64_tr_b16 a[96:97], v242 offset:256
    ds_read_b64_tr_b16 a[98:99], v242 offset:2304
    v_mfma_f32_16x16x32_bf16 v[28:31], a[100:103], a[120:123], v[28:31]
    buffer_load_dwordx4 v204, s[8:11], s60 offen offset:0 nt lds
    v_mfma_f32_16x16x32_bf16 v[60:63], a[100:103], a[124:127], v[60:63]
    v_mfma_f32_16x16x32_bf16 a[12:15], a[100:103], a[128:131], a[12:15]
    v_mfma_f32_16x16x32_bf16 a[44:47], a[100:103], a[132:135], a[44:47]
    v_mfma_f32_16x16x32_bf16 v[12:15], a[100:103], a[136:139], v[12:15]
    ds_read_b64_tr_b16 a[100:101], v242 offset:264
    ds_read_b64_tr_b16 a[102:103], v242 offset:2312
    v_mfma_f32_16x16x32_bf16 v[32:35], a[104:107], a[120:123], v[32:35]
    buffer_load_dwordx4 v205, s[8:11], s60 offen offset:1024 nt lds
    v_mfma_f32_16x16x32_bf16 v[64:67], a[104:107], a[124:127], v[64:67]
    v_mfma_f32_16x16x32_bf16 a[16:19], a[104:107], a[128:131], a[16:19]
    v_mfma_f32_16x16x32_bf16 a[48:51], a[104:107], a[132:135], a[48:51]
    ds_read_b64_tr_b16 a[104:105], v243 offset:256
    ds_read_b64_tr_b16 a[106:107], v243 offset:2304
    v_mfma_f32_16x16x32_bf16 v[36:39], a[108:111], a[120:123], v[36:39]
    v_mfma_f32_16x16x32_bf16 v[68:71], a[108:111], a[124:127], v[68:71]
    buffer_load_dwordx4 v206, s[8:11], s60 offen offset:2048 nt lds
    v_mfma_f32_16x16x32_bf16 a[20:23], a[108:111], a[128:131], a[20:23]
    v_mfma_f32_16x16x32_bf16 a[52:55], a[108:111], a[132:135], a[52:55]
    s_waitcnt lgkmcnt(2)
    ds_read_b64_tr_b16 a[108:109], v243 offset:264
    ds_read_b64_tr_b16 a[110:111], v243 offset:2312
    v_mfma_f32_16x16x32_bf16 v[40:43], a[112:115], a[120:123], v[40:43]
    v_mfma_f32_16x16x32_bf16 v[72:75], a[112:115], a[124:127], v[72:75]
    v_mfma_f32_16x16x32_bf16 a[24:27], a[112:115], a[128:131], a[24:27]
    buffer_load_dwordx4 v207, s[8:11], s60 offen offset:3072 nt lds
    v_mfma_f32_16x16x32_bf16 a[56:59], a[112:115], a[132:135], a[56:59]
    s_add_u32 m0, s83, 73728
    ds_read_b64_tr_b16 a[112:113], v244 offset:256
    ds_read_b64_tr_b16 a[114:115], v244 offset:2304
    v_mfma_f32_16x16x32_bf16 v[44:47], a[116:119], a[120:123], v[44:47]
    s_add_u32 s60, s81, 33152
    v_mfma_f32_16x16x32_bf16 v[76:79], a[116:119], a[124:127], v[76:79]
    v_mfma_f32_16x16x32_bf16 a[28:31], a[116:119], a[128:131], a[28:31]
    v_mfma_f32_16x16x32_bf16 a[60:63], a[116:119], a[132:135], a[60:63]
    ds_read_b64_tr_b16 a[116:117], v244 offset:264
    ds_read_b64_tr_b16 a[118:119], v244 offset:2312
    v_mfma_f32_16x16x32_bf16 v[80:83], a[88:91], a[120:123], v[80:83]
    buffer_load_dwordx4 v204, s[8:11], s60 offen offset:0 nt lds
    v_mfma_f32_16x16x32_bf16 v[112:115], a[88:91], a[124:127], v[112:115]
    v_mfma_f32_16x16x32_bf16 v[144:147], a[88:91], a[128:131], v[144:147]
    v_mfma_f32_16x16x32_bf16 v[168:171], a[88:91], a[132:135], v[168:171]
    v_mfma_f32_16x16x32_bf16 v[152:155], a[88:91], a[136:139], v[152:155]
    ds_read_b64_tr_b16 a[88:89], v241 offset:16384
    ds_read_b64_tr_b16 a[90:91], v241 offset:18432
    v_mfma_f32_16x16x32_bf16 v[84:87], a[92:95], a[120:123], v[84:87]
    buffer_load_dwordx4 v205, s[8:11], s60 offen offset:1024 nt lds
    v_mfma_f32_16x16x32_bf16 v[116:119], a[92:95], a[124:127], v[116:119]
    v_mfma_f32_16x16x32_bf16 v[148:151], a[92:95], a[128:131], v[148:151]
    v_mfma_f32_16x16x32_bf16 v[172:175], a[92:95], a[132:135], v[172:175]
    v_mfma_f32_16x16x32_bf16 v[156:159], a[92:95], a[136:139], v[156:159]
    ds_read_b64_tr_b16 a[92:93], v241 offset:16392
    ds_read_b64_tr_b16 a[94:95], v241 offset:18440
    v_mfma_f32_16x16x32_bf16 v[88:91], a[96:99], a[120:123], v[88:91]
    buffer_load_dwordx4 v206, s[8:11], s60 offen offset:2048 nt lds
    v_mfma_f32_16x16x32_bf16 v[120:123], a[96:99], a[124:127], v[120:123]
    v_mfma_f32_16x16x32_bf16 a[64:67], a[96:99], a[128:131], a[64:67]
    v_mfma_f32_16x16x32_bf16 v[176:179], a[96:99], a[132:135], v[176:179]
    v_mfma_f32_16x16x32_bf16 v[160:163], a[96:99], a[136:139], v[160:163]
    ds_read_b64_tr_b16 a[96:97], v242 offset:16384
    ds_read_b64_tr_b16 a[98:99], v242 offset:18432
    v_mfma_f32_16x16x32_bf16 v[92:95], a[100:103], a[120:123], v[92:95]
    buffer_load_dwordx4 v207, s[8:11], s60 offen offset:3072 nt lds
    v_mfma_f32_16x16x32_bf16 v[124:127], a[100:103], a[124:127], v[124:127]
    s_add_u32 m0, s84, 69632
    s_mov_b32 s60, 384
    v_mfma_f32_16x16x32_bf16 a[68:71], a[100:103], a[128:131], a[68:71]
    v_mfma_f32_16x16x32_bf16 v[180:183], a[100:103], a[132:135], v[180:183]
    v_mfma_f32_16x16x32_bf16 v[164:167], a[100:103], a[136:139], v[164:167]
    s_waitcnt lgkmcnt(2)
    ds_read_b64_tr_b16 a[100:101], v242 offset:16392
    ds_read_b64_tr_b16 a[102:103], v242 offset:18440
    v_mfma_f32_16x16x32_bf16 v[96:99], a[104:107], a[120:123], v[96:99]
    buffer_load_dwordx4 v240, s[8:11], s60 offen nt lds
    v_mfma_f32_16x16x32_bf16 v[128:131], a[104:107], a[124:127], v[128:131]
    s_add_u32 s60, s80, 2097152
    v_mfma_f32_16x16x32_bf16 a[72:75], a[104:107], a[128:131], a[72:75]
    v_mfma_f32_16x16x32_bf16 v[184:187], a[104:107], a[132:135], v[184:187]
    ds_read_b64_tr_b16 a[104:105], v243 offset:16384
    ds_read_b64_tr_b16 a[106:107], v243 offset:18432
    v_mfma_f32_16x16x32_bf16 v[100:103], a[108:111], a[120:123], v[100:103]
    buffer_load_dword v238, v253, s[12:15], s60 offen
    v_mfma_f32_16x16x32_bf16 v[132:135], a[108:111], a[124:127], v[132:135]
    v_mfma_f32_16x16x32_bf16 a[76:79], a[108:111], a[128:131], a[76:79]
    v_mfma_f32_16x16x32_bf16 v[188:191], a[108:111], a[132:135], v[188:191]
    ds_read_b64_tr_b16 a[108:109], v243 offset:16392
    ds_read_b64_tr_b16 a[110:111], v243 offset:18440
    v_mfma_f32_16x16x32_bf16 v[104:107], a[112:115], a[120:123], v[104:107]
    v_mfma_f32_16x16x32_bf16 v[136:139], a[112:115], a[124:127], v[136:139]
    buffer_load_dword v238, v226, s[8:11], 0 offen offset:512 nt
    v_mfma_f32_16x16x32_bf16 a[80:83], a[112:115], a[128:131], a[80:83]
    v_mfma_f32_16x16x32_bf16 v[192:195], a[112:115], a[132:135], v[192:195]
    ds_read_b64_tr_b16 a[112:113], v244 offset:16384
    ds_read_b64_tr_b16 a[114:115], v244 offset:18432
    v_mfma_f32_16x16x32_bf16 v[108:111], a[116:119], a[120:123], v[108:111]
    v_mfma_f32_16x16x32_bf16 v[140:143], a[116:119], a[124:127], v[140:143]
    v_mfma_f32_16x16x32_bf16 a[84:87], a[116:119], a[128:131], a[84:87]
    v_mfma_f32_16x16x32_bf16 v[196:199], a[116:119], a[132:135], v[196:199]
    ds_read_b64_tr_b16 a[116:117], v244 offset:16392
    ds_read_b64_tr_b16 a[118:119], v244 offset:18440
    v_mfma_f32_16x16x32_bf16 v[16:19], a[88:91], a[140:143], v[16:19]
    v_mfma_f32_16x16x32_bf16 v[48:51], a[88:91], a[144:147], v[48:51]
    v_mfma_f32_16x16x32_bf16 a[0:3], a[88:91], a[148:151], a[0:3]
    v_mfma_f32_16x16x32_bf16 a[32:35], a[88:91], a[152:155], a[32:35]
    v_mfma_f32_16x16x32_bf16 v[0:3], a[88:91], a[156:159], v[0:3]
    ds_read_b64_tr_b16 a[88:89], v241 offset:16640
    ds_read_b64_tr_b16 a[90:91], v241 offset:18688
    v_mfma_f32_16x16x32_bf16 v[20:23], a[92:95], a[140:143], v[20:23]
    v_mfma_f32_16x16x32_bf16 v[52:55], a[92:95], a[144:147], v[52:55]
    v_mfma_f32_16x16x32_bf16 a[4:7], a[92:95], a[148:151], a[4:7]
    v_mfma_f32_16x16x32_bf16 a[36:39], a[92:95], a[152:155], a[36:39]
    v_mfma_f32_16x16x32_bf16 v[4:7], a[92:95], a[156:159], v[4:7]
    s_waitcnt lgkmcnt(2)
    ds_read_b64_tr_b16 a[92:93], v241 offset:16648
    ds_read_b64_tr_b16 a[94:95], v241 offset:18696
    v_mfma_f32_16x16x32_bf16 v[24:27], a[96:99], a[140:143], v[24:27]
    v_add_u32 v241, 69632, v241
    v_mfma_f32_16x16x32_bf16 v[56:59], a[96:99], a[144:147], v[56:59]
    v_mfma_f32_16x16x32_bf16 a[8:11], a[96:99], a[148:151], a[8:11]
    v_mfma_f32_16x16x32_bf16 a[40:43], a[96:99], a[152:155], a[40:43]
    v_mfma_f32_16x16x32_bf16 v[8:11], a[96:99], a[156:159], v[8:11]
    ds_read_b64_tr_b16 a[96:97], v242 offset:16640
    ds_read_b64_tr_b16 a[98:99], v242 offset:18688
    v_mfma_f32_16x16x32_bf16 v[28:31], a[100:103], a[140:143], v[28:31]
    v_mfma_f32_16x16x32_bf16 v[60:63], a[100:103], a[144:147], v[60:63]
    v_mfma_f32_16x16x32_bf16 a[12:15], a[100:103], a[148:151], a[12:15]
    v_mfma_f32_16x16x32_bf16 a[44:47], a[100:103], a[152:155], a[44:47]
    v_mfma_f32_16x16x32_bf16 v[12:15], a[100:103], a[156:159], v[12:15]
    ds_read_b64_tr_b16 a[100:101], v242 offset:16648
    ds_read_b64_tr_b16 a[102:103], v242 offset:18696
    v_mfma_f32_16x16x32_bf16 v[32:35], a[104:107], a[140:143], v[32:35]
    v_add_u32 v242, 69632, v242
    v_mfma_f32_16x16x32_bf16 v[64:67], a[104:107], a[144:147], v[64:67]
    v_mfma_f32_16x16x32_bf16 a[16:19], a[104:107], a[148:151], a[16:19]
    v_mfma_f32_16x16x32_bf16 a[48:51], a[104:107], a[152:155], a[48:51]
    ds_read_b64_tr_b16 a[104:105], v243 offset:16640
    ds_read_b64_tr_b16 a[106:107], v243 offset:18688
    v_mfma_f32_16x16x32_bf16 v[36:39], a[108:111], a[140:143], v[36:39]
    v_mfma_f32_16x16x32_bf16 v[68:71], a[108:111], a[144:147], v[68:71]
    v_mfma_f32_16x16x32_bf16 a[20:23], a[108:111], a[148:151], a[20:23]
    v_mfma_f32_16x16x32_bf16 a[52:55], a[108:111], a[152:155], a[52:55]
    ds_read_b64_tr_b16 a[108:109], v243 offset:16648
    ds_read_b64_tr_b16 a[110:111], v243 offset:18696
    v_mfma_f32_16x16x32_bf16 v[40:43], a[112:115], a[140:143], v[40:43]
    v_add_u32 v243, 69632, v243
    v_mfma_f32_16x16x32_bf16 v[72:75], a[112:115], a[144:147], v[72:75]
    v_mfma_f32_16x16x32_bf16 a[24:27], a[112:115], a[148:151], a[24:27]
    v_mfma_f32_16x16x32_bf16 a[56:59], a[112:115], a[152:155], a[56:59]
    ds_read_b64_tr_b16 a[112:113], v244 offset:16640
    ds_read_b64_tr_b16 a[114:115], v244 offset:18688
    v_mfma_f32_16x16x32_bf16 v[44:47], a[116:119], a[140:143], v[44:47]
    v_mfma_f32_16x16x32_bf16 v[76:79], a[116:119], a[144:147], v[76:79]
    v_mfma_f32_16x16x32_bf16 a[28:31], a[116:119], a[148:151], a[28:31]
    v_mfma_f32_16x16x32_bf16 a[60:63], a[116:119], a[152:155], a[60:63]
    s_waitcnt lgkmcnt(2)
    ds_read_b64_tr_b16 a[116:117], v244 offset:16648
    ds_read_b64_tr_b16 a[118:119], v244 offset:18696
    v_mfma_f32_16x16x32_bf16 v[80:83], a[88:91], a[140:143], v[80:83]
    v_add_u32 v244, 69632, v244
    v_mfma_f32_16x16x32_bf16 v[112:115], a[88:91], a[144:147], v[112:115]
    v_mfma_f32_16x16x32_bf16 v[144:147], a[88:91], a[148:151], v[144:147]
    v_mfma_f32_16x16x32_bf16 v[168:171], a[88:91], a[152:155], v[168:171]
    v_mfma_f32_16x16x32_bf16 v[152:155], a[88:91], a[156:159], v[152:155]
    v_mfma_f32_16x16x32_bf16 v[84:87], a[92:95], a[140:143], v[84:87]
    v_mfma_f32_16x16x32_bf16 v[116:119], a[92:95], a[144:147], v[116:119]
    v_mfma_f32_16x16x32_bf16 v[148:151], a[92:95], a[148:151], v[148:151]
    v_mfma_f32_16x16x32_bf16 v[172:175], a[92:95], a[152:155], v[172:175]
    v_mfma_f32_16x16x32_bf16 v[156:159], a[92:95], a[156:159], v[156:159]
    v_mfma_f32_16x16x32_bf16 v[88:91], a[96:99], a[140:143], v[88:91]
    s_waitcnt vmcnt(2) lgkmcnt(0)
    s_barrier
    v_mfma_f32_16x16x32_bf16 v[120:123], a[96:99], a[144:147], v[120:123]
    s_add_u32 m0, s82, 0
    ds_read_b64_tr_b16 a[88:89], v241 offset:0
    ds_read_b64_tr_b16 a[90:91], v241 offset:2048
    v_mfma_f32_16x16x32_bf16 a[64:67], a[96:99], a[148:151], a[64:67]
    s_add_u32 s60, s80, 2097152
    ds_read_b128 a[120:123], v245 offset:0
    ds_read_b128 a[124:127], v245 offset:2048
    v_mfma_f32_16x16x32_bf16 v[176:179], a[96:99], a[152:155], v[176:179]
    ds_read_b128 a[128:131], v245 offset:4096
    ds_read_b128 a[132:135], v245 offset:6144
    v_mfma_f32_16x16x32_bf16 v[160:163], a[96:99], a[156:159], v[160:163]
    ds_read_b128 a[136:139], v247
    ds_read_b64_tr_b16 a[92:93], v241 offset:8
    v_mfma_f32_16x16x32_bf16 v[92:95], a[100:103], a[140:143], v[92:95]
    ds_read_b64_tr_b16 a[94:95], v241 offset:2056
    ds_read_b64_tr_b16 a[96:97], v242 offset:0
    v_mfma_f32_16x16x32_bf16 v[124:127], a[100:103], a[144:147], v[124:127]
    ds_read_b64_tr_b16 a[98:99], v242 offset:2048
    v_subrev_u32 v245, 69632, v245
    v_mfma_f32_16x16x32_bf16 a[68:71], a[100:103], a[148:151], a[68:71]
    v_subrev_u32 v247, 69632, v247
    v_mfma_f32_16x16x32_bf16 v[180:183], a[100:103], a[152:155], v[180:183]
    buffer_load_dwordx4 v200, s[12:15], s60 offen offset:0  lds
    v_mfma_f32_16x16x32_bf16 v[164:167], a[100:103], a[156:159], v[164:167]
    ds_read_b64_tr_b16 a[100:101], v242 offset:8
    ds_read_b64_tr_b16 a[102:103], v242 offset:2056
    v_mfma_f32_16x16x32_bf16 v[96:99], a[104:107], a[140:143], v[96:99]
    buffer_load_dwordx4 v201, s[12:15], s60 offen offset:1024  lds
    v_mfma_f32_16x16x32_bf16 v[128:131], a[104:107], a[144:147], v[128:131]
    buffer_load_dwordx4 v202, s[12:15], s60 offen offset:2048  lds
    v_mfma_f32_16x16x32_bf16 a[72:75], a[104:107], a[148:151], a[72:75]
    v_mfma_f32_16x16x32_bf16 v[184:187], a[104:107], a[152:155], v[184:187]
    ds_read_b64_tr_b16 a[104:105], v243 offset:0
    ds_read_b64_tr_b16 a[106:107], v243 offset:2048
    v_mfma_f32_16x16x32_bf16 v[100:103], a[108:111], a[140:143], v[100:103]
    v_mfma_f32_16x16x32_bf16 v[132:135], a[108:111], a[144:147], v[132:135]
    v_mfma_f32_16x16x32_bf16 a[76:79], a[108:111], a[148:151], a[76:79]
    buffer_load_dwordx4 v203, s[12:15], s60 offen offset:3072  lds
    v_mfma_f32_16x16x32_bf16 v[188:191], a[108:111], a[152:155], v[188:191]
    s_add_u32 m0, s82, 4096
    ds_read_b64_tr_b16 a[108:109], v243 offset:8
    ds_read_b64_tr_b16 a[110:111], v243 offset:2056
    v_mfma_f32_16x16x32_bf16 v[104:107], a[112:115], a[140:143], v[104:107]
    s_add_u32 s60, s80, 2162688
    v_mfma_f32_16x16x32_bf16 v[136:139], a[112:115], a[144:147], v[136:139]
    v_mfma_f32_16x16x32_bf16 a[80:83], a[112:115], a[148:151], a[80:83]
    v_mfma_f32_16x16x32_bf16 v[192:195], a[112:115], a[152:155], v[192:195]
    ds_read_b64_tr_b16 a[112:113], v244 offset:0
    ds_read_b64_tr_b16 a[114:115], v244 offset:2048
    v_mfma_f32_16x16x32_bf16 v[108:111], a[116:119], a[140:143], v[108:111]
    buffer_load_dwordx4 v200, s[12:15], s60 offen offset:0  lds
    v_mfma_f32_16x16x32_bf16 v[140:143], a[116:119], a[144:147], v[140:143]
    v_mfma_f32_16x16x32_bf16 a[84:87], a[116:119], a[148:151], a[84:87]
    v_mfma_f32_16x16x32_bf16 v[196:199], a[116:119], a[152:155], v[196:199]
    s_waitcnt lgkmcnt(2)
    ds_read_b64_tr_b16 a[116:117], v244 offset:8
    ds_read_b64_tr_b16 a[118:119], v244 offset:2056
    v_mfma_f32_16x16x32_bf16 v[16:19], a[88:91], a[120:123], v[16:19]
    ds_read_b128 a[140:143], v246 offset:0
    ds_read_b128 a[144:147], v246 offset:2048
    v_mfma_f32_16x16x32_bf16 v[48:51], a[88:91], a[124:127], v[48:51]
    ds_read_b128 a[148:151], v246 offset:4096
    ds_read_b128 a[152:155], v246 offset:6144
    v_mfma_f32_16x16x32_bf16 a[0:3], a[88:91], a[128:131], a[0:3]
    ds_read_b128 a[156:159], v248
    v_subrev_u32 v246, 69632, v246
    v_mfma_f32_16x16x32_bf16 a[32:35], a[88:91], a[132:135], a[32:35]
    v_subrev_u32 v248, 69632, v248
    v_mfma_f32_16x16x32_bf16 v[0:3], a[88:91], a[136:139], v[0:3]
    ds_read_b64_tr_b16 a[88:89], v241 offset:256
    ds_read_b64_tr_b16 a[90:91], v241 offset:2304
    v_mfma_f32_16x16x32_bf16 v[20:23], a[92:95], a[120:123], v[20:23]
    buffer_load_dwordx4 v201, s[12:15], s60 offen offset:1024  lds
    v_mfma_f32_16x16x32_bf16 v[52:55], a[92:95], a[124:127], v[52:55]
    buffer_load_dwordx4 v202, s[12:15], s60 offen offset:2048  lds
    v_mfma_f32_16x16x32_bf16 a[4:7], a[92:95], a[128:131], a[4:7]
    v_mfma_f32_16x16x32_bf16 a[36:39], a[92:95], a[132:135], a[36:39]
    v_mfma_f32_16x16x32_bf16 v[4:7], a[92:95], a[136:139], v[4:7]
    ds_read_b64_tr_b16 a[92:93], v241 offset:264
    ds_read_b64_tr_b16 a[94:95], v241 offset:2312
    v_mfma_f32_16x16x32_bf16 v[24:27], a[96:99], a[120:123], v[24:27]
    buffer_load_dwordx4 v203, s[12:15], s60 offen offset:3072  lds
    v_mfma_f32_16x16x32_bf16 v[56:59], a[96:99], a[124:127], v[56:59]
    s_add_u32 m0, s83, 0
    s_add_u32 s60, s81, 512
    v_mfma_f32_16x16x32_bf16 a[8:11], a[96:99], a[128:131], a[8:11]
    v_mfma_f32_16x16x32_bf16 a[40:43], a[96:99], a[132:135], a[40:43]
    v_mfma_f32_16x16x32_bf16 v[8:11], a[96:99], a[136:139], v[8:11]
    ds_read_b64_tr_b16 a[96:97], v242 offset:256
    ds_read_b64_tr_b16 a[98:99], v242 offset:2304
    v_mfma_f32_16x16x32_bf16 v[28:31], a[100:103], a[120:123], v[28:31]
    buffer_load_dwordx4 v204, s[8:11], s60 offen offset:0 nt lds
    v_mfma_f32_16x16x32_bf16 v[60:63], a[100:103], a[124:127], v[60:63]
    v_mfma_f32_16x16x32_bf16 a[12:15], a[100:103], a[128:131], a[12:15]
    v_mfma_f32_16x16x32_bf16 a[44:47], a[100:103], a[132:135], a[44:47]
    v_mfma_f32_16x16x32_bf16 v[12:15], a[100:103], a[136:139], v[12:15]
    ds_read_b64_tr_b16 a[100:101], v242 offset:264
    ds_read_b64_tr_b16 a[102:103], v242 offset:2312
    v_mfma_f32_16x16x32_bf16 v[32:35], a[104:107], a[120:123], v[32:35]
    buffer_load_dwordx4 v205, s[8:11], s60 offen offset:1024 nt lds
    v_mfma_f32_16x16x32_bf16 v[64:67], a[104:107], a[124:127], v[64:67]
    v_mfma_f32_16x16x32_bf16 a[16:19], a[104:107], a[128:131], a[16:19]
    v_mfma_f32_16x16x32_bf16 a[48:51], a[104:107], a[132:135], a[48:51]
    ds_read_b64_tr_b16 a[104:105], v243 offset:256
    ds_read_b64_tr_b16 a[106:107], v243 offset:2304
    v_mfma_f32_16x16x32_bf16 v[36:39], a[108:111], a[120:123], v[36:39]
    v_mfma_f32_16x16x32_bf16 v[68:71], a[108:111], a[124:127], v[68:71]
    buffer_load_dwordx4 v206, s[8:11], s60 offen offset:2048 nt lds
    v_mfma_f32_16x16x32_bf16 a[20:23], a[108:111], a[128:131], a[20:23]
    v_mfma_f32_16x16x32_bf16 a[52:55], a[108:111], a[132:135], a[52:55]
    s_waitcnt lgkmcnt(2)
    ds_read_b64_tr_b16 a[108:109], v243 offset:264
    ds_read_b64_tr_b16 a[110:111], v243 offset:2312
    v_mfma_f32_16x16x32_bf16 v[40:43], a[112:115], a[120:123], v[40:43]
    v_mfma_f32_16x16x32_bf16 v[72:75], a[112:115], a[124:127], v[72:75]
    v_mfma_f32_16x16x32_bf16 a[24:27], a[112:115], a[128:131], a[24:27]
    buffer_load_dwordx4 v207, s[8:11], s60 offen offset:3072 nt lds
    v_mfma_f32_16x16x32_bf16 a[56:59], a[112:115], a[132:135], a[56:59]
    s_add_u32 m0, s83, 4096
    ds_read_b64_tr_b16 a[112:113], v244 offset:256
    ds_read_b64_tr_b16 a[114:115], v244 offset:2304
    v_mfma_f32_16x16x32_bf16 v[44:47], a[116:119], a[120:123], v[44:47]
    s_add_u32 s60, s81, 33280
    v_mfma_f32_16x16x32_bf16 v[76:79], a[116:119], a[124:127], v[76:79]
    v_mfma_f32_16x16x32_bf16 a[28:31], a[116:119], a[128:131], a[28:31]
    v_mfma_f32_16x16x32_bf16 a[60:63], a[116:119], a[132:135], a[60:63]
    ds_read_b64_tr_b16 a[116:117], v244 offset:264
    ds_read_b64_tr_b16 a[118:119], v244 offset:2312
    v_mfma_f32_16x16x32_bf16 v[80:83], a[88:91], a[120:123], v[80:83]
    buffer_load_dwordx4 v204, s[8:11], s60 offen offset:0 nt lds
    v_mfma_f32_16x16x32_bf16 v[112:115], a[88:91], a[124:127], v[112:115]
    v_mfma_f32_16x16x32_bf16 v[144:147], a[88:91], a[128:131], v[144:147]
    v_mfma_f32_16x16x32_bf16 v[168:171], a[88:91], a[132:135], v[168:171]
    v_mfma_f32_16x16x32_bf16 v[152:155], a[88:91], a[136:139], v[152:155]
    ds_read_b64_tr_b16 a[88:89], v241 offset:16384
    ds_read_b64_tr_b16 a[90:91], v241 offset:18432
    v_mfma_f32_16x16x32_bf16 v[84:87], a[92:95], a[120:123], v[84:87]
    buffer_load_dwordx4 v205, s[8:11], s60 offen offset:1024 nt lds
    v_mfma_f32_16x16x32_bf16 v[116:119], a[92:95], a[124:127], v[116:119]
    v_mfma_f32_16x16x32_bf16 v[148:151], a[92:95], a[128:131], v[148:151]
    v_mfma_f32_16x16x32_bf16 v[172:175], a[92:95], a[132:135], v[172:175]
    v_mfma_f32_16x16x32_bf16 v[156:159], a[92:95], a[136:139], v[156:159]
    ds_read_b64_tr_b16 a[92:93], v241 offset:16392
    ds_read_b64_tr_b16 a[94:95], v241 offset:18440
    v_mfma_f32_16x16x32_bf16 v[88:91], a[96:99], a[120:123], v[88:91]
    buffer_load_dwordx4 v206, s[8:11], s60 offen offset:2048 nt lds
    v_mfma_f32_16x16x32_bf16 v[120:123], a[96:99], a[124:127], v[120:123]
    v_mfma_f32_16x16x32_bf16 a[64:67], a[96:99], a[128:131], a[64:67]
    v_mfma_f32_16x16x32_bf16 v[176:179], a[96:99], a[132:135], v[176:179]
    v_mfma_f32_16x16x32_bf16 v[160:163], a[96:99], a[136:139], v[160:163]
    ds_read_b64_tr_b16 a[96:97], v242 offset:16384
    ds_read_b64_tr_b16 a[98:99], v242 offset:18432
    v_mfma_f32_16x16x32_bf16 v[92:95], a[100:103], a[120:123], v[92:95]
    buffer_load_dwordx4 v207, s[8:11], s60 offen offset:3072 nt lds
    v_mfma_f32_16x16x32_bf16 v[124:127], a[100:103], a[124:127], v[124:127]
    s_add_u32 m0, s84, 0
    s_mov_b32 s60, 512
    v_mfma_f32_16x16x32_bf16 a[68:71], a[100:103], a[128:131], a[68:71]
    v_mfma_f32_16x16x32_bf16 v[180:183], a[100:103], a[132:135], v[180:183]
    v_mfma_f32_16x16x32_bf16 v[164:167], a[100:103], a[136:139], v[164:167]
    s_waitcnt lgkmcnt(2)
    ds_read_b64_tr_b16 a[100:101], v242 offset:16392
    ds_read_b64_tr_b16 a[102:103], v242 offset:18440
    v_mfma_f32_16x16x32_bf16 v[96:99], a[104:107], a[120:123], v[96:99]
    buffer_load_dwordx4 v240, s[8:11], s60 offen nt lds
    v_mfma_f32_16x16x32_bf16 v[128:131], a[104:107], a[124:127], v[128:131]
    s_add_u32 s60, s80, 2621440
    v_mfma_f32_16x16x32_bf16 a[72:75], a[104:107], a[128:131], a[72:75]
    v_mfma_f32_16x16x32_bf16 v[184:187], a[104:107], a[132:135], v[184:187]
    ds_read_b64_tr_b16 a[104:105], v243 offset:16384
    ds_read_b64_tr_b16 a[106:107], v243 offset:18432
    v_mfma_f32_16x16x32_bf16 v[100:103], a[108:111], a[120:123], v[100:103]
    buffer_load_dword v238, v253, s[12:15], s60 offen
    v_mfma_f32_16x16x32_bf16 v[132:135], a[108:111], a[124:127], v[132:135]
    v_mfma_f32_16x16x32_bf16 a[76:79], a[108:111], a[128:131], a[76:79]
    v_mfma_f32_16x16x32_bf16 v[188:191], a[108:111], a[132:135], v[188:191]
    ds_read_b64_tr_b16 a[108:109], v243 offset:16392
    ds_read_b64_tr_b16 a[110:111], v243 offset:18440
    v_mfma_f32_16x16x32_bf16 v[104:107], a[112:115], a[120:123], v[104:107]
    v_mfma_f32_16x16x32_bf16 v[136:139], a[112:115], a[124:127], v[136:139]
    buffer_load_dword v238, v226, s[8:11], 0 offen offset:640 nt
    v_mfma_f32_16x16x32_bf16 a[80:83], a[112:115], a[128:131], a[80:83]
    v_mfma_f32_16x16x32_bf16 v[192:195], a[112:115], a[132:135], v[192:195]
    ds_read_b64_tr_b16 a[112:113], v244 offset:16384
    ds_read_b64_tr_b16 a[114:115], v244 offset:18432
    v_mfma_f32_16x16x32_bf16 v[108:111], a[116:119], a[120:123], v[108:111]
    v_mfma_f32_16x16x32_bf16 v[140:143], a[116:119], a[124:127], v[140:143]
    v_mfma_f32_16x16x32_bf16 a[84:87], a[116:119], a[128:131], a[84:87]
    v_mfma_f32_16x16x32_bf16 v[196:199], a[116:119], a[132:135], v[196:199]
    ds_read_b64_tr_b16 a[116:117], v244 offset:16392
    ds_read_b64_tr_b16 a[118:119], v244 offset:18440
    v_mfma_f32_16x16x32_bf16 v[16:19], a[88:91], a[140:143], v[16:19]
    v_mfma_f32_16x16x32_bf16 v[48:51], a[88:91], a[144:147], v[48:51]
    v_mfma_f32_16x16x32_bf16 a[0:3], a[88:91], a[148:151], a[0:3]
    v_mfma_f32_16x16x32_bf16 a[32:35], a[88:91], a[152:155], a[32:35]
    v_mfma_f32_16x16x32_bf16 v[0:3], a[88:91], a[156:159], v[0:3]
    ds_read_b64_tr_b16 a[88:89], v241 offset:16640
    ds_read_b64_tr_b16 a[90:91], v241 offset:18688
    v_mfma_f32_16x16x32_bf16 v[20:23], a[92:95], a[140:143], v[20:23]
    v_mfma_f32_16x16x32_bf16 v[52:55], a[92:95], a[144:147], v[52:55]
    v_mfma_f32_16x16x32_bf16 a[4:7], a[92:95], a[148:151], a[4:7]
    v_mfma_f32_16x16x32_bf16 a[36:39], a[92:95], a[152:155], a[36:39]
    v_mfma_f32_16x16x32_bf16 v[4:7], a[92:95], a[156:159], v[4:7]
    s_waitcnt lgkmcnt(2)
    ds_read_b64_tr_b16 a[92:93], v241 offset:16648
    ds_read_b64_tr_b16 a[94:95], v241 offset:18696
    v_mfma_f32_16x16x32_bf16 v[24:27], a[96:99], a[140:143], v[24:27]
    v_subrev_u32 v241, 69632, v241
    v_mfma_f32_16x16x32_bf16 v[56:59], a[96:99], a[144:147], v[56:59]
    v_mfma_f32_16x16x32_bf16 a[8:11], a[96:99], a[148:151], a[8:11]
    v_mfma_f32_16x16x32_bf16 a[40:43], a[96:99], a[152:155], a[40:43]
    v_mfma_f32_16x16x32_bf16 v[8:11], a[96:99], a[156:159], v[8:11]
    ds_read_b64_tr_b16 a[96:97], v242 offset:16640
    ds_read_b64_tr_b16 a[98:99], v242 offset:18688
    v_mfma_f32_16x16x32_bf16 v[28:31], a[100:103], a[140:143], v[28:31]
    v_mfma_f32_16x16x32_bf16 v[60:63], a[100:103], a[144:147], v[60:63]
    v_mfma_f32_16x16x32_bf16 a[12:15], a[100:103], a[148:151], a[12:15]
    v_mfma_f32_16x16x32_bf16 a[44:47], a[100:103], a[152:155], a[44:47]
    v_mfma_f32_16x16x32_bf16 v[12:15], a[100:103], a[156:159], v[12:15]
    ds_read_b64_tr_b16 a[100:101], v242 offset:16648
    ds_read_b64_tr_b16 a[102:103], v242 offset:18696
    v_mfma_f32_16x16x32_bf16 v[32:35], a[104:107], a[140:143], v[32:35]
    v_subrev_u32 v242, 69632, v242
    v_mfma_f32_16x16x32_bf16 v[64:67], a[104:107], a[144:147], v[64:67]
    v_mfma_f32_16x16x32_bf16 a[16:19], a[104:107], a[148:151], a[16:19]
    v_mfma_f32_16x16x32_bf16 a[48:51], a[104:107], a[152:155], a[48:51]
    ds_read_b64_tr_b16 a[104:105], v243 offset:16640
    ds_read_b64_tr_b16 a[106:107], v243 offset:18688
    v_mfma_f32_16x16x32_bf16 v[36:39], a[108:111], a[140:143], v[36:39]
    v_mfma_f32_16x16x32_bf16 v[68:71], a[108:111], a[144:147], v[68:71]
    v_mfma_f32_16x16x32_bf16 a[20:23], a[108:111], a[148:151], a[20:23]
    v_mfma_f32_16x16x32_bf16 a[52:55], a[108:111], a[152:155], a[52:55]
    ds_read_b64_tr_b16 a[108:109], v243 offset:16648
    ds_read_b64_tr_b16 a[110:111], v243 offset:18696
    v_mfma_f32_16x16x32_bf16 v[40:43], a[112:115], a[140:143], v[40:43]
    v_subrev_u32 v243, 69632, v243
    v_mfma_f32_16x16x32_bf16 v[72:75], a[112:115], a[144:147], v[72:75]
    v_mfma_f32_16x16x32_bf16 a[24:27], a[112:115], a[148:151], a[24:27]
    v_mfma_f32_16x16x32_bf16 a[56:59], a[112:115], a[152:155], a[56:59]
    ds_read_b64_tr_b16 a[112:113], v244 offset:16640
    ds_read_b64_tr_b16 a[114:115], v244 offset:18688
    v_mfma_f32_16x16x32_bf16 v[44:47], a[116:119], a[140:143], v[44:47]
    v_mfma_f32_16x16x32_bf16 v[76:79], a[116:119], a[144:147], v[76:79]
    v_mfma_f32_16x16x32_bf16 a[28:31], a[116:119], a[148:151], a[28:31]
    v_mfma_f32_16x16x32_bf16 a[60:63], a[116:119], a[152:155], a[60:63]
    s_waitcnt lgkmcnt(2)
    ds_read_b64_tr_b16 a[116:117], v244 offset:16648
    ds_read_b64_tr_b16 a[118:119], v244 offset:18696
    v_mfma_f32_16x16x32_bf16 v[80:83], a[88:91], a[140:143], v[80:83]
    v_subrev_u32 v244, 69632, v244
    v_mfma_f32_16x16x32_bf16 v[112:115], a[88:91], a[144:147], v[112:115]
    v_mfma_f32_16x16x32_bf16 v[144:147], a[88:91], a[148:151], v[144:147]
    v_mfma_f32_16x16x32_bf16 v[168:171], a[88:91], a[152:155], v[168:171]
    v_mfma_f32_16x16x32_bf16 v[152:155], a[88:91], a[156:159], v[152:155]
    v_mfma_f32_16x16x32_bf16 v[84:87], a[92:95], a[140:143], v[84:87]
    v_mfma_f32_16x16x32_bf16 v[116:119], a[92:95], a[144:147], v[116:119]
    v_mfma_f32_16x16x32_bf16 v[148:151], a[92:95], a[148:151], v[148:151]
    v_mfma_f32_16x16x32_bf16 v[172:175], a[92:95], a[152:155], v[172:175]
    v_mfma_f32_16x16x32_bf16 v[156:159], a[92:95], a[156:159], v[156:159]
    v_mfma_f32_16x16x32_bf16 v[88:91], a[96:99], a[140:143], v[88:91]
    s_waitcnt vmcnt(2) lgkmcnt(0)
    s_barrier
    v_mfma_f32_16x16x32_bf16 v[120:123], a[96:99], a[144:147], v[120:123]
    s_add_u32 m0, s3, 139264
    ds_read_b64_tr_b16 a[88:89], v241 offset:0
    ds_read_b64_tr_b16 a[90:91], v241 offset:2048
    v_mfma_f32_16x16x32_bf16 a[64:67], a[96:99], a[148:151], a[64:67]
    s_add_u32 s87, s3, s86
    ds_read_b128 a[120:123], v245 offset:0
    ds_read_b128 a[124:127], v245 offset:2048
    v_mfma_f32_16x16x32_bf16 v[176:179], a[96:99], a[152:155], v[176:179]
    s_add_u32 s87, s87, 0
    ds_read_b128 a[128:131], v245 offset:4096
    ds_read_b128 a[132:135], v245 offset:6144
    v_mfma_f32_16x16x32_bf16 v[160:163], a[96:99], a[156:159], v[160:163]
    ds_read_b128 a[136:139], v247
    ds_read_b64_tr_b16 a[92:93], v241 offset:8
    v_mfma_f32_16x16x32_bf16 v[92:95], a[100:103], a[140:143], v[92:95]
    ds_read_b64_tr_b16 a[94:95], v241 offset:2056
    ds_read_b64_tr_b16 a[96:97], v242 offset:0
    v_mfma_f32_16x16x32_bf16 v[124:127], a[100:103], a[144:147], v[124:127]
    ds_read_b64_tr_b16 a[98:99], v242 offset:2048
    v_add_u32 v245, 69632, v245
    v_mfma_f32_16x16x32_bf16 a[68:71], a[100:103], a[148:151], a[68:71]
    v_add_u32 v247, 69632, v247
    v_mfma_f32_16x16x32_bf16 v[180:183], a[100:103], a[152:155], v[180:183]
    buffer_load_dwordx4 v220, s[20:23], s87 offen nt lds
    v_mfma_f32_16x16x32_bf16 v[164:167], a[100:103], a[156:159], v[164:167]
    s_add_u32 m0, s3, 143360
    ds_read_b64_tr_b16 a[100:101], v242 offset:8
    ds_read_b64_tr_b16 a[102:103], v242 offset:2056
    v_mfma_f32_16x16x32_bf16 v[96:99], a[104:107], a[140:143], v[96:99]
    s_add_u32 s87, s3, s86
    s_add_u32 s87, s87, 4096
    v_mfma_f32_16x16x32_bf16 v[128:131], a[104:107], a[144:147], v[128:131]
    buffer_load_dwordx4 v220, s[20:23], s87 offen nt lds
    v_mfma_f32_16x16x32_bf16 a[72:75], a[104:107], a[148:151], a[72:75]
    s_add_u32 m0, s82, 69632
    s_add_u32 s60, s80, 2621440
    v_mfma_f32_16x16x32_bf16 v[184:187], a[104:107], a[152:155], v[184:187]
    ds_read_b64_tr_b16 a[104:105], v243 offset:0
    ds_read_b64_tr_b16 a[106:107], v243 offset:2048
    v_mfma_f32_16x16x32_bf16 v[100:103], a[108:111], a[140:143], v[100:103]
    buffer_load_dwordx4 v200, s[12:15], s60 offen offset:0  lds
    v_mfma_f32_16x16x32_bf16 v[132:135], a[108:111], a[144:147], v[132:135]
    v_mfma_f32_16x16x32_bf16 a[76:79], a[108:111], a[148:151], a[76:79]
    buffer_load_dwordx4 v201, s[12:15], s60 offen offset:1024  lds
    v_mfma_f32_16x16x32_bf16 v[188:191], a[108:111], a[152:155], v[188:191]
    ds_read_b64_tr_b16 a[108:109], v243 offset:8
    ds_read_b64_tr_b16 a[110:111], v243 offset:2056
    v_mfma_f32_16x16x32_bf16 v[104:107], a[112:115], a[140:143], v[104:107]
    v_mfma_f32_16x16x32_bf16 v[136:139], a[112:115], a[144:147], v[136:139]
    v_mfma_f32_16x16x32_bf16 a[80:83], a[112:115], a[148:151], a[80:83]
    v_mfma_f32_16x16x32_bf16 v[192:195], a[112:115], a[152:155], v[192:195]
    ds_read_b64_tr_b16 a[112:113], v244 offset:0
    ds_read_b64_tr_b16 a[114:115], v244 offset:2048
    v_mfma_f32_16x16x32_bf16 v[108:111], a[116:119], a[140:143], v[108:111]
    buffer_load_dwordx4 v202, s[12:15], s60 offen offset:2048  lds
    v_mfma_f32_16x16x32_bf16 v[140:143], a[116:119], a[144:147], v[140:143]
    v_mfma_f32_16x16x32_bf16 a[84:87], a[116:119], a[148:151], a[84:87]
    v_mfma_f32_16x16x32_bf16 v[196:199], a[116:119], a[152:155], v[196:199]
    s_waitcnt lgkmcnt(2)
    ds_read_b64_tr_b16 a[116:117], v244 offset:8
    ds_read_b64_tr_b16 a[118:119], v244 offset:2056
    v_mfma_f32_16x16x32_bf16 v[16:19], a[88:91], a[120:123], v[16:19]
    ds_read_b128 a[140:143], v246 offset:0
    ds_read_b128 a[144:147], v246 offset:2048
    v_mfma_f32_16x16x32_bf16 v[48:51], a[88:91], a[124:127], v[48:51]
    ds_read_b128 a[148:151], v246 offset:4096
    ds_read_b128 a[152:155], v246 offset:6144
    v_mfma_f32_16x16x32_bf16 a[0:3], a[88:91], a[128:131], a[0:3]
    ds_read_b128 a[156:159], v248
    v_add_u32 v246, 69632, v246
    v_mfma_f32_16x16x32_bf16 a[32:35], a[88:91], a[132:135], a[32:35]
    v_add_u32 v248, 69632, v248
    v_mfma_f32_16x16x32_bf16 v[0:3], a[88:91], a[136:139], v[0:3]
    ds_read_b64_tr_b16 a[88:89], v241 offset:256
    ds_read_b64_tr_b16 a[90:91], v241 offset:2304
    v_mfma_f32_16x16x32_bf16 v[20:23], a[92:95], a[120:123], v[20:23]
    buffer_load_dwordx4 v203, s[12:15], s60 offen offset:3072  lds
    v_mfma_f32_16x16x32_bf16 v[52:55], a[92:95], a[124:127], v[52:55]
    s_add_u32 m0, s82, 73728
    s_add_u32 s60, s80, 2686976
    v_mfma_f32_16x16x32_bf16 a[4:7], a[92:95], a[128:131], a[4:7]
    buffer_load_dwordx4 v200, s[12:15], s60 offen offset:0  lds
    v_mfma_f32_16x16x32_bf16 a[36:39], a[92:95], a[132:135], a[36:39]
    v_mfma_f32_16x16x32_bf16 v[4:7], a[92:95], a[136:139], v[4:7]
    ds_read_b64_tr_b16 a[92:93], v241 offset:264
    ds_read_b64_tr_b16 a[94:95], v241 offset:2312
    v_mfma_f32_16x16x32_bf16 v[24:27], a[96:99], a[120:123], v[24:27]
    buffer_load_dwordx4 v201, s[12:15], s60 offen offset:1024  lds
    v_mfma_f32_16x16x32_bf16 v[56:59], a[96:99], a[124:127], v[56:59]
    v_mfma_f32_16x16x32_bf16 a[8:11], a[96:99], a[128:131], a[8:11]
    v_mfma_f32_16x16x32_bf16 a[40:43], a[96:99], a[132:135], a[40:43]
    v_mfma_f32_16x16x32_bf16 v[8:11], a[96:99], a[136:139], v[8:11]
    ds_read_b64_tr_b16 a[96:97], v242 offset:256
    ds_read_b64_tr_b16 a[98:99], v242 offset:2304
    v_mfma_f32_16x16x32_bf16 v[28:31], a[100:103], a[120:123], v[28:31]
    buffer_load_dwordx4 v202, s[12:15], s60 offen offset:2048  lds
    v_mfma_f32_16x16x32_bf16 v[60:63], a[100:103], a[124:127], v[60:63]
    v_mfma_f32_16x16x32_bf16 a[12:15], a[100:103], a[128:131], a[12:15]
    v_mfma_f32_16x16x32_bf16 a[44:47], a[100:103], a[132:135], a[44:47]
    v_mfma_f32_16x16x32_bf16 v[12:15], a[100:103], a[136:139], v[12:15]
    ds_read_b64_tr_b16 a[100:101], v242 offset:264
    ds_read_b64_tr_b16 a[102:103], v242 offset:2312
    v_mfma_f32_16x16x32_bf16 v[32:35], a[104:107], a[120:123], v[32:35]
    buffer_load_dwordx4 v203, s[12:15], s60 offen offset:3072  lds
    v_mfma_f32_16x16x32_bf16 v[64:67], a[104:107], a[124:127], v[64:67]
    s_add_u32 m0, s83, 69632
    s_add_u32 s60, s81, 640
    v_mfma_f32_16x16x32_bf16 a[16:19], a[104:107], a[128:131], a[16:19]
    v_mfma_f32_16x16x32_bf16 a[48:51], a[104:107], a[132:135], a[48:51]
    ds_read_b64_tr_b16 a[104:105], v243 offset:256
    ds_read_b64_tr_b16 a[106:107], v243 offset:2304
    v_mfma_f32_16x16x32_bf16 v[36:39], a[108:111], a[120:123], v[36:39]
    v_mfma_f32_16x16x32_bf16 v[68:71], a[108:111], a[124:127], v[68:71]
    buffer_load_dwordx4 v204, s[8:11], s60 offen offset:0 nt lds
    v_mfma_f32_16x16x32_bf16 a[20:23], a[108:111], a[128:131], a[20:23]
    v_mfma_f32_16x16x32_bf16 a[52:55], a[108:111], a[132:135], a[52:55]
    s_waitcnt lgkmcnt(2)
    ds_read_b64_tr_b16 a[108:109], v243 offset:264
    ds_read_b64_tr_b16 a[110:111], v243 offset:2312
    v_mfma_f32_16x16x32_bf16 v[40:43], a[112:115], a[120:123], v[40:43]
    v_mfma_f32_16x16x32_bf16 v[72:75], a[112:115], a[124:127], v[72:75]
    v_mfma_f32_16x16x32_bf16 a[24:27], a[112:115], a[128:131], a[24:27]
    buffer_load_dwordx4 v205, s[8:11], s60 offen offset:1024 nt lds
    v_mfma_f32_16x16x32_bf16 a[56:59], a[112:115], a[132:135], a[56:59]
    ds_read_b64_tr_b16 a[112:113], v244 offset:256
    ds_read_b64_tr_b16 a[114:115], v244 offset:2304
    v_mfma_f32_16x16x32_bf16 v[44:47], a[116:119], a[120:123], v[44:47]
    v_mfma_f32_16x16x32_bf16 v[76:79], a[116:119], a[124:127], v[76:79]
    v_mfma_f32_16x16x32_bf16 a[28:31], a[116:119], a[128:131], a[28:31]
    v_mfma_f32_16x16x32_bf16 a[60:63], a[116:119], a[132:135], a[60:63]
    ds_read_b64_tr_b16 a[116:117], v244 offset:264
    ds_read_b64_tr_b16 a[118:119], v244 offset:2312
    v_mfma_f32_16x16x32_bf16 v[80:83], a[88:91], a[120:123], v[80:83]
    buffer_load_dwordx4 v206, s[8:11], s60 offen offset:2048 nt lds
    v_mfma_f32_16x16x32_bf16 v[112:115], a[88:91], a[124:127], v[112:115]
    v_mfma_f32_16x16x32_bf16 v[144:147], a[88:91], a[128:131], v[144:147]
    v_mfma_f32_16x16x32_bf16 v[168:171], a[88:91], a[132:135], v[168:171]
    v_mfma_f32_16x16x32_bf16 v[152:155], a[88:91], a[136:139], v[152:155]
    ds_read_b64_tr_b16 a[88:89], v241 offset:16384
    ds_read_b64_tr_b16 a[90:91], v241 offset:18432
    v_mfma_f32_16x16x32_bf16 v[84:87], a[92:95], a[120:123], v[84:87]
    buffer_load_dwordx4 v207, s[8:11], s60 offen offset:3072 nt lds
    v_mfma_f32_16x16x32_bf16 v[116:119], a[92:95], a[124:127], v[116:119]
    s_add_u32 m0, s83, 73728
    s_add_u32 s60, s81, 33408
    v_mfma_f32_16x16x32_bf16 v[148:151], a[92:95], a[128:131], v[148:151]
    v_mfma_f32_16x16x32_bf16 v[172:175], a[92:95], a[132:135], v[172:175]
    v_mfma_f32_16x16x32_bf16 v[156:159], a[92:95], a[136:139], v[156:159]
    ds_read_b64_tr_b16 a[92:93], v241 offset:16392
    ds_read_b64_tr_b16 a[94:95], v241 offset:18440
    v_mfma_f32_16x16x32_bf16 v[88:91], a[96:99], a[120:123], v[88:91]
    buffer_load_dwordx4 v204, s[8:11], s60 offen offset:0 nt lds
    v_mfma_f32_16x16x32_bf16 v[120:123], a[96:99], a[124:127], v[120:123]
    v_mfma_f32_16x16x32_bf16 a[64:67], a[96:99], a[128:131], a[64:67]
    v_mfma_f32_16x16x32_bf16 v[176:179], a[96:99], a[132:135], v[176:179]
    v_mfma_f32_16x16x32_bf16 v[160:163], a[96:99], a[136:139], v[160:163]
    ds_read_b64_tr_b16 a[96:97], v242 offset:16384
    ds_read_b64_tr_b16 a[98:99], v242 offset:18432
    v_mfma_f32_16x16x32_bf16 v[92:95], a[100:103], a[120:123], v[92:95]
    buffer_load_dwordx4 v205, s[8:11], s60 offen offset:1024 nt lds
    v_mfma_f32_16x16x32_bf16 v[124:127], a[100:103], a[124:127], v[124:127]
    v_mfma_f32_16x16x32_bf16 a[68:71], a[100:103], a[128:131], a[68:71]
    v_mfma_f32_16x16x32_bf16 v[180:183], a[100:103], a[132:135], v[180:183]
    v_mfma_f32_16x16x32_bf16 v[164:167], a[100:103], a[136:139], v[164:167]
    s_waitcnt lgkmcnt(2)
    ds_read_b64_tr_b16 a[100:101], v242 offset:16392
    ds_read_b64_tr_b16 a[102:103], v242 offset:18440
    v_mfma_f32_16x16x32_bf16 v[96:99], a[104:107], a[120:123], v[96:99]
    buffer_load_dwordx4 v206, s[8:11], s60 offen offset:2048 nt lds
    v_mfma_f32_16x16x32_bf16 v[128:131], a[104:107], a[124:127], v[128:131]
    v_mfma_f32_16x16x32_bf16 a[72:75], a[104:107], a[128:131], a[72:75]
    v_mfma_f32_16x16x32_bf16 v[184:187], a[104:107], a[132:135], v[184:187]
    ds_read_b64_tr_b16 a[104:105], v243 offset:16384
    ds_read_b64_tr_b16 a[106:107], v243 offset:18432
    v_mfma_f32_16x16x32_bf16 v[100:103], a[108:111], a[120:123], v[100:103]
    buffer_load_dwordx4 v207, s[8:11], s60 offen offset:3072 nt lds
    v_mfma_f32_16x16x32_bf16 v[132:135], a[108:111], a[124:127], v[132:135]
    s_add_u32 m0, s84, 69632
    s_mov_b32 s60, 640
    v_mfma_f32_16x16x32_bf16 a[76:79], a[108:111], a[128:131], a[76:79]
    v_mfma_f32_16x16x32_bf16 v[188:191], a[108:111], a[132:135], v[188:191]
    ds_read_b64_tr_b16 a[108:109], v243 offset:16392
    ds_read_b64_tr_b16 a[110:111], v243 offset:18440
    v_mfma_f32_16x16x32_bf16 v[104:107], a[112:115], a[120:123], v[104:107]
    v_mfma_f32_16x16x32_bf16 v[136:139], a[112:115], a[124:127], v[136:139]
    buffer_load_dwordx4 v240, s[8:11], s60 offen nt lds
    v_mfma_f32_16x16x32_bf16 a[80:83], a[112:115], a[128:131], a[80:83]
    s_add_u32 s60, s80, 3145728
    v_mfma_f32_16x16x32_bf16 v[192:195], a[112:115], a[132:135], v[192:195]
    ds_read_b64_tr_b16 a[112:113], v244 offset:16384
    ds_read_b64_tr_b16 a[114:115], v244 offset:18432
    v_mfma_f32_16x16x32_bf16 v[108:111], a[116:119], a[120:123], v[108:111]
    v_mfma_f32_16x16x32_bf16 v[140:143], a[116:119], a[124:127], v[140:143]
    v_mfma_f32_16x16x32_bf16 a[84:87], a[116:119], a[128:131], a[84:87]
    buffer_load_dword v238, v253, s[12:15], s60 offen
    v_mfma_f32_16x16x32_bf16 v[196:199], a[116:119], a[132:135], v[196:199]
    ds_read_b64_tr_b16 a[116:117], v244 offset:16392
    ds_read_b64_tr_b16 a[118:119], v244 offset:18440
    v_mfma_f32_16x16x32_bf16 v[16:19], a[88:91], a[140:143], v[16:19]
    v_mfma_f32_16x16x32_bf16 v[48:51], a[88:91], a[144:147], v[48:51]
    v_mfma_f32_16x16x32_bf16 a[0:3], a[88:91], a[148:151], a[0:3]
    v_mfma_f32_16x16x32_bf16 a[32:35], a[88:91], a[152:155], a[32:35]
    buffer_load_dword v238, v226, s[8:11], 0 offen offset:768 nt
    v_mfma_f32_16x16x32_bf16 v[0:3], a[88:91], a[156:159], v[0:3]
    ds_read_b64_tr_b16 a[88:89], v241 offset:16640
    ds_read_b64_tr_b16 a[90:91], v241 offset:18688
    v_mfma_f32_16x16x32_bf16 v[20:23], a[92:95], a[140:143], v[20:23]
    v_mfma_f32_16x16x32_bf16 v[52:55], a[92:95], a[144:147], v[52:55]
    v_mfma_f32_16x16x32_bf16 a[4:7], a[92:95], a[148:151], a[4:7]
    v_mfma_f32_16x16x32_bf16 a[36:39], a[92:95], a[152:155], a[36:39]
    v_mfma_f32_16x16x32_bf16 v[4:7], a[92:95], a[156:159], v[4:7]
    s_waitcnt lgkmcnt(2)
    ds_read_b64_tr_b16 a[92:93], v241 offset:16648
    ds_read_b64_tr_b16 a[94:95], v241 offset:18696
    v_mfma_f32_16x16x32_bf16 v[24:27], a[96:99], a[140:143], v[24:27]
    v_add_u32 v241, 69632, v241
    v_mfma_f32_16x16x32_bf16 v[56:59], a[96:99], a[144:147], v[56:59]
    v_mfma_f32_16x16x32_bf16 a[8:11], a[96:99], a[148:151], a[8:11]
    v_mfma_f32_16x16x32_bf16 a[40:43], a[96:99], a[152:155], a[40:43]
    v_mfma_f32_16x16x32_bf16 v[8:11], a[96:99], a[156:159], v[8:11]
    ds_read_b64_tr_b16 a[96:97], v242 offset:16640
    ds_read_b64_tr_b16 a[98:99], v242 offset:18688
    v_mfma_f32_16x16x32_bf16 v[28:31], a[100:103], a[140:143], v[28:31]
    v_mfma_f32_16x16x32_bf16 v[60:63], a[100:103], a[144:147], v[60:63]
    v_mfma_f32_16x16x32_bf16 a[12:15], a[100:103], a[148:151], a[12:15]
    v_mfma_f32_16x16x32_bf16 a[44:47], a[100:103], a[152:155], a[44:47]
    v_mfma_f32_16x16x32_bf16 v[12:15], a[100:103], a[156:159], v[12:15]
    ds_read_b64_tr_b16 a[100:101], v242 offset:16648
    ds_read_b64_tr_b16 a[102:103], v242 offset:18696
    v_mfma_f32_16x16x32_bf16 v[32:35], a[104:107], a[140:143], v[32:35]
    v_add_u32 v242, 69632, v242
    v_mfma_f32_16x16x32_bf16 v[64:67], a[104:107], a[144:147], v[64:67]
    v_mfma_f32_16x16x32_bf16 a[16:19], a[104:107], a[148:151], a[16:19]
    v_mfma_f32_16x16x32_bf16 a[48:51], a[104:107], a[152:155], a[48:51]
    ds_read_b64_tr_b16 a[104:105], v243 offset:16640
    ds_read_b64_tr_b16 a[106:107], v243 offset:18688
    v_mfma_f32_16x16x32_bf16 v[36:39], a[108:111], a[140:143], v[36:39]
    v_mfma_f32_16x16x32_bf16 v[68:71], a[108:111], a[144:147], v[68:71]
    v_mfma_f32_16x16x32_bf16 a[20:23], a[108:111], a[148:151], a[20:23]
    v_mfma_f32_16x16x32_bf16 a[52:55], a[108:111], a[152:155], a[52:55]
    ds_read_b64_tr_b16 a[108:109], v243 offset:16648
    ds_read_b64_tr_b16 a[110:111], v243 offset:18696
    v_mfma_f32_16x16x32_bf16 v[40:43], a[112:115], a[140:143], v[40:43]
    v_add_u32 v243, 69632, v243
    v_mfma_f32_16x16x32_bf16 v[72:75], a[112:115], a[144:147], v[72:75]
    v_mfma_f32_16x16x32_bf16 a[24:27], a[112:115], a[148:151], a[24:27]
    v_mfma_f32_16x16x32_bf16 a[56:59], a[112:115], a[152:155], a[56:59]
    ds_read_b64_tr_b16 a[112:113], v244 offset:16640
    ds_read_b64_tr_b16 a[114:115], v244 offset:18688
    v_mfma_f32_16x16x32_bf16 v[44:47], a[116:119], a[140:143], v[44:47]
    v_mfma_f32_16x16x32_bf16 v[76:79], a[116:119], a[144:147], v[76:79]
    v_mfma_f32_16x16x32_bf16 a[28:31], a[116:119], a[148:151], a[28:31]
    v_mfma_f32_16x16x32_bf16 a[60:63], a[116:119], a[152:155], a[60:63]
    s_waitcnt lgkmcnt(2)
    ds_read_b64_tr_b16 a[116:117], v244 offset:16648
    ds_read_b64_tr_b16 a[118:119], v244 offset:18696
    v_mfma_f32_16x16x32_bf16 v[80:83], a[88:91], a[140:143], v[80:83]
    v_add_u32 v244, 69632, v244
    v_mfma_f32_16x16x32_bf16 v[112:115], a[88:91], a[144:147], v[112:115]
    v_mfma_f32_16x16x32_bf16 v[144:147], a[88:91], a[148:151], v[144:147]
    v_mfma_f32_16x16x32_bf16 v[168:171], a[88:91], a[152:155], v[168:171]
    v_mfma_f32_16x16x32_bf16 v[152:155], a[88:91], a[156:159], v[152:155]
    v_mfma_f32_16x16x32_bf16 v[84:87], a[92:95], a[140:143], v[84:87]
    v_mfma_f32_16x16x32_bf16 v[116:119], a[92:95], a[144:147], v[116:119]
    v_mfma_f32_16x16x32_bf16 v[148:151], a[92:95], a[148:151], v[148:151]
    v_mfma_f32_16x16x32_bf16 v[172:175], a[92:95], a[152:155], v[172:175]
    v_mfma_f32_16x16x32_bf16 v[156:159], a[92:95], a[156:159], v[156:159]
    v_mfma_f32_16x16x32_bf16 v[88:91], a[96:99], a[140:143], v[88:91]
    s_waitcnt vmcnt(2) lgkmcnt(0)
    s_barrier
    v_mfma_f32_16x16x32_bf16 v[120:123], a[96:99], a[144:147], v[120:123]
    s_add_u32 m0, s82, 0
    ds_read_b64_tr_b16 a[88:89], v241 offset:0
    ds_read_b64_tr_b16 a[90:91], v241 offset:2048
    v_mfma_f32_16x16x32_bf16 a[64:67], a[96:99], a[148:151], a[64:67]
    s_add_u32 s60, s80, 3145728
    ds_read_b128 a[120:123], v245 offset:0
    ds_read_b128 a[124:127], v245 offset:2048
    v_mfma_f32_16x16x32_bf16 v[176:179], a[96:99], a[152:155], v[176:179]
    ds_read_b128 a[128:131], v245 offset:4096
    ds_read_b128 a[132:135], v245 offset:6144
    v_mfma_f32_16x16x32_bf16 v[160:163], a[96:99], a[156:159], v[160:163]
    ds_read_b128 a[136:139], v247
    ds_read_b64_tr_b16 a[92:93], v241 offset:8
    v_mfma_f32_16x16x32_bf16 v[92:95], a[100:103], a[140:143], v[92:95]
    ds_read_b64_tr_b16 a[94:95], v241 offset:2056
    ds_read_b64_tr_b16 a[96:97], v242 offset:0
    v_mfma_f32_16x16x32_bf16 v[124:127], a[100:103], a[144:147], v[124:127]
    ds_read_b64_tr_b16 a[98:99], v242 offset:2048
    v_subrev_u32 v245, 69632, v245
    v_mfma_f32_16x16x32_bf16 a[68:71], a[100:103], a[148:151], a[68:71]
    v_subrev_u32 v247, 69632, v247
    v_mfma_f32_16x16x32_bf16 v[180:183], a[100:103], a[152:155], v[180:183]
    buffer_load_dwordx4 v200, s[12:15], s60 offen offset:0  lds
    v_mfma_f32_16x16x32_bf16 v[164:167], a[100:103], a[156:159], v[164:167]
    ds_read_b64_tr_b16 a[100:101], v242 offset:8
    ds_read_b64_tr_b16 a[102:103], v242 offset:2056
    v_mfma_f32_16x16x32_bf16 v[96:99], a[104:107], a[140:143], v[96:99]
    buffer_load_dwordx4 v201, s[12:15], s60 offen offset:1024  lds
    v_mfma_f32_16x16x32_bf16 v[128:131], a[104:107], a[144:147], v[128:131]
    buffer_load_dwordx4 v202, s[12:15], s60 offen offset:2048  lds
    v_mfma_f32_16x16x32_bf16 a[72:75], a[104:107], a[148:151], a[72:75]
    v_mfma_f32_16x16x32_bf16 v[184:187], a[104:107], a[152:155], v[184:187]
    ds_read_b64_tr_b16 a[104:105], v243 offset:0
    ds_read_b64_tr_b16 a[106:107], v243 offset:2048
    v_mfma_f32_16x16x32_bf16 v[100:103], a[108:111], a[140:143], v[100:103]
    v_mfma_f32_16x16x32_bf16 v[132:135], a[108:111], a[144:147], v[132:135]
    v_mfma_f32_16x16x32_bf16 a[76:79], a[108:111], a[148:151], a[76:79]
    buffer_load_dwordx4 v203, s[12:15], s60 offen offset:3072  lds
    v_mfma_f32_16x16x32_bf16 v[188:191], a[108:111], a[152:155], v[188:191]
    s_add_u32 m0, s82, 4096
    ds_read_b64_tr_b16 a[108:109], v243 offset:8
    ds_read_b64_tr_b16 a[110:111], v243 offset:2056
    v_mfma_f32_16x16x32_bf16 v[104:107], a[112:115], a[140:143], v[104:107]
    s_add_u32 s60, s80, 3211264
    v_mfma_f32_16x16x32_bf16 v[136:139], a[112:115], a[144:147], v[136:139]
    v_mfma_f32_16x16x32_bf16 a[80:83], a[112:115], a[148:151], a[80:83]
    v_mfma_f32_16x16x32_bf16 v[192:195], a[112:115], a[152:155], v[192:195]
    ds_read_b64_tr_b16 a[112:113], v244 offset:0
    ds_read_b64_tr_b16 a[114:115], v244 offset:2048
    v_mfma_f32_16x16x32_bf16 v[108:111], a[116:119], a[140:143], v[108:111]
    buffer_load_dwordx4 v200, s[12:15], s60 offen offset:0  lds
    v_mfma_f32_16x16x32_bf16 v[140:143], a[116:119], a[144:147], v[140:143]
    v_mfma_f32_16x16x32_bf16 a[84:87], a[116:119], a[148:151], a[84:87]
    v_mfma_f32_16x16x32_bf16 v[196:199], a[116:119], a[152:155], v[196:199]
    s_waitcnt lgkmcnt(2)
    ds_read_b64_tr_b16 a[116:117], v244 offset:8
    ds_read_b64_tr_b16 a[118:119], v244 offset:2056
    v_mfma_f32_16x16x32_bf16 v[16:19], a[88:91], a[120:123], v[16:19]
    ds_read_b128 a[140:143], v246 offset:0
    ds_read_b128 a[144:147], v246 offset:2048
    v_mfma_f32_16x16x32_bf16 v[48:51], a[88:91], a[124:127], v[48:51]
    ds_read_b128 a[148:151], v246 offset:4096
    ds_read_b128 a[152:155], v246 offset:6144
    v_mfma_f32_16x16x32_bf16 a[0:3], a[88:91], a[128:131], a[0:3]
    ds_read_b128 a[156:159], v248
    v_subrev_u32 v246, 69632, v246
    v_mfma_f32_16x16x32_bf16 a[32:35], a[88:91], a[132:135], a[32:35]
    v_subrev_u32 v248, 69632, v248
    v_mfma_f32_16x16x32_bf16 v[0:3], a[88:91], a[136:139], v[0:3]
    ds_read_b64_tr_b16 a[88:89], v241 offset:256
    ds_read_b64_tr_b16 a[90:91], v241 offset:2304
    v_mfma_f32_16x16x32_bf16 v[20:23], a[92:95], a[120:123], v[20:23]
    buffer_load_dwordx4 v201, s[12:15], s60 offen offset:1024  lds
    v_mfma_f32_16x16x32_bf16 v[52:55], a[92:95], a[124:127], v[52:55]
    buffer_load_dwordx4 v202, s[12:15], s60 offen offset:2048  lds
    v_mfma_f32_16x16x32_bf16 a[4:7], a[92:95], a[128:131], a[4:7]
    v_mfma_f32_16x16x32_bf16 a[36:39], a[92:95], a[132:135], a[36:39]
    v_mfma_f32_16x16x32_bf16 v[4:7], a[92:95], a[136:139], v[4:7]
    ds_read_b64_tr_b16 a[92:93], v241 offset:264
    ds_read_b64_tr_b16 a[94:95], v241 offset:2312
    v_mfma_f32_16x16x32_bf16 v[24:27], a[96:99], a[120:123], v[24:27]
    buffer_load_dwordx4 v203, s[12:15], s60 offen offset:3072  lds
    v_mfma_f32_16x16x32_bf16 v[56:59], a[96:99], a[124:127], v[56:59]
    s_add_u32 m0, s83, 0
    s_add_u32 s60, s81, 768
    v_mfma_f32_16x16x32_bf16 a[8:11], a[96:99], a[128:131], a[8:11]
    v_mfma_f32_16x16x32_bf16 a[40:43], a[96:99], a[132:135], a[40:43]
    v_mfma_f32_16x16x32_bf16 v[8:11], a[96:99], a[136:139], v[8:11]
    ds_read_b64_tr_b16 a[96:97], v242 offset:256
    ds_read_b64_tr_b16 a[98:99], v242 offset:2304
    v_mfma_f32_16x16x32_bf16 v[28:31], a[100:103], a[120:123], v[28:31]
    buffer_load_dwordx4 v204, s[8:11], s60 offen offset:0 nt lds
    v_mfma_f32_16x16x32_bf16 v[60:63], a[100:103], a[124:127], v[60:63]
    v_mfma_f32_16x16x32_bf16 a[12:15], a[100:103], a[128:131], a[12:15]
    v_mfma_f32_16x16x32_bf16 a[44:47], a[100:103], a[132:135], a[44:47]
    v_mfma_f32_16x16x32_bf16 v[12:15], a[100:103], a[136:139], v[12:15]
    ds_read_b64_tr_b16 a[100:101], v242 offset:264
    ds_read_b64_tr_b16 a[102:103], v242 offset:2312
    v_mfma_f32_16x16x32_bf16 v[32:35], a[104:107], a[120:123], v[32:35]
    buffer_load_dwordx4 v205, s[8:11], s60 offen offset:1024 nt lds
    v_mfma_f32_16x16x32_bf16 v[64:67], a[104:107], a[124:127], v[64:67]
    v_mfma_f32_16x16x32_bf16 a[16:19], a[104:107], a[128:131], a[16:19]
    v_mfma_f32_16x16x32_bf16 a[48:51], a[104:107], a[132:135], a[48:51]
    ds_read_b64_tr_b16 a[104:105], v243 offset:256
    ds_read_b64_tr_b16 a[106:107], v243 offset:2304
    v_mfma_f32_16x16x32_bf16 v[36:39], a[108:111], a[120:123], v[36:39]
    v_mfma_f32_16x16x32_bf16 v[68:71], a[108:111], a[124:127], v[68:71]
    buffer_load_dwordx4 v206, s[8:11], s60 offen offset:2048 nt lds
    v_mfma_f32_16x16x32_bf16 a[20:23], a[108:111], a[128:131], a[20:23]
    v_mfma_f32_16x16x32_bf16 a[52:55], a[108:111], a[132:135], a[52:55]
    s_waitcnt lgkmcnt(2)
    ds_read_b64_tr_b16 a[108:109], v243 offset:264
    ds_read_b64_tr_b16 a[110:111], v243 offset:2312
    v_mfma_f32_16x16x32_bf16 v[40:43], a[112:115], a[120:123], v[40:43]
    v_mfma_f32_16x16x32_bf16 v[72:75], a[112:115], a[124:127], v[72:75]
    v_mfma_f32_16x16x32_bf16 a[24:27], a[112:115], a[128:131], a[24:27]
    buffer_load_dwordx4 v207, s[8:11], s60 offen offset:3072 nt lds
    v_mfma_f32_16x16x32_bf16 a[56:59], a[112:115], a[132:135], a[56:59]
    s_add_u32 m0, s83, 4096
    ds_read_b64_tr_b16 a[112:113], v244 offset:256
    ds_read_b64_tr_b16 a[114:115], v244 offset:2304
    v_mfma_f32_16x16x32_bf16 v[44:47], a[116:119], a[120:123], v[44:47]
    s_add_u32 s60, s81, 33536
    v_mfma_f32_16x16x32_bf16 v[76:79], a[116:119], a[124:127], v[76:79]
    v_mfma_f32_16x16x32_bf16 a[28:31], a[116:119], a[128:131], a[28:31]
    v_mfma_f32_16x16x32_bf16 a[60:63], a[116:119], a[132:135], a[60:63]
    ds_read_b64_tr_b16 a[116:117], v244 offset:264
    ds_read_b64_tr_b16 a[118:119], v244 offset:2312
    v_mfma_f32_16x16x32_bf16 v[80:83], a[88:91], a[120:123], v[80:83]
    buffer_load_dwordx4 v204, s[8:11], s60 offen offset:0 nt lds
    v_mfma_f32_16x16x32_bf16 v[112:115], a[88:91], a[124:127], v[112:115]
    v_mfma_f32_16x16x32_bf16 v[144:147], a[88:91], a[128:131], v[144:147]
    v_mfma_f32_16x16x32_bf16 v[168:171], a[88:91], a[132:135], v[168:171]
    v_mfma_f32_16x16x32_bf16 v[152:155], a[88:91], a[136:139], v[152:155]
    ds_read_b64_tr_b16 a[88:89], v241 offset:16384
    ds_read_b64_tr_b16 a[90:91], v241 offset:18432
    v_mfma_f32_16x16x32_bf16 v[84:87], a[92:95], a[120:123], v[84:87]
    buffer_load_dwordx4 v205, s[8:11], s60 offen offset:1024 nt lds
    v_mfma_f32_16x16x32_bf16 v[116:119], a[92:95], a[124:127], v[116:119]
    v_mfma_f32_16x16x32_bf16 v[148:151], a[92:95], a[128:131], v[148:151]
    v_mfma_f32_16x16x32_bf16 v[172:175], a[92:95], a[132:135], v[172:175]
    v_mfma_f32_16x16x32_bf16 v[156:159], a[92:95], a[136:139], v[156:159]
    ds_read_b64_tr_b16 a[92:93], v241 offset:16392
    ds_read_b64_tr_b16 a[94:95], v241 offset:18440
    v_mfma_f32_16x16x32_bf16 v[88:91], a[96:99], a[120:123], v[88:91]
    buffer_load_dwordx4 v206, s[8:11], s60 offen offset:2048 nt lds
    v_mfma_f32_16x16x32_bf16 v[120:123], a[96:99], a[124:127], v[120:123]
    v_mfma_f32_16x16x32_bf16 a[64:67], a[96:99], a[128:131], a[64:67]
    v_mfma_f32_16x16x32_bf16 v[176:179], a[96:99], a[132:135], v[176:179]
    v_mfma_f32_16x16x32_bf16 v[160:163], a[96:99], a[136:139], v[160:163]
    ds_read_b64_tr_b16 a[96:97], v242 offset:16384
    ds_read_b64_tr_b16 a[98:99], v242 offset:18432
    v_mfma_f32_16x16x32_bf16 v[92:95], a[100:103], a[120:123], v[92:95]
    buffer_load_dwordx4 v207, s[8:11], s60 offen offset:3072 nt lds
    v_mfma_f32_16x16x32_bf16 v[124:127], a[100:103], a[124:127], v[124:127]
    s_add_u32 m0, s84, 0
    s_mov_b32 s60, 768
    v_mfma_f32_16x16x32_bf16 a[68:71], a[100:103], a[128:131], a[68:71]
    v_mfma_f32_16x16x32_bf16 v[180:183], a[100:103], a[132:135], v[180:183]
    v_mfma_f32_16x16x32_bf16 v[164:167], a[100:103], a[136:139], v[164:167]
    s_waitcnt lgkmcnt(2)
    ds_read_b64_tr_b16 a[100:101], v242 offset:16392
    ds_read_b64_tr_b16 a[102:103], v242 offset:18440
    v_mfma_f32_16x16x32_bf16 v[96:99], a[104:107], a[120:123], v[96:99]
    buffer_load_dwordx4 v240, s[8:11], s60 offen nt lds
    v_mfma_f32_16x16x32_bf16 v[128:131], a[104:107], a[124:127], v[128:131]
    s_add_u32 s60, s80, 3670016
    v_mfma_f32_16x16x32_bf16 a[72:75], a[104:107], a[128:131], a[72:75]
    v_mfma_f32_16x16x32_bf16 v[184:187], a[104:107], a[132:135], v[184:187]
    ds_read_b64_tr_b16 a[104:105], v243 offset:16384
    ds_read_b64_tr_b16 a[106:107], v243 offset:18432
    v_mfma_f32_16x16x32_bf16 v[100:103], a[108:111], a[120:123], v[100:103]
    buffer_load_dword v238, v253, s[12:15], s60 offen
    v_mfma_f32_16x16x32_bf16 v[132:135], a[108:111], a[124:127], v[132:135]
    v_mfma_f32_16x16x32_bf16 a[76:79], a[108:111], a[128:131], a[76:79]
    v_mfma_f32_16x16x32_bf16 v[188:191], a[108:111], a[132:135], v[188:191]
    ds_read_b64_tr_b16 a[108:109], v243 offset:16392
    ds_read_b64_tr_b16 a[110:111], v243 offset:18440
    v_mfma_f32_16x16x32_bf16 v[104:107], a[112:115], a[120:123], v[104:107]
    v_mfma_f32_16x16x32_bf16 v[136:139], a[112:115], a[124:127], v[136:139]
    buffer_load_dword v238, v226, s[8:11], 0 offen offset:896 nt
    v_mfma_f32_16x16x32_bf16 a[80:83], a[112:115], a[128:131], a[80:83]
    v_mfma_f32_16x16x32_bf16 v[192:195], a[112:115], a[132:135], v[192:195]
    ds_read_b64_tr_b16 a[112:113], v244 offset:16384
    ds_read_b64_tr_b16 a[114:115], v244 offset:18432
    v_mfma_f32_16x16x32_bf16 v[108:111], a[116:119], a[120:123], v[108:111]
    v_mfma_f32_16x16x32_bf16 v[140:143], a[116:119], a[124:127], v[140:143]
    v_mfma_f32_16x16x32_bf16 a[84:87], a[116:119], a[128:131], a[84:87]
    v_mfma_f32_16x16x32_bf16 v[196:199], a[116:119], a[132:135], v[196:199]
    ds_read_b64_tr_b16 a[116:117], v244 offset:16392
    ds_read_b64_tr_b16 a[118:119], v244 offset:18440
    v_mfma_f32_16x16x32_bf16 v[16:19], a[88:91], a[140:143], v[16:19]
    v_mfma_f32_16x16x32_bf16 v[48:51], a[88:91], a[144:147], v[48:51]
    v_mfma_f32_16x16x32_bf16 a[0:3], a[88:91], a[148:151], a[0:3]
    v_mfma_f32_16x16x32_bf16 a[32:35], a[88:91], a[152:155], a[32:35]
    v_mfma_f32_16x16x32_bf16 v[0:3], a[88:91], a[156:159], v[0:3]
    ds_read_b64_tr_b16 a[88:89], v241 offset:16640
    ds_read_b64_tr_b16 a[90:91], v241 offset:18688
    v_mfma_f32_16x16x32_bf16 v[20:23], a[92:95], a[140:143], v[20:23]
    v_mfma_f32_16x16x32_bf16 v[52:55], a[92:95], a[144:147], v[52:55]
    v_mfma_f32_16x16x32_bf16 a[4:7], a[92:95], a[148:151], a[4:7]
    v_mfma_f32_16x16x32_bf16 a[36:39], a[92:95], a[152:155], a[36:39]
    v_mfma_f32_16x16x32_bf16 v[4:7], a[92:95], a[156:159], v[4:7]
    s_waitcnt lgkmcnt(2)
    ds_read_b64_tr_b16 a[92:93], v241 offset:16648
    ds_read_b64_tr_b16 a[94:95], v241 offset:18696
    v_mfma_f32_16x16x32_bf16 v[24:27], a[96:99], a[140:143], v[24:27]
    v_subrev_u32 v241, 69632, v241
    v_mfma_f32_16x16x32_bf16 v[56:59], a[96:99], a[144:147], v[56:59]
    v_mfma_f32_16x16x32_bf16 a[8:11], a[96:99], a[148:151], a[8:11]
    v_mfma_f32_16x16x32_bf16 a[40:43], a[96:99], a[152:155], a[40:43]
    v_mfma_f32_16x16x32_bf16 v[8:11], a[96:99], a[156:159], v[8:11]
    ds_read_b64_tr_b16 a[96:97], v242 offset:16640
    ds_read_b64_tr_b16 a[98:99], v242 offset:18688
    v_mfma_f32_16x16x32_bf16 v[28:31], a[100:103], a[140:143], v[28:31]
    v_mfma_f32_16x16x32_bf16 v[60:63], a[100:103], a[144:147], v[60:63]
    v_mfma_f32_16x16x32_bf16 a[12:15], a[100:103], a[148:151], a[12:15]
    v_mfma_f32_16x16x32_bf16 a[44:47], a[100:103], a[152:155], a[44:47]
    v_mfma_f32_16x16x32_bf16 v[12:15], a[100:103], a[156:159], v[12:15]
    ds_read_b64_tr_b16 a[100:101], v242 offset:16648
    ds_read_b64_tr_b16 a[102:103], v242 offset:18696
    v_mfma_f32_16x16x32_bf16 v[32:35], a[104:107], a[140:143], v[32:35]
    v_subrev_u32 v242, 69632, v242
    v_mfma_f32_16x16x32_bf16 v[64:67], a[104:107], a[144:147], v[64:67]
    v_mfma_f32_16x16x32_bf16 a[16:19], a[104:107], a[148:151], a[16:19]
    v_mfma_f32_16x16x32_bf16 a[48:51], a[104:107], a[152:155], a[48:51]
    ds_read_b64_tr_b16 a[104:105], v243 offset:16640
    ds_read_b64_tr_b16 a[106:107], v243 offset:18688
    v_mfma_f32_16x16x32_bf16 v[36:39], a[108:111], a[140:143], v[36:39]
    v_mfma_f32_16x16x32_bf16 v[68:71], a[108:111], a[144:147], v[68:71]
    v_mfma_f32_16x16x32_bf16 a[20:23], a[108:111], a[148:151], a[20:23]
    v_mfma_f32_16x16x32_bf16 a[52:55], a[108:111], a[152:155], a[52:55]
    ds_read_b64_tr_b16 a[108:109], v243 offset:16648
    ds_read_b64_tr_b16 a[110:111], v243 offset:18696
    v_mfma_f32_16x16x32_bf16 v[40:43], a[112:115], a[140:143], v[40:43]
    v_subrev_u32 v243, 69632, v243
    v_mfma_f32_16x16x32_bf16 v[72:75], a[112:115], a[144:147], v[72:75]
    v_mfma_f32_16x16x32_bf16 a[24:27], a[112:115], a[148:151], a[24:27]
    v_mfma_f32_16x16x32_bf16 a[56:59], a[112:115], a[152:155], a[56:59]
    ds_read_b64_tr_b16 a[112:113], v244 offset:16640
    ds_read_b64_tr_b16 a[114:115], v244 offset:18688
    v_mfma_f32_16x16x32_bf16 v[44:47], a[116:119], a[140:143], v[44:47]
    v_mfma_f32_16x16x32_bf16 v[76:79], a[116:119], a[144:147], v[76:79]
    v_mfma_f32_16x16x32_bf16 a[28:31], a[116:119], a[148:151], a[28:31]
    v_mfma_f32_16x16x32_bf16 a[60:63], a[116:119], a[152:155], a[60:63]
    s_waitcnt lgkmcnt(2)
    ds_read_b64_tr_b16 a[116:117], v244 offset:16648
    ds_read_b64_tr_b16 a[118:119], v244 offset:18696
    v_mfma_f32_16x16x32_bf16 v[80:83], a[88:91], a[140:143], v[80:83]
    v_subrev_u32 v244, 69632, v244
    v_mfma_f32_16x16x32_bf16 v[112:115], a[88:91], a[144:147], v[112:115]
    v_mfma_f32_16x16x32_bf16 v[144:147], a[88:91], a[148:151], v[144:147]
    v_mfma_f32_16x16x32_bf16 v[168:171], a[88:91], a[152:155], v[168:171]
    v_mfma_f32_16x16x32_bf16 v[152:155], a[88:91], a[156:159], v[152:155]
    v_mfma_f32_16x16x32_bf16 v[84:87], a[92:95], a[140:143], v[84:87]
    v_mfma_f32_16x16x32_bf16 v[116:119], a[92:95], a[144:147], v[116:119]
    v_mfma_f32_16x16x32_bf16 v[148:151], a[92:95], a[148:151], v[148:151]
    v_mfma_f32_16x16x32_bf16 v[172:175], a[92:95], a[152:155], v[172:175]
    v_mfma_f32_16x16x32_bf16 v[156:159], a[92:95], a[156:159], v[156:159]
    v_mfma_f32_16x16x32_bf16 v[88:91], a[96:99], a[140:143], v[88:91]
    s_waitcnt vmcnt(2) lgkmcnt(0)
    s_barrier
    v_mfma_f32_16x16x32_bf16 v[120:123], a[96:99], a[144:147], v[120:123]
    s_add_u32 m0, s82, 69632
    ds_read_b64_tr_b16 a[88:89], v241 offset:0
    ds_read_b64_tr_b16 a[90:91], v241 offset:2048
    v_mfma_f32_16x16x32_bf16 a[64:67], a[96:99], a[148:151], a[64:67]
    s_add_u32 s60, s80, 3670016
    ds_read_b128 a[120:123], v245 offset:0
    ds_read_b128 a[124:127], v245 offset:2048
    v_mfma_f32_16x16x32_bf16 v[176:179], a[96:99], a[152:155], v[176:179]
    ds_read_b128 a[128:131], v245 offset:4096
    ds_read_b128 a[132:135], v245 offset:6144
    v_mfma_f32_16x16x32_bf16 v[160:163], a[96:99], a[156:159], v[160:163]
    ds_read_b128 a[136:139], v247
    ds_read_b64_tr_b16 a[92:93], v241 offset:8
    v_mfma_f32_16x16x32_bf16 v[92:95], a[100:103], a[140:143], v[92:95]
    ds_read_b64_tr_b16 a[94:95], v241 offset:2056
    ds_read_b64_tr_b16 a[96:97], v242 offset:0
    v_mfma_f32_16x16x32_bf16 v[124:127], a[100:103], a[144:147], v[124:127]
    ds_read_b64_tr_b16 a[98:99], v242 offset:2048
    v_add_u32 v245, 69632, v245
    v_mfma_f32_16x16x32_bf16 a[68:71], a[100:103], a[148:151], a[68:71]
    v_add_u32 v247, 69632, v247
    v_mfma_f32_16x16x32_bf16 v[180:183], a[100:103], a[152:155], v[180:183]
    buffer_load_dwordx4 v200, s[12:15], s60 offen offset:0  lds
    v_mfma_f32_16x16x32_bf16 v[164:167], a[100:103], a[156:159], v[164:167]
    ds_read_b64_tr_b16 a[100:101], v242 offset:8
    ds_read_b64_tr_b16 a[102:103], v242 offset:2056
    v_mfma_f32_16x16x32_bf16 v[96:99], a[104:107], a[140:143], v[96:99]
    buffer_load_dwordx4 v201, s[12:15], s60 offen offset:1024  lds
    v_mfma_f32_16x16x32_bf16 v[128:131], a[104:107], a[144:147], v[128:131]
    buffer_load_dwordx4 v202, s[12:15], s60 offen offset:2048  lds
    v_mfma_f32_16x16x32_bf16 a[72:75], a[104:107], a[148:151], a[72:75]
    v_mfma_f32_16x16x32_bf16 v[184:187], a[104:107], a[152:155], v[184:187]
    ds_read_b64_tr_b16 a[104:105], v243 offset:0
    ds_read_b64_tr_b16 a[106:107], v243 offset:2048
    v_mfma_f32_16x16x32_bf16 v[100:103], a[108:111], a[140:143], v[100:103]
    v_mfma_f32_16x16x32_bf16 v[132:135], a[108:111], a[144:147], v[132:135]
    v_mfma_f32_16x16x32_bf16 a[76:79], a[108:111], a[148:151], a[76:79]
    buffer_load_dwordx4 v203, s[12:15], s60 offen offset:3072  lds
    v_mfma_f32_16x16x32_bf16 v[188:191], a[108:111], a[152:155], v[188:191]
    s_add_u32 m0, s82, 73728
    ds_read_b64_tr_b16 a[108:109], v243 offset:8
    ds_read_b64_tr_b16 a[110:111], v243 offset:2056
    v_mfma_f32_16x16x32_bf16 v[104:107], a[112:115], a[140:143], v[104:107]
    s_add_u32 s60, s80, 3735552
    v_mfma_f32_16x16x32_bf16 v[136:139], a[112:115], a[144:147], v[136:139]
    v_mfma_f32_16x16x32_bf16 a[80:83], a[112:115], a[148:151], a[80:83]
    v_mfma_f32_16x16x32_bf16 v[192:195], a[112:115], a[152:155], v[192:195]
    ds_read_b64_tr_b16 a[112:113], v244 offset:0
    ds_read_b64_tr_b16 a[114:115], v244 offset:2048
    v_mfma_f32_16x16x32_bf16 v[108:111], a[116:119], a[140:143], v[108:111]
    buffer_load_dwordx4 v200, s[12:15], s60 offen offset:0  lds
    v_mfma_f32_16x16x32_bf16 v[140:143], a[116:119], a[144:147], v[140:143]
    v_mfma_f32_16x16x32_bf16 a[84:87], a[116:119], a[148:151], a[84:87]
    v_mfma_f32_16x16x32_bf16 v[196:199], a[116:119], a[152:155], v[196:199]
    s_waitcnt lgkmcnt(2)
    ds_read_b64_tr_b16 a[116:117], v244 offset:8
    ds_read_b64_tr_b16 a[118:119], v244 offset:2056
    v_mfma_f32_16x16x32_bf16 v[16:19], a[88:91], a[120:123], v[16:19]
    ds_read_b128 a[140:143], v246 offset:0
    ds_read_b128 a[144:147], v246 offset:2048
    v_mfma_f32_16x16x32_bf16 v[48:51], a[88:91], a[124:127], v[48:51]
    ds_read_b128 a[148:151], v246 offset:4096
    ds_read_b128 a[152:155], v246 offset:6144
    v_mfma_f32_16x16x32_bf16 a[0:3], a[88:91], a[128:131], a[0:3]
    ds_read_b128 a[156:159], v248
    v_add_u32 v246, 69632, v246
    v_mfma_f32_16x16x32_bf16 a[32:35], a[88:91], a[132:135], a[32:35]
    v_add_u32 v248, 69632, v248
    v_mfma_f32_16x16x32_bf16 v[0:3], a[88:91], a[136:139], v[0:3]
    ds_read_b64_tr_b16 a[88:89], v241 offset:256
    ds_read_b64_tr_b16 a[90:91], v241 offset:2304
    v_mfma_f32_16x16x32_bf16 v[20:23], a[92:95], a[120:123], v[20:23]
    buffer_load_dwordx4 v201, s[12:15], s60 offen offset:1024  lds
    v_mfma_f32_16x16x32_bf16 v[52:55], a[92:95], a[124:127], v[52:55]
    buffer_load_dwordx4 v202, s[12:15], s60 offen offset:2048  lds
    v_mfma_f32_16x16x32_bf16 a[4:7], a[92:95], a[128:131], a[4:7]
    v_mfma_f32_16x16x32_bf16 a[36:39], a[92:95], a[132:135], a[36:39]
    v_mfma_f32_16x16x32_bf16 v[4:7], a[92:95], a[136:139], v[4:7]
    ds_read_b64_tr_b16 a[92:93], v241 offset:264
    ds_read_b64_tr_b16 a[94:95], v241 offset:2312
    v_mfma_f32_16x16x32_bf16 v[24:27], a[96:99], a[120:123], v[24:27]
    buffer_load_dwordx4 v203, s[12:15], s60 offen offset:3072  lds
    v_mfma_f32_16x16x32_bf16 v[56:59], a[96:99], a[124:127], v[56:59]
    s_add_u32 m0, s83, 69632
    s_add_u32 s60, s81, 896
    v_mfma_f32_16x16x32_bf16 a[8:11], a[96:99], a[128:131], a[8:11]
    v_mfma_f32_16x16x32_bf16 a[40:43], a[96:99], a[132:135], a[40:43]
    v_mfma_f32_16x16x32_bf16 v[8:11], a[96:99], a[136:139], v[8:11]
    ds_read_b64_tr_b16 a[96:97], v242 offset:256
    ds_read_b64_tr_b16 a[98:99], v242 offset:2304
    v_mfma_f32_16x16x32_bf16 v[28:31], a[100:103], a[120:123], v[28:31]
    buffer_load_dwordx4 v204, s[8:11], s60 offen offset:0 nt lds
    v_mfma_f32_16x16x32_bf16 v[60:63], a[100:103], a[124:127], v[60:63]
    v_add_u32 v251, 139264, v208
    v_mfma_f32_16x16x32_bf16 a[12:15], a[100:103], a[128:131], a[12:15]
    ds_read_b128 a[192:195], v251 offset:0
    ds_read_b128 a[208:211], v251 offset:4096
    v_mfma_f32_16x16x32_bf16 a[44:47], a[100:103], a[132:135], a[44:47]
    v_add_u32 v252, 139264, v209
    v_mfma_f32_16x16x32_bf16 v[12:15], a[100:103], a[136:139], v[12:15]
    ds_read_b64_tr_b16 a[100:101], v242 offset:264
    ds_read_b64_tr_b16 a[102:103], v242 offset:2312
    v_mfma_f32_16x16x32_bf16 v[32:35], a[104:107], a[120:123], v[32:35]
    buffer_load_dwordx4 v205, s[8:11], s60 offen offset:1024 nt lds
    v_mfma_f32_16x16x32_bf16 v[64:67], a[104:107], a[124:127], v[64:67]
    ds_read_b128 a[196:199], v252 offset:0
    ds_read_b128 a[212:215], v252 offset:4096
    v_mfma_f32_16x16x32_bf16 a[16:19], a[104:107], a[128:131], a[16:19]
    v_add_u32 v251, 139264, v210
    v_mfma_f32_16x16x32_bf16 a[48:51], a[104:107], a[132:135], a[48:51]
    ds_read_b64_tr_b16 a[104:105], v243 offset:256
    ds_read_b64_tr_b16 a[106:107], v243 offset:2304
    v_mfma_f32_16x16x32_bf16 v[36:39], a[108:111], a[120:123], v[36:39]
    ds_read_b128 a[200:203], v251 offset:0
    ds_read_b128 a[216:219], v251 offset:4096
    v_mfma_f32_16x16x32_bf16 v[68:71], a[108:111], a[124:127], v[68:71]
    buffer_load_dwordx4 v206, s[8:11], s60 offen offset:2048 nt lds
    v_mfma_f32_16x16x32_bf16 a[20:23], a[108:111], a[128:131], a[20:23]
    v_add_u32 v252, 139264, v211
    v_mfma_f32_16x16x32_bf16 a[52:55], a[108:111], a[132:135], a[52:55]
    s_waitcnt lgkmcnt(6)
    ds_read_b64_tr_b16 a[108:109], v243 offset:264
    ds_read_b64_tr_b16 a[110:111], v243 offset:2312
    v_mfma_f32_16x16x32_bf16 v[40:43], a[112:115], a[120:123], v[40:43]
    ds_read_b128 a[204:207], v252 offset:0
    ds_read_b128 a[220:223], v252 offset:4096
    v_mfma_f32_16x16x32_bf16 v[72:75], a[112:115], a[124:127], v[72:75]
    v_mfma_f32_16x16x32_bf16 a[24:27], a[112:115], a[128:131], a[24:27]
    buffer_load_dwordx4 v207, s[8:11], s60 offen offset:3072 nt lds
    v_mfma_f32_16x16x32_bf16 a[56:59], a[112:115], a[132:135], a[56:59]
    s_add_u32 m0, s83, 73728
    ds_read_b64_tr_b16 a[112:113], v244 offset:256
    ds_read_b64_tr_b16 a[114:115], v244 offset:2304
    v_mfma_f32_16x16x32_bf16 v[44:47], a[116:119], a[120:123], v[44:47]
    s_add_u32 s60, s81, 33664
    v_mfma_f32_16x16x32_bf16 v[76:79], a[116:119], a[124:127], v[76:79]
    v_mfma_f32_16x16x32_bf16 a[28:31], a[116:119], a[128:131], a[28:31]
    v_mfma_f32_16x16x32_bf16 a[60:63], a[116:119], a[132:135], a[60:63]
    ds_read_b64_tr_b16 a[116:117], v244 offset:264
    ds_read_b64_tr_b16 a[118:119], v244 offset:2312
    v_mfma_f32_16x16x32_bf16 v[80:83], a[88:91], a[120:123], v[80:83]
    buffer_load_dwordx4 v204, s[8:11], s60 offen offset:0 nt lds
    v_mfma_f32_16x16x32_bf16 v[112:115], a[88:91], a[124:127], v[112:115]
    v_mfma_f32_16x16x32_bf16 v[144:147], a[88:91], a[128:131], v[144:147]
    v_mfma_f32_16x16x32_bf16 v[168:171], a[88:91], a[132:135], v[168:171]
    v_mfma_f32_16x16x32_bf16 v[152:155], a[88:91], a[136:139], v[152:155]
    ds_read_b64_tr_b16 a[88:89], v241 offset:16384
    ds_read_b64_tr_b16 a[90:91], v241 offset:18432
    v_mfma_f32_16x16x32_bf16 v[84:87], a[92:95], a[120:123], v[84:87]
    buffer_load_dwordx4 v205, s[8:11], s60 offen offset:1024 nt lds
    v_mfma_f32_16x16x32_bf16 v[116:119], a[92:95], a[124:127], v[116:119]
    v_mfma_f32_16x16x32_bf16 v[148:151], a[92:95], a[128:131], v[148:151]
    v_mfma_f32_16x16x32_bf16 v[172:175], a[92:95], a[132:135], v[172:175]
    v_mfma_f32_16x16x32_bf16 v[156:159], a[92:95], a[136:139], v[156:159]
    ds_read_b64_tr_b16 a[92:93], v241 offset:16392
    ds_read_b64_tr_b16 a[94:95], v241 offset:18440
    v_mfma_f32_16x16x32_bf16 v[88:91], a[96:99], a[120:123], v[88:91]
    buffer_load_dwordx4 v206, s[8:11], s60 offen offset:2048 nt lds
    v_mfma_f32_16x16x32_bf16 v[120:123], a[96:99], a[124:127], v[120:123]
    v_mfma_f32_16x16x32_bf16 a[64:67], a[96:99], a[128:131], a[64:67]
    v_mfma_f32_16x16x32_bf16 v[176:179], a[96:99], a[132:135], v[176:179]
    v_mfma_f32_16x16x32_bf16 v[160:163], a[96:99], a[136:139], v[160:163]
    ds_read_b64_tr_b16 a[96:97], v242 offset:16384
    ds_read_b64_tr_b16 a[98:99], v242 offset:18432
    v_mfma_f32_16x16x32_bf16 v[92:95], a[100:103], a[120:123], v[92:95]
    buffer_load_dwordx4 v207, s[8:11], s60 offen offset:3072 nt lds
    v_mfma_f32_16x16x32_bf16 v[124:127], a[100:103], a[124:127], v[124:127]
    s_add_u32 m0, s84, 69632
    s_mov_b32 s60, 896
    v_mfma_f32_16x16x32_bf16 a[68:71], a[100:103], a[128:131], a[68:71]
    v_mfma_f32_16x16x32_bf16 v[180:183], a[100:103], a[132:135], v[180:183]
    v_mfma_f32_16x16x32_bf16 v[164:167], a[100:103], a[136:139], v[164:167]
    s_waitcnt lgkmcnt(2)
    ds_read_b64_tr_b16 a[100:101], v242 offset:16392
    ds_read_b64_tr_b16 a[102:103], v242 offset:18440
    v_mfma_f32_16x16x32_bf16 v[96:99], a[104:107], a[120:123], v[96:99]
    buffer_load_dwordx4 v240, s[8:11], s60 offen nt lds
    v_mfma_f32_16x16x32_bf16 v[128:131], a[104:107], a[124:127], v[128:131]
    v_mfma_f32_16x16x32_bf16 a[72:75], a[104:107], a[128:131], a[72:75]
    v_mfma_f32_16x16x32_bf16 v[184:187], a[104:107], a[132:135], v[184:187]
    ds_read_b64_tr_b16 a[104:105], v243 offset:16384
    ds_read_b64_tr_b16 a[106:107], v243 offset:18432
    v_mfma_f32_16x16x32_bf16 v[100:103], a[108:111], a[120:123], v[100:103]
    v_mfma_f32_16x16x32_bf16 v[132:135], a[108:111], a[124:127], v[132:135]
    v_mfma_f32_16x16x32_bf16 a[76:79], a[108:111], a[128:131], a[76:79]
    v_mfma_f32_16x16x32_bf16 v[188:191], a[108:111], a[132:135], v[188:191]
    ds_read_b64_tr_b16 a[108:109], v243 offset:16392
    ds_read_b64_tr_b16 a[110:111], v243 offset:18440
    v_mfma_f32_16x16x32_bf16 v[104:107], a[112:115], a[120:123], v[104:107]
    v_mfma_f32_16x16x32_bf16 v[136:139], a[112:115], a[124:127], v[136:139]
    v_mfma_f32_16x16x32_bf16 a[80:83], a[112:115], a[128:131], a[80:83]
    v_mfma_f32_16x16x32_bf16 v[192:195], a[112:115], a[132:135], v[192:195]
    ds_read_b64_tr_b16 a[112:113], v244 offset:16384
    ds_read_b64_tr_b16 a[114:115], v244 offset:18432
    v_mfma_f32_16x16x32_bf16 v[108:111], a[116:119], a[120:123], v[108:111]
    v_mfma_f32_16x16x32_bf16 v[140:143], a[116:119], a[124:127], v[140:143]
    v_mfma_f32_16x16x32_bf16 a[84:87], a[116:119], a[128:131], a[84:87]
    v_mfma_f32_16x16x32_bf16 v[196:199], a[116:119], a[132:135], v[196:199]
    ds_read_b64_tr_b16 a[116:117], v244 offset:16392
    ds_read_b64_tr_b16 a[118:119], v244 offset:18440
    v_mfma_f32_16x16x32_bf16 v[16:19], a[88:91], a[140:143], v[16:19]
    v_mfma_f32_16x16x32_bf16 v[48:51], a[88:91], a[144:147], v[48:51]
    v_mfma_f32_16x16x32_bf16 a[0:3], a[88:91], a[148:151], a[0:3]
    v_mfma_f32_16x16x32_bf16 a[32:35], a[88:91], a[152:155], a[32:35]
    v_mfma_f32_16x16x32_bf16 v[0:3], a[88:91], a[156:159], v[0:3]
    ds_read_b64_tr_b16 a[88:89], v241 offset:16640
    ds_read_b64_tr_b16 a[90:91], v241 offset:18688
    v_mfma_f32_16x16x32_bf16 v[20:23], a[92:95], a[140:143], v[20:23]
    v_mfma_f32_16x16x32_bf16 v[52:55], a[92:95], a[144:147], v[52:55]
    v_mfma_f32_16x16x32_bf16 a[4:7], a[92:95], a[148:151], a[4:7]
    v_mfma_f32_16x16x32_bf16 a[36:39], a[92:95], a[152:155], a[36:39]
    v_mfma_f32_16x16x32_bf16 v[4:7], a[92:95], a[156:159], v[4:7]
    s_waitcnt lgkmcnt(2)
    ds_read_b64_tr_b16 a[92:93], v241 offset:16648
    ds_read_b64_tr_b16 a[94:95], v241 offset:18696
    v_mfma_f32_16x16x32_bf16 v[24:27], a[96:99], a[140:143], v[24:27]
    v_add_u32 v241, 69632, v241
    v_mfma_f32_16x16x32_bf16 v[56:59], a[96:99], a[144:147], v[56:59]
    v_mfma_f32_16x16x32_bf16 a[8:11], a[96:99], a[148:151], a[8:11]
    v_mfma_f32_16x16x32_bf16 a[40:43], a[96:99], a[152:155], a[40:43]
    v_mfma_f32_16x16x32_bf16 v[8:11], a[96:99], a[156:159], v[8:11]
    ds_read_b64_tr_b16 a[96:97], v242 offset:16640
    ds_read_b64_tr_b16 a[98:99], v242 offset:18688
    v_mfma_f32_16x16x32_bf16 v[28:31], a[100:103], a[140:143], v[28:31]
    v_mfma_f32_16x16x32_bf16 v[60:63], a[100:103], a[144:147], v[60:63]
    v_mfma_f32_16x16x32_bf16 a[12:15], a[100:103], a[148:151], a[12:15]
    v_mfma_f32_16x16x32_bf16 a[44:47], a[100:103], a[152:155], a[44:47]
    v_mfma_f32_16x16x32_bf16 v[12:15], a[100:103], a[156:159], v[12:15]
    ds_read_b64_tr_b16 a[100:101], v242 offset:16648
    ds_read_b64_tr_b16 a[102:103], v242 offset:18696
    v_mfma_f32_16x16x32_bf16 v[32:35], a[104:107], a[140:143], v[32:35]
    v_add_u32 v242, 69632, v242
    v_mfma_f32_16x16x32_bf16 v[64:67], a[104:107], a[144:147], v[64:67]
    v_mfma_f32_16x16x32_bf16 a[16:19], a[104:107], a[148:151], a[16:19]
    v_mfma_f32_16x16x32_bf16 a[48:51], a[104:107], a[152:155], a[48:51]
    ds_read_b64_tr_b16 a[104:105], v243 offset:16640
    ds_read_b64_tr_b16 a[106:107], v243 offset:18688
    v_mfma_f32_16x16x32_bf16 v[36:39], a[108:111], a[140:143], v[36:39]
    v_mfma_f32_16x16x32_bf16 v[68:71], a[108:111], a[144:147], v[68:71]
    v_mfma_f32_16x16x32_bf16 a[20:23], a[108:111], a[148:151], a[20:23]
    v_mfma_f32_16x16x32_bf16 a[52:55], a[108:111], a[152:155], a[52:55]
    ds_read_b64_tr_b16 a[108:109], v243 offset:16648
    ds_read_b64_tr_b16 a[110:111], v243 offset:18696
    v_mfma_f32_16x16x32_bf16 v[40:43], a[112:115], a[140:143], v[40:43]
    v_add_u32 v243, 69632, v243
    v_mfma_f32_16x16x32_bf16 v[72:75], a[112:115], a[144:147], v[72:75]
    v_mfma_f32_16x16x32_bf16 a[24:27], a[112:115], a[148:151], a[24:27]
    v_mfma_f32_16x16x32_bf16 a[56:59], a[112:115], a[152:155], a[56:59]
    ds_read_b64_tr_b16 a[112:113], v244 offset:16640
    ds_read_b64_tr_b16 a[114:115], v244 offset:18688
    v_mfma_f32_16x16x32_bf16 v[44:47], a[116:119], a[140:143], v[44:47]
    v_mfma_f32_16x16x32_bf16 v[76:79], a[116:119], a[144:147], v[76:79]
    v_mfma_f32_16x16x32_bf16 a[28:31], a[116:119], a[148:151], a[28:31]
    v_mfma_f32_16x16x32_bf16 a[60:63], a[116:119], a[152:155], a[60:63]
    s_waitcnt lgkmcnt(2)
    ds_read_b64_tr_b16 a[116:117], v244 offset:16648
    ds_read_b64_tr_b16 a[118:119], v244 offset:18696
    v_mfma_f32_16x16x32_bf16 v[80:83], a[88:91], a[140:143], v[80:83]
    v_add_u32 v244, 69632, v244
    v_mfma_f32_16x16x32_bf16 v[112:115], a[88:91], a[144:147], v[112:115]
    v_mfma_f32_16x16x32_bf16 v[144:147], a[88:91], a[148:151], v[144:147]
    v_mfma_f32_16x16x32_bf16 v[168:171], a[88:91], a[152:155], v[168:171]
    v_mfma_f32_16x16x32_bf16 v[152:155], a[88:91], a[156:159], v[152:155]
    v_mfma_f32_16x16x32_bf16 v[84:87], a[92:95], a[140:143], v[84:87]
    v_mfma_f32_16x16x32_bf16 v[116:119], a[92:95], a[144:147], v[116:119]
    v_mfma_f32_16x16x32_bf16 v[148:151], a[92:95], a[148:151], v[148:151]
    v_mfma_f32_16x16x32_bf16 v[172:175], a[92:95], a[152:155], v[172:175]
    v_mfma_f32_16x16x32_bf16 v[156:159], a[92:95], a[156:159], v[156:159]
    v_mfma_f32_16x16x32_bf16 v[88:91], a[96:99], a[140:143], v[88:91]
    s_waitcnt vmcnt(0) lgkmcnt(0)
    s_barrier
    v_mfma_f32_16x16x32_bf16 v[120:123], a[96:99], a[144:147], v[120:123]
    ds_read_b64_tr_b16 a[88:89], v241 offset:0
    ds_read_b64_tr_b16 a[90:91], v241 offset:2048
    v_mfma_f32_16x16x32_bf16 a[64:67], a[96:99], a[148:151], a[64:67]
    ds_read_b128 a[120:123], v245 offset:0
    ds_read_b128 a[124:127], v245 offset:2048
    v_mfma_f32_16x16x32_bf16 v[176:179], a[96:99], a[152:155], v[176:179]
    ds_read_b128 a[128:131], v245 offset:4096
    ds_read_b128 a[132:135], v245 offset:6144
    v_mfma_f32_16x16x32_bf16 v[160:163], a[96:99], a[156:159], v[160:163]
    ds_read_b128 a[136:139], v247
    ds_read_b64_tr_b16 a[92:93], v241 offset:8
    v_mfma_f32_16x16x32_bf16 v[92:95], a[100:103], a[140:143], v[92:95]
    ds_read_b64_tr_b16 a[94:95], v241 offset:2056
    ds_read_b64_tr_b16 a[96:97], v242 offset:0
    v_mfma_f32_16x16x32_bf16 v[124:127], a[100:103], a[144:147], v[124:127]
    ds_read_b64_tr_b16 a[98:99], v242 offset:2048
    v_mfma_f32_16x16x32_bf16 a[68:71], a[100:103], a[148:151], a[68:71]
    global_load_dword v238, v237, s[94:95]
    v_mfma_f32_16x16x32_bf16 v[180:183], a[100:103], a[152:155], v[180:183]
    s_add_u32 m0, s3, 0
    s_xor_b32 s87, s85, s86
    s_add_u32 s85, s85, 4096
    v_mfma_f32_16x16x32_bf16 v[164:167], a[100:103], a[156:159], v[164:167]
    ds_read_b64_tr_b16 a[100:101], v242 offset:8
    ds_read_b64_tr_b16 a[102:103], v242 offset:2056
    v_mfma_f32_16x16x32_bf16 v[96:99], a[104:107], a[140:143], v[96:99]
    v_mfma_f32_16x16x32_bf16 v[128:131], a[104:107], a[144:147], v[128:131]
    v_mfma_f32_16x16x32_bf16 a[72:75], a[104:107], a[148:151], a[72:75]
    v_mfma_f32_16x16x32_bf16 v[184:187], a[104:107], a[152:155], v[184:187]
    ds_read_b64_tr_b16 a[104:105], v243 offset:0
    ds_read_b64_tr_b16 a[106:107], v243 offset:2048
    v_mfma_f32_16x16x32_bf16 v[100:103], a[108:111], a[140:143], v[100:103]
    v_mfma_f32_16x16x32_bf16 v[132:135], a[108:111], a[144:147], v[132:135]
    v_mfma_f32_16x16x32_bf16 a[76:79], a[108:111], a[148:151], a[76:79]
    v_mfma_f32_16x16x32_bf16 v[188:191], a[108:111], a[152:155], v[188:191]
    ds_read_b64_tr_b16 a[108:109], v243 offset:8
    ds_read_b64_tr_b16 a[110:111], v243 offset:2056
    v_mfma_f32_16x16x32_bf16 v[104:107], a[112:115], a[140:143], v[104:107]
    buffer_load_dwordx4 v220, s[20:23], s87 offen nt lds
    v_mfma_f32_16x16x32_bf16 v[136:139], a[112:115], a[144:147], v[136:139]
    s_add_u32 m0, s3, 4096
    s_xor_b32 s87, s85, s86
    s_add_u32 s85, s85, 4096
    v_mfma_f32_16x16x32_bf16 a[80:83], a[112:115], a[148:151], a[80:83]
    v_mfma_f32_16x16x32_bf16 v[192:195], a[112:115], a[152:155], v[192:195]
    ds_read_b64_tr_b16 a[112:113], v244 offset:0
    ds_read_b64_tr_b16 a[114:115], v244 offset:2048
    v_mfma_f32_16x16x32_bf16 v[108:111], a[116:119], a[140:143], v[108:111]
    v_mfma_f32_16x16x32_bf16 v[140:143], a[116:119], a[144:147], v[140:143]
    v_mfma_f32_16x16x32_bf16 a[84:87], a[116:119], a[148:151], a[84:87]
    v_mfma_f32_16x16x32_bf16 v[196:199], a[116:119], a[152:155], v[196:199]
    s_waitcnt lgkmcnt(2)
    ds_read_b64_tr_b16 a[116:117], v244 offset:8
    ds_read_b64_tr_b16 a[118:119], v244 offset:2056
    v_mfma_f32_16x16x32_bf16 v[16:19], a[88:91], a[120:123], v[16:19]
    ds_read_b128 a[140:143], v246 offset:0
    ds_read_b128 a[144:147], v246 offset:2048
    v_mfma_f32_16x16x32_bf16 v[48:51], a[88:91], a[124:127], v[48:51]
    ds_read_b128 a[148:151], v246 offset:4096
    ds_read_b128 a[152:155], v246 offset:6144
    v_mfma_f32_16x16x32_bf16 a[0:3], a[88:91], a[128:131], a[0:3]
    ds_read_b128 a[156:159], v248
    v_mfma_f32_16x16x32_bf16 a[32:35], a[88:91], a[132:135], a[32:35]
    v_mfma_f32_16x16x32_bf16 v[0:3], a[88:91], a[136:139], v[0:3]
    ds_read_b64_tr_b16 a[88:89], v241 offset:256
    ds_read_b64_tr_b16 a[90:91], v241 offset:2304
    v_mfma_f32_16x16x32_bf16 v[20:23], a[92:95], a[120:123], v[20:23]
    v_mfma_f32_16x16x32_bf16 v[52:55], a[92:95], a[124:127], v[52:55]
    v_mfma_f32_16x16x32_bf16 a[4:7], a[92:95], a[128:131], a[4:7]
    v_mfma_f32_16x16x32_bf16 a[36:39], a[92:95], a[132:135], a[36:39]
    v_mfma_f32_16x16x32_bf16 v[4:7], a[92:95], a[136:139], v[4:7]
    ds_read_b64_tr_b16 a[92:93], v241 offset:264
    ds_read_b64_tr_b16 a[94:95], v241 offset:2312
    v_mfma_f32_16x16x32_bf16 v[24:27], a[96:99], a[120:123], v[24:27]
    buffer_load_dwordx4 v220, s[20:23], s87 offen nt lds
    v_mfma_f32_16x16x32_bf16 v[56:59], a[96:99], a[124:127], v[56:59]
    s_add_u32 m0, s3, 8192
    s_xor_b32 s87, s85, s86
    s_add_u32 s85, s85, 4096
    v_mfma_f32_16x16x32_bf16 a[8:11], a[96:99], a[128:131], a[8:11]
    v_mfma_f32_16x16x32_bf16 a[40:43], a[96:99], a[132:135], a[40:43]
    v_mfma_f32_16x16x32_bf16 v[8:11], a[96:99], a[136:139], v[8:11]
    ds_read_b64_tr_b16 a[96:97], v242 offset:256
    ds_read_b64_tr_b16 a[98:99], v242 offset:2304
    v_mfma_f32_16x16x32_bf16 v[28:31], a[100:103], a[120:123], v[28:31]
    v_mfma_f32_16x16x32_bf16 v[60:63], a[100:103], a[124:127], v[60:63]
    v_mfma_f32_16x16x32_bf16 a[12:15], a[100:103], a[128:131], a[12:15]
    v_mfma_f32_16x16x32_bf16 a[44:47], a[100:103], a[132:135], a[44:47]
    v_mfma_f32_16x16x32_bf16 v[12:15], a[100:103], a[136:139], v[12:15]
    ds_read_b64_tr_b16 a[100:101], v242 offset:264
    ds_read_b64_tr_b16 a[102:103], v242 offset:2312
    v_mfma_f32_16x16x32_bf16 v[32:35], a[104:107], a[120:123], v[32:35]
    v_mfma_f32_16x16x32_bf16 v[64:67], a[104:107], a[124:127], v[64:67]
    v_mfma_f32_16x16x32_bf16 a[16:19], a[104:107], a[128:131], a[16:19]
    v_mfma_f32_16x16x32_bf16 a[48:51], a[104:107], a[132:135], a[48:51]
    ds_read_b64_tr_b16 a[104:105], v243 offset:256
    ds_read_b64_tr_b16 a[106:107], v243 offset:2304
    v_mfma_f32_16x16x32_bf16 v[36:39], a[108:111], a[120:123], v[36:39]
    v_mfma_f32_16x16x32_bf16 v[68:71], a[108:111], a[124:127], v[68:71]
    v_mfma_f32_16x16x32_bf16 a[20:23], a[108:111], a[128:131], a[20:23]
    buffer_load_dwordx4 v220, s[20:23], s87 offen nt lds
    v_mfma_f32_16x16x32_bf16 a[52:55], a[108:111], a[132:135], a[52:55]
    s_waitcnt lgkmcnt(2)
    ds_read_b64_tr_b16 a[108:109], v243 offset:264
    ds_read_b64_tr_b16 a[110:111], v243 offset:2312
    v_mfma_f32_16x16x32_bf16 v[40:43], a[112:115], a[120:123], v[40:43]
    s_add_u32 m0, s3, 12288
    s_xor_b32 s87, s85, s86
    s_add_u32 s85, s85, 4096
    v_mfma_f32_16x16x32_bf16 v[72:75], a[112:115], a[124:127], v[72:75]
    v_mfma_f32_16x16x32_bf16 a[24:27], a[112:115], a[128:131], a[24:27]
    v_mfma_f32_16x16x32_bf16 a[56:59], a[112:115], a[132:135], a[56:59]
    ds_read_b64_tr_b16 a[112:113], v244 offset:256
    ds_read_b64_tr_b16 a[114:115], v244 offset:2304
    v_mfma_f32_16x16x32_bf16 v[44:47], a[116:119], a[120:123], v[44:47]
    v_mfma_f32_16x16x32_bf16 v[76:79], a[116:119], a[124:127], v[76:79]
    v_mfma_f32_16x16x32_bf16 a[28:31], a[116:119], a[128:131], a[28:31]
    v_mfma_f32_16x16x32_bf16 a[60:63], a[116:119], a[132:135], a[60:63]
    ds_read_b64_tr_b16 a[116:117], v244 offset:264
    ds_read_b64_tr_b16 a[118:119], v244 offset:2312
    v_mfma_f32_16x16x32_bf16 v[80:83], a[88:91], a[120:123], v[80:83]
    v_mfma_f32_16x16x32_bf16 v[112:115], a[88:91], a[124:127], v[112:115]
    v_mfma_f32_16x16x32_bf16 v[144:147], a[88:91], a[128:131], v[144:147]
    v_mfma_f32_16x16x32_bf16 v[168:171], a[88:91], a[132:135], v[168:171]
    v_mfma_f32_16x16x32_bf16 v[152:155], a[88:91], a[136:139], v[152:155]
    ds_read_b64_tr_b16 a[88:89], v241 offset:16384
    ds_read_b64_tr_b16 a[90:91], v241 offset:18432
    v_mfma_f32_16x16x32_bf16 v[84:87], a[92:95], a[120:123], v[84:87]
    v_mfma_f32_16x16x32_bf16 v[116:119], a[92:95], a[124:127], v[116:119]
    v_mfma_f32_16x16x32_bf16 v[148:151], a[92:95], a[128:131], v[148:151]
    buffer_load_dwordx4 v220, s[20:23], s87 offen nt lds
    v_mfma_f32_16x16x32_bf16 v[172:175], a[92:95], a[132:135], v[172:175]
    s_add_u32 m0, s3, 16384
    s_xor_b32 s87, s37, s86
    s_add_u32 s37, s37, 4096
    v_mfma_f32_16x16x32_bf16 v[156:159], a[92:95], a[136:139], v[156:159]
    ds_read_b64_tr_b16 a[92:93], v241 offset:16392
    ds_read_b64_tr_b16 a[94:95], v241 offset:18440
    v_mfma_f32_16x16x32_bf16 v[88:91], a[96:99], a[120:123], v[88:91]
    v_mfma_f32_16x16x32_bf16 v[120:123], a[96:99], a[124:127], v[120:123]
    v_mfma_f32_16x16x32_bf16 a[64:67], a[96:99], a[128:131], a[64:67]
    v_mfma_f32_16x16x32_bf16 v[176:179], a[96:99], a[132:135], v[176:179]
    v_mfma_f32_16x16x32_bf16 v[160:163], a[96:99], a[136:139], v[160:163]
    ds_read_b64_tr_b16 a[96:97], v242 offset:16384
    ds_read_b64_tr_b16 a[98:99], v242 offset:18432
    v_mfma_f32_16x16x32_bf16 v[92:95], a[100:103], a[120:123], v[92:95]
    v_mfma_f32_16x16x32_bf16 v[124:127], a[100:103], a[124:127], v[124:127]
    v_mfma_f32_16x16x32_bf16 a[68:71], a[100:103], a[128:131], a[68:71]
    v_mfma_f32_16x16x32_bf16 v[180:183], a[100:103], a[132:135], v[180:183]
    v_mfma_f32_16x16x32_bf16 v[164:167], a[100:103], a[136:139], v[164:167]
    s_waitcnt lgkmcnt(2)
    ds_read_b64_tr_b16 a[100:101], v242 offset:16392
    ds_read_b64_tr_b16 a[102:103], v242 offset:18440
    v_mfma_f32_16x16x32_bf16 v[96:99], a[104:107], a[120:123], v[96:99]
    v_mfma_f32_16x16x32_bf16 v[128:131], a[104:107], a[124:127], v[128:131]
    v_mfma_f32_16x16x32_bf16 a[72:75], a[104:107], a[128:131], a[72:75]
    v_mfma_f32_16x16x32_bf16 v[184:187], a[104:107], a[132:135], v[184:187]
    ds_read_b64_tr_b16 a[104:105], v243 offset:16384
    ds_read_b64_tr_b16 a[106:107], v243 offset:18432
    v_mfma_f32_16x16x32_bf16 v[100:103], a[108:111], a[120:123], v[100:103]
    buffer_load_dwordx4 v224, s[24:27], s87 offen nt lds
    v_mfma_f32_16x16x32_bf16 v[132:135], a[108:111], a[124:127], v[132:135]
    s_add_u32 m0, s3, 20480
    s_xor_b32 s87, s37, s86
    s_add_u32 s37, s37, 4096
    v_mfma_f32_16x16x32_bf16 a[76:79], a[108:111], a[128:131], a[76:79]
    v_mfma_f32_16x16x32_bf16 v[188:191], a[108:111], a[132:135], v[188:191]
    ds_read_b64_tr_b16 a[108:109], v243 offset:16392
    ds_read_b64_tr_b16 a[110:111], v243 offset:18440
    v_mfma_f32_16x16x32_bf16 v[104:107], a[112:115], a[120:123], v[104:107]
    v_mfma_f32_16x16x32_bf16 v[136:139], a[112:115], a[124:127], v[136:139]
    v_mfma_f32_16x16x32_bf16 a[80:83], a[112:115], a[128:131], a[80:83]
    v_mfma_f32_16x16x32_bf16 v[192:195], a[112:115], a[132:135], v[192:195]
    ds_read_b64_tr_b16 a[112:113], v244 offset:16384
    ds_read_b64_tr_b16 a[114:115], v244 offset:18432
    v_mfma_f32_16x16x32_bf16 v[108:111], a[116:119], a[120:123], v[108:111]
    v_mfma_f32_16x16x32_bf16 v[140:143], a[116:119], a[124:127], v[140:143]
    v_mfma_f32_16x16x32_bf16 a[84:87], a[116:119], a[128:131], a[84:87]
    v_mfma_f32_16x16x32_bf16 v[196:199], a[116:119], a[132:135], v[196:199]
    ds_read_b64_tr_b16 a[116:117], v244 offset:16392
    ds_read_b64_tr_b16 a[118:119], v244 offset:18440
    v_mfma_f32_16x16x32_bf16 v[16:19], a[88:91], a[140:143], v[16:19]
    v_mfma_f32_16x16x32_bf16 v[48:51], a[88:91], a[144:147], v[48:51]
    v_mfma_f32_16x16x32_bf16 a[0:3], a[88:91], a[148:151], a[0:3]
    v_mfma_f32_16x16x32_bf16 a[32:35], a[88:91], a[152:155], a[32:35]
    v_mfma_f32_16x16x32_bf16 v[0:3], a[88:91], a[156:159], v[0:3]
    ds_read_b64_tr_b16 a[88:89], v241 offset:16640
    ds_read_b64_tr_b16 a[90:91], v241 offset:18688
    v_mfma_f32_16x16x32_bf16 v[20:23], a[92:95], a[140:143], v[20:23]
    buffer_load_dwordx4 v224, s[24:27], s87 offen nt lds
    v_mfma_f32_16x16x32_bf16 v[52:55], a[92:95], a[144:147], v[52:55]
    s_add_u32 m0, s3, 24576
    s_xor_b32 s87, s37, s86
    s_add_u32 s37, s37, 4096
    v_mfma_f32_16x16x32_bf16 a[4:7], a[92:95], a[148:151], a[4:7]
    v_mfma_f32_16x16x32_bf16 a[36:39], a[92:95], a[152:155], a[36:39]
    v_mfma_f32_16x16x32_bf16 v[4:7], a[92:95], a[156:159], v[4:7]
    s_waitcnt lgkmcnt(2)
    ds_read_b64_tr_b16 a[92:93], v241 offset:16648
    ds_read_b64_tr_b16 a[94:95], v241 offset:18696
    v_mfma_f32_16x16x32_bf16 v[24:27], a[96:99], a[140:143], v[24:27]
    v_mfma_f32_16x16x32_bf16 v[56:59], a[96:99], a[144:147], v[56:59]
    v_mfma_f32_16x16x32_bf16 a[8:11], a[96:99], a[148:151], a[8:11]
    v_mfma_f32_16x16x32_bf16 a[40:43], a[96:99], a[152:155], a[40:43]
    v_mfma_f32_16x16x32_bf16 v[8:11], a[96:99], a[156:159], v[8:11]
    ds_read_b64_tr_b16 a[96:97], v242 offset:16640
    ds_read_b64_tr_b16 a[98:99], v242 offset:18688
    v_mfma_f32_16x16x32_bf16 v[28:31], a[100:103], a[140:143], v[28:31]
    v_mfma_f32_16x16x32_bf16 v[60:63], a[100:103], a[144:147], v[60:63]
    v_mfma_f32_16x16x32_bf16 a[12:15], a[100:103], a[148:151], a[12:15]
    v_mfma_f32_16x16x32_bf16 a[44:47], a[100:103], a[152:155], a[44:47]
    v_mfma_f32_16x16x32_bf16 v[12:15], a[100:103], a[156:159], v[12:15]
    ds_read_b64_tr_b16 a[100:101], v242 offset:16648
    ds_read_b64_tr_b16 a[102:103], v242 offset:18696
    v_mfma_f32_16x16x32_bf16 v[32:35], a[104:107], a[140:143], v[32:35]
    v_mfma_f32_16x16x32_bf16 v[64:67], a[104:107], a[144:147], v[64:67]
    v_mfma_f32_16x16x32_bf16 a[16:19], a[104:107], a[148:151], a[16:19]
    buffer_load_dwordx4 v224, s[24:27], s87 offen nt lds
    v_mfma_f32_16x16x32_bf16 a[48:51], a[104:107], a[152:155], a[48:51]
    s_add_u32 m0, s3, 28672
    ds_read_b64_tr_b16 a[104:105], v243 offset:16640
    ds_read_b64_tr_b16 a[106:107], v243 offset:18688
    v_mfma_f32_16x16x32_bf16 v[36:39], a[108:111], a[140:143], v[36:39]
    s_xor_b32 s87, s37, s86
    s_add_u32 s37, s37, 4096
    v_mfma_f32_16x16x32_bf16 v[68:71], a[108:111], a[144:147], v[68:71]
    v_mfma_f32_16x16x32_bf16 a[20:23], a[108:111], a[148:151], a[20:23]
    v_mfma_f32_16x16x32_bf16 a[52:55], a[108:111], a[152:155], a[52:55]
    ds_read_b64_tr_b16 a[108:109], v243 offset:16648
    ds_read_b64_tr_b16 a[110:111], v243 offset:18696
    v_mfma_f32_16x16x32_bf16 v[40:43], a[112:115], a[140:143], v[40:43]
    v_mfma_f32_16x16x32_bf16 v[72:75], a[112:115], a[144:147], v[72:75]
    v_mfma_f32_16x16x32_bf16 a[24:27], a[112:115], a[148:151], a[24:27]
    v_mfma_f32_16x16x32_bf16 a[56:59], a[112:115], a[152:155], a[56:59]
    ds_read_b64_tr_b16 a[112:113], v244 offset:16640
    ds_read_b64_tr_b16 a[114:115], v244 offset:18688
    v_mfma_f32_16x16x32_bf16 v[44:47], a[116:119], a[140:143], v[44:47]
    v_mfma_f32_16x16x32_bf16 v[76:79], a[116:119], a[144:147], v[76:79]
    v_mfma_f32_16x16x32_bf16 a[28:31], a[116:119], a[148:151], a[28:31]
    v_mfma_f32_16x16x32_bf16 a[60:63], a[116:119], a[152:155], a[60:63]
    s_waitcnt lgkmcnt(2)
    ds_read_b64_tr_b16 a[116:117], v244 offset:16648
    ds_read_b64_tr_b16 a[118:119], v244 offset:18696
    v_mfma_f32_16x16x32_bf16 v[80:83], a[88:91], a[140:143], v[80:83]
    v_mfma_f32_16x16x32_bf16 v[112:115], a[88:91], a[144:147], v[112:115]
    v_mfma_f32_16x16x32_bf16 v[144:147], a[88:91], a[148:151], v[144:147]
    v_mfma_f32_16x16x32_bf16 v[168:171], a[88:91], a[152:155], v[168:171]
    buffer_load_dwordx4 v224, s[24:27], s87 offen nt lds
    v_mfma_f32_16x16x32_bf16 v[152:155], a[88:91], a[156:159], v[152:155]
    v_mfma_f32_16x16x32_bf16 v[84:87], a[92:95], a[140:143], v[84:87]
    v_mfma_f32_16x16x32_bf16 v[116:119], a[92:95], a[144:147], v[116:119]
    v_mfma_f32_16x16x32_bf16 v[148:151], a[92:95], a[148:151], v[148:151]
    v_mfma_f32_16x16x32_bf16 v[172:175], a[92:95], a[152:155], v[172:175]
    v_mfma_f32_16x16x32_bf16 v[156:159], a[92:95], a[156:159], v[156:159]
    v_mfma_f32_16x16x32_bf16 v[88:91], a[96:99], a[140:143], v[88:91]
    v_mfma_f32_16x16x32_bf16 v[120:123], a[96:99], a[144:147], v[120:123]
    v_mfma_f32_16x16x32_bf16 a[64:67], a[96:99], a[148:151], a[64:67]
    v_mfma_f32_16x16x32_bf16 v[176:179], a[96:99], a[152:155], v[176:179]
    v_mfma_f32_16x16x32_bf16 v[160:163], a[96:99], a[156:159], v[160:163]
    v_mfma_f32_16x16x32_bf16 v[92:95], a[100:103], a[140:143], v[92:95]
    v_mfma_f32_16x16x32_bf16 v[124:127], a[100:103], a[144:147], v[124:127]
    v_mfma_f32_16x16x32_bf16 a[68:71], a[100:103], a[148:151], a[68:71]
    v_mfma_f32_16x16x32_bf16 v[180:183], a[100:103], a[152:155], v[180:183]
    v_mfma_f32_16x16x32_bf16 v[164:167], a[100:103], a[156:159], v[164:167]
    v_mfma_f32_16x16x32_bf16 v[96:99], a[104:107], a[140:143], v[96:99]
    v_mfma_f32_16x16x32_bf16 v[128:131], a[104:107], a[144:147], v[128:131]
    v_mfma_f32_16x16x32_bf16 a[72:75], a[104:107], a[148:151], a[72:75]
    v_mfma_f32_16x16x32_bf16 v[184:187], a[104:107], a[152:155], v[184:187]
    v_mfma_f32_16x16x32_bf16 v[100:103], a[108:111], a[140:143], v[100:103]
    v_mfma_f32_16x16x32_bf16 v[132:135], a[108:111], a[144:147], v[132:135]
    v_mfma_f32_16x16x32_bf16 a[76:79], a[108:111], a[148:151], a[76:79]
    v_mfma_f32_16x16x32_bf16 v[188:191], a[108:111], a[152:155], v[188:191]
    s_waitcnt lgkmcnt(0)
    v_mfma_f32_16x16x32_bf16 v[104:107], a[112:115], a[140:143], v[104:107]
    v_mfma_f32_16x16x32_bf16 v[136:139], a[112:115], a[144:147], v[136:139]
    v_mfma_f32_16x16x32_bf16 a[80:83], a[112:115], a[148:151], a[80:83]
    v_mfma_f32_16x16x32_bf16 v[192:195], a[112:115], a[152:155], v[192:195]
    v_mfma_f32_16x16x32_bf16 v[108:111], a[116:119], a[140:143], v[108:111]
    v_mfma_f32_16x16x32_bf16 v[140:143], a[116:119], a[144:147], v[140:143]
    v_mfma_f32_16x16x32_bf16 a[84:87], a[116:119], a[148:151], a[84:87]
    v_mfma_f32_16x16x32_bf16 v[196:199], a[116:119], a[152:155], v[196:199]
    s_mov_b32 s68, 0x3e0293ee
    s_mov_b32 s69, 0x3e0293ee
    s_add_u32 s60, s47, 147456
    v_add_u32 v240, s60, v233
    v_xor_b32 v241, 4096, v240
    s_nop 3
    v_pk_mul_f32 v[152:153], v[152:153], s[68:69]
    v_pk_mul_f32 v[154:155], v[154:155], s[68:69]
    v_pk_mul_f32 v[156:157], v[156:157], s[68:69]
    v_pk_mul_f32 v[158:159], v[158:159], s[68:69]
    v_cvt_pk_bf16_f32 v152, v152, v153
    v_cvt_pk_bf16_f32 v153, v154, v155
    v_cvt_pk_bf16_f32 v154, v156, v157
    v_cvt_pk_bf16_f32 v155, v158, v159
    ds_write_b128 v240, v[152:155] offset:2048
    v_accvgpr_write_b32 a176, v152
    v_accvgpr_write_b32 a177, v153
    v_accvgpr_write_b32 a178, v154
    v_accvgpr_write_b32 a179, v155
    v_pk_mul_f32 v[160:161], v[160:161], s[68:69]
    v_pk_mul_f32 v[162:163], v[162:163], s[68:69]
    v_pk_mul_f32 v[164:165], v[164:165], s[68:69]
    v_pk_mul_f32 v[166:167], v[166:167], s[68:69]
    v_cvt_pk_bf16_f32 v160, v160, v161
    v_cvt_pk_bf16_f32 v161, v162, v163
    v_cvt_pk_bf16_f32 v162, v164, v165
    v_cvt_pk_bf16_f32 v163, v166, v167
    ds_write_b128 v240, v[160:163] offset:3072
    v_accvgpr_write_b32 a180, v160
    v_accvgpr_write_b32 a181, v161
    v_accvgpr_write_b32 a182, v162
    v_accvgpr_write_b32 a183, v163
    v_pk_mul_f32 v[168:169], v[168:169], s[68:69]
    v_pk_mul_f32 v[170:171], v[170:171], s[68:69]
    v_pk_mul_f32 v[172:173], v[172:173], s[68:69]
    v_pk_mul_f32 v[174:175], v[174:175], s[68:69]
    v_cvt_pk_bf16_f32 v168, v168, v169
    v_cvt_pk_bf16_f32 v169, v170, v171
    v_cvt_pk_bf16_f32 v170, v172, v173
    s_add_u32 m0, s3, 32768
    s_xor_b32 s87, s85, s86
    s_add_u32 s85, s85, 4096
    buffer_load_dwordx4 v220, s[20:23], s87 offen nt lds
    v_cvt_pk_bf16_f32 v171, v174, v175
    v_accvgpr_write_b32 a160, v168
    v_accvgpr_write_b32 a161, v169
    v_accvgpr_write_b32 a162, v170
    v_accvgpr_write_b32 a163, v171
    v_pk_mul_f32 v[176:177], v[176:177], s[68:69]
    v_pk_mul_f32 v[178:179], v[178:179], s[68:69]
    v_pk_mul_f32 v[180:181], v[180:181], s[68:69]
    v_pk_mul_f32 v[182:183], v[182:183], s[68:69]
    v_cvt_pk_bf16_f32 v176, v176, v177
    v_cvt_pk_bf16_f32 v177, v178, v179
    v_cvt_pk_bf16_f32 v178, v180, v181
    v_cvt_pk_bf16_f32 v179, v182, v183
    v_accvgpr_write_b32 a164, v176
    v_accvgpr_write_b32 a165, v177
    v_accvgpr_write_b32 a166, v178
    v_accvgpr_write_b32 a167, v179
    v_pk_mul_f32 v[184:185], v[184:185], s[68:69]
    v_pk_mul_f32 v[186:187], v[186:187], s[68:69]
    v_pk_mul_f32 v[188:189], v[188:189], s[68:69]
    v_pk_mul_f32 v[190:191], v[190:191], s[68:69]
    v_cvt_pk_bf16_f32 v184, v184, v185
    v_cvt_pk_bf16_f32 v185, v186, v187
    v_cvt_pk_bf16_f32 v186, v188, v189
    v_cvt_pk_bf16_f32 v187, v190, v191
    v_accvgpr_write_b32 a168, v184
    v_accvgpr_write_b32 a169, v185
    v_accvgpr_write_b32 a170, v186
    v_accvgpr_write_b32 a171, v187
    v_pk_mul_f32 v[192:193], v[192:193], s[68:69]
    v_pk_mul_f32 v[194:195], v[194:195], s[68:69]
    v_pk_mul_f32 v[196:197], v[196:197], s[68:69]
    v_pk_mul_f32 v[198:199], v[198:199], s[68:69]
    s_add_u32 m0, s3, 36864
    s_xor_b32 s87, s85, s86
    s_add_u32 s85, s85, 4096
    buffer_load_dwordx4 v220, s[20:23], s87 offen nt lds
    v_cvt_pk_bf16_f32 v192, v192, v193
    v_cvt_pk_bf16_f32 v193, v194, v195
    v_cvt_pk_bf16_f32 v194, v196, v197
    v_cvt_pk_bf16_f32 v195, v198, v199
    v_accvgpr_write_b32 a172, v192
    v_accvgpr_write_b32 a173, v193
    v_accvgpr_write_b32 a174, v194
    v_accvgpr_write_b32 a175, v195
    v_pk_mul_f32 v[80:81], v[80:81], s[68:69]
    v_pk_mul_f32 v[82:83], v[82:83], s[68:69]
    v_pk_mul_f32 v[84:85], v[84:85], s[68:69]
    v_pk_mul_f32 v[86:87], v[86:87], s[68:69]
    v_cvt_pk_bf16_f32 v160, v80, v81
    v_cvt_pk_bf16_f32 v161, v82, v83
    v_cvt_pk_bf16_f32 v162, v84, v85
    v_cvt_pk_bf16_f32 v163, v86, v87
    v_pk_mul_f32 v[88:89], v[88:89], s[68:69]
    v_pk_mul_f32 v[90:91], v[90:91], s[68:69]
    v_pk_mul_f32 v[92:93], v[92:93], s[68:69]
    v_pk_mul_f32 v[94:95], v[94:95], s[68:69]
    v_cvt_pk_bf16_f32 v164, v88, v89
    v_cvt_pk_bf16_f32 v165, v90, v91
    v_cvt_pk_bf16_f32 v166, v92, v93
    v_cvt_pk_bf16_f32 v167, v94, v95
    v_pk_mul_f32 v[96:97], v[96:97], s[68:69]
    v_pk_mul_f32 v[98:99], v[98:99], s[68:69]
    v_pk_mul_f32 v[100:101], v[100:101], s[68:69]
    v_pk_mul_f32 v[102:103], v[102:103], s[68:69]
    v_cvt_pk_bf16_f32 v168, v96, v97
    v_cvt_pk_bf16_f32 v169, v98, v99
    v_cvt_pk_bf16_f32 v170, v100, v101
    v_cvt_pk_bf16_f32 v171, v102, v103
    v_pk_mul_f32 v[104:105], v[104:105], s[68:69]
    s_add_u32 m0, s3, 40960
    s_xor_b32 s87, s85, s86
    s_add_u32 s85, s85, 4096
    buffer_load_dwordx4 v220, s[20:23], s87 offen nt lds
    v_pk_mul_f32 v[106:107], v[106:107], s[68:69]
    v_pk_mul_f32 v[108:109], v[108:109], s[68:69]
    v_pk_mul_f32 v[110:111], v[110:111], s[68:69]
    v_cvt_pk_bf16_f32 v172, v104, v105
    v_cvt_pk_bf16_f32 v173, v106, v107
    v_cvt_pk_bf16_f32 v174, v108, v109
    v_cvt_pk_bf16_f32 v175, v110, v111
    v_pk_mul_f32 v[112:113], v[112:113], s[68:69]
    v_pk_mul_f32 v[114:115], v[114:115], s[68:69]
    v_pk_mul_f32 v[116:117], v[116:117], s[68:69]
    v_pk_mul_f32 v[118:119], v[118:119], s[68:69]
    v_cvt_pk_bf16_f32 v176, v112, v113
    v_cvt_pk_bf16_f32 v177, v114, v115
    v_cvt_pk_bf16_f32 v178, v116, v117
    v_cvt_pk_bf16_f32 v179, v118, v119
    v_pk_mul_f32 v[120:121], v[120:121], s[68:69]
    v_pk_mul_f32 v[122:123], v[122:123], s[68:69]
    v_pk_mul_f32 v[124:125], v[124:125], s[68:69]
    v_pk_mul_f32 v[126:127], v[126:127], s[68:69]
    v_cvt_pk_bf16_f32 v180, v120, v121
    v_cvt_pk_bf16_f32 v181, v122, v123
    v_cvt_pk_bf16_f32 v182, v124, v125
    v_cvt_pk_bf16_f32 v183, v126, v127
    v_pk_mul_f32 v[128:129], v[128:129], s[68:69]
    v_pk_mul_f32 v[130:131], v[130:131], s[68:69]
    v_pk_mul_f32 v[132:133], v[132:133], s[68:69]
    v_pk_mul_f32 v[134:135], v[134:135], s[68:69]
    v_cvt_pk_bf16_f32 v184, v128, v129
    v_cvt_pk_bf16_f32 v185, v130, v131
    v_cvt_pk_bf16_f32 v186, v132, v133
    v_cvt_pk_bf16_f32 v187, v134, v135
    v_pk_mul_f32 v[136:137], v[136:137], s[68:69]
    v_pk_mul_f32 v[138:139], v[138:139], s[68:69]
    s_add_u32 m0, s3, 45056
    s_xor_b32 s87, s85, s86
    s_add_u32 s85, s85, 4096
    buffer_load_dwordx4 v220, s[20:23], s87 offen nt lds
    v_pk_mul_f32 v[140:141], v[140:141], s[68:69]
    v_pk_mul_f32 v[142:143], v[142:143], s[68:69]
    v_cvt_pk_bf16_f32 v188, v136, v137
    v_cvt_pk_bf16_f32 v189, v138, v139
    v_cvt_pk_bf16_f32 v190, v140, v141
    v_cvt_pk_bf16_f32 v191, v142, v143
    v_pk_mul_f32 v[144:145], v[144:145], s[68:69]
    v_pk_mul_f32 v[146:147], v[146:147], s[68:69]
    v_pk_mul_f32 v[148:149], v[148:149], s[68:69]
    v_pk_mul_f32 v[150:151], v[150:151], s[68:69]
    v_cvt_pk_bf16_f32 v192, v144, v145
    v_cvt_pk_bf16_f32 v193, v146, v147
    v_cvt_pk_bf16_f32 v194, v148, v149
    v_cvt_pk_bf16_f32 v195, v150, v151
    v_pk_mul_f32 v[0:1], v[0:1], s[68:69]
    v_pk_mul_f32 v[2:3], v[2:3], s[68:69]
    v_pk_mul_f32 v[4:5], v[4:5], s[68:69]
    v_pk_mul_f32 v[6:7], v[6:7], s[68:69]
    v_cvt_pk_bf16_f32 v144, v0, v1
    v_cvt_pk_bf16_f32 v145, v2, v3
    v_cvt_pk_bf16_f32 v146, v4, v5
    v_cvt_pk_bf16_f32 v147, v6, v7
    ds_write_b128 v240, v[144:147] offset:0
    v_pk_mul_f32 v[8:9], v[8:9], s[68:69]
    v_pk_mul_f32 v[10:11], v[10:11], s[68:69]
    v_pk_mul_f32 v[12:13], v[12:13], s[68:69]
    v_pk_mul_f32 v[14:15], v[14:15], s[68:69]
    v_cvt_pk_bf16_f32 v148, v8, v9
    v_cvt_pk_bf16_f32 v149, v10, v11
    v_cvt_pk_bf16_f32 v150, v12, v13
    v_cvt_pk_bf16_f32 v151, v14, v15
    ds_write_b128 v240, v[148:151] offset:1024
    s_waitcnt lgkmcnt(0)
    s_barrier
    ds_read_b128 v[152:155], v241 offset:0
    ds_read_b128 v[156:159], v241 offset:1024
    ds_read_b128 a[184:187], v241 offset:2048
    ds_read_b128 a[188:191], v241 offset:3072
    v_pk_mul_f32 v[16:17], v[16:17], s[68:69]
    v_pk_mul_f32 v[18:19], v[18:19], s[68:69]
    v_pk_mul_f32 v[20:21], v[20:21], s[68:69]
    v_pk_mul_f32 v[22:23], v[22:23], s[68:69]
    v_cvt_pk_bf16_f32 v80, v16, v17
    v_cvt_pk_bf16_f32 v81, v18, v19
    v_cvt_pk_bf16_f32 v82, v20, v21
    v_cvt_pk_bf16_f32 v83, v22, v23
    v_pk_mul_f32 v[24:25], v[24:25], s[68:69]
    v_pk_mul_f32 v[26:27], v[26:27], s[68:69]
    v_pk_mul_f32 v[28:29], v[28:29], s[68:69]
    v_pk_mul_f32 v[30:31], v[30:31], s[68:69]
    v_cvt_pk_bf16_f32 v84, v24, v25
    v_cvt_pk_bf16_f32 v85, v26, v27
    v_cvt_pk_bf16_f32 v86, v28, v29
    v_cvt_pk_bf16_f32 v87, v30, v31
    v_pk_mul_f32 v[32:33], v[32:33], s[68:69]
    v_pk_mul_f32 v[34:35], v[34:35], s[68:69]
    v_pk_mul_f32 v[36:37], v[36:37], s[68:69]
    v_pk_mul_f32 v[38:39], v[38:39], s[68:69]
    v_cvt_pk_bf16_f32 v88, v32, v33
    v_cvt_pk_bf16_f32 v89, v34, v35
    v_cvt_pk_bf16_f32 v90, v36, v37
    v_cvt_pk_bf16_f32 v91, v38, v39
    v_pk_mul_f32 v[40:41], v[40:41], s[68:69]
    v_pk_mul_f32 v[42:43], v[42:43], s[68:69]
    v_pk_mul_f32 v[44:45], v[44:45], s[68:69]
    v_pk_mul_f32 v[46:47], v[46:47], s[68:69]
    v_cvt_pk_bf16_f32 v92, v40, v41
    v_cvt_pk_bf16_f32 v93, v42, v43
    v_cvt_pk_bf16_f32 v94, v44, v45
    v_cvt_pk_bf16_f32 v95, v46, v47
    v_pk_mul_f32 v[48:49], v[48:49], s[68:69]
    v_pk_mul_f32 v[50:51], v[50:51], s[68:69]
    v_pk_mul_f32 v[52:53], v[52:53], s[68:69]
    v_pk_mul_f32 v[54:55], v[54:55], s[68:69]
    v_cvt_pk_bf16_f32 v96, v48, v49
    v_cvt_pk_bf16_f32 v97, v50, v51
    v_cvt_pk_bf16_f32 v98, v52, v53
    v_cvt_pk_bf16_f32 v99, v54, v55
    v_pk_mul_f32 v[56:57], v[56:57], s[68:69]
    v_pk_mul_f32 v[58:59], v[58:59], s[68:69]
    v_pk_mul_f32 v[60:61], v[60:61], s[68:69]
    v_pk_mul_f32 v[62:63], v[62:63], s[68:69]
    v_cvt_pk_bf16_f32 v100, v56, v57
    v_cvt_pk_bf16_f32 v101, v58, v59
    v_cvt_pk_bf16_f32 v102, v60, v61
    v_cvt_pk_bf16_f32 v103, v62, v63
    s_add_u32 m0, s3, 49152
    s_xor_b32 s87, s37, s86
    s_add_u32 s37, s37, 4096
    buffer_load_dwordx4 v224, s[24:27], s87 offen nt lds
    v_pk_mul_f32 v[64:65], v[64:65], s[68:69]
    v_pk_mul_f32 v[66:67], v[66:67], s[68:69]
    v_pk_mul_f32 v[68:69], v[68:69], s[68:69]
    v_pk_mul_f32 v[70:71], v[70:71], s[68:69]
    v_cvt_pk_bf16_f32 v104, v64, v65
    v_cvt_pk_bf16_f32 v105, v66, v67
    v_cvt_pk_bf16_f32 v106, v68, v69
    v_cvt_pk_bf16_f32 v107, v70, v71
    v_pk_mul_f32 v[72:73], v[72:73], s[68:69]
    v_pk_mul_f32 v[74:75], v[74:75], s[68:69]
    v_pk_mul_f32 v[76:77], v[76:77], s[68:69]
    v_pk_mul_f32 v[78:79], v[78:79], s[68:69]
    v_cvt_pk_bf16_f32 v108, v72, v73
    v_cvt_pk_bf16_f32 v109, v74, v75
    v_cvt_pk_bf16_f32 v110, v76, v77
    v_cvt_pk_bf16_f32 v111, v78, v79
    v_accvgpr_read_b32 v244, a0
    v_accvgpr_read_b32 v245, a1
    v_accvgpr_read_b32 v246, a2
    v_accvgpr_read_b32 v247, a3
    v_accvgpr_read_b32 v248, a4
    v_accvgpr_read_b32 v249, a5
    v_accvgpr_read_b32 v250, a6
    v_accvgpr_read_b32 v251, a7
    v_pk_mul_f32 v[244:245], v[244:245], s[68:69]
    v_pk_mul_f32 v[246:247], v[246:247], s[68:69]
    v_pk_mul_f32 v[248:249], v[248:249], s[68:69]
    v_pk_mul_f32 v[250:251], v[250:251], s[68:69]
    v_cvt_pk_bf16_f32 v112, v244, v245
    v_cvt_pk_bf16_f32 v113, v246, v247
    v_cvt_pk_bf16_f32 v114, v248, v249
    v_cvt_pk_bf16_f32 v115, v250, v251
    v_accvgpr_read_b32 v244, a8
    v_accvgpr_read_b32 v245, a9
    v_accvgpr_read_b32 v246, a10
    v_accvgpr_read_b32 v247, a11
    v_accvgpr_read_b32 v248, a12
    v_accvgpr_read_b32 v249, a13
    v_accvgpr_read_b32 v250, a14
    v_accvgpr_read_b32 v251, a15
    v_pk_mul_f32 v[244:245], v[244:245], s[68:69]
    v_pk_mul_f32 v[246:247], v[246:247], s[68:69]
    v_pk_mul_f32 v[248:249], v[248:249], s[68:69]
    v_pk_mul_f32 v[250:251], v[250:251], s[68:69]
    v_cvt_pk_bf16_f32 v116, v244, v245
    v_cvt_pk_bf16_f32 v117, v246, v247
    v_cvt_pk_bf16_f32 v118, v248, v249
    v_cvt_pk_bf16_f32 v119, v250, v251
    s_add_u32 m0, s3, 53248
    s_xor_b32 s87, s37, s86
    s_add_u32 s37, s37, 4096
    buffer_load_dwordx4 v224, s[24:27], s87 offen nt lds
    v_accvgpr_read_b32 v244, a16
    v_accvgpr_read_b32 v245, a17
    v_accvgpr_read_b32 v246, a18
    v_accvgpr_read_b32 v247, a19
    v_accvgpr_read_b32 v248, a20
    v_accvgpr_read_b32 v249, a21
    v_accvgpr_read_b32 v250, a22
    v_accvgpr_read_b32 v251, a23
    v_pk_mul_f32 v[244:245], v[244:245], s[68:69]
    v_pk_mul_f32 v[246:247], v[246:247], s[68:69]
    v_pk_mul_f32 v[248:249], v[248:249], s[68:69]
    v_pk_mul_f32 v[250:251], v[250:251], s[68:69]
    v_cvt_pk_bf16_f32 v120, v244, v245
    v_cvt_pk_bf16_f32 v121, v246, v247
    v_cvt_pk_bf16_f32 v122, v248, v249
    v_cvt_pk_bf16_f32 v123, v250, v251
    v_accvgpr_read_b32 v244, a24
    v_accvgpr_read_b32 v245, a25
    v_accvgpr_read_b32 v246, a26
    v_accvgpr_read_b32 v247, a27
    v_accvgpr_read_b32 v248, a28
    v_accvgpr_read_b32 v249, a29
    v_accvgpr_read_b32 v250, a30
    v_accvgpr_read_b32 v251, a31
    v_pk_mul_f32 v[244:245], v[244:245], s[68:69]
    v_pk_mul_f32 v[246:247], v[246:247], s[68:69]
    v_pk_mul_f32 v[248:249], v[248:249], s[68:69]
    v_pk_mul_f32 v[250:251], v[250:251], s[68:69]
    v_cvt_pk_bf16_f32 v124, v244, v245
    v_cvt_pk_bf16_f32 v125, v246, v247
    v_cvt_pk_bf16_f32 v126, v248, v249
    v_cvt_pk_bf16_f32 v127, v250, v251
    v_accvgpr_read_b32 v244, a32
    v_accvgpr_read_b32 v245, a33
    v_accvgpr_read_b32 v246, a34
    v_accvgpr_read_b32 v247, a35
    v_accvgpr_read_b32 v248, a36
    v_accvgpr_read_b32 v249, a37
    v_accvgpr_read_b32 v250, a38
    v_accvgpr_read_b32 v251, a39
    v_pk_mul_f32 v[244:245], v[244:245], s[68:69]
    v_pk_mul_f32 v[246:247], v[246:247], s[68:69]
    v_pk_mul_f32 v[248:249], v[248:249], s[68:69]
    v_pk_mul_f32 v[250:251], v[250:251], s[68:69]
    v_cvt_pk_bf16_f32 v128, v244, v245
    v_cvt_pk_bf16_f32 v129, v246, v247
    v_cvt_pk_bf16_f32 v130, v248, v249
    v_cvt_pk_bf16_f32 v131, v250, v251
    s_add_u32 m0, s3, 57344
    s_xor_b32 s87, s37, s86
    s_add_u32 s37, s37, 4096
    buffer_load_dwordx4 v224, s[24:27], s87 offen nt lds
    v_accvgpr_read_b32 v244, a40
    v_accvgpr_read_b32 v245, a41
    v_accvgpr_read_b32 v246, a42
    v_accvgpr_read_b32 v247, a43
    v_accvgpr_read_b32 v248, a44
    v_accvgpr_read_b32 v249, a45
    v_accvgpr_read_b32 v250, a46
    v_accvgpr_read_b32 v251, a47
    v_pk_mul_f32 v[244:245], v[244:245], s[68:69]
    v_pk_mul_f32 v[246:247], v[246:247], s[68:69]
    v_pk_mul_f32 v[248:249], v[248:249], s[68:69]
    v_pk_mul_f32 v[250:251], v[250:251], s[68:69]
    v_cvt_pk_bf16_f32 v132, v244, v245
    v_cvt_pk_bf16_f32 v133, v246, v247
    v_cvt_pk_bf16_f32 v134, v248, v249
    v_cvt_pk_bf16_f32 v135, v250, v251
    v_accvgpr_read_b32 v244, a48
    v_accvgpr_read_b32 v245, a49
    v_accvgpr_read_b32 v246, a50
    v_accvgpr_read_b32 v247, a51
    v_accvgpr_read_b32 v248, a52
    v_accvgpr_read_b32 v249, a53
    v_accvgpr_read_b32 v250, a54
    v_accvgpr_read_b32 v251, a55
    v_pk_mul_f32 v[244:245], v[244:245], s[68:69]
    v_pk_mul_f32 v[246:247], v[246:247], s[68:69]
    v_pk_mul_f32 v[248:249], v[248:249], s[68:69]
    v_pk_mul_f32 v[250:251], v[250:251], s[68:69]
    v_cvt_pk_bf16_f32 v136, v244, v245
    v_cvt_pk_bf16_f32 v137, v246, v247
    v_cvt_pk_bf16_f32 v138, v248, v249
    v_cvt_pk_bf16_f32 v139, v250, v251
    v_accvgpr_read_b32 v244, a56
    v_accvgpr_read_b32 v245, a57
    v_accvgpr_read_b32 v246, a58
    v_accvgpr_read_b32 v247, a59
    v_accvgpr_read_b32 v248, a60
    v_accvgpr_read_b32 v249, a61
    v_accvgpr_read_b32 v250, a62
    v_accvgpr_read_b32 v251, a63
    v_pk_mul_f32 v[244:245], v[244:245], s[68:69]
    v_pk_mul_f32 v[246:247], v[246:247], s[68:69]
    v_pk_mul_f32 v[248:249], v[248:249], s[68:69]
    v_pk_mul_f32 v[250:251], v[250:251], s[68:69]
    v_cvt_pk_bf16_f32 v140, v244, v245
    v_cvt_pk_bf16_f32 v141, v246, v247
    v_cvt_pk_bf16_f32 v142, v248, v249
    v_cvt_pk_bf16_f32 v143, v250, v251
    s_add_u32 m0, s3, 61440
    s_xor_b32 s87, s37, s86
    s_add_u32 s37, s37, 4096
    buffer_load_dwordx4 v224, s[24:27], s87 offen nt lds
    v_accvgpr_read_b32 v244, a64
    v_accvgpr_read_b32 v245, a65
    v_accvgpr_read_b32 v246, a66
    v_accvgpr_read_b32 v247, a67
    v_accvgpr_read_b32 v248, a68
    v_accvgpr_read_b32 v249, a69
    v_accvgpr_read_b32 v250, a70
    v_accvgpr_read_b32 v251, a71
    v_pk_mul_f32 v[244:245], v[244:245], s[68:69]
    v_pk_mul_f32 v[246:247], v[246:247], s[68:69]
    v_pk_mul_f32 v[248:249], v[248:249], s[68:69]
    v_pk_mul_f32 v[250:251], v[250:251], s[68:69]
    v_cvt_pk_bf16_f32 v196, v244, v245
    v_cvt_pk_bf16_f32 v197, v246, v247
    v_cvt_pk_bf16_f32 v198, v248, v249
    v_cvt_pk_bf16_f32 v199, v250, v251
    v_accvgpr_read_b32 v244, a72
    v_accvgpr_read_b32 v245, a73
    v_accvgpr_read_b32 v246, a74
    v_accvgpr_read_b32 v247, a75
    v_accvgpr_read_b32 v248, a76
    v_accvgpr_read_b32 v249, a77
    v_accvgpr_read_b32 v250, a78
    v_accvgpr_read_b32 v251, a79
    v_pk_mul_f32 v[244:245], v[244:245], s[68:69]
    v_pk_mul_f32 v[246:247], v[246:247], s[68:69]
    v_pk_mul_f32 v[248:249], v[248:249], s[68:69]
    v_pk_mul_f32 v[250:251], v[250:251], s[68:69]
    v_cvt_pk_bf16_f32 v200, v244, v245
    v_cvt_pk_bf16_f32 v201, v246, v247
    v_cvt_pk_bf16_f32 v202, v248, v249
    v_cvt_pk_bf16_f32 v203, v250, v251
    v_accvgpr_read_b32 v244, a80
    v_accvgpr_read_b32 v245, a81
    v_accvgpr_read_b32 v246, a82
    v_accvgpr_read_b32 v247, a83
    v_accvgpr_read_b32 v248, a84
    v_accvgpr_read_b32 v249, a85
    v_accvgpr_read_b32 v250, a86
    v_accvgpr_read_b32 v251, a87
    v_pk_mul_f32 v[244:245], v[244:245], s[68:69]
    v_pk_mul_f32 v[246:247], v[246:247], s[68:69]
    v_pk_mul_f32 v[248:249], v[248:249], s[68:69]
    v_pk_mul_f32 v[250:251], v[250:251], s[68:69]
    v_cvt_pk_bf16_f32 v204, v244, v245
    v_cvt_pk_bf16_f32 v205, v246, v247
    v_cvt_pk_bf16_f32 v206, v248, v249
    v_cvt_pk_bf16_f32 v207, v250, v251
    v_lshlrev_b32 v237, 7, v232
    v_cmp_gt_u32 vcc, 8, v232
    v_mov_b32 v240, 0x100000
    s_mov_b32 s76, 0
    v_cndmask_b32 v237, v240, v237, vcc
    s_cmp_lg_u32 s75, 0
    s_cselect_b32 s41, 1, 0
    s_cbranch_scc1 MP0
    s_bitcmp1_b32 s36, 0
    s_cbranch_scc1 A1h0_head
A0h0_head:
    s_mov_b32 s39, 16
    s_mov_b32 s2, 7
    s_waitcnt lgkmcnt(0)
    v_mfma_f32_16x16x32_bf16 v[0:3], a[192:195], v[80:83], 0
    v_mfma_f32_16x16x32_bf16 v[0:3], a[196:199], v[84:87], v[0:3]
    v_mfma_f32_16x16x32_bf16 v[0:3], a[200:203], v[88:91], v[0:3]
    v_mfma_f32_16x16x32_bf16 v[0:3], a[204:207], v[92:95], v[0:3]
    s_waitcnt vmcnt(8) lgkmcnt(0)
    s_barrier
    v_mfma_f32_16x16x32_bf16 v[4:7], a[208:211], v[80:83], 0
    s_add_u32 s74, s74, s44
    ds_read_b64_tr_b16 a[224:225], v212 offset:16384
    ds_read_b64_tr_b16 a[226:227], v212 offset:20480
    v_mfma_f32_16x16x32_bf16 v[4:7], a[212:215], v[84:87], v[4:7]
    s_xor_b32 s38, s74, 0x10000
    ds_read_b64_tr_b16 a[248:249], v218 offset:16384
    ds_read_b64_tr_b16 a[250:251], v218 offset:20480
    v_mfma_f32_16x16x32_bf16 v[4:7], a[216:219], v[88:91], v[4:7]
    s_add_u32 s38, s38, s3
    ds_read_b64_tr_b16 a[228:229], v213 offset:16384
    ds_read_b64_tr_b16 a[230:231], v213 offset:20480
    v_mfma_f32_16x16x32_bf16 v[4:7], a[220:223], v[92:95], v[4:7]
    s_add_u32 m0, s38, 0
    ds_read_b64_tr_b16 a[252:253], v219 offset:16384
    ds_read_b64_tr_b16 a[254:255], v219 offset:20480
    v_mfma_f32_16x16x32_bf16 v[8:11], a[192:195], v[96:99], 0
    s_xor_b32 s87, s85, s86
    ds_read_b64_tr_b16 a[232:233], v214 offset:16384
    ds_read_b64_tr_b16 a[234:235], v214 offset:20480
    v_mfma_f32_16x16x32_bf16 v[8:11], a[196:199], v[100:103], v[8:11]
    s_add_u32 s85, s85, 4096
    s_cmp_eq_u32 s74, 0x18000
    s_cselect_b32 s44, s45, s46
    v_mfma_f32_16x16x32_bf16 v[8:11], a[200:203], v[104:107], v[8:11]
    ds_read_b64_tr_b16 a[236:237], v215 offset:16384
    ds_read_b64_tr_b16 a[238:239], v215 offset:20480
    v_max3_f32 v240, v0, v1, v2
    v_max3_f32 v241, v3, v4, v5
    v_max3_f32 v240, v240, v6, v7
    v_max_f32 v240, v240, v241
    v_mfma_f32_16x16x32_bf16 v[8:11], a[204:207], v[108:111], v[8:11]
    buffer_load_dwordx4 v220, s[20:23], s87 offen nt lds
    v_mov_b32 v241, v240
    s_nop 1
    v_permlane32_swap_b32 v240, v241
    v_max_f32 v240, v240, v241
    v_mfma_f32_16x16x32_bf16 v[12:15], a[208:211], v[96:99], 0
    s_add_u32 m0, s38, 4096
    ds_read_b64_tr_b16 a[240:241], v216 offset:16384
    ds_read_b64_tr_b16 a[242:243], v216 offset:20480
    v_mov_b32 v241, v240
    s_nop 1
    v_permlane16_swap_b32 v240, v241
    v_max_f32 v240, v240, v241
    v_mfma_f32_16x16x32_bf16 v[12:15], a[212:215], v[100:103], v[12:15]
    s_xor_b32 s87, s85, s86
    s_add_u32 s85, s85, 4096
    v_sub_f32 v0, v0, v240
    v_sub_f32 v1, v1, v240
    v_sub_f32 v2, v2, v240
    v_sub_f32 v3, v3, v240
    v_sub_f32 v4, v4, v240
    v_sub_f32 v5, v5, v240
    v_mfma_f32_16x16x32_bf16 v[12:15], a[216:219], v[104:107], v[12:15]
    ds_read_b64_tr_b16 a[244:245], v217 offset:16384
    ds_read_b64_tr_b16 a[246:247], v217 offset:20480
    v_sub_f32 v6, v6, v240
    v_sub_f32 v7, v7, v240
    v_sub_f32 v40, 0, v240
    v_sub_f32 v41, 0, v240
    v_sub_f32 v42, 0, v240
    v_mfma_f32_16x16x32_bf16 v[12:15], a[220:223], v[108:111], v[12:15]
    buffer_load_dwordx4 v220, s[20:23], s87 offen nt lds
    v_sub_f32 v43, 0, v240
    v_exp_f32 v0, v0
    v_exp_f32 v1, v1
    v_mfma_f32_16x16x32_bf16 v[16:19], a[192:195], v[112:115], 0
    s_add_u32 m0, s38, 8192
    s_xor_b32 s87, s85, s86
    s_add_u32 s85, s85, 4096
    v_exp_f32 v2, v2
    v_exp_f32 v3, v3
    v_cvt_pk_bf16_f32 v0, v0, v1
    v_mfma_f32_16x16x32_bf16 v[16:19], a[196:199], v[116:119], v[16:19]
    buffer_load_dwordx4 v220, s[20:23], s87 offen nt lds
    v_cvt_pk_bf16_f32 v1, v2, v3
    v_exp_f32 v4, v4
    v_exp_f32 v5, v5
    v_mfma_f32_16x16x32_bf16 v[16:19], a[200:203], v[120:123], v[16:19]
    s_add_u32 m0, s38, 12288
    s_xor_b32 s87, s85, s86
    s_add_u32 s85, s85, 4096
    v_exp_f32 v6, v6
    v_exp_f32 v7, v7
    v_cvt_pk_bf16_f32 v2, v4, v5
    v_mfma_f32_16x16x32_bf16 v[16:19], a[204:207], v[124:127], v[16:19]
    v_cvt_pk_bf16_f32 v3, v6, v7
    v_max3_f32 v242, v8, v9, v10
    v_max3_f32 v243, v11, v12, v13
    v_mfma_f32_16x16x32_bf16 v[20:23], a[208:211], v[112:115], 0
    v_max3_f32 v242, v242, v14, v15
    v_max_f32 v242, v242, v243
    v_mfma_f32_16x16x32_bf16 v[20:23], a[212:215], v[116:119], v[20:23]
    v_mov_b32 v243, v242
    s_nop 1
    v_permlane32_swap_b32 v242, v243
    v_max_f32 v242, v242, v243
    v_mfma_f32_16x16x32_bf16 v[20:23], a[216:219], v[120:123], v[20:23]
    v_mov_b32 v243, v242
    s_nop 1
    v_permlane16_swap_b32 v242, v243
    v_max_f32 v242, v242, v243
    v_mfma_f32_16x16x32_bf16 v[20:23], a[220:223], v[124:127], v[20:23]
    s_waitcnt lgkmcnt(0)
    v_sub_f32 v8, v8, v242
    v_sub_f32 v9, v9, v242
    v_sub_f32 v10, v10, v242
    v_mfma_f32_16x16x32_bf16 a[0:3], a[224:227], v[0:3], 0
    v_sub_f32 v11, v11, v242
    v_sub_f32 v12, v12, v242
    v_sub_f32 v13, v13, v242
    v_mfma_f32_16x16x32_bf16 a[4:7], a[228:231], v[0:3], 0
    buffer_load_dwordx4 v220, s[20:23], s87 offen nt lds
    v_sub_f32 v14, v14, v242
    v_mfma_f32_16x16x32_bf16 a[8:11], a[232:235], v[0:3], 0
    s_add_u32 m0, s38, 16384
    s_xor_b32 s87, s37, s86
    s_add_u32 s37, s37, 4096
    v_sub_f32 v15, v15, v242
    v_max3_f32 v240, v16, v17, v18
    v_mfma_f32_16x16x32_bf16 a[12:15], a[236:239], v[0:3], 0
    v_sub_f32 v44, 0, v242
    v_sub_f32 v45, 0, v242
    v_sub_f32 v46, 0, v242
    v_max3_f32 v241, v19, v20, v21
    v_mfma_f32_16x16x32_bf16 a[16:19], a[240:243], v[0:3], 0
    v_sub_f32 v47, 0, v242
    v_exp_f32 v8, v8
    v_max3_f32 v240, v240, v22, v23
    v_mfma_f32_16x16x32_bf16 a[20:23], a[244:247], v[0:3], 0
    v_exp_f32 v9, v9
    v_max_f32 v240, v240, v241
    v_mfma_f32_16x16x32_bf16 a[24:27], a[248:251], v[0:3], 0
    v_exp_f32 v10, v10
    v_mov_b32 v241, v240
    s_nop 1
    v_permlane32_swap_b32 v240, v241
    v_max_f32 v240, v240, v241
    v_mfma_f32_16x16x32_bf16 a[28:31], a[252:255], v[0:3], 0
    v_exp_f32 v11, v11
    v_cvt_pk_bf16_f32 v8, v8, v9
    v_mfma_f32_16x16x32_bf16 v[60:63], v[228:231], v[0:3], 0
    v_cvt_pk_bf16_f32 v9, v10, v11
    v_exp_f32 v12, v12
    v_mfma_f32_16x16x32_bf16 v[24:27], a[192:195], v[128:131], 0
    v_exp_f32 v13, v13
    v_mov_b32 v241, v240
    s_nop 1
    v_permlane16_swap_b32 v240, v241
    v_max_f32 v240, v240, v241
    v_mfma_f32_16x16x32_bf16 v[24:27], a[196:199], v[132:135], v[24:27]
    v_exp_f32 v14, v14
    v_sub_f32 v16, v16, v240
    v_sub_f32 v17, v17, v240
    v_mfma_f32_16x16x32_bf16 v[24:27], a[200:203], v[136:139], v[24:27]
    v_exp_f32 v15, v15
    v_cvt_pk_bf16_f32 v10, v12, v13
    v_sub_f32 v18, v18, v240
    v_mfma_f32_16x16x32_bf16 v[24:27], a[204:207], v[140:143], v[24:27]
    v_cvt_pk_bf16_f32 v11, v14, v15
    v_sub_f32 v19, v19, v240
    v_sub_f32 v20, v20, v240
    v_sub_f32 v21, v21, v240
    v_mfma_f32_16x16x32_bf16 v[28:31], a[208:211], v[128:131], 0
    buffer_load_dwordx4 v224, s[24:27], s87 offen nt lds
    v_sub_f32 v22, v22, v240
    v_sub_f32 v23, v23, v240
    v_mfma_f32_16x16x32_bf16 v[28:31], a[212:215], v[132:135], v[28:31]
    s_add_u32 m0, s38, 20480
    s_xor_b32 s87, s37, s86
    s_add_u32 s37, s37, 4096
    v_sub_f32 v48, 0, v240
    v_sub_f32 v49, 0, v240
    v_mfma_f32_16x16x32_bf16 v[28:31], a[216:219], v[136:139], v[28:31]
    v_sub_f32 v50, 0, v240
    v_sub_f32 v51, 0, v240
    v_exp_f32 v16, v16
    v_mfma_f32_16x16x32_bf16 v[28:31], a[220:223], v[140:143], v[28:31]
    v_exp_f32 v17, v17
    v_exp_f32 v18, v18
    v_mfma_f32_16x16x32_bf16 a[32:35], a[224:227], v[8:11], 0
    v_exp_f32 v19, v19
    v_cvt_pk_bf16_f32 v16, v16, v17
    v_cvt_pk_bf16_f32 v17, v18, v19
    v_mfma_f32_16x16x32_bf16 a[36:39], a[228:231], v[8:11], 0
    v_exp_f32 v20, v20
    v_exp_f32 v21, v21
    v_mfma_f32_16x16x32_bf16 a[40:43], a[232:235], v[8:11], 0
    v_exp_f32 v22, v22
    v_exp_f32 v23, v23
    v_mfma_f32_16x16x32_bf16 a[44:47], a[236:239], v[8:11], 0
    v_cvt_pk_bf16_f32 v18, v20, v21
    v_cvt_pk_bf16_f32 v19, v22, v23
    v_mfma_f32_16x16x32_bf16 a[48:51], a[240:243], v[8:11], 0
    v_max3_f32 v242, v24, v25, v26
    v_max3_f32 v243, v27, v28, v29
    v_mfma_f32_16x16x32_bf16 a[52:55], a[244:247], v[8:11], 0
    v_max3_f32 v242, v242, v30, v31
    v_max_f32 v242, v242, v243
    v_mfma_f32_16x16x32_bf16 a[56:59], a[248:251], v[8:11], 0
    v_mov_b32 v243, v242
    s_nop 1
    v_permlane32_swap_b32 v242, v243
    v_max_f32 v242, v242, v243
    v_mfma_f32_16x16x32_bf16 a[60:63], a[252:255], v[8:11], 0
    v_mov_b32 v243, v242
    s_nop 1
    v_permlane16_swap_b32 v242, v243
    v_max_f32 v242, v242, v243
    v_mfma_f32_16x16x32_bf16 v[64:67], v[228:231], v[8:11], 0
    buffer_load_dwordx4 v224, s[24:27], s87 offen nt lds
    v_mfma_f32_16x16x32_bf16 v[32:35], a[192:195], v[144:147], 0
    s_add_u32 m0, s38, 24576
    s_xor_b32 s87, s37, s86
    s_add_u32 s37, s37, 4096
    v_mfma_f32_16x16x32_bf16 v[32:35], a[196:199], v[148:151], v[32:35]
    ds_read_b128 a[192:195], v208 offset:0
    ds_read_b128 a[196:199], v209 offset:0
    v_mfma_f32_16x16x32_bf16 v[32:35], a[200:203], v[152:155], v[32:35]
    v_sub_f32 v24, v24, v242
    v_sub_f32 v25, v25, v242
    v_mfma_f32_16x16x32_bf16 v[32:35], a[204:207], v[156:159], v[32:35]
    ds_read_b128 a[200:203], v210 offset:0
    ds_read_b128 a[204:207], v211 offset:0
    v_mfma_f32_16x16x32_bf16 v[36:39], a[208:211], v[144:147], 0
    v_sub_f32 v26, v26, v242
    v_sub_f32 v27, v27, v242
    v_mfma_f32_16x16x32_bf16 v[36:39], a[212:215], v[148:151], v[36:39]
    ds_read_b128 a[208:211], v208 offset:4096
    ds_read_b128 a[212:215], v209 offset:4096
    v_mfma_f32_16x16x32_bf16 v[36:39], a[216:219], v[152:155], v[36:39]
    v_sub_f32 v28, v28, v242
    v_sub_f32 v29, v29, v242
    v_mfma_f32_16x16x32_bf16 v[36:39], a[220:223], v[156:159], v[36:39]
    ds_read_b128 a[216:219], v210 offset:4096
    ds_read_b128 a[220:223], v211 offset:4096
    v_mfma_f32_16x16x32_bf16 a[64:67], a[224:227], v[16:19], 0
    v_sub_f32 v30, v30, v242
    v_sub_f32 v31, v31, v242
    v_mfma_f32_16x16x32_bf16 a[68:71], a[228:231], v[16:19], 0
    v_sub_f32 v52, 0, v242
    v_sub_f32 v53, 0, v242
    v_mfma_f32_16x16x32_bf16 a[72:75], a[232:235], v[16:19], 0
    v_sub_f32 v54, 0, v242
    v_sub_f32 v55, 0, v242
    v_max3_f32 v240, v32, v33, v34
    v_mfma_f32_16x16x32_bf16 a[76:79], a[236:239], v[16:19], 0
    buffer_load_dwordx4 v224, s[24:27], s87 offen nt lds
    v_max3_f32 v241, v35, v36, v37
    v_mfma_f32_16x16x32_bf16 a[80:83], a[240:243], v[16:19], 0
    s_add_u32 m0, s38, 28672
    s_xor_b32 s87, s37, s86
    s_add_u32 s37, s37, 4096
    v_max3_f32 v240, v240, v38, v39
    v_mfma_f32_16x16x32_bf16 a[84:87], a[244:247], v[16:19], 0
    v_exp_f32 v24, v24
    v_max_f32 v240, v240, v241
    v_mfma_f32_16x16x32_bf16 a[88:91], a[248:251], v[16:19], 0
    v_exp_f32 v25, v25
    v_mfma_f32_16x16x32_bf16 a[92:95], a[252:255], v[16:19], 0
    v_exp_f32 v26, v26
    v_mfma_f32_16x16x32_bf16 v[68:71], v[228:231], v[16:19], 0
    s_waitcnt lgkmcnt(0)
    v_exp_f32 v27, v27
    v_mfma_f32_16x16x32_bf16 v[0:3], a[192:195], v[80:83], v[40:43]
    v_cvt_pk_bf16_f32 v24, v24, v25
    v_cvt_pk_bf16_f32 v25, v26, v27
    v_mfma_f32_16x16x32_bf16 v[0:3], a[196:199], v[84:87], v[0:3]
    v_exp_f32 v28, v28
    v_mfma_f32_16x16x32_bf16 v[0:3], a[200:203], v[88:91], v[0:3]
    v_exp_f32 v29, v29
    v_mfma_f32_16x16x32_bf16 v[0:3], a[204:207], v[92:95], v[0:3]
    v_exp_f32 v30, v30
    v_mfma_f32_16x16x32_bf16 v[4:7], a[208:211], v[80:83], v[40:43]
    v_exp_f32 v31, v31
    v_mfma_f32_16x16x32_bf16 v[4:7], a[212:215], v[84:87], v[4:7]
    v_cvt_pk_bf16_f32 v26, v28, v29
    v_cvt_pk_bf16_f32 v27, v30, v31
    v_mfma_f32_16x16x32_bf16 v[4:7], a[216:219], v[88:91], v[4:7]
    buffer_load_dwordx4 v224, s[24:27], s87 offen nt lds
    v_exp_f32 v0, v0
    v_mfma_f32_16x16x32_bf16 v[4:7], a[220:223], v[92:95], v[4:7]
    s_xor_b32 s82, s76, 8192
    s_add_u32 s76, s76, 1024
    v_mov_b32 v241, v240
    s_nop 1
    v_permlane32_swap_b32 v240, v241
    v_max_f32 v240, v240, v241
    v_mfma_f32_16x16x32_bf16 a[96:99], a[224:227], v[24:27], 0
    v_mov_b32 v241, v240
    s_nop 1
    v_permlane16_swap_b32 v240, v241
    v_max_f32 v240, v240, v241
    v_mfma_f32_16x16x32_bf16 a[100:103], a[228:231], v[24:27], 0
    v_sub_f32 v32, v32, v240
    v_sub_f32 v33, v33, v240
    v_sub_f32 v34, v34, v240
    v_mfma_f32_16x16x32_bf16 a[104:107], a[232:235], v[24:27], 0
    v_sub_f32 v35, v35, v240
    v_sub_f32 v36, v36, v240
    v_sub_f32 v37, v37, v240
    v_mfma_f32_16x16x32_bf16 a[108:111], a[236:239], v[24:27], 0
    v_sub_f32 v38, v38, v240
    v_sub_f32 v39, v39, v240
    v_sub_f32 v56, 0, v240
    v_mfma_f32_16x16x32_bf16 a[112:115], a[240:243], v[24:27], 0
    v_sub_f32 v57, 0, v240
    v_sub_f32 v58, 0, v240
    v_sub_f32 v59, 0, v240
    v_mfma_f32_16x16x32_bf16 a[116:119], a[244:247], v[24:27], 0
    v_exp_f32 v32, v32
    v_exp_f32 v1, v1
    v_mfma_f32_16x16x32_bf16 a[120:123], a[248:251], v[24:27], 0
    v_exp_f32 v33, v33
    v_exp_f32 v2, v2
    v_mfma_f32_16x16x32_bf16 a[124:127], a[252:255], v[24:27], 0
    v_exp_f32 v34, v34
    v_exp_f32 v3, v3
    v_mfma_f32_16x16x32_bf16 v[72:75], v[228:231], v[24:27], 0
    v_exp_f32 v35, v35
    v_cvt_pk_bf16_f32 v32, v32, v33
    v_cvt_pk_bf16_f32 v0, v0, v1
    v_mfma_f32_16x16x32_bf16 v[8:11], a[192:195], v[96:99], v[44:47]
    v_cvt_pk_bf16_f32 v33, v34, v35
    v_exp_f32 v36, v36
    v_cvt_pk_bf16_f32 v1, v2, v3
    v_mfma_f32_16x16x32_bf16 v[8:11], a[196:199], v[100:103], v[8:11]
    buffer_load_dword v226, v237, s[16:19], s82 offen
    v_exp_f32 v4, v4
    v_mfma_f32_16x16x32_bf16 v[8:11], a[200:203], v[104:107], v[8:11]
    v_exp_f32 v37, v37
    v_exp_f32 v5, v5
    v_mfma_f32_16x16x32_bf16 v[8:11], a[204:207], v[108:111], v[8:11]
    v_exp_f32 v38, v38
    v_exp_f32 v6, v6
    v_mfma_f32_16x16x32_bf16 v[12:15], a[208:211], v[96:99], v[44:47]
    v_exp_f32 v39, v39
    v_cvt_pk_bf16_f32 v34, v36, v37
    v_mfma_f32_16x16x32_bf16 v[12:15], a[212:215], v[100:103], v[12:15]
    v_cvt_pk_bf16_f32 v35, v38, v39
    v_exp_f32 v7, v7
    v_cvt_pk_bf16_f32 v2, v4, v5
    v_mfma_f32_16x16x32_bf16 v[12:15], a[216:219], v[104:107], v[12:15]
    v_cvt_pk_bf16_f32 v3, v6, v7
    v_mfma_f32_16x16x32_bf16 v[12:15], a[220:223], v[108:111], v[12:15]
    v_exp_f32 v8, v8
    v_mfma_f32_16x16x32_bf16 a[128:131], a[224:227], v[32:35], 0
    ds_read_b64_tr_b16 a[224:225], v212 offset:24576
    ds_read_b64_tr_b16 a[226:227], v212 offset:28672
    v_mfma_f32_16x16x32_bf16 a[132:135], a[228:231], v[32:35], 0
    v_exp_f32 v9, v9
    v_mfma_f32_16x16x32_bf16 a[136:139], a[232:235], v[32:35], 0
    ds_read_b64_tr_b16 a[228:229], v213 offset:24576
    ds_read_b64_tr_b16 a[230:231], v213 offset:28672
    v_mfma_f32_16x16x32_bf16 a[140:143], a[236:239], v[32:35], 0
    v_add_u32 v212, s44, v212
    v_add_u32 v213, s44, v213
    v_mfma_f32_16x16x32_bf16 a[144:147], a[240:243], v[32:35], 0
    ds_read_b64_tr_b16 a[232:233], v214 offset:24576
    ds_read_b64_tr_b16 a[234:235], v214 offset:28672
    v_mfma_f32_16x16x32_bf16 a[148:151], a[244:247], v[32:35], 0
    v_exp_f32 v10, v10
    v_mfma_f32_16x16x32_bf16 a[152:155], a[248:251], v[32:35], 0
    ds_read_b64_tr_b16 a[236:237], v215 offset:24576
    ds_read_b64_tr_b16 a[238:239], v215 offset:28672
    v_mfma_f32_16x16x32_bf16 a[156:159], a[252:255], v[32:35], 0
    v_add_u32 v214, s44, v214
    v_add_u32 v215, s44, v215
    v_mfma_f32_16x16x32_bf16 v[76:79], v[228:231], v[32:35], 0
    ds_read_b64_tr_b16 a[240:241], v216 offset:24576
    ds_read_b64_tr_b16 a[242:243], v216 offset:28672
    v_mfma_f32_16x16x32_bf16 v[16:19], a[192:195], v[112:115], v[48:51]
    v_exp_f32 v11, v11
    v_mfma_f32_16x16x32_bf16 v[16:19], a[196:199], v[116:119], v[16:19]
    ds_read_b64_tr_b16 a[244:245], v217 offset:24576
    ds_read_b64_tr_b16 a[246:247], v217 offset:28672
    v_mfma_f32_16x16x32_bf16 v[16:19], a[200:203], v[120:123], v[16:19]
    v_add_u32 v216, s44, v216
    v_add_u32 v217, s44, v217
    v_mfma_f32_16x16x32_bf16 v[16:19], a[204:207], v[124:127], v[16:19]
    ds_read_b64_tr_b16 a[248:249], v218 offset:24576
    ds_read_b64_tr_b16 a[250:251], v218 offset:28672
    v_mfma_f32_16x16x32_bf16 v[20:23], a[208:211], v[112:115], v[48:51]
    v_cvt_pk_bf16_f32 v8, v8, v9
    v_cvt_pk_bf16_f32 v9, v10, v11
    v_mfma_f32_16x16x32_bf16 v[20:23], a[212:215], v[116:119], v[20:23]
    ds_read_b64_tr_b16 a[252:253], v219 offset:24576
    ds_read_b64_tr_b16 a[254:255], v219 offset:28672
    v_mfma_f32_16x16x32_bf16 v[20:23], a[216:219], v[120:123], v[20:23]
    v_add_u32 v218, s44, v218
    v_add_u32 v219, s44, v219
    v_mfma_f32_16x16x32_bf16 v[20:23], a[220:223], v[124:127], v[20:23]
    s_waitcnt lgkmcnt(6)
    v_exp_f32 v12, v12
    v_mfma_f32_16x16x32_bf16 a[0:3], a[224:227], v[0:3], a[0:3]
    v_exp_f32 v13, v13
    v_mfma_f32_16x16x32_bf16 a[4:7], a[228:231], v[0:3], a[4:7]
    v_exp_f32 v14, v14
    v_mfma_f32_16x16x32_bf16 a[8:11], a[232:235], v[0:3], a[8:11]
    v_exp_f32 v15, v15
    v_mfma_f32_16x16x32_bf16 a[12:15], a[236:239], v[0:3], a[12:15]
    v_cvt_pk_bf16_f32 v10, v12, v13
    v_cvt_pk_bf16_f32 v11, v14, v15
    v_mfma_f32_16x16x32_bf16 a[16:19], a[240:243], v[0:3], a[16:19]
    s_waitcnt lgkmcnt(2)
    v_exp_f32 v16, v16
    v_mfma_f32_16x16x32_bf16 a[20:23], a[244:247], v[0:3], a[20:23]
    v_exp_f32 v17, v17
    v_mfma_f32_16x16x32_bf16 a[24:27], a[248:251], v[0:3], a[24:27]
    s_waitcnt lgkmcnt(0)
    v_exp_f32 v18, v18
    v_mfma_f32_16x16x32_bf16 a[28:31], a[252:255], v[0:3], a[28:31]
    v_exp_f32 v19, v19
    v_mfma_f32_16x16x32_bf16 v[60:63], v[228:231], v[0:3], v[60:63]
    v_cvt_pk_bf16_f32 v16, v16, v17
    v_cvt_pk_bf16_f32 v17, v18, v19
    v_mfma_f32_16x16x32_bf16 v[24:27], a[192:195], v[128:131], v[52:55]
    v_exp_f32 v20, v20
    v_mfma_f32_16x16x32_bf16 v[24:27], a[196:199], v[132:135], v[24:27]
    ds_read_b128 a[192:195], v208 offset:8192
    ds_read_b128 a[196:199], v209 offset:8192
    v_mfma_f32_16x16x32_bf16 v[24:27], a[200:203], v[136:139], v[24:27]
    v_exp_f32 v21, v21
    v_mfma_f32_16x16x32_bf16 v[24:27], a[204:207], v[140:143], v[24:27]
    ds_read_b128 a[200:203], v210 offset:8192
    ds_read_b128 a[204:207], v211 offset:8192
    v_mfma_f32_16x16x32_bf16 v[28:31], a[208:211], v[128:131], v[52:55]
    v_exp_f32 v22, v22
    v_mfma_f32_16x16x32_bf16 v[28:31], a[212:215], v[132:135], v[28:31]
    s_sub_u32 s39, s39, 1
    ds_read_b128 a[208:211], v208 offset:12288
    ds_read_b128 a[212:215], v209 offset:12288
    v_mfma_f32_16x16x32_bf16 v[28:31], a[216:219], v[136:139], v[28:31]
    v_add_u32 v208, s44, v208
    v_add_u32 v209, s44, v209
    v_mfma_f32_16x16x32_bf16 v[28:31], a[220:223], v[140:143], v[28:31]
    ds_read_b128 a[216:219], v210 offset:12288
    ds_read_b128 a[220:223], v211 offset:12288
    v_mfma_f32_16x16x32_bf16 a[32:35], a[224:227], v[8:11], a[32:35]
    v_add_u32 v210, s44, v210
    v_add_u32 v211, s44, v211
    v_mfma_f32_16x16x32_bf16 a[36:39], a[228:231], v[8:11], a[36:39]
    v_exp_f32 v23, v23
    v_mfma_f32_16x16x32_bf16 a[40:43], a[232:235], v[8:11], a[40:43]
    v_cvt_pk_bf16_f32 v18, v20, v21
    v_cvt_pk_bf16_f32 v19, v22, v23
    v_mfma_f32_16x16x32_bf16 a[44:47], a[236:239], v[8:11], a[44:47]
    v_exp_f32 v24, v24
    v_mfma_f32_16x16x32_bf16 a[48:51], a[240:243], v[8:11], a[48:51]
    v_exp_f32 v25, v25
    v_mfma_f32_16x16x32_bf16 a[52:55], a[244:247], v[8:11], a[52:55]
    v_exp_f32 v26, v26
    v_mfma_f32_16x16x32_bf16 a[56:59], a[248:251], v[8:11], a[56:59]
    v_exp_f32 v27, v27
    v_mfma_f32_16x16x32_bf16 a[60:63], a[252:255], v[8:11], a[60:63]
    v_cvt_pk_bf16_f32 v24, v24, v25
    v_cvt_pk_bf16_f32 v25, v26, v27
    v_mfma_f32_16x16x32_bf16 v[64:67], v[228:231], v[8:11], v[64:67]
    s_waitcnt lgkmcnt(0)
.p2align 6
A0h0_loop:
    v_mfma_f32_16x16x32_bf16 v[0:3], a[192:195], v[80:83], v[40:43]
    v_exp_f32 v28, v28
    v_mfma_f32_16x16x32_bf16 v[0:3], a[196:199], v[84:87], v[0:3]
    v_exp_f32 v29, v29
    v_mfma_f32_16x16x32_bf16 v[0:3], a[200:203], v[88:91], v[0:3]
    v_exp_f32 v30, v30
    v_mfma_f32_16x16x32_bf16 v[0:3], a[204:207], v[92:95], v[0:3]
    v_exp_f32 v31, v31
    v_mfma_f32_16x16x32_bf16 v[4:7], a[208:211], v[80:83], v[40:43]
    v_cvt_pk_bf16_f32 v26, v28, v29
    v_cvt_pk_bf16_f32 v27, v30, v31
    v_mfma_f32_16x16x32_bf16 v[4:7], a[212:215], v[84:87], v[4:7]
    v_mfma_f32_16x16x32_bf16 v[4:7], a[216:219], v[88:91], v[4:7]
    v_exp_f32 v0, v0
    v_mfma_f32_16x16x32_bf16 v[4:7], a[220:223], v[92:95], v[4:7]
    v_exp_f32 v1, v1
    v_mfma_f32_16x16x32_bf16 a[64:67], a[224:227], v[16:19], a[64:67]
    v_exp_f32 v2, v2
    v_mfma_f32_16x16x32_bf16 a[68:71], a[228:231], v[16:19], a[68:71]
    v_exp_f32 v3, v3
    v_mfma_f32_16x16x32_bf16 a[72:75], a[232:235], v[16:19], a[72:75]
    s_waitcnt vmcnt(9) lgkmcnt(0)
    s_barrier
    v_mfma_f32_16x16x32_bf16 a[76:79], a[236:239], v[16:19], a[76:79]
    s_add_u32 s74, s74, s44
    v_cvt_pk_bf16_f32 v0, v0, v1
    v_cvt_pk_bf16_f32 v1, v2, v3
    v_mfma_f32_16x16x32_bf16 a[80:83], a[240:243], v[16:19], a[80:83]
    s_xor_b32 s38, s74, 0x10000
    v_exp_f32 v4, v4
    v_mfma_f32_16x16x32_bf16 a[84:87], a[244:247], v[16:19], a[84:87]
    s_add_u32 s38, s38, s3
    v_exp_f32 v5, v5
    v_mfma_f32_16x16x32_bf16 a[88:91], a[248:251], v[16:19], a[88:91]
    s_add_u32 m0, s38, 0
    s_xor_b32 s87, s85, s86
    s_add_u32 s85, s85, 4096
    v_mfma_f32_16x16x32_bf16 a[92:95], a[252:255], v[16:19], a[92:95]
    buffer_load_dwordx4 v220, s[20:23], s87 offen nt lds
    v_mfma_f32_16x16x32_bf16 v[68:71], v[228:231], v[16:19], v[68:71]
    s_add_u32 m0, s38, 4096
    s_xor_b32 s87, s85, s86
    s_add_u32 s85, s85, 4096
    v_mfma_f32_16x16x32_bf16 v[8:11], a[192:195], v[96:99], v[44:47]
    s_cmp_eq_u32 s74, 0x18000
    s_cselect_b32 s44, s45, s46
    v_mfma_f32_16x16x32_bf16 v[8:11], a[196:199], v[100:103], v[8:11]
    v_exp_f32 v6, v6
    v_mfma_f32_16x16x32_bf16 v[8:11], a[200:203], v[104:107], v[8:11]
    v_exp_f32 v7, v7
    v_mfma_f32_16x16x32_bf16 v[8:11], a[204:207], v[108:111], v[8:11]
    v_cvt_pk_bf16_f32 v2, v4, v5
    v_cvt_pk_bf16_f32 v3, v6, v7
    v_mfma_f32_16x16x32_bf16 v[12:15], a[208:211], v[96:99], v[44:47]
    v_mfma_f32_16x16x32_bf16 v[12:15], a[212:215], v[100:103], v[12:15]
    v_mfma_f32_16x16x32_bf16 v[12:15], a[216:219], v[104:107], v[12:15]
    v_exp_f32 v8, v8
    v_mfma_f32_16x16x32_bf16 v[12:15], a[220:223], v[108:111], v[12:15]
    v_exp_f32 v9, v9
    v_mfma_f32_16x16x32_bf16 a[96:99], a[224:227], v[24:27], a[96:99]
    ds_read_b64_tr_b16 a[224:225], v212 offset:16384
    ds_read_b64_tr_b16 a[226:227], v212 offset:20480
    v_mfma_f32_16x16x32_bf16 a[100:103], a[228:231], v[24:27], a[100:103]
    buffer_load_dwordx4 v220, s[20:23], s87 offen nt lds
    v_mfma_f32_16x16x32_bf16 a[104:107], a[232:235], v[24:27], a[104:107]
    s_add_u32 m0, s38, 8192
    ds_read_b64_tr_b16 a[228:229], v213 offset:16384
    ds_read_b64_tr_b16 a[230:231], v213 offset:20480
    v_mfma_f32_16x16x32_bf16 a[108:111], a[236:239], v[24:27], a[108:111]
    s_xor_b32 s87, s85, s86
    s_add_u32 s85, s85, 4096
    v_mfma_f32_16x16x32_bf16 a[112:115], a[240:243], v[24:27], a[112:115]
    ds_read_b64_tr_b16 a[232:233], v214 offset:16384
    ds_read_b64_tr_b16 a[234:235], v214 offset:20480
    v_mfma_f32_16x16x32_bf16 a[116:119], a[244:247], v[24:27], a[116:119]
    v_exp_f32 v10, v10
    v_mfma_f32_16x16x32_bf16 a[120:123], a[248:251], v[24:27], a[120:123]
    ds_read_b64_tr_b16 a[236:237], v215 offset:16384
    ds_read_b64_tr_b16 a[238:239], v215 offset:20480
    v_mfma_f32_16x16x32_bf16 a[124:127], a[252:255], v[24:27], a[124:127]
    v_exp_f32 v11, v11
    v_mfma_f32_16x16x32_bf16 v[72:75], v[228:231], v[24:27], v[72:75]
    ds_read_b64_tr_b16 a[240:241], v216 offset:16384
    ds_read_b64_tr_b16 a[242:243], v216 offset:20480
    v_mfma_f32_16x16x32_bf16 v[16:19], a[192:195], v[112:115], v[48:51]
    v_cvt_pk_bf16_f32 v8, v8, v9
    v_cvt_pk_bf16_f32 v9, v10, v11
    v_mfma_f32_16x16x32_bf16 v[16:19], a[196:199], v[116:119], v[16:19]
    ds_read_b64_tr_b16 a[244:245], v217 offset:16384
    ds_read_b64_tr_b16 a[246:247], v217 offset:20480
    v_mfma_f32_16x16x32_bf16 v[16:19], a[200:203], v[120:123], v[16:19]
    v_exp_f32 v12, v12
    v_mfma_f32_16x16x32_bf16 v[16:19], a[204:207], v[124:127], v[16:19]
    ds_read_b64_tr_b16 a[248:249], v218 offset:16384
    ds_read_b64_tr_b16 a[250:251], v218 offset:20480
    v_mfma_f32_16x16x32_bf16 v[20:23], a[208:211], v[112:115], v[48:51]
    buffer_load_dwordx4 v220, s[20:23], s87 offen nt lds
    v_mfma_f32_16x16x32_bf16 v[20:23], a[212:215], v[116:119], v[20:23]
    s_add_u32 m0, s38, 12288
    ds_read_b64_tr_b16 a[252:253], v219 offset:16384
    ds_read_b64_tr_b16 a[254:255], v219 offset:20480
    v_mfma_f32_16x16x32_bf16 v[20:23], a[216:219], v[120:123], v[20:23]
    s_xor_b32 s87, s85, s86
    s_add_u32 s85, s85, 4096
    v_mfma_f32_16x16x32_bf16 v[20:23], a[220:223], v[124:127], v[20:23]
    s_waitcnt lgkmcnt(6)
    v_exp_f32 v13, v13
    v_mfma_f32_16x16x32_bf16 a[0:3], a[224:227], v[0:3], a[0:3]
    v_exp_f32 v14, v14
    v_mfma_f32_16x16x32_bf16 a[4:7], a[228:231], v[0:3], a[4:7]
    v_exp_f32 v15, v15
    v_mfma_f32_16x16x32_bf16 a[8:11], a[232:235], v[0:3], a[8:11]
    v_cvt_pk_bf16_f32 v10, v12, v13
    v_cvt_pk_bf16_f32 v11, v14, v15
    v_mfma_f32_16x16x32_bf16 a[12:15], a[236:239], v[0:3], a[12:15]
    v_exp_f32 v16, v16
    v_mfma_f32_16x16x32_bf16 a[16:19], a[240:243], v[0:3], a[16:19]
    s_waitcnt lgkmcnt(2)
    v_exp_f32 v17, v17
    v_mfma_f32_16x16x32_bf16 a[20:23], a[244:247], v[0:3], a[20:23]
    v_exp_f32 v18, v18
    v_mfma_f32_16x16x32_bf16 a[24:27], a[248:251], v[0:3], a[24:27]
    s_waitcnt lgkmcnt(0)
    v_exp_f32 v19, v19
    v_mfma_f32_16x16x32_bf16 a[28:31], a[252:255], v[0:3], a[28:31]
    v_cvt_pk_bf16_f32 v16, v16, v17
    v_cvt_pk_bf16_f32 v17, v18, v19
    v_mfma_f32_16x16x32_bf16 v[60:63], v[228:231], v[0:3], v[60:63]
    buffer_load_dwordx4 v220, s[20:23], s87 offen nt lds
    v_mfma_f32_16x16x32_bf16 v[24:27], a[192:195], v[128:131], v[52:55]
    s_add_u32 m0, s38, 16384
    s_xor_b32 s87, s37, s86
    s_add_u32 s37, s37, 4096
    v_mfma_f32_16x16x32_bf16 v[24:27], a[196:199], v[132:135], v[24:27]
    v_exp_f32 v20, v20
    v_mfma_f32_16x16x32_bf16 v[24:27], a[200:203], v[136:139], v[24:27]
    v_exp_f32 v21, v21
    v_mfma_f32_16x16x32_bf16 v[24:27], a[204:207], v[140:143], v[24:27]
    v_exp_f32 v22, v22
    v_mfma_f32_16x16x32_bf16 v[28:31], a[208:211], v[128:131], v[52:55]
    v_exp_f32 v23, v23
    v_mfma_f32_16x16x32_bf16 v[28:31], a[212:215], v[132:135], v[28:31]
    v_cvt_pk_bf16_f32 v18, v20, v21
    v_cvt_pk_bf16_f32 v19, v22, v23
    v_mfma_f32_16x16x32_bf16 v[28:31], a[216:219], v[136:139], v[28:31]
    v_exp_f32 v24, v24
    v_mfma_f32_16x16x32_bf16 v[28:31], a[220:223], v[140:143], v[28:31]
    v_exp_f32 v25, v25
    v_mfma_f32_16x16x32_bf16 a[32:35], a[224:227], v[8:11], a[32:35]
    v_exp_f32 v26, v26
    v_mfma_f32_16x16x32_bf16 a[36:39], a[228:231], v[8:11], a[36:39]
    v_exp_f32 v27, v27
    v_mfma_f32_16x16x32_bf16 a[40:43], a[232:235], v[8:11], a[40:43]
    v_cvt_pk_bf16_f32 v24, v24, v25
    v_cvt_pk_bf16_f32 v25, v26, v27
    v_mfma_f32_16x16x32_bf16 a[44:47], a[236:239], v[8:11], a[44:47]
    buffer_load_dwordx4 v224, s[24:27], s87 offen nt lds
    v_mfma_f32_16x16x32_bf16 a[48:51], a[240:243], v[8:11], a[48:51]
    s_add_u32 m0, s38, 20480
    s_xor_b32 s87, s37, s86
    s_add_u32 s37, s37, 4096
    v_mfma_f32_16x16x32_bf16 a[52:55], a[244:247], v[8:11], a[52:55]
    v_exp_f32 v28, v28
    v_mfma_f32_16x16x32_bf16 a[56:59], a[248:251], v[8:11], a[56:59]
    v_exp_f32 v29, v29
    v_mfma_f32_16x16x32_bf16 a[60:63], a[252:255], v[8:11], a[60:63]
    v_exp_f32 v30, v30
    v_mfma_f32_16x16x32_bf16 v[64:67], v[228:231], v[8:11], v[64:67]
    v_exp_f32 v31, v31
    v_mfma_f32_16x16x32_bf16 v[32:35], a[192:195], v[144:147], v[56:59]
    v_cvt_pk_bf16_f32 v26, v28, v29
    v_cvt_pk_bf16_f32 v27, v30, v31
    v_mfma_f32_16x16x32_bf16 v[32:35], a[196:199], v[148:151], v[32:35]
    ds_read_b128 a[192:195], v208 offset:0
    ds_read_b128 a[196:199], v209 offset:0
    v_mfma_f32_16x16x32_bf16 v[32:35], a[200:203], v[152:155], v[32:35]
    v_mfma_f32_16x16x32_bf16 v[32:35], a[204:207], v[156:159], v[32:35]
    ds_read_b128 a[200:203], v210 offset:0
    ds_read_b128 a[204:207], v211 offset:0
    v_mfma_f32_16x16x32_bf16 v[36:39], a[208:211], v[144:147], v[56:59]
    v_mfma_f32_16x16x32_bf16 v[36:39], a[212:215], v[148:151], v[36:39]
    ds_read_b128 a[208:211], v208 offset:4096
    ds_read_b128 a[212:215], v209 offset:4096
    v_mfma_f32_16x16x32_bf16 v[36:39], a[216:219], v[152:155], v[36:39]
    buffer_load_dwordx4 v224, s[24:27], s87 offen nt lds
    v_mfma_f32_16x16x32_bf16 v[36:39], a[220:223], v[156:159], v[36:39]
    s_add_u32 m0, s38, 24576
    ds_read_b128 a[216:219], v210 offset:4096
    ds_read_b128 a[220:223], v211 offset:4096
    v_mfma_f32_16x16x32_bf16 a[64:67], a[224:227], v[16:19], a[64:67]
    s_xor_b32 s87, s37, s86
    s_add_u32 s37, s37, 4096
    v_mfma_f32_16x16x32_bf16 a[68:71], a[228:231], v[16:19], a[68:71]
    v_exp_f32 v32, v32
    v_mfma_f32_16x16x32_bf16 a[72:75], a[232:235], v[16:19], a[72:75]
    v_exp_f32 v33, v33
    v_mfma_f32_16x16x32_bf16 a[76:79], a[236:239], v[16:19], a[76:79]
    v_exp_f32 v34, v34
    v_mfma_f32_16x16x32_bf16 a[80:83], a[240:243], v[16:19], a[80:83]
    v_exp_f32 v35, v35
    v_mfma_f32_16x16x32_bf16 a[84:87], a[244:247], v[16:19], a[84:87]
    v_cvt_pk_bf16_f32 v32, v32, v33
    v_cvt_pk_bf16_f32 v33, v34, v35
    v_mfma_f32_16x16x32_bf16 a[88:91], a[248:251], v[16:19], a[88:91]
    v_exp_f32 v36, v36
    v_mfma_f32_16x16x32_bf16 a[92:95], a[252:255], v[16:19], a[92:95]
    v_exp_f32 v37, v37
    v_mfma_f32_16x16x32_bf16 v[68:71], v[228:231], v[16:19], v[68:71]
    s_waitcnt lgkmcnt(0)
    v_exp_f32 v38, v38
    v_mfma_f32_16x16x32_bf16 v[0:3], a[192:195], v[80:83], v[40:43]
    v_exp_f32 v39, v39
    v_mfma_f32_16x16x32_bf16 v[0:3], a[196:199], v[84:87], v[0:3]
    buffer_load_dwordx4 v224, s[24:27], s87 offen nt lds
    v_mfma_f32_16x16x32_bf16 v[0:3], a[200:203], v[88:91], v[0:3]
    s_add_u32 m0, s38, 28672
    s_xor_b32 s87, s37, s86
    s_add_u32 s37, s37, 4096
    v_mfma_f32_16x16x32_bf16 v[0:3], a[204:207], v[92:95], v[0:3]
    v_cvt_pk_bf16_f32 v34, v36, v37
    v_cvt_pk_bf16_f32 v35, v38, v39
    v_mfma_f32_16x16x32_bf16 v[4:7], a[208:211], v[80:83], v[40:43]
    v_mfma_f32_16x16x32_bf16 v[4:7], a[212:215], v[84:87], v[4:7]
    v_mfma_f32_16x16x32_bf16 v[4:7], a[216:219], v[88:91], v[4:7]
    v_exp_f32 v0, v0
    v_mfma_f32_16x16x32_bf16 v[4:7], a[220:223], v[92:95], v[4:7]
    v_exp_f32 v1, v1
    v_mfma_f32_16x16x32_bf16 a[96:99], a[224:227], v[24:27], a[96:99]
    v_exp_f32 v2, v2
    v_mfma_f32_16x16x32_bf16 a[100:103], a[228:231], v[24:27], a[100:103]
    v_exp_f32 v3, v3
    v_mfma_f32_16x16x32_bf16 a[104:107], a[232:235], v[24:27], a[104:107]
    v_cvt_pk_bf16_f32 v0, v0, v1
    v_cvt_pk_bf16_f32 v1, v2, v3
    v_mfma_f32_16x16x32_bf16 a[108:111], a[236:239], v[24:27], a[108:111]
    v_exp_f32 v4, v4
    v_mfma_f32_16x16x32_bf16 a[112:115], a[240:243], v[24:27], a[112:115]
    v_exp_f32 v5, v5
    v_mfma_f32_16x16x32_bf16 a[116:119], a[244:247], v[24:27], a[116:119]
    buffer_load_dwordx4 v224, s[24:27], s87 offen nt lds
    v_mfma_f32_16x16x32_bf16 a[120:123], a[248:251], v[24:27], a[120:123]
    s_xor_b32 s82, s76, 8192
    s_add_u32 s76, s76, 1024
    v_mfma_f32_16x16x32_bf16 a[124:127], a[252:255], v[24:27], a[124:127]
    v_exp_f32 v6, v6
    v_mfma_f32_16x16x32_bf16 v[72:75], v[228:231], v[24:27], v[72:75]
    v_exp_f32 v7, v7
    v_mfma_f32_16x16x32_bf16 v[8:11], a[192:195], v[96:99], v[44:47]
    v_cvt_pk_bf16_f32 v2, v4, v5
    v_cvt_pk_bf16_f32 v3, v6, v7
    v_mfma_f32_16x16x32_bf16 v[8:11], a[196:199], v[100:103], v[8:11]
    v_mfma_f32_16x16x32_bf16 v[8:11], a[200:203], v[104:107], v[8:11]
    v_mfma_f32_16x16x32_bf16 v[8:11], a[204:207], v[108:111], v[8:11]
    v_mfma_f32_16x16x32_bf16 v[12:15], a[208:211], v[96:99], v[44:47]
    v_mfma_f32_16x16x32_bf16 v[12:15], a[212:215], v[100:103], v[12:15]
    v_mfma_f32_16x16x32_bf16 v[12:15], a[216:219], v[104:107], v[12:15]
    v_exp_f32 v8, v8
    v_mfma_f32_16x16x32_bf16 v[12:15], a[220:223], v[108:111], v[12:15]
    v_exp_f32 v9, v9
    v_mfma_f32_16x16x32_bf16 a[128:131], a[224:227], v[32:35], a[128:131]
    ds_read_b64_tr_b16 a[224:225], v212 offset:24576
    ds_read_b64_tr_b16 a[226:227], v212 offset:28672
    v_mfma_f32_16x16x32_bf16 a[132:135], a[228:231], v[32:35], a[132:135]
    buffer_load_dword v226, v237, s[16:19], s82 offen
    v_mfma_f32_16x16x32_bf16 a[136:139], a[232:235], v[32:35], a[136:139]
    ds_read_b64_tr_b16 a[228:229], v213 offset:24576
    ds_read_b64_tr_b16 a[230:231], v213 offset:28672
    v_mfma_f32_16x16x32_bf16 a[140:143], a[236:239], v[32:35], a[140:143]
    v_add_u32 v212, s44, v212
    v_add_u32 v213, s44, v213
    v_mfma_f32_16x16x32_bf16 a[144:147], a[240:243], v[32:35], a[144:147]
    ds_read_b64_tr_b16 a[232:233], v214 offset:24576
    ds_read_b64_tr_b16 a[234:235], v214 offset:28672
    v_mfma_f32_16x16x32_bf16 a[148:151], a[244:247], v[32:35], a[148:151]
    v_exp_f32 v10, v10
    v_mfma_f32_16x16x32_bf16 a[152:155], a[248:251], v[32:35], a[152:155]
    ds_read_b64_tr_b16 a[236:237], v215 offset:24576
    ds_read_b64_tr_b16 a[238:239], v215 offset:28672
    v_mfma_f32_16x16x32_bf16 a[156:159], a[252:255], v[32:35], a[156:159]
    v_add_u32 v214, s44, v214
    v_add_u32 v215, s44, v215
    v_mfma_f32_16x16x32_bf16 v[76:79], v[228:231], v[32:35], v[76:79]
    ds_read_b64_tr_b16 a[240:241], v216 offset:24576
    ds_read_b64_tr_b16 a[242:243], v216 offset:28672
    v_mfma_f32_16x16x32_bf16 v[16:19], a[192:195], v[112:115], v[48:51]
    v_exp_f32 v11, v11
    v_mfma_f32_16x16x32_bf16 v[16:19], a[196:199], v[116:119], v[16:19]
    ds_read_b64_tr_b16 a[244:245], v217 offset:24576
    ds_read_b64_tr_b16 a[246:247], v217 offset:28672
    v_mfma_f32_16x16x32_bf16 v[16:19], a[200:203], v[120:123], v[16:19]
    v_add_u32 v216, s44, v216
    v_add_u32 v217, s44, v217
    v_mfma_f32_16x16x32_bf16 v[16:19], a[204:207], v[124:127], v[16:19]
    ds_read_b64_tr_b16 a[248:249], v218 offset:24576
    ds_read_b64_tr_b16 a[250:251], v218 offset:28672
    v_mfma_f32_16x16x32_bf16 v[20:23], a[208:211], v[112:115], v[48:51]
    v_cvt_pk_bf16_f32 v8, v8, v9
    v_cvt_pk_bf16_f32 v9, v10, v11
    v_mfma_f32_16x16x32_bf16 v[20:23], a[212:215], v[116:119], v[20:23]
    ds_read_b64_tr_b16 a[252:253], v219 offset:24576
    ds_read_b64_tr_b16 a[254:255], v219 offset:28672
    v_mfma_f32_16x16x32_bf16 v[20:23], a[216:219], v[120:123], v[20:23]
    v_add_u32 v218, s44, v218
    v_add_u32 v219, s44, v219
    v_mfma_f32_16x16x32_bf16 v[20:23], a[220:223], v[124:127], v[20:23]
    s_waitcnt lgkmcnt(6)
    v_exp_f32 v12, v12
    v_mfma_f32_16x16x32_bf16 a[0:3], a[224:227], v[0:3], a[0:3]
    v_exp_f32 v13, v13
    v_mfma_f32_16x16x32_bf16 a[4:7], a[228:231], v[0:3], a[4:7]
    v_exp_f32 v14, v14
    v_mfma_f32_16x16x32_bf16 a[8:11], a[232:235], v[0:3], a[8:11]
    v_exp_f32 v15, v15
    v_mfma_f32_16x16x32_bf16 a[12:15], a[236:239], v[0:3], a[12:15]
    v_cvt_pk_bf16_f32 v10, v12, v13
    v_cvt_pk_bf16_f32 v11, v14, v15
    v_mfma_f32_16x16x32_bf16 a[16:19], a[240:243], v[0:3], a[16:19]
    s_waitcnt lgkmcnt(2)
    v_exp_f32 v16, v16
    v_mfma_f32_16x16x32_bf16 a[20:23], a[244:247], v[0:3], a[20:23]
    v_exp_f32 v17, v17
    v_mfma_f32_16x16x32_bf16 a[24:27], a[248:251], v[0:3], a[24:27]
    s_waitcnt lgkmcnt(0)
    v_exp_f32 v18, v18
    v_mfma_f32_16x16x32_bf16 a[28:31], a[252:255], v[0:3], a[28:31]
    v_exp_f32 v19, v19
    v_mfma_f32_16x16x32_bf16 v[60:63], v[228:231], v[0:3], v[60:63]
    v_cvt_pk_bf16_f32 v16, v16, v17
    v_cvt_pk_bf16_f32 v17, v18, v19
    v_mfma_f32_16x16x32_bf16 v[24:27], a[192:195], v[128:131], v[52:55]
    v_exp_f32 v20, v20
    v_mfma_f32_16x16x32_bf16 v[24:27], a[196:199], v[132:135], v[24:27]
    ds_read_b128 a[192:195], v208 offset:8192
    ds_read_b128 a[196:199], v209 offset:8192
    v_mfma_f32_16x16x32_bf16 v[24:27], a[200:203], v[136:139], v[24:27]
    v_exp_f32 v21, v21
    v_mfma_f32_16x16x32_bf16 v[24:27], a[204:207], v[140:143], v[24:27]
    ds_read_b128 a[200:203], v210 offset:8192
    ds_read_b128 a[204:207], v211 offset:8192
    v_mfma_f32_16x16x32_bf16 v[28:31], a[208:211], v[128:131], v[52:55]
    v_exp_f32 v22, v22
    v_mfma_f32_16x16x32_bf16 v[28:31], a[212:215], v[132:135], v[28:31]
    s_sub_u32 s39, s39, 1
    ds_read_b128 a[208:211], v208 offset:12288
    ds_read_b128 a[212:215], v209 offset:12288
    v_mfma_f32_16x16x32_bf16 v[28:31], a[216:219], v[136:139], v[28:31]
    v_add_u32 v208, s44, v208
    v_add_u32 v209, s44, v209
    v_mfma_f32_16x16x32_bf16 v[28:31], a[220:223], v[140:143], v[28:31]
    ds_read_b128 a[216:219], v210 offset:12288
    ds_read_b128 a[220:223], v211 offset:12288
    v_mfma_f32_16x16x32_bf16 a[32:35], a[224:227], v[8:11], a[32:35]
    v_add_u32 v210, s44, v210
    v_add_u32 v211, s44, v211
    v_mfma_f32_16x16x32_bf16 a[36:39], a[228:231], v[8:11], a[36:39]
    v_exp_f32 v23, v23
    v_mfma_f32_16x16x32_bf16 a[40:43], a[232:235], v[8:11], a[40:43]
    v_cvt_pk_bf16_f32 v18, v20, v21
    v_cvt_pk_bf16_f32 v19, v22, v23
    v_mfma_f32_16x16x32_bf16 a[44:47], a[236:239], v[8:11], a[44:47]
    v_exp_f32 v24, v24
    v_mfma_f32_16x16x32_bf16 a[48:51], a[240:243], v[8:11], a[48:51]
    v_exp_f32 v25, v25
    v_mfma_f32_16x16x32_bf16 a[52:55], a[244:247], v[8:11], a[52:55]
    v_exp_f32 v26, v26
    v_mfma_f32_16x16x32_bf16 a[56:59], a[248:251], v[8:11], a[56:59]
    v_exp_f32 v27, v27
    v_mfma_f32_16x16x32_bf16 a[60:63], a[252:255], v[8:11], a[60:63]
    v_cvt_pk_bf16_f32 v24, v24, v25
    v_cvt_pk_bf16_f32 v25, v26, v27
    v_mfma_f32_16x16x32_bf16 v[64:67], v[228:231], v[8:11], v[64:67]
    s_waitcnt lgkmcnt(0)
    s_cmp_lg_u32 s39, 0
    s_cbranch_scc1 A0h0_loop
    s_branch A0h1_head
A0s_redo:
    s_cmp_lg_u32 s41, 0
    s_cbranch_scc1 A0s_ok
    s_waitcnt vmcnt(0) lgkmcnt(0)
    s_barrier
    s_lshl_b32 s75, s78, 4
    s_add_u32 s75, s75, s77
    s_add_u32 s75, s75, 1
    v_mov_b32 v0, v236
    s_branch K1_again
A0h0_enter:
    v_mov_b32 v16, 0
    v_mov_b32 v17, 0
    v_mov_b32 v18, 0
    v_mov_b32 v19, 0
    v_mov_b32 v20, 0
    v_mov_b32 v21, 0
    v_mov_b32 v22, 0
    v_mov_b32 v23, 0
    v_mov_b32 v24, 0
    v_mov_b32 v25, 0
    v_mov_b32 v26, 0
    v_mov_b32 v27, 0
    v_mov_b32 v28, 0xff800000
    v_mov_b32 v29, 0xff800000
    v_mov_b32 v30, 0xff800000
    v_mov_b32 v31, 0xff800000
    s_mov_b32 s39, 16
    s_mov_b32 s2, 3
    s_branch A0h0_loop
A1h0_head:
    s_mov_b32 s39, 16
    s_mov_b32 s2, 7
    s_waitcnt lgkmcnt(0)
    v_mfma_f32_16x16x32_bf16 v[0:3], a[192:195], v[80:83], 0
    v_accvgpr_write_b32 a128, 0
    v_accvgpr_write_b32 a129, 0
    v_accvgpr_write_b32 a130, 0
    v_mfma_f32_16x16x32_bf16 v[0:3], a[196:199], v[84:87], v[0:3]
    v_accvgpr_write_b32 a131, 0
    v_accvgpr_write_b32 a132, 0
    v_accvgpr_write_b32 a133, 0
    v_mfma_f32_16x16x32_bf16 v[0:3], a[200:203], v[88:91], v[0:3]
    v_accvgpr_write_b32 a134, 0
    v_accvgpr_write_b32 a135, 0
    v_accvgpr_write_b32 a136, 0
    v_mfma_f32_16x16x32_bf16 v[0:3], a[204:207], v[92:95], v[0:3]
    s_waitcnt vmcnt(8) lgkmcnt(0)
    s_barrier
    v_mfma_f32_16x16x32_bf16 v[4:7], a[208:211], v[80:83], 0
    s_add_u32 s74, s74, s44
    ds_read_b64_tr_b16 a[224:225], v212 offset:16384
    ds_read_b64_tr_b16 a[226:227], v212 offset:20480
    v_accvgpr_write_b32 a137, 0
    v_mfma_f32_16x16x32_bf16 v[4:7], a[212:215], v[84:87], v[4:7]
    s_xor_b32 s38, s74, 0x10000
    ds_read_b64_tr_b16 a[248:249], v218 offset:16384
    ds_read_b64_tr_b16 a[250:251], v218 offset:20480
    v_accvgpr_write_b32 a138, 0
    v_mfma_f32_16x16x32_bf16 v[4:7], a[216:219], v[88:91], v[4:7]
    s_add_u32 s38, s38, s3
    ds_read_b64_tr_b16 a[228:229], v213 offset:16384
    ds_read_b64_tr_b16 a[230:231], v213 offset:20480
    v_accvgpr_write_b32 a139, 0
    v_mfma_f32_16x16x32_bf16 v[4:7], a[220:223], v[92:95], v[4:7]
    s_add_u32 m0, s38, 0
    ds_read_b64_tr_b16 a[252:253], v219 offset:16384
    ds_read_b64_tr_b16 a[254:255], v219 offset:20480
    v_accvgpr_write_b32 a140, 0
    v_mfma_f32_16x16x32_bf16 v[8:11], a[192:195], v[96:99], 0
    s_xor_b32 s87, s85, s86
    ds_read_b64_tr_b16 a[232:233], v214 offset:16384
    ds_read_b64_tr_b16 a[234:235], v214 offset:20480
    v_accvgpr_write_b32 a141, 0
    v_mfma_f32_16x16x32_bf16 v[8:11], a[196:199], v[100:103], v[8:11]
    s_add_u32 s85, s85, 4096
    s_cmp_eq_u32 s74, 0x18000
    s_cselect_b32 s44, s45, s46
    v_accvgpr_write_b32 a142, 0
    v_mfma_f32_16x16x32_bf16 v[8:11], a[200:203], v[104:107], v[8:11]
    ds_read_b64_tr_b16 a[236:237], v215 offset:16384
    ds_read_b64_tr_b16 a[238:239], v215 offset:20480
    v_max3_f32 v240, v0, v1, v2
    v_max3_f32 v241, v3, v4, v5
    v_max3_f32 v240, v240, v6, v7
    v_max_f32 v240, v240, v241
    v_mfma_f32_16x16x32_bf16 v[8:11], a[204:207], v[108:111], v[8:11]
    buffer_load_dwordx4 v220, s[20:23], s87 offen nt lds
    v_mov_b32 v241, v240
    s_nop 1
    v_permlane32_swap_b32 v240, v241
    v_max_f32 v240, v240, v241
    v_mfma_f32_16x16x32_bf16 v[12:15], a[208:211], v[96:99], 0
    s_add_u32 m0, s38, 4096
    ds_read_b64_tr_b16 a[240:241], v216 offset:16384
    ds_read_b64_tr_b16 a[242:243], v216 offset:20480
    v_mov_b32 v241, v240
    s_nop 1
    v_permlane16_swap_b32 v240, v241
    v_max_f32 v240, v240, v241
    v_mfma_f32_16x16x32_bf16 v[12:15], a[212:215], v[100:103], v[12:15]
    s_xor_b32 s87, s85, s86
    s_add_u32 s85, s85, 4096
    v_sub_f32 v0, v0, v240
    v_sub_f32 v1, v1, v240
    v_sub_f32 v2, v2, v240
    v_sub_f32 v3, v3, v240
    v_sub_f32 v4, v4, v240
    v_sub_f32 v5, v5, v240
    v_mfma_f32_16x16x32_bf16 v[12:15], a[216:219], v[104:107], v[12:15]
    ds_read_b64_tr_b16 a[244:245], v217 offset:16384
    ds_read_b64_tr_b16 a[246:247], v217 offset:20480
    v_sub_f32 v6, v6, v240
    v_sub_f32 v7, v7, v240
    v_sub_f32 v40, 0, v240
    v_sub_f32 v41, 0, v240
    v_sub_f32 v42, 0, v240
    v_mfma_f32_16x16x32_bf16 v[12:15], a[220:223], v[108:111], v[12:15]
    buffer_load_dwordx4 v220, s[20:23], s87 offen nt lds
    v_sub_f32 v43, 0, v240
    v_exp_f32 v0, v0
    v_exp_f32 v1, v1
    v_mfma_f32_16x16x32_bf16 v[16:19], a[192:195], v[112:115], 0
    s_add_u32 m0, s38, 8192
    s_xor_b32 s87, s85, s86
    s_add_u32 s85, s85, 4096
    v_exp_f32 v2, v2
    v_exp_f32 v3, v3
    v_cvt_pk_bf16_f32 v0, v0, v1
    v_mfma_f32_16x16x32_bf16 v[16:19], a[196:199], v[116:119], v[16:19]
    buffer_load_dwordx4 v220, s[20:23], s87 offen nt lds
    v_cvt_pk_bf16_f32 v1, v2, v3
    v_exp_f32 v4, v4
    v_exp_f32 v5, v5
    v_mfma_f32_16x16x32_bf16 v[16:19], a[200:203], v[120:123], v[16:19]
    s_add_u32 m0, s38, 12288
    s_xor_b32 s87, s85, s86
    s_add_u32 s85, s85, 4096
    v_exp_f32 v6, v6
    v_exp_f32 v7, v7
    v_cvt_pk_bf16_f32 v2, v4, v5
    v_mfma_f32_16x16x32_bf16 v[16:19], a[204:207], v[124:127], v[16:19]
    v_cvt_pk_bf16_f32 v3, v6, v7
    v_max3_f32 v242, v8, v9, v10
    v_max3_f32 v243, v11, v12, v13
    v_max3_f32 v242, v242, v14, v15
    v_mfma_f32_16x16x32_bf16 v[20:23], a[208:211], v[112:115], 0
    v_max_f32 v242, v242, v243
    v_mov_b32 v243, v242
    s_nop 1
    v_permlane32_swap_b32 v242, v243
    v_max_f32 v242, v242, v243
    v_mfma_f32_16x16x32_bf16 v[20:23], a[212:215], v[116:119], v[20:23]
    v_mov_b32 v243, v242
    s_nop 1
    v_permlane16_swap_b32 v242, v243
    v_max_f32 v242, v242, v243
    v_mfma_f32_16x16x32_bf16 v[20:23], a[216:219], v[120:123], v[20:23]
    v_sub_f32 v8, v8, v242
    v_sub_f32 v9, v9, v242
    v_sub_f32 v10, v10, v242
    v_sub_f32 v11, v11, v242
    v_mfma_f32_16x16x32_bf16 v[20:23], a[220:223], v[124:127], v[20:23]
    s_waitcnt lgkmcnt(0)
    v_sub_f32 v12, v12, v242
    v_sub_f32 v13, v13, v242
    v_sub_f32 v14, v14, v242
    v_sub_f32 v15, v15, v242
    v_mfma_f32_16x16x32_bf16 a[0:3], a[224:227], v[0:3], 0
    v_sub_f32 v44, 0, v242
    v_sub_f32 v45, 0, v242
    v_sub_f32 v46, 0, v242
    v_sub_f32 v47, 0, v242
    v_mfma_f32_16x16x32_bf16 a[4:7], a[228:231], v[0:3], 0
    buffer_load_dwordx4 v220, s[20:23], s87 offen nt lds
    v_exp_f32 v8, v8
    v_mfma_f32_16x16x32_bf16 a[8:11], a[232:235], v[0:3], 0
    s_add_u32 m0, s38, 16384
    s_xor_b32 s87, s37, s86
    s_add_u32 s37, s37, 4096
    v_exp_f32 v9, v9
    v_mfma_f32_16x16x32_bf16 a[12:15], a[236:239], v[0:3], 0
    v_exp_f32 v10, v10
    v_exp_f32 v11, v11
    v_mfma_f32_16x16x32_bf16 a[16:19], a[240:243], v[0:3], 0
    v_cvt_pk_bf16_f32 v8, v8, v9
    v_cvt_pk_bf16_f32 v9, v10, v11
    v_exp_f32 v12, v12
    v_mfma_f32_16x16x32_bf16 a[20:23], a[244:247], v[0:3], 0
    v_exp_f32 v13, v13
    v_exp_f32 v14, v14
    v_mfma_f32_16x16x32_bf16 a[24:27], a[248:251], v[0:3], 0
    v_exp_f32 v15, v15
    v_cvt_pk_bf16_f32 v10, v12, v13
    v_cvt_pk_bf16_f32 v11, v14, v15
    v_mfma_f32_16x16x32_bf16 a[28:31], a[252:255], v[0:3], 0
    v_max3_f32 v240, v16, v17, v18
    v_max3_f32 v241, v19, v20, v21
    v_max3_f32 v240, v240, v22, v23
    v_mfma_f32_16x16x32_bf16 v[60:63], v[228:231], v[0:3], 0
    v_max_f32 v240, v240, v241
    v_mov_b32 v241, v240
    s_nop 1
    v_permlane32_swap_b32 v240, v241
    v_max_f32 v240, v240, v241
    v_mfma_f32_16x16x32_bf16 v[24:27], a[192:195], v[128:131], 0
    v_mov_b32 v241, v240
    s_nop 1
    v_permlane16_swap_b32 v240, v241
    v_max_f32 v240, v240, v241
    v_mfma_f32_16x16x32_bf16 v[24:27], a[196:199], v[132:135], v[24:27]
    ds_read_b128 a[192:195], v208 offset:0
    ds_read_b128 a[196:199], v209 offset:0
    v_sub_f32 v16, v16, v240
    v_mfma_f32_16x16x32_bf16 v[24:27], a[200:203], v[136:139], v[24:27]
    v_sub_f32 v17, v17, v240
    v_sub_f32 v18, v18, v240
    v_sub_f32 v19, v19, v240
    v_mfma_f32_16x16x32_bf16 v[24:27], a[204:207], v[140:143], v[24:27]
    ds_read_b128 a[200:203], v210 offset:0
    ds_read_b128 a[204:207], v211 offset:0
    v_sub_f32 v20, v20, v240
    v_mfma_f32_16x16x32_bf16 v[28:31], a[208:211], v[128:131], 0
    buffer_load_dwordx4 v224, s[24:27], s87 offen nt lds
    v_sub_f32 v21, v21, v240
    v_mfma_f32_16x16x32_bf16 v[28:31], a[212:215], v[132:135], v[28:31]
    s_add_u32 m0, s38, 20480
    ds_read_b128 a[208:211], v208 offset:4096
    ds_read_b128 a[212:215], v209 offset:4096
    v_sub_f32 v22, v22, v240
    v_mfma_f32_16x16x32_bf16 v[28:31], a[216:219], v[136:139], v[28:31]
    s_xor_b32 s87, s37, s86
    s_add_u32 s37, s37, 4096
    v_sub_f32 v23, v23, v240
    v_sub_f32 v48, 0, v240
    v_mfma_f32_16x16x32_bf16 v[28:31], a[220:223], v[140:143], v[28:31]
    ds_read_b128 a[216:219], v210 offset:4096
    ds_read_b128 a[220:223], v211 offset:4096
    v_sub_f32 v49, 0, v240
    v_mfma_f32_16x16x32_bf16 a[32:35], a[224:227], v[8:11], 0
    v_sub_f32 v50, 0, v240
    v_sub_f32 v51, 0, v240
    v_accvgpr_write_b32 a143, 0
    v_mfma_f32_16x16x32_bf16 a[36:39], a[228:231], v[8:11], 0
    v_exp_f32 v16, v16
    v_accvgpr_write_b32 a144, 0
    v_mfma_f32_16x16x32_bf16 a[40:43], a[232:235], v[8:11], 0
    v_exp_f32 v17, v17
    v_max3_f32 v242, v24, v25, v26
    v_mfma_f32_16x16x32_bf16 a[44:47], a[236:239], v[8:11], 0
    v_exp_f32 v18, v18
    v_max3_f32 v243, v27, v28, v29
    v_mfma_f32_16x16x32_bf16 a[48:51], a[240:243], v[8:11], 0
    v_exp_f32 v19, v19
    v_cvt_pk_bf16_f32 v16, v16, v17
    v_mfma_f32_16x16x32_bf16 a[52:55], a[244:247], v[8:11], 0
    v_cvt_pk_bf16_f32 v17, v18, v19
    v_exp_f32 v20, v20
    v_mfma_f32_16x16x32_bf16 a[56:59], a[248:251], v[8:11], 0
    v_exp_f32 v21, v21
    v_max3_f32 v242, v242, v30, v31
    v_mfma_f32_16x16x32_bf16 a[60:63], a[252:255], v[8:11], 0
    v_exp_f32 v22, v22
    v_max_f32 v242, v242, v243
    v_mfma_f32_16x16x32_bf16 v[64:67], v[228:231], v[8:11], 0
    s_waitcnt lgkmcnt(0)
    v_exp_f32 v23, v23
    v_cvt_pk_bf16_f32 v18, v20, v21
    v_mfma_f32_16x16x32_bf16 v[0:3], a[192:195], v[80:83], v[40:43]
    buffer_load_dwordx4 v224, s[24:27], s87 offen nt lds
    v_cvt_pk_bf16_f32 v19, v22, v23
    v_mfma_f32_16x16x32_bf16 v[0:3], a[196:199], v[84:87], v[0:3]
    s_add_u32 m0, s38, 24576
    s_xor_b32 s87, s37, s86
    s_add_u32 s37, s37, 4096
    v_accvgpr_write_b32 a145, 0
    v_mfma_f32_16x16x32_bf16 v[0:3], a[200:203], v[88:91], v[0:3]
    v_mov_b32 v243, v242
    s_nop 1
    v_permlane32_swap_b32 v242, v243
    v_max_f32 v242, v242, v243
    v_mfma_f32_16x16x32_bf16 v[0:3], a[204:207], v[92:95], v[0:3]
    v_mov_b32 v243, v242
    s_nop 1
    v_permlane16_swap_b32 v242, v243
    v_max_f32 v242, v242, v243
    v_mfma_f32_16x16x32_bf16 v[4:7], a[208:211], v[80:83], v[40:43]
    v_sub_f32 v24, v24, v242
    v_sub_f32 v25, v25, v242
    v_sub_f32 v26, v26, v242
    v_mfma_f32_16x16x32_bf16 v[4:7], a[212:215], v[84:87], v[4:7]
    v_sub_f32 v27, v27, v242
    v_sub_f32 v28, v28, v242
    v_sub_f32 v29, v29, v242
    v_mfma_f32_16x16x32_bf16 v[4:7], a[216:219], v[88:91], v[4:7]
    v_sub_f32 v30, v30, v242
    v_sub_f32 v31, v31, v242
    v_sub_f32 v52, 0, v242
    v_mfma_f32_16x16x32_bf16 v[4:7], a[220:223], v[92:95], v[4:7]
    v_sub_f32 v53, 0, v242
    v_sub_f32 v54, 0, v242
    v_sub_f32 v55, 0, v242
    v_mfma_f32_16x16x32_bf16 a[64:67], a[224:227], v[16:19], 0
    v_exp_f32 v24, v24
    v_accvgpr_write_b32 a146, 0
    v_mfma_f32_16x16x32_bf16 a[68:71], a[228:231], v[16:19], 0
    v_exp_f32 v25, v25
    v_accvgpr_write_b32 a147, 0
    v_mfma_f32_16x16x32_bf16 a[72:75], a[232:235], v[16:19], 0
    v_exp_f32 v26, v26
    v_accvgpr_write_b32 a148, 0
    v_mfma_f32_16x16x32_bf16 a[76:79], a[236:239], v[16:19], 0
    buffer_load_dwordx4 v224, s[24:27], s87 offen nt lds
    v_accvgpr_write_b32 a149, 0
    v_mfma_f32_16x16x32_bf16 a[80:83], a[240:243], v[16:19], 0
    s_add_u32 m0, s38, 28672
    s_xor_b32 s87, s37, s86
    s_add_u32 s37, s37, 4096
    v_accvgpr_write_b32 a150, 0
    v_mfma_f32_16x16x32_bf16 a[84:87], a[244:247], v[16:19], 0
    v_exp_f32 v27, v27
    v_cvt_pk_bf16_f32 v24, v24, v25
    v_mfma_f32_16x16x32_bf16 a[88:91], a[248:251], v[16:19], 0
    v_cvt_pk_bf16_f32 v25, v26, v27
    v_exp_f32 v28, v28
    v_mfma_f32_16x16x32_bf16 a[92:95], a[252:255], v[16:19], 0
    v_exp_f32 v29, v29
    v_accvgpr_write_b32 a151, 0
    v_mfma_f32_16x16x32_bf16 v[68:71], v[228:231], v[16:19], 0
    v_exp_f32 v30, v30
    v_accvgpr_write_b32 a152, 0
    v_mfma_f32_16x16x32_bf16 v[8:11], a[192:195], v[96:99], v[44:47]
    v_exp_f32 v31, v31
    v_cvt_pk_bf16_f32 v26, v28, v29
    v_mfma_f32_16x16x32_bf16 v[8:11], a[196:199], v[100:103], v[8:11]
    v_cvt_pk_bf16_f32 v27, v30, v31
    v_exp_f32 v0, v0
    v_mfma_f32_16x16x32_bf16 v[8:11], a[200:203], v[104:107], v[8:11]
    v_exp_f32 v1, v1
    v_accvgpr_write_b32 a153, 0
    v_mfma_f32_16x16x32_bf16 v[8:11], a[204:207], v[108:111], v[8:11]
    v_exp_f32 v2, v2
    v_accvgpr_write_b32 a154, 0
    v_mfma_f32_16x16x32_bf16 v[12:15], a[208:211], v[96:99], v[44:47]
    v_exp_f32 v3, v3
    v_cvt_pk_bf16_f32 v0, v0, v1
    v_mfma_f32_16x16x32_bf16 v[12:15], a[212:215], v[100:103], v[12:15]
    v_cvt_pk_bf16_f32 v1, v2, v3
    v_exp_f32 v4, v4
    v_mfma_f32_16x16x32_bf16 v[12:15], a[216:219], v[104:107], v[12:15]
    buffer_load_dwordx4 v224, s[24:27], s87 offen nt lds
    v_accvgpr_write_b32 a155, 0
    v_mfma_f32_16x16x32_bf16 v[12:15], a[220:223], v[108:111], v[12:15]
    s_xor_b32 s82, s76, 8192
    s_add_u32 s76, s76, 1024
    v_exp_f32 v5, v5
    v_mfma_f32_16x16x32_bf16 a[96:99], a[224:227], v[24:27], 0
    ds_read_b64_tr_b16 a[224:225], v212 offset:24576
    ds_read_b64_tr_b16 a[226:227], v212 offset:28672
    v_accvgpr_write_b32 a156, 0
    v_mfma_f32_16x16x32_bf16 a[100:103], a[228:231], v[24:27], 0
    v_exp_f32 v6, v6
    v_accvgpr_write_b32 a157, 0
    v_mfma_f32_16x16x32_bf16 a[104:107], a[232:235], v[24:27], 0
    ds_read_b64_tr_b16 a[228:229], v213 offset:24576
    ds_read_b64_tr_b16 a[230:231], v213 offset:28672
    v_accvgpr_write_b32 a158, 0
    v_mfma_f32_16x16x32_bf16 a[108:111], a[236:239], v[24:27], 0
    v_add_u32 v212, s44, v212
    v_add_u32 v213, s44, v213
    v_accvgpr_write_b32 a159, 0
    v_mfma_f32_16x16x32_bf16 a[112:115], a[240:243], v[24:27], 0
    ds_read_b64_tr_b16 a[232:233], v214 offset:24576
    ds_read_b64_tr_b16 a[234:235], v214 offset:28672
    v_mov_b32 v76, 0
    v_mfma_f32_16x16x32_bf16 a[116:119], a[244:247], v[24:27], 0
    v_exp_f32 v7, v7
    v_cvt_pk_bf16_f32 v2, v4, v5
    v_mfma_f32_16x16x32_bf16 a[120:123], a[248:251], v[24:27], 0
    ds_read_b64_tr_b16 a[236:237], v215 offset:24576
    ds_read_b64_tr_b16 a[238:239], v215 offset:28672
    v_cvt_pk_bf16_f32 v3, v6, v7
    v_mfma_f32_16x16x32_bf16 a[124:127], a[252:255], v[24:27], 0
    v_add_u32 v214, s44, v214
    v_add_u32 v215, s44, v215
    v_mov_b32 v77, 0
    v_mfma_f32_16x16x32_bf16 v[72:75], v[228:231], v[24:27], 0
    ds_read_b64_tr_b16 a[240:241], v216 offset:24576
    ds_read_b64_tr_b16 a[242:243], v216 offset:28672
    v_mov_b32 v78, 0
    v_mfma_f32_16x16x32_bf16 v[16:19], a[192:195], v[112:115], v[48:51]
    v_exp_f32 v8, v8
    v_mov_b32 v79, 0
    v_mfma_f32_16x16x32_bf16 v[16:19], a[196:199], v[116:119], v[16:19]
    ds_read_b64_tr_b16 a[244:245], v217 offset:24576
    ds_read_b64_tr_b16 a[246:247], v217 offset:28672
    v_mfma_f32_16x16x32_bf16 v[16:19], a[200:203], v[120:123], v[16:19]
    buffer_load_dword v226, v237, s[16:19], s82 offen
    v_mfma_f32_16x16x32_bf16 v[16:19], a[204:207], v[124:127], v[16:19]
    ds_read_b64_tr_b16 a[248:249], v218 offset:24576
    ds_read_b64_tr_b16 a[250:251], v218 offset:28672
    v_mfma_f32_16x16x32_bf16 v[20:23], a[208:211], v[112:115], v[48:51]
    v_add_u32 v216, s44, v216
    v_add_u32 v217, s44, v217
    v_mfma_f32_16x16x32_bf16 v[20:23], a[212:215], v[116:119], v[20:23]
    ds_read_b64_tr_b16 a[252:253], v219 offset:24576
    ds_read_b64_tr_b16 a[254:255], v219 offset:28672
    v_mfma_f32_16x16x32_bf16 v[20:23], a[216:219], v[120:123], v[20:23]
    v_add_u32 v218, s44, v218
    v_add_u32 v219, s44, v219
    v_mfma_f32_16x16x32_bf16 v[20:23], a[220:223], v[124:127], v[20:23]
    s_waitcnt lgkmcnt(6)
    v_exp_f32 v9, v9
    v_mfma_f32_16x16x32_bf16 a[0:3], a[224:227], v[0:3], a[0:3]
    v_exp_f32 v10, v10
    v_mfma_f32_16x16x32_bf16 a[4:7], a[228:231], v[0:3], a[4:7]
    v_exp_f32 v11, v11
    v_mfma_f32_16x16x32_bf16 a[8:11], a[232:235], v[0:3], a[8:11]
    v_cvt_pk_bf16_f32 v8, v8, v9
    v_cvt_pk_bf16_f32 v9, v10, v11
    v_mfma_f32_16x16x32_bf16 a[12:15], a[236:239], v[0:3], a[12:15]
    v_exp_f32 v12, v12
    v_mfma_f32_16x16x32_bf16 a[16:19], a[240:243], v[0:3], a[16:19]
    s_waitcnt lgkmcnt(2)
    v_exp_f32 v13, v13
    v_mfma_f32_16x16x32_bf16 a[20:23], a[244:247], v[0:3], a[20:23]
    v_exp_f32 v14, v14
    v_mfma_f32_16x16x32_bf16 a[24:27], a[248:251], v[0:3], a[24:27]
    s_waitcnt lgkmcnt(0)
    v_exp_f32 v15, v15
    v_mfma_f32_16x16x32_bf16 a[28:31], a[252:255], v[0:3], a[28:31]
    v_cvt_pk_bf16_f32 v10, v12, v13
    v_cvt_pk_bf16_f32 v11, v14, v15
    v_mfma_f32_16x16x32_bf16 v[60:63], v[228:231], v[0:3], v[60:63]
    v_exp_f32 v16, v16
    v_mfma_f32_16x16x32_bf16 v[24:27], a[192:195], v[128:131], v[52:55]
    v_exp_f32 v17, v17
    v_mfma_f32_16x16x32_bf16 v[24:27], a[196:199], v[132:135], v[24:27]
    v_exp_f32 v18, v18
    v_mfma_f32_16x16x32_bf16 v[24:27], a[200:203], v[136:139], v[24:27]
    v_exp_f32 v19, v19
    v_mfma_f32_16x16x32_bf16 v[24:27], a[204:207], v[140:143], v[24:27]
    v_cvt_pk_bf16_f32 v16, v16, v17
    v_cvt_pk_bf16_f32 v17, v18, v19
    v_mfma_f32_16x16x32_bf16 v[28:31], a[208:211], v[128:131], v[52:55]
    v_exp_f32 v20, v20
    v_mfma_f32_16x16x32_bf16 v[28:31], a[212:215], v[132:135], v[28:31]
    v_exp_f32 v21, v21
    v_mfma_f32_16x16x32_bf16 v[28:31], a[216:219], v[136:139], v[28:31]
    v_exp_f32 v22, v22
    v_mfma_f32_16x16x32_bf16 v[28:31], a[220:223], v[140:143], v[28:31]
    v_exp_f32 v23, v23
    v_mfma_f32_16x16x32_bf16 a[32:35], a[224:227], v[8:11], a[32:35]
    v_cvt_pk_bf16_f32 v18, v20, v21
    v_cvt_pk_bf16_f32 v19, v22, v23
    v_mfma_f32_16x16x32_bf16 a[36:39], a[228:231], v[8:11], a[36:39]
    v_exp_f32 v24, v24
    v_mfma_f32_16x16x32_bf16 a[40:43], a[232:235], v[8:11], a[40:43]
    v_exp_f32 v25, v25
    v_mfma_f32_16x16x32_bf16 a[44:47], a[236:239], v[8:11], a[44:47]
    v_exp_f32 v26, v26
    v_mfma_f32_16x16x32_bf16 a[48:51], a[240:243], v[8:11], a[48:51]
    v_exp_f32 v27, v27
    v_mfma_f32_16x16x32_bf16 a[52:55], a[244:247], v[8:11], a[52:55]
    v_cvt_pk_bf16_f32 v24, v24, v25
    v_cvt_pk_bf16_f32 v25, v26, v27
    v_mfma_f32_16x16x32_bf16 a[56:59], a[248:251], v[8:11], a[56:59]
    v_exp_f32 v28, v28
    v_mfma_f32_16x16x32_bf16 a[60:63], a[252:255], v[8:11], a[60:63]
    v_exp_f32 v29, v29
    v_mfma_f32_16x16x32_bf16 v[64:67], v[228:231], v[8:11], v[64:67]
    v_exp_f32 v30, v30
    v_mfma_f32_16x16x32_bf16 v[32:35], a[192:195], v[144:147], 0
    v_exp_f32 v31, v31
    v_mfma_f32_16x16x32_bf16 v[32:35], a[196:199], v[148:151], v[32:35]
    ds_read_b128 a[192:195], v208 offset:8192
    ds_read_b128 a[196:199], v209 offset:8192
    v_mfma_f32_16x16x32_bf16 v[32:35], a[200:203], v[152:155], v[32:35]
    v_cvt_pk_bf16_f32 v26, v28, v29
    v_cvt_pk_bf16_f32 v27, v30, v31
    v_mfma_f32_16x16x32_bf16 v[32:35], a[204:207], v[156:159], v[32:35]
    ds_read_b128 a[200:203], v210 offset:8192
    ds_read_b128 a[204:207], v211 offset:8192
    v_mfma_f32_16x16x32_bf16 v[36:39], a[208:211], v[144:147], 0
    v_mfma_f32_16x16x32_bf16 v[36:39], a[212:215], v[148:151], v[36:39]
    s_sub_u32 s39, s39, 1
    ds_read_b128 a[208:211], v208 offset:12288
    ds_read_b128 a[212:215], v209 offset:12288
    v_mfma_f32_16x16x32_bf16 v[36:39], a[216:219], v[152:155], v[36:39]
    v_add_u32 v208, s44, v208
    v_add_u32 v209, s44, v209
    v_mfma_f32_16x16x32_bf16 v[36:39], a[220:223], v[156:159], v[36:39]
    ds_read_b128 a[216:219], v210 offset:12288
    ds_read_b128 a[220:223], v211 offset:12288
    v_mfma_f32_16x16x32_bf16 a[64:67], a[224:227], v[16:19], a[64:67]
    v_add_u32 v210, s44, v210
    v_add_u32 v211, s44, v211
    v_mfma_f32_16x16x32_bf16 a[68:71], a[228:231], v[16:19], a[68:71]
    v_mfma_f32_16x16x32_bf16 a[72:75], a[232:235], v[16:19], a[72:75]
    v_max3_f32 v240, v32, v33, v34
    v_max3_f32 v241, v35, v36, v37
    v_mfma_f32_16x16x32_bf16 a[76:79], a[236:239], v[16:19], a[76:79]
    v_max3_f32 v240, v240, v38, v39
    v_max_f32 v240, v240, v241
    v_mfma_f32_16x16x32_bf16 a[80:83], a[240:243], v[16:19], a[80:83]
    v_mov_b32 v241, v240
    s_nop 1
    v_permlane32_swap_b32 v240, v241
    v_max_f32 v240, v240, v241
    v_mfma_f32_16x16x32_bf16 a[84:87], a[244:247], v[16:19], a[84:87]
    v_mov_b32 v241, v240
    s_nop 1
    v_permlane16_swap_b32 v240, v241
    v_max_f32 v240, v240, v241
    v_mfma_f32_16x16x32_bf16 a[88:91], a[248:251], v[16:19], a[88:91]
    v_sub_f32 v32, v32, v240
    v_sub_f32 v33, v33, v240
    v_mfma_f32_16x16x32_bf16 a[92:95], a[252:255], v[16:19], a[92:95]
    v_sub_f32 v34, v34, v240
    v_sub_f32 v35, v35, v240
    v_mfma_f32_16x16x32_bf16 v[68:71], v[228:231], v[16:19], v[68:71]
    v_sub_f32 v36, v36, v240
    v_sub_f32 v37, v37, v240
    v_sub_f32 v38, v38, v240
    v_sub_f32 v39, v39, v240
    v_sub_f32 v56, 0, v240
    v_sub_f32 v57, 0, v240
    v_sub_f32 v58, 0, v240
    v_sub_f32 v59, 0, v240
    v_exp_f32 v32, v32
    v_exp_f32 v33, v33
    v_exp_f32 v34, v34
    v_exp_f32 v35, v35
    v_cvt_pk_bf16_f32 v32, v32, v33
    v_cvt_pk_bf16_f32 v33, v34, v35
    v_exp_f32 v36, v36
    v_exp_f32 v37, v37
    s_waitcnt lgkmcnt(0)
.p2align 6
A1h0_loop:
    v_mfma_f32_16x16x32_bf16 v[0:3], a[192:195], v[80:83], v[40:43]
    v_exp_f32 v38, v38
    v_mfma_f32_16x16x32_bf16 v[0:3], a[196:199], v[84:87], v[0:3]
    v_exp_f32 v39, v39
    v_mfma_f32_16x16x32_bf16 v[0:3], a[200:203], v[88:91], v[0:3]
    v_cvt_pk_bf16_f32 v34, v36, v37
    v_cvt_pk_bf16_f32 v35, v38, v39
    v_mfma_f32_16x16x32_bf16 v[0:3], a[204:207], v[92:95], v[0:3]
    v_mfma_f32_16x16x32_bf16 v[4:7], a[208:211], v[80:83], v[40:43]
    v_mfma_f32_16x16x32_bf16 v[4:7], a[212:215], v[84:87], v[4:7]
    v_mfma_f32_16x16x32_bf16 v[4:7], a[216:219], v[88:91], v[4:7]
    v_exp_f32 v0, v0
    v_mfma_f32_16x16x32_bf16 v[4:7], a[220:223], v[92:95], v[4:7]
    v_exp_f32 v1, v1
    v_mfma_f32_16x16x32_bf16 a[96:99], a[224:227], v[24:27], a[96:99]
    v_exp_f32 v2, v2
    v_mfma_f32_16x16x32_bf16 a[100:103], a[228:231], v[24:27], a[100:103]
    v_exp_f32 v3, v3
    v_mfma_f32_16x16x32_bf16 a[104:107], a[232:235], v[24:27], a[104:107]
    s_waitcnt vmcnt(9) lgkmcnt(0)
    s_barrier
    v_mfma_f32_16x16x32_bf16 a[108:111], a[236:239], v[24:27], a[108:111]
    s_add_u32 s74, s74, s44
    v_cvt_pk_bf16_f32 v0, v0, v1
    v_cvt_pk_bf16_f32 v1, v2, v3
    v_mfma_f32_16x16x32_bf16 a[112:115], a[240:243], v[24:27], a[112:115]
    s_xor_b32 s38, s74, 0x10000
    v_exp_f32 v4, v4
    v_mfma_f32_16x16x32_bf16 a[116:119], a[244:247], v[24:27], a[116:119]
    s_add_u32 s38, s38, s3
    v_exp_f32 v5, v5
    v_mfma_f32_16x16x32_bf16 a[120:123], a[248:251], v[24:27], a[120:123]
    s_add_u32 m0, s38, 0
    s_xor_b32 s87, s85, s86
    s_add_u32 s85, s85, 4096
    v_mfma_f32_16x16x32_bf16 a[124:127], a[252:255], v[24:27], a[124:127]
    buffer_load_dwordx4 v220, s[20:23], s87 offen nt lds
    v_mfma_f32_16x16x32_bf16 v[72:75], v[228:231], v[24:27], v[72:75]
    s_add_u32 m0, s38, 4096
    s_xor_b32 s87, s85, s86
    s_add_u32 s85, s85, 4096
    v_mfma_f32_16x16x32_bf16 v[8:11], a[192:195], v[96:99], v[44:47]
    s_cmp_eq_u32 s74, 0x18000
    s_cselect_b32 s44, s45, s46
    v_mfma_f32_16x16x32_bf16 v[8:11], a[196:199], v[100:103], v[8:11]
    v_exp_f32 v6, v6
    v_mfma_f32_16x16x32_bf16 v[8:11], a[200:203], v[104:107], v[8:11]
    v_exp_f32 v7, v7
    v_mfma_f32_16x16x32_bf16 v[8:11], a[204:207], v[108:111], v[8:11]
    v_cvt_pk_bf16_f32 v2, v4, v5
    v_cvt_pk_bf16_f32 v3, v6, v7
    v_mfma_f32_16x16x32_bf16 v[12:15], a[208:211], v[96:99], v[44:47]
    v_mfma_f32_16x16x32_bf16 v[12:15], a[212:215], v[100:103], v[12:15]
    v_mfma_f32_16x16x32_bf16 v[12:15], a[216:219], v[104:107], v[12:15]
    v_exp_f32 v8, v8
    v_mfma_f32_16x16x32_bf16 v[12:15], a[220:223], v[108:111], v[12:15]
    v_exp_f32 v9, v9
    v_mfma_f32_16x16x32_bf16 a[128:131], a[224:227], v[32:35], a[128:131]
    ds_read_b64_tr_b16 a[224:225], v212 offset:16384
    ds_read_b64_tr_b16 a[226:227], v212 offset:20480
    v_mfma_f32_16x16x32_bf16 a[132:135], a[228:231], v[32:35], a[132:135]
    buffer_load_dwordx4 v220, s[20:23], s87 offen nt lds
    v_mfma_f32_16x16x32_bf16 a[136:139], a[232:235], v[32:35], a[136:139]
    s_add_u32 m0, s38, 8192
    ds_read_b64_tr_b16 a[228:229], v213 offset:16384
    ds_read_b64_tr_b16 a[230:231], v213 offset:20480
    v_mfma_f32_16x16x32_bf16 a[140:143], a[236:239], v[32:35], a[140:143]
    s_xor_b32 s87, s85, s86
    s_add_u32 s85, s85, 4096
    v_mfma_f32_16x16x32_bf16 a[144:147], a[240:243], v[32:35], a[144:147]
    ds_read_b64_tr_b16 a[232:233], v214 offset:16384
    ds_read_b64_tr_b16 a[234:235], v214 offset:20480
    v_mfma_f32_16x16x32_bf16 a[148:151], a[244:247], v[32:35], a[148:151]
    v_exp_f32 v10, v10
    v_mfma_f32_16x16x32_bf16 a[152:155], a[248:251], v[32:35], a[152:155]
    ds_read_b64_tr_b16 a[236:237], v215 offset:16384
    ds_read_b64_tr_b16 a[238:239], v215 offset:20480
    v_mfma_f32_16x16x32_bf16 a[156:159], a[252:255], v[32:35], a[156:159]
    v_exp_f32 v11, v11
    v_mfma_f32_16x16x32_bf16 v[76:79], v[228:231], v[32:35], v[76:79]
    ds_read_b64_tr_b16 a[240:241], v216 offset:16384
    ds_read_b64_tr_b16 a[242:243], v216 offset:20480
    v_mfma_f32_16x16x32_bf16 v[16:19], a[192:195], v[112:115], v[48:51]
    v_cvt_pk_bf16_f32 v8, v8, v9
    v_cvt_pk_bf16_f32 v9, v10, v11
    v_mfma_f32_16x16x32_bf16 v[16:19], a[196:199], v[116:119], v[16:19]
    ds_read_b64_tr_b16 a[244:245], v217 offset:16384
    ds_read_b64_tr_b16 a[246:247], v217 offset:20480
    v_mfma_f32_16x16x32_bf16 v[16:19], a[200:203], v[120:123], v[16:19]
    v_exp_f32 v12, v12
    v_mfma_f32_16x16x32_bf16 v[16:19], a[204:207], v[124:127], v[16:19]
    ds_read_b64_tr_b16 a[248:249], v218 offset:16384
    ds_read_b64_tr_b16 a[250:251], v218 offset:20480
    v_mfma_f32_16x16x32_bf16 v[20:23], a[208:211], v[112:115], v[48:51]
    buffer_load_dwordx4 v220, s[20:23], s87 offen nt lds
    v_mfma_f32_16x16x32_bf16 v[20:23], a[212:215], v[116:119], v[20:23]
    s_add_u32 m0, s38, 12288
    ds_read_b64_tr_b16 a[252:253], v219 offset:16384
    ds_read_b64_tr_b16 a[254:255], v219 offset:20480
    v_mfma_f32_16x16x32_bf16 v[20:23], a[216:219], v[120:123], v[20:23]
    s_xor_b32 s87, s85, s86
    s_add_u32 s85, s85, 4096
    v_mfma_f32_16x16x32_bf16 v[20:23], a[220:223], v[124:127], v[20:23]
    s_waitcnt lgkmcnt(6)
    v_exp_f32 v13, v13
    v_mfma_f32_16x16x32_bf16 a[0:3], a[224:227], v[0:3], a[0:3]
    v_exp_f32 v14, v14
    v_mfma_f32_16x16x32_bf16 a[4:7], a[228:231], v[0:3], a[4:7]
    v_exp_f32 v15, v15
    v_mfma_f32_16x16x32_bf16 a[8:11], a[232:235], v[0:3], a[8:11]
    v_cvt_pk_bf16_f32 v10, v12, v13
    v_cvt_pk_bf16_f32 v11, v14, v15
    v_mfma_f32_16x16x32_bf16 a[12:15], a[236:239], v[0:3], a[12:15]
    v_exp_f32 v16, v16
    v_mfma_f32_16x16x32_bf16 a[16:19], a[240:243], v[0:3], a[16:19]
    s_waitcnt lgkmcnt(2)
    v_exp_f32 v17, v17
    v_mfma_f32_16x16x32_bf16 a[20:23], a[244:247], v[0:3], a[20:23]
    v_exp_f32 v18, v18
    v_mfma_f32_16x16x32_bf16 a[24:27], a[248:251], v[0:3], a[24:27]
    s_waitcnt lgkmcnt(0)
    v_exp_f32 v19, v19
    v_mfma_f32_16x16x32_bf16 a[28:31], a[252:255], v[0:3], a[28:31]
    v_cvt_pk_bf16_f32 v16, v16, v17
    v_cvt_pk_bf16_f32 v17, v18, v19
    v_mfma_f32_16x16x32_bf16 v[60:63], v[228:231], v[0:3], v[60:63]
    buffer_load_dwordx4 v220, s[20:23], s87 offen nt lds
    v_mfma_f32_16x16x32_bf16 v[24:27], a[192:195], v[128:131], v[52:55]
    s_add_u32 m0, s38, 16384
    s_xor_b32 s87, s37, s86
    s_add_u32 s37, s37, 4096
    v_mfma_f32_16x16x32_bf16 v[24:27], a[196:199], v[132:135], v[24:27]
    ds_read_b128 a[192:195], v208 offset:0
    ds_read_b128 a[196:199], v209 offset:0
    v_mfma_f32_16x16x32_bf16 v[24:27], a[200:203], v[136:139], v[24:27]
    v_exp_f32 v20, v20
    v_mfma_f32_16x16x32_bf16 v[24:27], a[204:207], v[140:143], v[24:27]
    ds_read_b128 a[200:203], v210 offset:0
    ds_read_b128 a[204:207], v211 offset:0
    v_mfma_f32_16x16x32_bf16 v[28:31], a[208:211], v[128:131], v[52:55]
    v_exp_f32 v21, v21
    v_mfma_f32_16x16x32_bf16 v[28:31], a[212:215], v[132:135], v[28:31]
    ds_read_b128 a[208:211], v208 offset:4096
    ds_read_b128 a[212:215], v209 offset:4096
    v_mfma_f32_16x16x32_bf16 v[28:31], a[216:219], v[136:139], v[28:31]
    v_exp_f32 v22, v22
    v_mfma_f32_16x16x32_bf16 v[28:31], a[220:223], v[140:143], v[28:31]
    ds_read_b128 a[216:219], v210 offset:4096
    ds_read_b128 a[220:223], v211 offset:4096
    v_mfma_f32_16x16x32_bf16 a[32:35], a[224:227], v[8:11], a[32:35]
    v_exp_f32 v23, v23
    v_mfma_f32_16x16x32_bf16 a[36:39], a[228:231], v[8:11], a[36:39]
    v_cvt_pk_bf16_f32 v18, v20, v21
    v_cvt_pk_bf16_f32 v19, v22, v23
    v_mfma_f32_16x16x32_bf16 a[40:43], a[232:235], v[8:11], a[40:43]
    v_exp_f32 v24, v24
    v_mfma_f32_16x16x32_bf16 a[44:47], a[236:239], v[8:11], a[44:47]
    buffer_load_dwordx4 v224, s[24:27], s87 offen nt lds
    v_mfma_f32_16x16x32_bf16 a[48:51], a[240:243], v[8:11], a[48:51]
    s_add_u32 m0, s38, 20480
    s_xor_b32 s87, s37, s86
    s_add_u32 s37, s37, 4096
    v_mfma_f32_16x16x32_bf16 a[52:55], a[244:247], v[8:11], a[52:55]
    v_exp_f32 v25, v25
    v_mfma_f32_16x16x32_bf16 a[56:59], a[248:251], v[8:11], a[56:59]
    v_exp_f32 v26, v26
    v_mfma_f32_16x16x32_bf16 a[60:63], a[252:255], v[8:11], a[60:63]
    v_exp_f32 v27, v27
    v_mfma_f32_16x16x32_bf16 v[64:67], v[228:231], v[8:11], v[64:67]
    s_waitcnt lgkmcnt(0)
    v_cvt_pk_bf16_f32 v24, v24, v25
    v_cvt_pk_bf16_f32 v25, v26, v27
    v_mfma_f32_16x16x32_bf16 v[0:3], a[192:195], v[80:83], v[40:43]
    v_exp_f32 v28, v28
    v_mfma_f32_16x16x32_bf16 v[0:3], a[196:199], v[84:87], v[0:3]
    v_exp_f32 v29, v29
    v_mfma_f32_16x16x32_bf16 v[0:3], a[200:203], v[88:91], v[0:3]
    v_exp_f32 v30, v30
    v_mfma_f32_16x16x32_bf16 v[0:3], a[204:207], v[92:95], v[0:3]
    v_exp_f32 v31, v31
    v_mfma_f32_16x16x32_bf16 v[4:7], a[208:211], v[80:83], v[40:43]
    v_cvt_pk_bf16_f32 v26, v28, v29
    v_cvt_pk_bf16_f32 v27, v30, v31
    v_mfma_f32_16x16x32_bf16 v[4:7], a[212:215], v[84:87], v[4:7]
    v_mfma_f32_16x16x32_bf16 v[4:7], a[216:219], v[88:91], v[4:7]
    buffer_load_dwordx4 v224, s[24:27], s87 offen nt lds
    v_mfma_f32_16x16x32_bf16 v[4:7], a[220:223], v[92:95], v[4:7]
    s_add_u32 m0, s38, 24576
    s_xor_b32 s87, s37, s86
    s_add_u32 s37, s37, 4096
    v_mfma_f32_16x16x32_bf16 a[64:67], a[224:227], v[16:19], a[64:67]
    v_exp_f32 v0, v0
    v_mfma_f32_16x16x32_bf16 a[68:71], a[228:231], v[16:19], a[68:71]
    v_exp_f32 v1, v1
    v_mfma_f32_16x16x32_bf16 a[72:75], a[232:235], v[16:19], a[72:75]
    v_exp_f32 v2, v2
    v_mfma_f32_16x16x32_bf16 a[76:79], a[236:239], v[16:19], a[76:79]
    v_exp_f32 v3, v3
    v_mfma_f32_16x16x32_bf16 a[80:83], a[240:243], v[16:19], a[80:83]
    v_cvt_pk_bf16_f32 v0, v0, v1
    v_cvt_pk_bf16_f32 v1, v2, v3
    v_mfma_f32_16x16x32_bf16 a[84:87], a[244:247], v[16:19], a[84:87]
    v_exp_f32 v4, v4
    v_mfma_f32_16x16x32_bf16 a[88:91], a[248:251], v[16:19], a[88:91]
    v_exp_f32 v5, v5
    v_mfma_f32_16x16x32_bf16 a[92:95], a[252:255], v[16:19], a[92:95]
    v_exp_f32 v6, v6
    v_mfma_f32_16x16x32_bf16 v[68:71], v[228:231], v[16:19], v[68:71]
    v_exp_f32 v7, v7
    v_mfma_f32_16x16x32_bf16 v[8:11], a[192:195], v[96:99], v[44:47]
    v_cvt_pk_bf16_f32 v2, v4, v5
    v_cvt_pk_bf16_f32 v3, v6, v7
    v_mfma_f32_16x16x32_bf16 v[8:11], a[196:199], v[100:103], v[8:11]
    buffer_load_dwordx4 v224, s[24:27], s87 offen nt lds
    v_mfma_f32_16x16x32_bf16 v[8:11], a[200:203], v[104:107], v[8:11]
    s_add_u32 m0, s38, 28672
    s_xor_b32 s87, s37, s86
    s_add_u32 s37, s37, 4096
    v_mfma_f32_16x16x32_bf16 v[8:11], a[204:207], v[108:111], v[8:11]
    v_mfma_f32_16x16x32_bf16 v[12:15], a[208:211], v[96:99], v[44:47]
    v_mfma_f32_16x16x32_bf16 v[12:15], a[212:215], v[100:103], v[12:15]
    v_mfma_f32_16x16x32_bf16 v[12:15], a[216:219], v[104:107], v[12:15]
    v_exp_f32 v8, v8
    v_mfma_f32_16x16x32_bf16 v[12:15], a[220:223], v[108:111], v[12:15]
    v_exp_f32 v9, v9
    v_mfma_f32_16x16x32_bf16 a[96:99], a[224:227], v[24:27], a[96:99]
    ds_read_b64_tr_b16 a[224:225], v212 offset:24576
    ds_read_b64_tr_b16 a[226:227], v212 offset:28672
    v_mfma_f32_16x16x32_bf16 a[100:103], a[228:231], v[24:27], a[100:103]
    v_exp_f32 v10, v10
    v_mfma_f32_16x16x32_bf16 a[104:107], a[232:235], v[24:27], a[104:107]
    ds_read_b64_tr_b16 a[228:229], v213 offset:24576
    ds_read_b64_tr_b16 a[230:231], v213 offset:28672
    v_mfma_f32_16x16x32_bf16 a[108:111], a[236:239], v[24:27], a[108:111]
    v_add_u32 v212, s44, v212
    v_add_u32 v213, s44, v213
    v_mfma_f32_16x16x32_bf16 a[112:115], a[240:243], v[24:27], a[112:115]
    ds_read_b64_tr_b16 a[232:233], v214 offset:24576
    ds_read_b64_tr_b16 a[234:235], v214 offset:28672
    v_mfma_f32_16x16x32_bf16 a[116:119], a[244:247], v[24:27], a[116:119]
    buffer_load_dwordx4 v224, s[24:27], s87 offen nt lds
    v_mfma_f32_16x16x32_bf16 a[120:123], a[248:251], v[24:27], a[120:123]
    s_xor_b32 s82, s76, 8192
    ds_read_b64_tr_b16 a[236:237], v215 offset:24576
    ds_read_b64_tr_b16 a[238:239], v215 offset:28672
    v_mfma_f32_16x16x32_bf16 a[124:127], a[252:255], v[24:27], a[124:127]
    s_add_u32 s76, s76, 1024
    v_add_u32 v214, s44, v214
    v_add_u32 v215, s44, v215
    v_mfma_f32_16x16x32_bf16 v[72:75], v[228:231], v[24:27], v[72:75]
    ds_read_b64_tr_b16 a[240:241], v216 offset:24576
    ds_read_b64_tr_b16 a[242:243], v216 offset:28672
    v_mfma_f32_16x16x32_bf16 v[16:19], a[192:195], v[112:115], v[48:51]
    v_exp_f32 v11, v11
    v_mfma_f32_16x16x32_bf16 v[16:19], a[196:199], v[116:119], v[16:19]
    ds_read_b64_tr_b16 a[244:245], v217 offset:24576
    ds_read_b64_tr_b16 a[246:247], v217 offset:28672
    v_mfma_f32_16x16x32_bf16 v[16:19], a[200:203], v[120:123], v[16:19]
    v_add_u32 v216, s44, v216
    v_add_u32 v217, s44, v217
    v_mfma_f32_16x16x32_bf16 v[16:19], a[204:207], v[124:127], v[16:19]
    ds_read_b64_tr_b16 a[248:249], v218 offset:24576
    ds_read_b64_tr_b16 a[250:251], v218 offset:28672
    v_mfma_f32_16x16x32_bf16 v[20:23], a[208:211], v[112:115], v[48:51]
    v_cvt_pk_bf16_f32 v8, v8, v9
    v_cvt_pk_bf16_f32 v9, v10, v11
    v_mfma_f32_16x16x32_bf16 v[20:23], a[212:215], v[116:119], v[20:23]
    ds_read_b64_tr_b16 a[252:253], v219 offset:24576
    ds_read_b64_tr_b16 a[254:255], v219 offset:28672
    v_mfma_f32_16x16x32_bf16 v[20:23], a[216:219], v[120:123], v[20:23]
    v_add_u32 v218, s44, v218
    v_add_u32 v219, s44, v219
    v_mfma_f32_16x16x32_bf16 v[20:23], a[220:223], v[124:127], v[20:23]
    s_waitcnt lgkmcnt(6)
    v_exp_f32 v12, v12
    v_mfma_f32_16x16x32_bf16 a[0:3], a[224:227], v[0:3], a[0:3]
    buffer_load_dword v226, v237, s[16:19], s82 offen
    v_mfma_f32_16x16x32_bf16 a[4:7], a[228:231], v[0:3], a[4:7]
    v_exp_f32 v13, v13
    v_mfma_f32_16x16x32_bf16 a[8:11], a[232:235], v[0:3], a[8:11]
    v_exp_f32 v14, v14
    v_mfma_f32_16x16x32_bf16 a[12:15], a[236:239], v[0:3], a[12:15]
    v_exp_f32 v15, v15
    v_mfma_f32_16x16x32_bf16 a[16:19], a[240:243], v[0:3], a[16:19]
    s_waitcnt lgkmcnt(2)
    v_cvt_pk_bf16_f32 v10, v12, v13
    v_cvt_pk_bf16_f32 v11, v14, v15
    v_mfma_f32_16x16x32_bf16 a[20:23], a[244:247], v[0:3], a[20:23]
    v_exp_f32 v16, v16
    v_mfma_f32_16x16x32_bf16 a[24:27], a[248:251], v[0:3], a[24:27]
    s_waitcnt lgkmcnt(0)
    v_exp_f32 v17, v17
    v_mfma_f32_16x16x32_bf16 a[28:31], a[252:255], v[0:3], a[28:31]
    v_exp_f32 v18, v18
    v_mfma_f32_16x16x32_bf16 v[60:63], v[228:231], v[0:3], v[60:63]
    v_exp_f32 v19, v19
    v_mfma_f32_16x16x32_bf16 v[24:27], a[192:195], v[128:131], v[52:55]
    v_cvt_pk_bf16_f32 v16, v16, v17
    v_cvt_pk_bf16_f32 v17, v18, v19
    v_mfma_f32_16x16x32_bf16 v[24:27], a[196:199], v[132:135], v[24:27]
    v_exp_f32 v20, v20
    v_mfma_f32_16x16x32_bf16 v[24:27], a[200:203], v[136:139], v[24:27]
    v_exp_f32 v21, v21
    v_mfma_f32_16x16x32_bf16 v[24:27], a[204:207], v[140:143], v[24:27]
    v_exp_f32 v22, v22
    v_mfma_f32_16x16x32_bf16 v[28:31], a[208:211], v[128:131], v[52:55]
    v_exp_f32 v23, v23
    v_mfma_f32_16x16x32_bf16 v[28:31], a[212:215], v[132:135], v[28:31]
    v_cvt_pk_bf16_f32 v18, v20, v21
    v_cvt_pk_bf16_f32 v19, v22, v23
    v_mfma_f32_16x16x32_bf16 v[28:31], a[216:219], v[136:139], v[28:31]
    v_exp_f32 v24, v24
    v_mfma_f32_16x16x32_bf16 v[28:31], a[220:223], v[140:143], v[28:31]
    v_exp_f32 v25, v25
    v_mfma_f32_16x16x32_bf16 a[32:35], a[224:227], v[8:11], a[32:35]
    v_exp_f32 v26, v26
    v_mfma_f32_16x16x32_bf16 a[36:39], a[228:231], v[8:11], a[36:39]
    v_exp_f32 v27, v27
    v_mfma_f32_16x16x32_bf16 a[40:43], a[232:235], v[8:11], a[40:43]
    v_cvt_pk_bf16_f32 v24, v24, v25
    v_cvt_pk_bf16_f32 v25, v26, v27
    v_mfma_f32_16x16x32_bf16 a[44:47], a[236:239], v[8:11], a[44:47]
    v_exp_f32 v28, v28
    v_mfma_f32_16x16x32_bf16 a[48:51], a[240:243], v[8:11], a[48:51]
    v_exp_f32 v29, v29
    v_mfma_f32_16x16x32_bf16 a[52:55], a[244:247], v[8:11], a[52:55]
    v_exp_f32 v30, v30
    v_mfma_f32_16x16x32_bf16 a[56:59], a[248:251], v[8:11], a[56:59]
    v_exp_f32 v31, v31
    v_mfma_f32_16x16x32_bf16 a[60:63], a[252:255], v[8:11], a[60:63]
    v_cvt_pk_bf16_f32 v26, v28, v29
    v_cvt_pk_bf16_f32 v27, v30, v31
    v_mfma_f32_16x16x32_bf16 v[64:67], v[228:231], v[8:11], v[64:67]
    v_mfma_f32_16x16x32_bf16 v[32:35], a[192:195], v[144:147], v[56:59]
    v_mfma_f32_16x16x32_bf16 v[32:35], a[196:199], v[148:151], v[32:35]
    ds_read_b128 a[192:195], v208 offset:8192
    ds_read_b128 a[196:199], v209 offset:8192
    v_mfma_f32_16x16x32_bf16 v[32:35], a[200:203], v[152:155], v[32:35]
    v_mfma_f32_16x16x32_bf16 v[32:35], a[204:207], v[156:159], v[32:35]
    ds_read_b128 a[200:203], v210 offset:8192
    ds_read_b128 a[204:207], v211 offset:8192
    v_mfma_f32_16x16x32_bf16 v[36:39], a[208:211], v[144:147], v[56:59]
    v_mfma_f32_16x16x32_bf16 v[36:39], a[212:215], v[148:151], v[36:39]
    s_sub_u32 s39, s39, 1
    ds_read_b128 a[208:211], v208 offset:12288
    ds_read_b128 a[212:215], v209 offset:12288
    v_mfma_f32_16x16x32_bf16 v[36:39], a[216:219], v[152:155], v[36:39]
    v_add_u32 v208, s44, v208
    v_add_u32 v209, s44, v209
    v_mfma_f32_16x16x32_bf16 v[36:39], a[220:223], v[156:159], v[36:39]
    ds_read_b128 a[216:219], v210 offset:12288
    ds_read_b128 a[220:223], v211 offset:12288
    v_mfma_f32_16x16x32_bf16 a[64:67], a[224:227], v[16:19], a[64:67]
    v_add_u32 v210, s44, v210
    v_add_u32 v211, s44, v211
    v_mfma_f32_16x16x32_bf16 a[68:71], a[228:231], v[16:19], a[68:71]
    v_exp_f32 v32, v32
    v_mfma_f32_16x16x32_bf16 a[72:75], a[232:235], v[16:19], a[72:75]
    v_exp_f32 v33, v33
    v_mfma_f32_16x16x32_bf16 a[76:79], a[236:239], v[16:19], a[76:79]
    v_exp_f32 v34, v34
    v_mfma_f32_16x16x32_bf16 a[80:83], a[240:243], v[16:19], a[80:83]
    v_exp_f32 v35, v35
    v_mfma_f32_16x16x32_bf16 a[84:87], a[244:247], v[16:19], a[84:87]
    v_cvt_pk_bf16_f32 v32, v32, v33
    v_cvt_pk_bf16_f32 v33, v34, v35
    v_mfma_f32_16x16x32_bf16 a[88:91], a[248:251], v[16:19], a[88:91]
    v_exp_f32 v36, v36
    v_mfma_f32_16x16x32_bf16 a[92:95], a[252:255], v[16:19], a[92:95]
    v_exp_f32 v37, v37
    v_mfma_f32_16x16x32_bf16 v[68:71], v[228:231], v[16:19], v[68:71]
    s_waitcnt lgkmcnt(0)
    s_cmp_lg_u32 s39, 0
    s_cbranch_scc1 A1h0_loop
    s_branch A1h1_head
A1s_redo:
    s_cmp_lg_u32 s41, 0
    s_cbranch_scc1 A1s_ok
    s_waitcnt vmcnt(0) lgkmcnt(0)
    s_barrier
    s_lshl_b32 s75, s78, 4
    s_add_u32 s75, s75, s77
    s_add_u32 s75, s75, 1
    v_mov_b32 v0, v236
    s_branch K1_again
A1h0_enter:
    v_mov_b32 v24, 0
    v_mov_b32 v25, 0
    v_mov_b32 v26, 0
    v_mov_b32 v27, 0
    v_mov_b32 v28, 0
    v_mov_b32 v29, 0
    v_mov_b32 v30, 0
    v_mov_b32 v31, 0
    v_mov_b32 v32, 0
    v_mov_b32 v33, 0
    v_mov_b32 v34, 0
    v_mov_b32 v35, 0
    v_mov_b32 v36, 0
    v_mov_b32 v37, 0
    v_mov_b32 v38, 0xff800000
    v_mov_b32 v39, 0xff800000
    s_mov_b32 s39, 16
    s_mov_b32 s2, 3
    s_branch A1h0_loop
A0h1_head:
    s_mov_b32 s39, 16
    s_mov_b32 s2, 7
    s_waitcnt lgkmcnt(0)
    v_mfma_f32_16x16x32_bf16 v[0:3], a[192:195], v[160:163], 0
    v_exp_f32 v28, v28
    v_mfma_f32_16x16x32_bf16 v[0:3], a[196:199], v[164:167], v[0:3]
    v_exp_f32 v29, v29
    v_mfma_f32_16x16x32_bf16 v[0:3], a[200:203], v[168:171], v[0:3]
    v_exp_f32 v30, v30
    v_mfma_f32_16x16x32_bf16 v[0:3], a[204:207], v[172:175], v[0:3]
    v_exp_f32 v31, v31
    v_mfma_f32_16x16x32_bf16 v[4:7], a[208:211], v[160:163], 0
    v_cvt_pk_bf16_f32 v26, v28, v29
    v_cvt_pk_bf16_f32 v27, v30, v31
    v_mfma_f32_16x16x32_bf16 v[4:7], a[212:215], v[164:167], v[4:7]
    v_mov_b32 v152, v56
    v_mfma_f32_16x16x32_bf16 v[4:7], a[216:219], v[168:171], v[4:7]
    s_lshl_b32 s60, s36, 10
    s_add_u32 s60, s60, 139264
    v_add_u32 v237, s60, v233
    v_mfma_f32_16x16x32_bf16 v[4:7], a[220:223], v[172:175], v[4:7]
    s_add_u32 s60, s47, 139264
    v_add_u32 v223, s60, v233
    v_mfma_f32_16x16x32_bf16 a[64:67], a[224:227], v[16:19], a[64:67]
    v_mfma_f32_16x16x32_bf16 a[68:71], a[228:231], v[16:19], a[68:71]
    v_mfma_f32_16x16x32_bf16 a[72:75], a[232:235], v[16:19], a[72:75]
    s_waitcnt vmcnt(9) lgkmcnt(0)
    s_barrier
    v_mfma_f32_16x16x32_bf16 a[76:79], a[236:239], v[16:19], a[76:79]
    s_add_u32 s38, s74, s3
    s_add_u32 m0, s3, 65536
    s_xor_b32 s87, s85, s86
    v_max3_f32 v240, v0, v1, v2
    v_mfma_f32_16x16x32_bf16 a[80:83], a[240:243], v[16:19], a[80:83]
    s_add_u32 s85, s85, 4096
    s_add_u32 s74, s74, s44
    v_max3_f32 v241, v3, v4, v5
    v_max3_f32 v240, v240, v6, v7
    v_mfma_f32_16x16x32_bf16 a[84:87], a[244:247], v[16:19], a[84:87]
    buffer_load_dwordx4 v220, s[20:23], s87 offen nt lds
    v_max_f32 v240, v240, v241
    v_mfma_f32_16x16x32_bf16 a[88:91], a[248:251], v[16:19], a[88:91]
    s_add_u32 m0, s3, 69632
    s_xor_b32 s87, s85, s86
    s_add_u32 s85, s85, 4096
    v_rcp_f32 v244, v60
    v_rcp_f32 v245, v60
    v_mfma_f32_16x16x32_bf16 a[92:95], a[252:255], v[16:19], a[92:95]
    s_cmp_eq_u32 s74, 0x18000
    s_cselect_b32 s44, s45, s46
    v_mov_b32 v241, v240
    s_nop 1
    v_permlane32_swap_b32 v240, v241
    v_max_f32 v240, v240, v241
    v_mfma_f32_16x16x32_bf16 v[68:71], v[228:231], v[16:19], v[68:71]
    v_mov_b32 v241, v240
    s_nop 1
    v_permlane16_swap_b32 v240, v241
    v_max_f32 v240, v240, v241
    v_mfma_f32_16x16x32_bf16 v[8:11], a[192:195], v[176:179], 0
    v_sub_f32 v0, v0, v240
    v_sub_f32 v1, v1, v240
    v_sub_f32 v2, v2, v240
    v_accvgpr_read_b32 v246, a0
    v_accvgpr_read_b32 v247, a1
    v_accvgpr_read_b32 v248, a2
    v_accvgpr_read_b32 v249, a3
    v_accvgpr_read_b32 v250, a4
    v_accvgpr_read_b32 v251, a5
    v_accvgpr_read_b32 v252, a6
    v_accvgpr_read_b32 v253, a7
    v_pk_mul_f32 v[246:247], v[246:247], v[244:245]
    v_pk_mul_f32 v[248:249], v[248:249], v[244:245]
    v_pk_mul_f32 v[250:251], v[250:251], v[244:245]
    v_pk_mul_f32 v[252:253], v[252:253], v[244:245]
    v_mfma_f32_16x16x32_bf16 v[8:11], a[196:199], v[180:183], v[8:11]
    v_sub_f32 v3, v3, v240
    v_sub_f32 v4, v4, v240
    v_sub_f32 v5, v5, v240
    v_cvt_pk_bf16_f32 v80, v246, v247
    v_cvt_pk_bf16_f32 v81, v248, v249
    v_mfma_f32_16x16x32_bf16 v[8:11], a[200:203], v[184:187], v[8:11]
    buffer_load_dwordx4 v220, s[20:23], s87 offen nt lds
    v_sub_f32 v6, v6, v240
    v_cvt_pk_bf16_f32 v82, v250, v251
    v_cvt_pk_bf16_f32 v83, v252, v253
    v_mfma_f32_16x16x32_bf16 v[8:11], a[204:207], v[188:191], v[8:11]
    s_add_u32 m0, s3, 73728
    s_xor_b32 s87, s85, s86
    s_add_u32 s85, s85, 4096
    v_sub_f32 v7, v7, v240
    v_accvgpr_read_b32 v246, a8
    v_accvgpr_read_b32 v247, a9
    v_accvgpr_read_b32 v248, a10
    v_accvgpr_read_b32 v249, a11
    v_accvgpr_read_b32 v250, a12
    v_accvgpr_read_b32 v251, a13
    v_accvgpr_read_b32 v252, a14
    v_accvgpr_read_b32 v253, a15
    v_pk_mul_f32 v[246:247], v[246:247], v[244:245]
    v_pk_mul_f32 v[248:249], v[248:249], v[244:245]
    v_pk_mul_f32 v[250:251], v[250:251], v[244:245]
    v_pk_mul_f32 v[252:253], v[252:253], v[244:245]
    v_mfma_f32_16x16x32_bf16 v[12:15], a[208:211], v[176:179], 0
    v_sub_f32 v40, 0, v240
    v_sub_f32 v41, 0, v240
    v_sub_f32 v42, 0, v240
    v_cvt_pk_bf16_f32 v84, v246, v247
    v_cvt_pk_bf16_f32 v85, v248, v249
    v_mfma_f32_16x16x32_bf16 v[12:15], a[212:215], v[180:183], v[12:15]
    v_sub_f32 v43, 0, v240
    v_exp_f32 v0, v0
    v_cvt_pk_bf16_f32 v86, v250, v251
    v_cvt_pk_bf16_f32 v87, v252, v253
    v_mfma_f32_16x16x32_bf16 v[12:15], a[216:219], v[184:187], v[12:15]
    v_exp_f32 v1, v1
    v_accvgpr_read_b32 v246, a16
    v_accvgpr_read_b32 v247, a17
    v_accvgpr_read_b32 v248, a18
    v_accvgpr_read_b32 v249, a19
    v_accvgpr_read_b32 v250, a20
    v_accvgpr_read_b32 v251, a21
    v_accvgpr_read_b32 v252, a22
    v_accvgpr_read_b32 v253, a23
    v_pk_mul_f32 v[246:247], v[246:247], v[244:245]
    v_pk_mul_f32 v[248:249], v[248:249], v[244:245]
    v_pk_mul_f32 v[250:251], v[250:251], v[244:245]
    v_pk_mul_f32 v[252:253], v[252:253], v[244:245]
    v_mfma_f32_16x16x32_bf16 v[12:15], a[220:223], v[188:191], v[12:15]
    v_exp_f32 v2, v2
    v_cvt_pk_bf16_f32 v88, v246, v247
    v_cvt_pk_bf16_f32 v89, v248, v249
    v_cvt_pk_bf16_f32 v90, v250, v251
    v_cvt_pk_bf16_f32 v91, v252, v253
    v_mfma_f32_16x16x32_bf16 a[96:99], a[224:227], v[24:27], a[96:99]
    ds_read_b64_tr_b16 a[224:225], v212 offset:16384
    ds_read_b64_tr_b16 a[226:227], v212 offset:20480
    v_accvgpr_read_b32 v246, a24
    v_accvgpr_read_b32 v247, a25
    v_accvgpr_read_b32 v248, a26
    v_accvgpr_read_b32 v249, a27
    v_accvgpr_read_b32 v250, a28
    v_accvgpr_read_b32 v251, a29
    v_accvgpr_read_b32 v252, a30
    v_accvgpr_read_b32 v253, a31
    v_pk_mul_f32 v[246:247], v[246:247], v[244:245]
    v_pk_mul_f32 v[248:249], v[248:249], v[244:245]
    v_pk_mul_f32 v[250:251], v[250:251], v[244:245]
    v_pk_mul_f32 v[252:253], v[252:253], v[244:245]
    v_mfma_f32_16x16x32_bf16 a[100:103], a[228:231], v[24:27], a[100:103]
    v_exp_f32 v3, v3
    v_cvt_pk_bf16_f32 v0, v0, v1
    v_cvt_pk_bf16_f32 v92, v246, v247
    v_cvt_pk_bf16_f32 v93, v248, v249
    v_mfma_f32_16x16x32_bf16 a[104:107], a[232:235], v[24:27], a[104:107]
    ds_read_b64_tr_b16 a[228:229], v213 offset:16384
    ds_read_b64_tr_b16 a[230:231], v213 offset:20480
    v_cvt_pk_bf16_f32 v1, v2, v3
    v_cvt_pk_bf16_f32 v94, v250, v251
    v_cvt_pk_bf16_f32 v95, v252, v253
    v_mfma_f32_16x16x32_bf16 a[108:111], a[236:239], v[24:27], a[108:111]
    buffer_load_dwordx4 v220, s[20:23], s87 offen nt lds
    v_max3_f32 v242, v8, v9, v10
    v_mfma_f32_16x16x32_bf16 a[112:115], a[240:243], v[24:27], a[112:115]
    s_add_u32 m0, s3, 77824
    ds_read_b64_tr_b16 a[232:233], v214 offset:16384
    ds_read_b64_tr_b16 a[234:235], v214 offset:20480
    v_max3_f32 v243, v11, v12, v13
    v_mfma_f32_16x16x32_bf16 a[116:119], a[244:247], v[24:27], a[116:119]
    s_xor_b32 s87, s85, s86
    s_add_u32 s85, s85, 4096
    v_exp_f32 v4, v4
    v_mfma_f32_16x16x32_bf16 a[120:123], a[248:251], v[24:27], a[120:123]
    ds_read_b64_tr_b16 a[236:237], v215 offset:16384
    ds_read_b64_tr_b16 a[238:239], v215 offset:20480
    v_max3_f32 v242, v242, v14, v15
    v_mfma_f32_16x16x32_bf16 a[124:127], a[252:255], v[24:27], a[124:127]
    v_exp_f32 v5, v5
    v_max_f32 v242, v242, v243
    v_mfma_f32_16x16x32_bf16 v[72:75], v[228:231], v[24:27], v[72:75]
    ds_read_b64_tr_b16 a[240:241], v216 offset:16384
    ds_read_b64_tr_b16 a[242:243], v216 offset:20480
    v_rcp_f32 v244, v64
    v_rcp_f32 v245, v64
    v_mfma_f32_16x16x32_bf16 v[16:19], a[192:195], v[192:195], 0
    v_exp_f32 v6, v6
    v_accvgpr_read_b32 v246, a32
    v_accvgpr_read_b32 v247, a33
    v_accvgpr_read_b32 v248, a34
    v_accvgpr_read_b32 v249, a35
    v_accvgpr_read_b32 v250, a36
    v_accvgpr_read_b32 v251, a37
    v_accvgpr_read_b32 v252, a38
    v_accvgpr_read_b32 v253, a39
    v_pk_mul_f32 v[246:247], v[246:247], v[244:245]
    v_pk_mul_f32 v[248:249], v[248:249], v[244:245]
    v_pk_mul_f32 v[250:251], v[250:251], v[244:245]
    v_pk_mul_f32 v[252:253], v[252:253], v[244:245]
    v_mfma_f32_16x16x32_bf16 v[16:19], a[196:199], v[196:199], v[16:19]
    ds_read_b64_tr_b16 a[244:245], v217 offset:16384
    ds_read_b64_tr_b16 a[246:247], v217 offset:20480
    v_cvt_pk_bf16_f32 v96, v246, v247
    v_cvt_pk_bf16_f32 v97, v248, v249
    v_cvt_pk_bf16_f32 v98, v250, v251
    v_cvt_pk_bf16_f32 v99, v252, v253
    v_mfma_f32_16x16x32_bf16 v[16:19], a[200:203], v[200:203], v[16:19]
    buffer_load_dwordx4 v220, s[20:23], s87 offen nt lds
    v_add_f32 v154, v60, v64
    v_add_f32 v155, v68, v72
    v_accvgpr_read_b32 v246, a40
    v_accvgpr_read_b32 v247, a41
    v_accvgpr_read_b32 v248, a42
    v_accvgpr_read_b32 v249, a43
    v_accvgpr_read_b32 v250, a44
    v_accvgpr_read_b32 v251, a45
    v_accvgpr_read_b32 v252, a46
    v_accvgpr_read_b32 v253, a47
    v_pk_mul_f32 v[246:247], v[246:247], v[244:245]
    v_pk_mul_f32 v[248:249], v[248:249], v[244:245]
    v_pk_mul_f32 v[250:251], v[250:251], v[244:245]
    v_pk_mul_f32 v[252:253], v[252:253], v[244:245]
    v_mfma_f32_16x16x32_bf16 v[16:19], a[204:207], v[204:207], v[16:19]
    s_add_u32 m0, s3, 81920
    ds_read_b64_tr_b16 a[248:249], v218 offset:16384
    ds_read_b64_tr_b16 a[250:251], v218 offset:20480
    v_mov_b32 v153, v76
    v_add_f32 v154, v154, v155
    v_add_f32 v154, v154, v76
    v_mfma_f32_16x16x32_bf16 v[20:23], a[208:211], v[192:195], 0
    s_xor_b32 s87, s37, s86
    s_add_u32 s37, s37, 4096
    v_exp_f32 v7, v7
    ds_write_b128 v237, v[152:155]
    ds_write_b128 v223, a[144:147] offset:4096
    v_mfma_f32_16x16x32_bf16 v[20:23], a[212:215], v[196:199], v[20:23]
    ds_read_b64_tr_b16 a[252:253], v219 offset:16384
    ds_read_b64_tr_b16 a[254:255], v219 offset:20480
    v_cvt_pk_bf16_f32 v2, v4, v5
    ds_write_b128 v223, a[148:151] offset:5120
    ds_write_b128 v223, a[152:155] offset:6144
    v_mfma_f32_16x16x32_bf16 v[20:23], a[216:219], v[200:203], v[20:23]
    v_cvt_pk_bf16_f32 v3, v6, v7
    v_mov_b32 v243, v242
    s_nop 1
    v_permlane32_swap_b32 v242, v243
    v_max_f32 v242, v242, v243
    v_mfma_f32_16x16x32_bf16 v[20:23], a[220:223], v[204:207], v[20:23]
    s_waitcnt lgkmcnt(10)
    v_mov_b32 v243, v242
    s_nop 1
    v_permlane16_swap_b32 v242, v243
    v_max_f32 v242, v242, v243
    v_mfma_f32_16x16x32_bf16 a[0:3], a[224:227], v[0:3], 0
    v_sub_f32 v8, v8, v242
    v_sub_f32 v9, v9, v242
    v_sub_f32 v10, v10, v242
    ds_write_b128 v223, a[156:159] offset:7168
    v_cvt_pk_bf16_f32 v100, v246, v247
    v_cvt_pk_bf16_f32 v101, v248, v249
    v_mfma_f32_16x16x32_bf16 a[4:7], a[228:231], v[0:3], 0
    buffer_load_dwordx4 v224, s[24:27], s87 offen nt lds
    v_sub_f32 v11, v11, v242
    v_xor_b32 v223, 4096, v223
    v_xor_b32 v237, 1024, v237
    v_mfma_f32_16x16x32_bf16 a[8:11], a[232:235], v[0:3], 0
    s_add_u32 m0, s3, 86016
    s_xor_b32 s87, s37, s86
    s_add_u32 s37, s37, 4096
    v_sub_f32 v12, v12, v242
    v_max3_f32 v240, v16, v17, v18
    v_cvt_pk_bf16_f32 v102, v250, v251
    v_cvt_pk_bf16_f32 v103, v252, v253
    v_mfma_f32_16x16x32_bf16 a[12:15], a[236:239], v[0:3], 0
    v_sub_f32 v13, v13, v242
    v_sub_f32 v14, v14, v242
    v_sub_f32 v15, v15, v242
    v_max3_f32 v241, v19, v20, v21
    v_accvgpr_read_b32 v246, a48
    v_accvgpr_read_b32 v247, a49
    v_accvgpr_read_b32 v248, a50
    v_accvgpr_read_b32 v249, a51
    v_accvgpr_read_b32 v250, a52
    v_accvgpr_read_b32 v251, a53
    v_accvgpr_read_b32 v252, a54
    v_accvgpr_read_b32 v253, a55
    v_pk_mul_f32 v[246:247], v[246:247], v[244:245]
    v_pk_mul_f32 v[248:249], v[248:249], v[244:245]
    v_pk_mul_f32 v[250:251], v[250:251], v[244:245]
    v_pk_mul_f32 v[252:253], v[252:253], v[244:245]
    v_mfma_f32_16x16x32_bf16 a[16:19], a[240:243], v[0:3], 0
    s_waitcnt lgkmcnt(5)
    v_sub_f32 v44, 0, v242
    v_sub_f32 v45, 0, v242
    v_sub_f32 v46, 0, v242
    v_max3_f32 v240, v240, v22, v23
    v_cvt_pk_bf16_f32 v104, v246, v247
    v_cvt_pk_bf16_f32 v105, v248, v249
    v_mfma_f32_16x16x32_bf16 a[20:23], a[244:247], v[0:3], 0
    v_sub_f32 v47, 0, v242
    v_exp_f32 v8, v8
    v_max_f32 v240, v240, v241
    v_cvt_pk_bf16_f32 v106, v250, v251
    v_cvt_pk_bf16_f32 v107, v252, v253
    v_mfma_f32_16x16x32_bf16 a[24:27], a[248:251], v[0:3], 0
    s_waitcnt lgkmcnt(1)
    v_exp_f32 v9, v9
    v_mov_b32 v241, v240
    s_nop 1
    v_permlane32_swap_b32 v240, v241
    v_max_f32 v240, v240, v241
    v_mfma_f32_16x16x32_bf16 a[28:31], a[252:255], v[0:3], 0
    v_exp_f32 v10, v10
    v_mov_b32 v241, v240
    s_nop 1
    v_permlane16_swap_b32 v240, v241
    v_max_f32 v240, v240, v241
    v_mfma_f32_16x16x32_bf16 v[60:63], v[228:231], v[0:3], 0
    v_exp_f32 v11, v11
    v_cvt_pk_bf16_f32 v8, v8, v9
    v_sub_f32 v16, v16, v240
    v_accvgpr_read_b32 v246, a56
    v_accvgpr_read_b32 v247, a57
    v_accvgpr_read_b32 v248, a58
    v_accvgpr_read_b32 v249, a59
    v_accvgpr_read_b32 v250, a60
    v_accvgpr_read_b32 v251, a61
    v_accvgpr_read_b32 v252, a62
    v_accvgpr_read_b32 v253, a63
    v_pk_mul_f32 v[246:247], v[246:247], v[244:245]
    v_pk_mul_f32 v[248:249], v[248:249], v[244:245]
    v_pk_mul_f32 v[250:251], v[250:251], v[244:245]
    v_pk_mul_f32 v[252:253], v[252:253], v[244:245]
    v_mfma_f32_16x16x32_bf16 v[24:27], a[192:195], a[160:163], 0
    buffer_load_dwordx4 v224, s[24:27], s87 offen nt lds
    v_cvt_pk_bf16_f32 v9, v10, v11
    v_sub_f32 v17, v17, v240
    v_cvt_pk_bf16_f32 v108, v246, v247
    v_cvt_pk_bf16_f32 v109, v248, v249
    v_mfma_f32_16x16x32_bf16 v[24:27], a[196:199], a[164:167], v[24:27]
    s_add_u32 m0, s3, 90112
    s_xor_b32 s87, s37, s86
    s_add_u32 s37, s37, 4096
    v_sub_f32 v18, v18, v240
    v_sub_f32 v19, v19, v240
    v_cvt_pk_bf16_f32 v110, v250, v251
    v_cvt_pk_bf16_f32 v111, v252, v253
    v_mfma_f32_16x16x32_bf16 v[24:27], a[200:203], a[168:171], v[24:27]
    v_exp_f32 v12, v12
    v_sub_f32 v20, v20, v240
    v_sub_f32 v21, v21, v240
    v_mfma_f32_16x16x32_bf16 v[24:27], a[204:207], a[172:175], v[24:27]
    v_exp_f32 v13, v13
    v_sub_f32 v22, v22, v240
    v_sub_f32 v23, v23, v240
    v_mfma_f32_16x16x32_bf16 v[28:31], a[208:211], a[160:163], 0
    v_exp_f32 v14, v14
    v_sub_f32 v48, 0, v240
    v_sub_f32 v49, 0, v240
    v_mfma_f32_16x16x32_bf16 v[28:31], a[212:215], a[164:167], v[28:31]
    v_exp_f32 v15, v15
    v_cvt_pk_bf16_f32 v10, v12, v13
    v_sub_f32 v50, 0, v240
    v_mfma_f32_16x16x32_bf16 v[28:31], a[216:219], a[168:171], v[28:31]
    v_cvt_pk_bf16_f32 v11, v14, v15
    v_sub_f32 v51, 0, v240
    v_exp_f32 v16, v16
    v_mfma_f32_16x16x32_bf16 v[28:31], a[220:223], a[172:175], v[28:31]
    v_exp_f32 v17, v17
    v_exp_f32 v18, v18
    s_waitcnt lgkmcnt(0)
    s_barrier
    v_mfma_f32_16x16x32_bf16 a[32:35], a[224:227], v[8:11], 0
    buffer_load_dwordx4 v224, s[24:27], s87 offen nt lds
    v_exp_f32 v19, v19
    ds_read_b128 v[156:159], v237
    v_xor_b32 v237, 2048, v237
    v_mfma_f32_16x16x32_bf16 a[36:39], a[228:231], v[8:11], 0
    s_add_u32 m0, s3, 94208
    s_xor_b32 s87, s37, s86
    s_add_u32 s37, s37, 4096
    v_cvt_pk_bf16_f32 v16, v16, v17
    v_cvt_pk_bf16_f32 v17, v18, v19
    ds_read_b32 v221, v237 offset:8
    v_xor_b32 v237, 1024, v237
    v_mfma_f32_16x16x32_bf16 a[40:43], a[232:235], v[8:11], 0
    v_exp_f32 v20, v20
    v_exp_f32 v21, v21
    ds_read_b32 v222, v237 offset:8
    ds_read_b128 v[144:147], v223 offset:4096
    v_mfma_f32_16x16x32_bf16 a[44:47], a[236:239], v[8:11], 0
    v_exp_f32 v22, v22
    v_exp_f32 v23, v23
    ds_read_b128 v[148:151], v223 offset:5120
    v_mfma_f32_16x16x32_bf16 a[48:51], a[240:243], v[8:11], 0
    v_cvt_pk_bf16_f32 v18, v20, v21
    v_cvt_pk_bf16_f32 v19, v22, v23
    v_max3_f32 v242, v24, v25, v26
    v_rcp_f32 v244, v68
    v_rcp_f32 v245, v68
    v_mfma_f32_16x16x32_bf16 a[52:55], a[244:247], v[8:11], 0
    v_max3_f32 v243, v27, v28, v29
    v_max3_f32 v242, v242, v30, v31
    v_max_f32 v242, v242, v243
    v_accvgpr_read_b32 v246, a64
    v_accvgpr_read_b32 v247, a65
    v_accvgpr_read_b32 v248, a66
    v_accvgpr_read_b32 v249, a67
    v_accvgpr_read_b32 v250, a68
    v_accvgpr_read_b32 v251, a69
    v_accvgpr_read_b32 v252, a70
    v_accvgpr_read_b32 v253, a71
    v_pk_mul_f32 v[246:247], v[246:247], v[244:245]
    v_pk_mul_f32 v[248:249], v[248:249], v[244:245]
    v_pk_mul_f32 v[250:251], v[250:251], v[244:245]
    v_pk_mul_f32 v[252:253], v[252:253], v[244:245]
    v_mfma_f32_16x16x32_bf16 a[56:59], a[248:251], v[8:11], 0
    v_mov_b32 v243, v242
    s_nop 1
    v_permlane32_swap_b32 v242, v243
    v_max_f32 v242, v242, v243
    v_cvt_pk_bf16_f32 v112, v246, v247
    v_cvt_pk_bf16_f32 v113, v248, v249
    v_mfma_f32_16x16x32_bf16 a[60:63], a[252:255], v[8:11], 0
    v_mov_b32 v243, v242
    s_nop 1
    v_permlane16_swap_b32 v242, v243
    v_max_f32 v242, v242, v243
    v_cvt_pk_bf16_f32 v114, v250, v251
    v_cvt_pk_bf16_f32 v115, v252, v253
    v_mfma_f32_16x16x32_bf16 v[64:67], v[228:231], v[8:11], 0
    buffer_load_dwordx4 v224, s[24:27], s87 offen nt lds
    v_sub_f32 v24, v24, v242
    s_waitcnt lgkmcnt(2)
    v_add_f32 v221, v221, v222
    v_add_f32 v222, v154, v158
    v_accvgpr_read_b32 v246, a72
    v_accvgpr_read_b32 v247, a73
    v_accvgpr_read_b32 v248, a74
    v_accvgpr_read_b32 v249, a75
    v_accvgpr_read_b32 v250, a76
    v_accvgpr_read_b32 v251, a77
    v_accvgpr_read_b32 v252, a78
    v_accvgpr_read_b32 v253, a79
    v_pk_mul_f32 v[246:247], v[246:247], v[244:245]
    v_pk_mul_f32 v[248:249], v[248:249], v[244:245]
    v_pk_mul_f32 v[250:251], v[250:251], v[244:245]
    v_pk_mul_f32 v[252:253], v[252:253], v[244:245]
    v_mfma_f32_16x16x32_bf16 v[32:35], a[192:195], a[176:179], 0
    s_add_u32 m0, s38, 0
    s_xor_b32 s87, s85, s86
    s_add_u32 s85, s85, 4096
    v_sub_f32 v25, v25, v242
    v_add_f32 v221, v221, v222
    v_cmp_nge_f32 vcc, s43, v221
    s_cbranch_vccnz A0s_redo
A0s_ok:
    v_mfma_f32_16x16x32_bf16 v[32:35], a[196:199], a[180:183], v[32:35]
    ds_read_b128 a[192:195], v208 offset:0
    ds_read_b128 a[196:199], v209 offset:0
    v_sub_f32 v26, v26, v242
    v_min_f32 v221, v152, v156
    v_sub_f32 v152, v221, v152
    v_cvt_pk_bf16_f32 v116, v246, v247
    v_cvt_pk_bf16_f32 v117, v248, v249
    v_mfma_f32_16x16x32_bf16 v[32:35], a[200:203], a[184:187], v[32:35]
    v_sub_f32 v27, v27, v242
    v_sub_f32 v28, v28, v242
    v_sub_f32 v29, v29, v242
    v_sub_f32 v156, v221, v156
    v_exp_f32 v152, v152
    v_mfma_f32_16x16x32_bf16 v[32:35], a[204:207], a[188:191], v[32:35]
    ds_read_b128 a[200:203], v210 offset:0
    ds_read_b128 a[204:207], v211 offset:0
    v_sub_f32 v30, v30, v242
    v_exp_f32 v156, v156
    v_mul_f32 v221, v152, v153
    v_mfma_f32_16x16x32_bf16 v[36:39], a[208:211], a[176:179], 0
    v_sub_f32 v31, v31, v242
    v_sub_f32 v52, 0, v242
    v_sub_f32 v53, 0, v242
    v_cvt_pk_bf16_f32 v118, v250, v251
    v_cvt_pk_bf16_f32 v119, v252, v253
    v_accvgpr_read_b32 v246, a80
    v_accvgpr_read_b32 v247, a81
    v_accvgpr_read_b32 v248, a82
    v_accvgpr_read_b32 v249, a83
    v_accvgpr_read_b32 v250, a84
    v_accvgpr_read_b32 v251, a85
    v_accvgpr_read_b32 v252, a86
    v_accvgpr_read_b32 v253, a87
    v_pk_mul_f32 v[246:247], v[246:247], v[244:245]
    v_pk_mul_f32 v[248:249], v[248:249], v[244:245]
    v_pk_mul_f32 v[250:251], v[250:251], v[244:245]
    v_pk_mul_f32 v[252:253], v[252:253], v[244:245]
    v_mfma_f32_16x16x32_bf16 v[36:39], a[212:215], a[180:183], v[36:39]
    ds_read_b128 a[208:211], v208 offset:4096
    ds_read_b128 a[212:215], v209 offset:4096
    v_sub_f32 v54, 0, v242
    v_cvt_pk_bf16_f32 v120, v246, v247
    v_cvt_pk_bf16_f32 v121, v248, v249
    v_cvt_pk_bf16_f32 v122, v250, v251
    v_cvt_pk_bf16_f32 v123, v252, v253
    v_mfma_f32_16x16x32_bf16 v[36:39], a[216:219], a[184:187], v[36:39]
    v_sub_f32 v55, 0, v242
    v_exp_f32 v24, v24
    v_accvgpr_read_b32 v246, a88
    v_accvgpr_read_b32 v247, a89
    v_accvgpr_read_b32 v248, a90
    v_accvgpr_read_b32 v249, a91
    v_accvgpr_read_b32 v250, a92
    v_accvgpr_read_b32 v251, a93
    v_accvgpr_read_b32 v252, a94
    v_accvgpr_read_b32 v253, a95
    v_pk_mul_f32 v[246:247], v[246:247], v[244:245]
    v_pk_mul_f32 v[248:249], v[248:249], v[244:245]
    v_pk_mul_f32 v[250:251], v[250:251], v[244:245]
    v_pk_mul_f32 v[252:253], v[252:253], v[244:245]
    v_mfma_f32_16x16x32_bf16 v[36:39], a[220:223], a[188:191], v[36:39]
    ds_read_b128 a[216:219], v210 offset:4096
    ds_read_b128 a[220:223], v211 offset:4096
    v_fmac_f32 v221, v156, v157
    v_rcp_f32 v221, v221
    s_nop 0
    v_mfma_f32_16x16x32_bf16 a[64:67], a[224:227], v[16:19], 0
    buffer_load_dwordx4 v220, s[20:23], s87 offen nt lds
    v_mul_f32 v222, v152, v221
    v_mul_f32 v225, v156, v221
    ds_read_b128 v[152:155], v223 offset:6144
    ds_read_b128 v[156:159], v223 offset:7168
    v_mfma_f32_16x16x32_bf16 a[68:71], a[228:231], v[16:19], 0
    s_add_u32 m0, s38, 4096
    s_xor_b32 s87, s85, s86
    s_add_u32 s85, s85, 4096
    v_cvt_pk_bf16_f32 v124, v246, v247
    v_cvt_pk_bf16_f32 v125, v248, v249
    v_cvt_pk_bf16_f32 v126, v250, v251
    v_cvt_pk_bf16_f32 v127, v252, v253
    v_mfma_f32_16x16x32_bf16 a[72:75], a[232:235], v[16:19], 0
    v_exp_f32 v25, v25
    v_max3_f32 v240, v32, v33, v34
    v_mfma_f32_16x16x32_bf16 a[76:79], a[236:239], v[16:19], 0
    v_exp_f32 v26, v26
    v_max3_f32 v241, v35, v36, v37
    v_mfma_f32_16x16x32_bf16 a[80:83], a[240:243], v[16:19], 0
    v_exp_f32 v27, v27
    v_cvt_pk_bf16_f32 v24, v24, v25
    v_mfma_f32_16x16x32_bf16 a[84:87], a[244:247], v[16:19], 0
    v_cvt_pk_bf16_f32 v25, v26, v27
    v_exp_f32 v28, v28
    v_mfma_f32_16x16x32_bf16 a[88:91], a[248:251], v[16:19], 0
    v_exp_f32 v29, v29
    v_max3_f32 v240, v240, v38, v39
    v_mfma_f32_16x16x32_bf16 a[92:95], a[252:255], v[16:19], 0
    buffer_load_dwordx4 v220, s[20:23], s87 offen nt lds
    v_max_f32 v240, v240, v241
    v_mfma_f32_16x16x32_bf16 v[68:71], v[228:231], v[16:19], 0
    s_waitcnt lgkmcnt(0)
    s_add_u32 m0, s38, 8192
    s_xor_b32 s87, s85, s86
    v_rcp_f32 v244, v72
    v_rcp_f32 v245, v72
    v_mfma_f32_16x16x32_bf16 v[0:3], a[192:195], v[160:163], v[40:43]
    s_add_u32 s85, s85, 4096
    v_exp_f32 v30, v30
    v_accvgpr_read_b32 v246, a96
    v_accvgpr_read_b32 v247, a97
    v_accvgpr_read_b32 v248, a98
    v_accvgpr_read_b32 v249, a99
    v_accvgpr_read_b32 v250, a100
    v_accvgpr_read_b32 v251, a101
    v_accvgpr_read_b32 v252, a102
    v_accvgpr_read_b32 v253, a103
    v_pk_mul_f32 v[246:247], v[246:247], v[244:245]
    v_pk_mul_f32 v[248:249], v[248:249], v[244:245]
    v_pk_mul_f32 v[250:251], v[250:251], v[244:245]
    v_pk_mul_f32 v[252:253], v[252:253], v[244:245]
    v_mfma_f32_16x16x32_bf16 v[0:3], a[196:199], v[164:167], v[0:3]
    v_exp_f32 v31, v31
    v_cvt_pk_bf16_f32 v26, v28, v29
    v_cvt_pk_bf16_f32 v128, v246, v247
    v_cvt_pk_bf16_f32 v129, v248, v249
    v_mfma_f32_16x16x32_bf16 v[0:3], a[200:203], v[168:171], v[0:3]
    v_cvt_pk_bf16_f32 v27, v30, v31
    v_mov_b32 v241, v240
    s_nop 1
    v_permlane32_swap_b32 v240, v241
    v_max_f32 v240, v240, v241
    v_mfma_f32_16x16x32_bf16 v[0:3], a[204:207], v[172:175], v[0:3]
    v_mov_b32 v241, v240
    s_nop 1
    v_permlane16_swap_b32 v240, v241
    v_max_f32 v240, v240, v241
    v_mfma_f32_16x16x32_bf16 v[4:7], a[208:211], v[160:163], v[40:43]
    v_sub_f32 v32, v32, v240
    v_sub_f32 v33, v33, v240
    v_sub_f32 v34, v34, v240
    v_cvt_pk_bf16_f32 v130, v250, v251
    v_cvt_pk_bf16_f32 v131, v252, v253
    v_mfma_f32_16x16x32_bf16 v[4:7], a[212:215], v[164:167], v[4:7]
    v_sub_f32 v35, v35, v240
    v_sub_f32 v36, v36, v240
    v_sub_f32 v37, v37, v240
    v_accvgpr_read_b32 v246, a104
    v_accvgpr_read_b32 v247, a105
    v_accvgpr_read_b32 v248, a106
    v_accvgpr_read_b32 v249, a107
    v_accvgpr_read_b32 v250, a108
    v_accvgpr_read_b32 v251, a109
    v_accvgpr_read_b32 v252, a110
    v_accvgpr_read_b32 v253, a111
    v_pk_mul_f32 v[246:247], v[246:247], v[244:245]
    v_pk_mul_f32 v[248:249], v[248:249], v[244:245]
    v_pk_mul_f32 v[250:251], v[250:251], v[244:245]
    v_pk_mul_f32 v[252:253], v[252:253], v[244:245]
    v_mfma_f32_16x16x32_bf16 v[4:7], a[216:219], v[168:171], v[4:7]
    buffer_load_dwordx4 v220, s[20:23], s87 offen nt lds
    v_sub_f32 v38, v38, v240
    v_cvt_pk_bf16_f32 v132, v246, v247
    v_cvt_pk_bf16_f32 v133, v248, v249
    v_mfma_f32_16x16x32_bf16 v[4:7], a[220:223], v[172:175], v[4:7]
    s_add_u32 m0, s38, 12288
    s_xor_b32 s87, s85, s86
    s_add_u32 s85, s85, 4096
    v_sub_f32 v39, v39, v240
    v_cvt_pk_bf16_f32 v134, v250, v251
    v_cvt_pk_bf16_f32 v135, v252, v253
    v_mfma_f32_16x16x32_bf16 a[96:99], a[224:227], v[24:27], 0
    v_sub_f32 v56, 0, v240
    v_sub_f32 v57, 0, v240
    v_sub_f32 v58, 0, v240
    v_accvgpr_read_b32 v246, a112
    v_accvgpr_read_b32 v247, a113
    v_accvgpr_read_b32 v248, a114
    v_accvgpr_read_b32 v249, a115
    v_accvgpr_read_b32 v250, a116
    v_accvgpr_read_b32 v251, a117
    v_accvgpr_read_b32 v252, a118
    v_accvgpr_read_b32 v253, a119
    v_pk_mul_f32 v[246:247], v[246:247], v[244:245]
    v_pk_mul_f32 v[248:249], v[248:249], v[244:245]
    v_pk_mul_f32 v[250:251], v[250:251], v[244:245]
    v_pk_mul_f32 v[252:253], v[252:253], v[244:245]
    v_mfma_f32_16x16x32_bf16 a[100:103], a[228:231], v[24:27], 0
    v_sub_f32 v59, 0, v240
    v_exp_f32 v32, v32
    v_cvt_pk_bf16_f32 v136, v246, v247
    v_cvt_pk_bf16_f32 v137, v248, v249
    v_mfma_f32_16x16x32_bf16 a[104:107], a[232:235], v[24:27], 0
    v_exp_f32 v33, v33
    v_exp_f32 v0, v0
    v_cvt_pk_bf16_f32 v138, v250, v251
    v_cvt_pk_bf16_f32 v139, v252, v253
    v_mfma_f32_16x16x32_bf16 a[108:111], a[236:239], v[24:27], 0
    v_exp_f32 v34, v34
    v_exp_f32 v1, v1
    v_accvgpr_read_b32 v246, a120
    v_accvgpr_read_b32 v247, a121
    v_accvgpr_read_b32 v248, a122
    v_accvgpr_read_b32 v249, a123
    v_accvgpr_read_b32 v250, a124
    v_accvgpr_read_b32 v251, a125
    v_accvgpr_read_b32 v252, a126
    v_accvgpr_read_b32 v253, a127
    v_pk_mul_f32 v[246:247], v[246:247], v[244:245]
    v_pk_mul_f32 v[248:249], v[248:249], v[244:245]
    v_pk_mul_f32 v[250:251], v[250:251], v[244:245]
    v_pk_mul_f32 v[252:253], v[252:253], v[244:245]
    v_mfma_f32_16x16x32_bf16 a[112:115], a[240:243], v[24:27], 0
    v_exp_f32 v35, v35
    v_cvt_pk_bf16_f32 v32, v32, v33
    v_cvt_pk_bf16_f32 v140, v246, v247
    v_cvt_pk_bf16_f32 v141, v248, v249
    v_mfma_f32_16x16x32_bf16 a[116:119], a[244:247], v[24:27], 0
    v_cvt_pk_bf16_f32 v33, v34, v35
    v_exp_f32 v36, v36
    v_cvt_pk_bf16_f32 v142, v250, v251
    v_cvt_pk_bf16_f32 v143, v252, v253
    v_mfma_f32_16x16x32_bf16 a[120:123], a[248:251], v[24:27], 0
    buffer_load_dwordx4 v220, s[20:23], s87 offen nt lds
    v_exp_f32 v2, v2
    v_accvgpr_read_b32 v246, a128
    v_accvgpr_read_b32 v247, a129
    v_mfma_f32_16x16x32_bf16 a[124:127], a[252:255], v[24:27], 0
    s_add_u32 m0, s38, 16384
    s_xor_b32 s87, s37, s86
    s_add_u32 s37, s37, 4096
    v_exp_f32 v3, v3
    v_accvgpr_read_b32 v248, a130
    v_accvgpr_read_b32 v249, a131
    v_mfma_f32_16x16x32_bf16 v[72:75], v[228:231], v[24:27], 0
    v_exp_f32 v37, v37
    v_cvt_pk_bf16_f32 v0, v0, v1
    v_cvt_pk_bf16_f32 v1, v2, v3
    v_accvgpr_read_b32 v250, a132
    v_accvgpr_read_b32 v251, a133
    v_mfma_f32_16x16x32_bf16 v[8:11], a[192:195], v[176:179], v[44:47]
    v_exp_f32 v38, v38
    v_exp_f32 v4, v4
    v_accvgpr_read_b32 v252, a134
    v_accvgpr_read_b32 v253, a135
    v_mfma_f32_16x16x32_bf16 v[8:11], a[196:199], v[180:183], v[8:11]
    v_exp_f32 v39, v39
    v_cvt_pk_bf16_f32 v34, v36, v37
    v_mul_f32 v246, v246, v222
    v_mul_f32 v247, v247, v222
    v_mfma_f32_16x16x32_bf16 v[8:11], a[200:203], v[184:187], v[8:11]
    v_cvt_pk_bf16_f32 v35, v38, v39
    v_exp_f32 v5, v5
    v_mul_f32 v248, v248, v222
    v_mul_f32 v249, v249, v222
    v_mfma_f32_16x16x32_bf16 v[8:11], a[204:207], v[188:191], v[8:11]
    v_exp_f32 v6, v6
    v_exp_f32 v7, v7
    v_mul_f32 v250, v250, v222
    v_mul_f32 v251, v251, v222
    v_mfma_f32_16x16x32_bf16 v[12:15], a[208:211], v[176:179], v[44:47]
    v_cvt_pk_bf16_f32 v2, v4, v5
    v_cvt_pk_bf16_f32 v3, v6, v7
    v_mul_f32 v252, v252, v222
    v_mul_f32 v253, v253, v222
    v_fmac_f32 v246, v144, v225
    v_fmac_f32 v247, v145, v225
    v_mfma_f32_16x16x32_bf16 v[12:15], a[212:215], v[180:183], v[12:15]
    buffer_load_dwordx4 v224, s[24:27], s87 offen nt lds
    v_fmac_f32 v248, v146, v225
    v_fmac_f32 v249, v147, v225
    v_fmac_f32 v250, v148, v225
    v_fmac_f32 v251, v149, v225
    v_mfma_f32_16x16x32_bf16 v[12:15], a[216:219], v[184:187], v[12:15]
    s_add_u32 m0, s38, 20480
    s_xor_b32 s87, s37, s86
    s_add_u32 s37, s37, 4096
    v_fmac_f32 v252, v150, v225
    v_fmac_f32 v253, v151, v225
    v_cvt_pk_bf16_f32 v144, v246, v247
    v_cvt_pk_bf16_f32 v145, v248, v249
    v_mfma_f32_16x16x32_bf16 v[12:15], a[220:223], v[188:191], v[12:15]
    v_exp_f32 v8, v8
    v_cvt_pk_bf16_f32 v146, v250, v251
    v_cvt_pk_bf16_f32 v147, v252, v253
    v_accvgpr_read_b32 v246, a136
    v_accvgpr_read_b32 v247, a137
    v_mfma_f32_16x16x32_bf16 a[128:131], a[224:227], v[32:35], 0
    ds_read_b64_tr_b16 a[224:225], v212 offset:24576
    ds_read_b64_tr_b16 a[226:227], v212 offset:28672
    v_accvgpr_read_b32 v248, a138
    v_accvgpr_read_b32 v249, a139
    v_accvgpr_read_b32 v250, a140
    v_accvgpr_read_b32 v251, a141
    v_mfma_f32_16x16x32_bf16 a[132:135], a[228:231], v[32:35], 0
    v_exp_f32 v9, v9
    v_accvgpr_read_b32 v252, a142
    v_accvgpr_read_b32 v253, a143
    v_mul_f32 v246, v246, v222
    v_mul_f32 v247, v247, v222
    v_mfma_f32_16x16x32_bf16 a[136:139], a[232:235], v[32:35], 0
    ds_read_b64_tr_b16 a[228:229], v213 offset:24576
    ds_read_b64_tr_b16 a[230:231], v213 offset:28672
    v_mul_f32 v248, v248, v222
    v_mul_f32 v249, v249, v222
    v_mul_f32 v250, v250, v222
    v_mul_f32 v251, v251, v222
    v_mfma_f32_16x16x32_bf16 a[140:143], a[236:239], v[32:35], 0
    v_add_u32 v212, s44, v212
    v_add_u32 v213, s44, v213
    v_mul_f32 v252, v252, v222
    v_mul_f32 v253, v253, v222
    v_fmac_f32 v246, v152, v225
    v_fmac_f32 v247, v153, v225
    v_mfma_f32_16x16x32_bf16 a[144:147], a[240:243], v[32:35], 0
    ds_read_b64_tr_b16 a[232:233], v214 offset:24576
    ds_read_b64_tr_b16 a[234:235], v214 offset:28672
    v_fmac_f32 v248, v154, v225
    v_fmac_f32 v249, v155, v225
    v_fmac_f32 v250, v156, v225
    v_fmac_f32 v251, v157, v225
    v_mfma_f32_16x16x32_bf16 a[148:151], a[244:247], v[32:35], 0
    buffer_load_dwordx4 v224, s[24:27], s87 offen nt lds
    v_fmac_f32 v252, v158, v225
    v_fmac_f32 v253, v159, v225
    v_cvt_pk_bf16_f32 v148, v246, v247
    v_cvt_pk_bf16_f32 v149, v248, v249
    v_mfma_f32_16x16x32_bf16 a[152:155], a[248:251], v[32:35], 0
    s_add_u32 m0, s38, 24576
    ds_read_b64_tr_b16 a[236:237], v215 offset:24576
    ds_read_b64_tr_b16 a[238:239], v215 offset:28672
    v_cvt_pk_bf16_f32 v150, v250, v251
    v_cvt_pk_bf16_f32 v151, v252, v253
    v_mfma_f32_16x16x32_bf16 a[156:159], a[252:255], v[32:35], 0
    s_xor_b32 s87, s37, s86
    s_add_u32 s37, s37, 4096
    s_mov_b32 s41, 1
    v_mfma_f32_16x16x32_bf16 v[76:79], v[228:231], v[32:35], 0
    ds_read_b64_tr_b16 a[240:241], v216 offset:24576
    ds_read_b64_tr_b16 a[242:243], v216 offset:28672
    s_mov_b32 s12, s28
    v_mfma_f32_16x16x32_bf16 v[16:19], a[192:195], v[192:195], v[48:51]
    v_add_u32 v214, s44, v214
    v_add_u32 v215, s44, v215
    s_mov_b32 s13, s29
    v_mfma_f32_16x16x32_bf16 v[16:19], a[196:199], v[196:199], v[16:19]
    ds_read_b64_tr_b16 a[244:245], v217 offset:24576
    ds_read_b64_tr_b16 a[246:247], v217 offset:28672
    s_mov_b32 s14, s30
    v_mfma_f32_16x16x32_bf16 v[16:19], a[200:203], v[200:203], v[16:19]
    v_add_u32 v216, s44, v216
    v_add_u32 v217, s44, v217
    s_lshl_b32 s81, s36, 13
    v_mfma_f32_16x16x32_bf16 v[16:19], a[204:207], v[204:207], v[16:19]
    ds_read_b64_tr_b16 a[248:249], v218 offset:24576
    ds_read_b64_tr_b16 a[250:251], v218 offset:28672
    s_lshr_b32 s60, s50, 3
    v_mfma_f32_16x16x32_bf16 v[20:23], a[208:211], v[192:195], v[48:51]
    buffer_load_dwordx4 v224, s[24:27], s87 offen nt lds
    v_mfma_f32_16x16x32_bf16 v[20:23], a[212:215], v[196:199], v[20:23]
    s_add_u32 m0, s38, 28672
    ds_read_b64_tr_b16 a[252:253], v219 offset:24576
    ds_read_b64_tr_b16 a[254:255], v219 offset:28672
    v_mfma_f32_16x16x32_bf16 v[20:23], a[216:219], v[200:203], v[20:23]
    s_xor_b32 s87, s37, s86
    s_add_u32 s37, s37, 4096
    s_lshr_b32 s61, s50, 1
    v_mfma_f32_16x16x32_bf16 v[20:23], a[220:223], v[204:207], v[20:23]
    s_waitcnt lgkmcnt(6)
    v_add_u32 v218, s44, v218
    v_add_u32 v219, s44, v219
    v_mfma_f32_16x16x32_bf16 a[0:3], a[224:227], v[0:3], a[0:3]
    v_exp_f32 v10, v10
    s_xor_b32 s60, s60, s61
    v_mfma_f32_16x16x32_bf16 a[4:7], a[228:231], v[0:3], a[4:7]
    v_exp_f32 v11, v11
    s_and_b32 s60, s60, 0
    v_mfma_f32_16x16x32_bf16 a[8:11], a[232:235], v[0:3], a[8:11]
    v_cvt_pk_bf16_f32 v8, v8, v9
    v_cvt_pk_bf16_f32 v9, v10, v11
    s_and_b32 s61, s50, 1
    v_mfma_f32_16x16x32_bf16 a[12:15], a[236:239], v[0:3], a[12:15]
    v_exp_f32 v12, v12
    s_lshl_b32 s61, s61, 2
    v_mfma_f32_16x16x32_bf16 a[16:19], a[240:243], v[0:3], a[16:19]
    s_waitcnt lgkmcnt(2)
    v_exp_f32 v13, v13
    v_mfma_f32_16x16x32_bf16 a[20:23], a[244:247], v[0:3], a[20:23]
    buffer_load_dwordx4 v224, s[24:27], s87 offen nt lds
    v_mfma_f32_16x16x32_bf16 a[24:27], a[248:251], v[0:3], a[24:27]
    s_waitcnt lgkmcnt(0)
    v_exp_f32 v14, v14
    v_mfma_f32_16x16x32_bf16 a[28:31], a[252:255], v[0:3], a[28:31]
    v_exp_f32 v15, v15
    s_or_b32 s61, s61, s36
    v_mfma_f32_16x16x32_bf16 v[60:63], v[228:231], v[0:3], v[60:63]
    v_cvt_pk_bf16_f32 v10, v12, v13
    v_cvt_pk_bf16_f32 v11, v14, v15
    s_lshl_b32 s80, s61, 19
    v_mfma_f32_16x16x32_bf16 v[24:27], a[192:195], a[160:163], v[52:55]
    v_exp_f32 v16, v16
    s_lshl_b32 s61, s60, 15
    v_mfma_f32_16x16x32_bf16 v[24:27], a[196:199], a[164:167], v[24:27]
    ds_read_b128 a[192:195], v208 offset:8192
    ds_read_b128 a[196:199], v209 offset:8192
    s_or_b32 s80, s80, s61
    v_mfma_f32_16x16x32_bf16 v[24:27], a[200:203], a[168:171], v[24:27]
    v_exp_f32 v17, v17
    s_lshl_b32 s61, s60, 10
    v_or_b32 v238, s61, v233
    v_mfma_f32_16x16x32_bf16 v[24:27], a[204:207], a[172:175], v[24:27]
    ds_read_b128 a[200:203], v210 offset:8192
    ds_read_b128 a[204:207], v211 offset:8192
    v_mfma_f32_16x16x32_bf16 v[28:31], a[208:211], a[160:163], v[52:55]
    v_exp_f32 v18, v18
    v_mfma_f32_16x16x32_bf16 v[28:31], a[212:215], a[164:167], v[28:31]
    s_sub_u32 s39, s39, 1
    ds_read_b128 a[208:211], v208 offset:12288
    ds_read_b128 a[212:215], v209 offset:12288
    v_mfma_f32_16x16x32_bf16 v[28:31], a[216:219], a[168:171], v[28:31]
    v_add_u32 v208, s44, v208
    v_add_u32 v209, s44, v209
    v_mfma_f32_16x16x32_bf16 v[28:31], a[220:223], a[172:175], v[28:31]
    ds_read_b128 a[216:219], v210 offset:12288
    ds_read_b128 a[220:223], v211 offset:12288
    v_mfma_f32_16x16x32_bf16 a[32:35], a[224:227], v[8:11], a[32:35]
    v_add_u32 v210, s44, v210
    v_add_u32 v211, s44, v211
    v_mfma_f32_16x16x32_bf16 a[36:39], a[228:231], v[8:11], a[36:39]
    v_exp_f32 v19, v19
    v_mfma_f32_16x16x32_bf16 a[40:43], a[232:235], v[8:11], a[40:43]
    v_cvt_pk_bf16_f32 v16, v16, v17
    v_cvt_pk_bf16_f32 v17, v18, v19
    v_mfma_f32_16x16x32_bf16 a[44:47], a[236:239], v[8:11], a[44:47]
    v_exp_f32 v20, v20
    v_mfma_f32_16x16x32_bf16 a[48:51], a[240:243], v[8:11], a[48:51]
    v_exp_f32 v21, v21
    v_mfma_f32_16x16x32_bf16 a[52:55], a[244:247], v[8:11], a[52:55]
    v_exp_f32 v22, v22
    v_mfma_f32_16x16x32_bf16 a[56:59], a[248:251], v[8:11], a[56:59]
    v_exp_f32 v23, v23
    v_mfma_f32_16x16x32_bf16 a[60:63], a[252:255], v[8:11], a[60:63]
    v_cvt_pk_bf16_f32 v18, v20, v21
    v_cvt_pk_bf16_f32 v19, v22, v23
    v_mfma_f32_16x16x32_bf16 v[64:67], v[228:231], v[8:11], v[64:67]
    v_exp_f32 v24, v24
    v_exp_f32 v25, v25
    v_exp_f32 v26, v26
    s_waitcnt lgkmcnt(0)
.p2align 6
A0h1_loop:
    v_mfma_f32_16x16x32_bf16 v[0:3], a[192:195], v[160:163], v[40:43]
    v_exp_f32 v27, v27
    v_mfma_f32_16x16x32_bf16 v[0:3], a[196:199], v[164:167], v[0:3]
    v_cvt_pk_bf16_f32 v24, v24, v25
    v_cvt_pk_bf16_f32 v25, v26, v27
    v_mfma_f32_16x16x32_bf16 v[0:3], a[200:203], v[168:171], v[0:3]
    v_exp_f32 v28, v28
    v_mfma_f32_16x16x32_bf16 v[0:3], a[204:207], v[172:175], v[0:3]
    v_exp_f32 v29, v29
    v_mfma_f32_16x16x32_bf16 v[4:7], a[208:211], v[160:163], v[40:43]
    v_exp_f32 v30, v30
    v_mfma_f32_16x16x32_bf16 v[4:7], a[212:215], v[164:167], v[4:7]
    v_exp_f32 v31, v31
    v_mfma_f32_16x16x32_bf16 v[4:7], a[216:219], v[168:171], v[4:7]
    v_exp_f32 v0, v0
    v_mfma_f32_16x16x32_bf16 v[4:7], a[220:223], v[172:175], v[4:7]
    v_exp_f32 v1, v1
    v_mfma_f32_16x16x32_bf16 a[64:67], a[224:227], v[16:19], a[64:67]
    v_exp_f32 v2, v2
    v_mfma_f32_16x16x32_bf16 a[68:71], a[228:231], v[16:19], a[68:71]
    v_exp_f32 v3, v3
    v_mfma_f32_16x16x32_bf16 a[72:75], a[232:235], v[16:19], a[72:75]
    s_waitcnt vmcnt(16) lgkmcnt(0)
    s_barrier
    v_mfma_f32_16x16x32_bf16 a[76:79], a[236:239], v[16:19], a[76:79]
    s_add_u32 s38, s74, s3
    s_add_u32 m0, s38, 0
    s_xor_b32 s87, s85, s86
    v_mfma_f32_16x16x32_bf16 a[80:83], a[240:243], v[16:19], a[80:83]
    s_add_u32 s85, s85, 4096
    s_add_u32 s74, s74, s44
    v_cvt_pk_bf16_f32 v0, v0, v1
    v_mfma_f32_16x16x32_bf16 a[84:87], a[244:247], v[16:19], a[84:87]
    buffer_load_dwordx4 v220, s[20:23], s87 offen nt lds
    v_mfma_f32_16x16x32_bf16 a[88:91], a[248:251], v[16:19], a[88:91]
    s_add_u32 m0, s38, 4096
    s_xor_b32 s87, s85, s86
    s_add_u32 s85, s85, 4096
    v_mfma_f32_16x16x32_bf16 a[92:95], a[252:255], v[16:19], a[92:95]
    s_cmp_eq_u32 s74, 0x18000
    s_cselect_b32 s44, s45, s46
    v_cvt_pk_bf16_f32 v1, v2, v3
    v_mfma_f32_16x16x32_bf16 v[68:71], v[228:231], v[16:19], v[68:71]
    v_exp_f32 v4, v4
    v_mfma_f32_16x16x32_bf16 v[8:11], a[192:195], v[176:179], v[44:47]
    v_exp_f32 v5, v5
    v_mfma_f32_16x16x32_bf16 v[8:11], a[196:199], v[180:183], v[8:11]
    v_exp_f32 v6, v6
    v_mfma_f32_16x16x32_bf16 v[8:11], a[200:203], v[184:187], v[8:11]
    v_exp_f32 v7, v7
    v_mfma_f32_16x16x32_bf16 v[8:11], a[204:207], v[188:191], v[8:11]
    v_cvt_pk_bf16_f32 v2, v4, v5
    v_cvt_pk_bf16_f32 v3, v6, v7
    v_mfma_f32_16x16x32_bf16 v[12:15], a[208:211], v[176:179], v[44:47]
    v_cvt_pk_bf16_f32 v26, v28, v29
    v_cvt_pk_bf16_f32 v27, v30, v31
    v_mfma_f32_16x16x32_bf16 v[12:15], a[212:215], v[180:183], v[12:15]
    v_mfma_f32_16x16x32_bf16 v[12:15], a[216:219], v[184:187], v[12:15]
    v_exp_f32 v8, v8
    v_mfma_f32_16x16x32_bf16 v[12:15], a[220:223], v[188:191], v[12:15]
    v_exp_f32 v9, v9
    v_mfma_f32_16x16x32_bf16 a[96:99], a[224:227], v[24:27], a[96:99]
    ds_read_b64_tr_b16 a[224:225], v212 offset:16384
    ds_read_b64_tr_b16 a[226:227], v212 offset:20480
    v_mfma_f32_16x16x32_bf16 a[100:103], a[228:231], v[24:27], a[100:103]
    v_exp_f32 v10, v10
    v_mfma_f32_16x16x32_bf16 a[104:107], a[232:235], v[24:27], a[104:107]
    ds_read_b64_tr_b16 a[228:229], v213 offset:16384
    ds_read_b64_tr_b16 a[230:231], v213 offset:20480
    v_mfma_f32_16x16x32_bf16 a[108:111], a[236:239], v[24:27], a[108:111]
    buffer_load_dwordx4 v220, s[20:23], s87 offen nt lds
    v_mfma_f32_16x16x32_bf16 a[112:115], a[240:243], v[24:27], a[112:115]
    s_add_u32 m0, s38, 8192
    ds_read_b64_tr_b16 a[232:233], v214 offset:16384
    ds_read_b64_tr_b16 a[234:235], v214 offset:20480
    v_mfma_f32_16x16x32_bf16 a[116:119], a[244:247], v[24:27], a[116:119]
    s_xor_b32 s87, s85, s86
    s_add_u32 s85, s85, 4096
    v_mfma_f32_16x16x32_bf16 a[120:123], a[248:251], v[24:27], a[120:123]
    ds_read_b64_tr_b16 a[236:237], v215 offset:16384
    ds_read_b64_tr_b16 a[238:239], v215 offset:20480
    v_mfma_f32_16x16x32_bf16 a[124:127], a[252:255], v[24:27], a[124:127]
    v_exp_f32 v11, v11
    v_mfma_f32_16x16x32_bf16 v[72:75], v[228:231], v[24:27], v[72:75]
    ds_read_b64_tr_b16 a[240:241], v216 offset:16384
    ds_read_b64_tr_b16 a[242:243], v216 offset:20480
    v_mfma_f32_16x16x32_bf16 v[16:19], a[192:195], v[192:195], v[48:51]
    v_cvt_pk_bf16_f32 v8, v8, v9
    v_cvt_pk_bf16_f32 v9, v10, v11
    v_mfma_f32_16x16x32_bf16 v[16:19], a[196:199], v[196:199], v[16:19]
    ds_read_b64_tr_b16 a[244:245], v217 offset:16384
    ds_read_b64_tr_b16 a[246:247], v217 offset:20480
    v_mfma_f32_16x16x32_bf16 v[16:19], a[200:203], v[200:203], v[16:19]
    v_exp_f32 v12, v12
    v_mfma_f32_16x16x32_bf16 v[16:19], a[204:207], v[204:207], v[16:19]
    ds_read_b64_tr_b16 a[248:249], v218 offset:16384
    ds_read_b64_tr_b16 a[250:251], v218 offset:20480
    v_mfma_f32_16x16x32_bf16 v[20:23], a[208:211], v[192:195], v[48:51]
    v_exp_f32 v13, v13
    v_mfma_f32_16x16x32_bf16 v[20:23], a[212:215], v[196:199], v[20:23]
    ds_read_b64_tr_b16 a[252:253], v219 offset:16384
    ds_read_b64_tr_b16 a[254:255], v219 offset:20480
    v_mfma_f32_16x16x32_bf16 v[20:23], a[216:219], v[200:203], v[20:23]
    v_exp_f32 v14, v14
    v_mfma_f32_16x16x32_bf16 v[20:23], a[220:223], v[204:207], v[20:23]
    s_waitcnt lgkmcnt(6)
    v_exp_f32 v15, v15
    v_mfma_f32_16x16x32_bf16 a[0:3], a[224:227], v[0:3], a[0:3]
    v_cvt_pk_bf16_f32 v10, v12, v13
    v_cvt_pk_bf16_f32 v11, v14, v15
    v_mfma_f32_16x16x32_bf16 a[4:7], a[228:231], v[0:3], a[4:7]
    v_exp_f32 v16, v16
    v_mfma_f32_16x16x32_bf16 a[8:11], a[232:235], v[0:3], a[8:11]
    v_exp_f32 v17, v17
    v_mfma_f32_16x16x32_bf16 a[12:15], a[236:239], v[0:3], a[12:15]
    buffer_load_dwordx4 v220, s[20:23], s87 offen nt lds
    v_mfma_f32_16x16x32_bf16 a[16:19], a[240:243], v[0:3], a[16:19]
    s_waitcnt lgkmcnt(2)
    s_add_u32 m0, s38, 12288
    s_xor_b32 s87, s85, s86
    v_mfma_f32_16x16x32_bf16 a[20:23], a[244:247], v[0:3], a[20:23]
    s_add_u32 s85, s85, 4096
    v_exp_f32 v18, v18
    v_mfma_f32_16x16x32_bf16 a[24:27], a[248:251], v[0:3], a[24:27]
    s_waitcnt lgkmcnt(0)
    v_exp_f32 v19, v19
    v_mfma_f32_16x16x32_bf16 a[28:31], a[252:255], v[0:3], a[28:31]
    v_cvt_pk_bf16_f32 v16, v16, v17
    v_cvt_pk_bf16_f32 v17, v18, v19
    v_mfma_f32_16x16x32_bf16 v[60:63], v[228:231], v[0:3], v[60:63]
    v_exp_f32 v20, v20
    v_mfma_f32_16x16x32_bf16 v[24:27], a[192:195], a[160:163], v[52:55]
    v_exp_f32 v21, v21
    v_mfma_f32_16x16x32_bf16 v[24:27], a[196:199], a[164:167], v[24:27]
    v_exp_f32 v22, v22
    v_mfma_f32_16x16x32_bf16 v[24:27], a[200:203], a[168:171], v[24:27]
    v_exp_f32 v23, v23
    v_mfma_f32_16x16x32_bf16 v[24:27], a[204:207], a[172:175], v[24:27]
    v_cvt_pk_bf16_f32 v18, v20, v21
    v_cvt_pk_bf16_f32 v19, v22, v23
    v_mfma_f32_16x16x32_bf16 v[28:31], a[208:211], a[160:163], v[52:55]
    v_mfma_f32_16x16x32_bf16 v[28:31], a[212:215], a[164:167], v[28:31]
    v_mfma_f32_16x16x32_bf16 v[28:31], a[216:219], a[168:171], v[28:31]
    v_exp_f32 v24, v24
    v_mfma_f32_16x16x32_bf16 v[28:31], a[220:223], a[172:175], v[28:31]
    v_exp_f32 v25, v25
    v_mfma_f32_16x16x32_bf16 a[32:35], a[224:227], v[8:11], a[32:35]
    v_exp_f32 v26, v26
    v_mfma_f32_16x16x32_bf16 a[36:39], a[228:231], v[8:11], a[36:39]
    v_exp_f32 v27, v27
    v_mfma_f32_16x16x32_bf16 a[40:43], a[232:235], v[8:11], a[40:43]
    v_cvt_pk_bf16_f32 v24, v24, v25
    v_cvt_pk_bf16_f32 v25, v26, v27
    v_mfma_f32_16x16x32_bf16 a[44:47], a[236:239], v[8:11], a[44:47]
    buffer_load_dwordx4 v220, s[20:23], s87 offen nt lds
    v_mfma_f32_16x16x32_bf16 a[48:51], a[240:243], v[8:11], a[48:51]
    s_add_u32 m0, s38, 16384
    s_xor_b32 s87, s37, s86
    s_add_u32 s37, s37, 4096
    v_mfma_f32_16x16x32_bf16 a[52:55], a[244:247], v[8:11], a[52:55]
    v_exp_f32 v28, v28
    v_mfma_f32_16x16x32_bf16 a[56:59], a[248:251], v[8:11], a[56:59]
    v_exp_f32 v29, v29
    v_mfma_f32_16x16x32_bf16 a[60:63], a[252:255], v[8:11], a[60:63]
    v_exp_f32 v30, v30
    v_mfma_f32_16x16x32_bf16 v[64:67], v[228:231], v[8:11], v[64:67]
    v_exp_f32 v31, v31
    v_mfma_f32_16x16x32_bf16 v[32:35], a[192:195], a[176:179], v[56:59]
    v_cvt_pk_bf16_f32 v26, v28, v29
    v_cvt_pk_bf16_f32 v27, v30, v31
    v_mfma_f32_16x16x32_bf16 v[32:35], a[196:199], a[180:183], v[32:35]
    ds_read_b128 a[192:195], v208 offset:0
    ds_read_b128 a[196:199], v209 offset:0
    v_mfma_f32_16x16x32_bf16 v[32:35], a[200:203], a[184:187], v[32:35]
    v_mfma_f32_16x16x32_bf16 v[32:35], a[204:207], a[188:191], v[32:35]
    ds_read_b128 a[200:203], v210 offset:0
    ds_read_b128 a[204:207], v211 offset:0
    v_mfma_f32_16x16x32_bf16 v[36:39], a[208:211], a[176:179], v[56:59]
    v_mfma_f32_16x16x32_bf16 v[36:39], a[212:215], a[180:183], v[36:39]
    ds_read_b128 a[208:211], v208 offset:4096
    ds_read_b128 a[212:215], v209 offset:4096
    v_mfma_f32_16x16x32_bf16 v[36:39], a[216:219], a[184:187], v[36:39]
    v_exp_f32 v32, v32
    v_mfma_f32_16x16x32_bf16 v[36:39], a[220:223], a[188:191], v[36:39]
    ds_read_b128 a[216:219], v210 offset:4096
    ds_read_b128 a[220:223], v211 offset:4096
    v_mfma_f32_16x16x32_bf16 a[64:67], a[224:227], v[16:19], a[64:67]
    v_exp_f32 v33, v33
    v_mfma_f32_16x16x32_bf16 a[68:71], a[228:231], v[16:19], a[68:71]
    v_exp_f32 v34, v34
    v_mfma_f32_16x16x32_bf16 a[72:75], a[232:235], v[16:19], a[72:75]
    v_exp_f32 v35, v35
    v_mfma_f32_16x16x32_bf16 a[76:79], a[236:239], v[16:19], a[76:79]
    buffer_load_dwordx4 v224, s[24:27], s87 offen nt lds
    v_mfma_f32_16x16x32_bf16 a[80:83], a[240:243], v[16:19], a[80:83]
    s_add_u32 m0, s38, 20480
    s_xor_b32 s87, s37, s86
    s_add_u32 s37, s37, 4096
    v_mfma_f32_16x16x32_bf16 a[84:87], a[244:247], v[16:19], a[84:87]
    v_cvt_pk_bf16_f32 v32, v32, v33
    v_cvt_pk_bf16_f32 v33, v34, v35
    v_mfma_f32_16x16x32_bf16 a[88:91], a[248:251], v[16:19], a[88:91]
    v_exp_f32 v36, v36
    v_mfma_f32_16x16x32_bf16 a[92:95], a[252:255], v[16:19], a[92:95]
    v_exp_f32 v37, v37
    v_mfma_f32_16x16x32_bf16 v[68:71], v[228:231], v[16:19], v[68:71]
    s_waitcnt lgkmcnt(0)
    v_exp_f32 v38, v38
    v_mfma_f32_16x16x32_bf16 v[0:3], a[192:195], v[160:163], v[40:43]
    v_exp_f32 v39, v39
    v_mfma_f32_16x16x32_bf16 v[0:3], a[196:199], v[164:167], v[0:3]
    v_cvt_pk_bf16_f32 v34, v36, v37
    v_cvt_pk_bf16_f32 v35, v38, v39
    v_mfma_f32_16x16x32_bf16 v[0:3], a[200:203], v[168:171], v[0:3]
    v_mfma_f32_16x16x32_bf16 v[0:3], a[204:207], v[172:175], v[0:3]
    v_mfma_f32_16x16x32_bf16 v[4:7], a[208:211], v[160:163], v[40:43]
    v_mfma_f32_16x16x32_bf16 v[4:7], a[212:215], v[164:167], v[4:7]
    v_mfma_f32_16x16x32_bf16 v[4:7], a[216:219], v[168:171], v[4:7]
    v_exp_f32 v0, v0
    v_mfma_f32_16x16x32_bf16 v[4:7], a[220:223], v[172:175], v[4:7]
    v_exp_f32 v1, v1
    v_mfma_f32_16x16x32_bf16 a[96:99], a[224:227], v[24:27], a[96:99]
    v_exp_f32 v2, v2
    v_mfma_f32_16x16x32_bf16 a[100:103], a[228:231], v[24:27], a[100:103]
    v_exp_f32 v3, v3
    v_mfma_f32_16x16x32_bf16 a[104:107], a[232:235], v[24:27], a[104:107]
    v_cvt_pk_bf16_f32 v0, v0, v1
    v_cvt_pk_bf16_f32 v1, v2, v3
    v_mfma_f32_16x16x32_bf16 a[108:111], a[236:239], v[24:27], a[108:111]
    buffer_load_dwordx4 v224, s[24:27], s87 offen nt lds
    v_mfma_f32_16x16x32_bf16 a[112:115], a[240:243], v[24:27], a[112:115]
    s_add_u32 m0, s38, 24576
    s_xor_b32 s87, s37, s86
    s_add_u32 s37, s37, 4096
    v_mfma_f32_16x16x32_bf16 a[116:119], a[244:247], v[24:27], a[116:119]
    v_exp_f32 v4, v4
    v_mfma_f32_16x16x32_bf16 a[120:123], a[248:251], v[24:27], a[120:123]
    v_exp_f32 v5, v5
    v_mfma_f32_16x16x32_bf16 a[124:127], a[252:255], v[24:27], a[124:127]
    v_exp_f32 v6, v6
    v_mfma_f32_16x16x32_bf16 v[72:75], v[228:231], v[24:27], v[72:75]
    v_exp_f32 v7, v7
    v_mfma_f32_16x16x32_bf16 v[8:11], a[192:195], v[176:179], v[44:47]
    v_cvt_pk_bf16_f32 v2, v4, v5
    v_cvt_pk_bf16_f32 v3, v6, v7
    v_mfma_f32_16x16x32_bf16 v[8:11], a[196:199], v[180:183], v[8:11]
    v_mfma_f32_16x16x32_bf16 v[8:11], a[200:203], v[184:187], v[8:11]
    v_mfma_f32_16x16x32_bf16 v[8:11], a[204:207], v[188:191], v[8:11]
    v_mfma_f32_16x16x32_bf16 v[12:15], a[208:211], v[176:179], v[44:47]
    v_mfma_f32_16x16x32_bf16 v[12:15], a[212:215], v[180:183], v[12:15]
    v_mfma_f32_16x16x32_bf16 v[12:15], a[216:219], v[184:187], v[12:15]
    v_exp_f32 v8, v8
    v_mfma_f32_16x16x32_bf16 v[12:15], a[220:223], v[188:191], v[12:15]
    v_exp_f32 v9, v9
    v_mfma_f32_16x16x32_bf16 a[128:131], a[224:227], v[32:35], a[128:131]
    ds_read_b64_tr_b16 a[224:225], v212 offset:24576
    ds_read_b64_tr_b16 a[226:227], v212 offset:28672
    v_mfma_f32_16x16x32_bf16 a[132:135], a[228:231], v[32:35], a[132:135]
    v_exp_f32 v10, v10
    v_mfma_f32_16x16x32_bf16 a[136:139], a[232:235], v[32:35], a[136:139]
    ds_read_b64_tr_b16 a[228:229], v213 offset:24576
    ds_read_b64_tr_b16 a[230:231], v213 offset:28672
    v_mfma_f32_16x16x32_bf16 a[140:143], a[236:239], v[32:35], a[140:143]
    buffer_load_dwordx4 v224, s[24:27], s87 offen nt lds
    v_mfma_f32_16x16x32_bf16 a[144:147], a[240:243], v[32:35], a[144:147]
    s_add_u32 m0, s38, 28672
    ds_read_b64_tr_b16 a[232:233], v214 offset:24576
    ds_read_b64_tr_b16 a[234:235], v214 offset:28672
    v_mfma_f32_16x16x32_bf16 a[148:151], a[244:247], v[32:35], a[148:151]
    s_xor_b32 s87, s37, s86
    s_add_u32 s37, s37, 4096
    v_mfma_f32_16x16x32_bf16 a[152:155], a[248:251], v[32:35], a[152:155]
    ds_read_b64_tr_b16 a[236:237], v215 offset:24576
    ds_read_b64_tr_b16 a[238:239], v215 offset:28672
    v_mfma_f32_16x16x32_bf16 a[156:159], a[252:255], v[32:35], a[156:159]
    v_add_u32 v212, s44, v212
    v_add_u32 v213, s44, v213
    v_mfma_f32_16x16x32_bf16 v[76:79], v[228:231], v[32:35], v[76:79]
    ds_read_b64_tr_b16 a[240:241], v216 offset:24576
    ds_read_b64_tr_b16 a[242:243], v216 offset:28672
    v_mfma_f32_16x16x32_bf16 v[16:19], a[192:195], v[192:195], v[48:51]
    v_add_u32 v214, s44, v214
    v_add_u32 v215, s44, v215
    v_mfma_f32_16x16x32_bf16 v[16:19], a[196:199], v[196:199], v[16:19]
    ds_read_b64_tr_b16 a[244:245], v217 offset:24576
    ds_read_b64_tr_b16 a[246:247], v217 offset:28672
    v_mfma_f32_16x16x32_bf16 v[16:19], a[200:203], v[200:203], v[16:19]
    v_add_u32 v216, s44, v216
    v_add_u32 v217, s44, v217
    v_mfma_f32_16x16x32_bf16 v[16:19], a[204:207], v[204:207], v[16:19]
    ds_read_b64_tr_b16 a[248:249], v218 offset:24576
    ds_read_b64_tr_b16 a[250:251], v218 offset:28672
    v_mfma_f32_16x16x32_bf16 v[20:23], a[208:211], v[192:195], v[48:51]
    v_exp_f32 v11, v11
    v_mfma_f32_16x16x32_bf16 v[20:23], a[212:215], v[196:199], v[20:23]
    ds_read_b64_tr_b16 a[252:253], v219 offset:24576
    ds_read_b64_tr_b16 a[254:255], v219 offset:28672
    v_mfma_f32_16x16x32_bf16 v[20:23], a[216:219], v[200:203], v[20:23]
    v_add_u32 v218, s44, v218
    v_add_u32 v219, s44, v219
    v_mfma_f32_16x16x32_bf16 v[20:23], a[220:223], v[204:207], v[20:23]
    s_waitcnt lgkmcnt(6)
    v_cvt_pk_bf16_f32 v8, v8, v9
    v_cvt_pk_bf16_f32 v9, v10, v11
    v_mfma_f32_16x16x32_bf16 a[0:3], a[224:227], v[0:3], a[0:3]
    v_exp_f32 v12, v12
    v_mfma_f32_16x16x32_bf16 a[4:7], a[228:231], v[0:3], a[4:7]
    v_exp_f32 v13, v13
    v_mfma_f32_16x16x32_bf16 a[8:11], a[232:235], v[0:3], a[8:11]
    v_exp_f32 v14, v14
    v_mfma_f32_16x16x32_bf16 a[12:15], a[236:239], v[0:3], a[12:15]
    buffer_load_dwordx4 v224, s[24:27], s87 offen nt lds
    v_mfma_f32_16x16x32_bf16 a[16:19], a[240:243], v[0:3], a[16:19]
    s_waitcnt lgkmcnt(2)
    v_exp_f32 v15, v15
    v_mfma_f32_16x16x32_bf16 a[20:23], a[244:247], v[0:3], a[20:23]
    v_cvt_pk_bf16_f32 v10, v12, v13
    v_cvt_pk_bf16_f32 v11, v14, v15
    v_mfma_f32_16x16x32_bf16 a[24:27], a[248:251], v[0:3], a[24:27]
    s_waitcnt lgkmcnt(0)
    v_exp_f32 v16, v16
    v_mfma_f32_16x16x32_bf16 a[28:31], a[252:255], v[0:3], a[28:31]
    v_exp_f32 v17, v17
    v_mfma_f32_16x16x32_bf16 v[60:63], v[228:231], v[0:3], v[60:63]
    v_exp_f32 v18, v18
    v_mfma_f32_16x16x32_bf16 v[24:27], a[192:195], a[160:163], v[52:55]
    v_exp_f32 v19, v19
    v_mfma_f32_16x16x32_bf16 v[24:27], a[196:199], a[164:167], v[24:27]
    ds_read_b128 a[192:195], v208 offset:8192
    ds_read_b128 a[196:199], v209 offset:8192
    v_mfma_f32_16x16x32_bf16 v[24:27], a[200:203], a[168:171], v[24:27]
    v_cvt_pk_bf16_f32 v16, v16, v17
    v_cvt_pk_bf16_f32 v17, v18, v19
    v_mfma_f32_16x16x32_bf16 v[24:27], a[204:207], a[172:175], v[24:27]
    ds_read_b128 a[200:203], v210 offset:8192
    ds_read_b128 a[204:207], v211 offset:8192
    v_mfma_f32_16x16x32_bf16 v[28:31], a[208:211], a[160:163], v[52:55]
    v_exp_f32 v20, v20
    v_mfma_f32_16x16x32_bf16 v[28:31], a[212:215], a[164:167], v[28:31]
    s_sub_u32 s39, s39, 1
    ds_read_b128 a[208:211], v208 offset:12288
    ds_read_b128 a[212:215], v209 offset:12288
    v_mfma_f32_16x16x32_bf16 v[28:31], a[216:219], a[168:171], v[28:31]
    v_add_u32 v208, s44, v208
    v_add_u32 v209, s44, v209
    v_mfma_f32_16x16x32_bf16 v[28:31], a[220:223], a[172:175], v[28:31]
    ds_read_b128 a[216:219], v210 offset:12288
    ds_read_b128 a[220:223], v211 offset:12288
    v_mfma_f32_16x16x32_bf16 a[32:35], a[224:227], v[8:11], a[32:35]
    v_add_u32 v210, s44, v210
    v_add_u32 v211, s44, v211
    v_mfma_f32_16x16x32_bf16 a[36:39], a[228:231], v[8:11], a[36:39]
    v_exp_f32 v21, v21
    v_mfma_f32_16x16x32_bf16 a[40:43], a[232:235], v[8:11], a[40:43]
    v_exp_f32 v22, v22
    v_mfma_f32_16x16x32_bf16 a[44:47], a[236:239], v[8:11], a[44:47]
    v_exp_f32 v23, v23
    v_mfma_f32_16x16x32_bf16 a[48:51], a[240:243], v[8:11], a[48:51]
    v_cvt_pk_bf16_f32 v18, v20, v21
    v_cvt_pk_bf16_f32 v19, v22, v23
    v_mfma_f32_16x16x32_bf16 a[52:55], a[244:247], v[8:11], a[52:55]
    v_exp_f32 v24, v24
    v_mfma_f32_16x16x32_bf16 a[56:59], a[248:251], v[8:11], a[56:59]
    v_exp_f32 v25, v25
    v_mfma_f32_16x16x32_bf16 a[60:63], a[252:255], v[8:11], a[60:63]
    v_exp_f32 v26, v26
    v_mfma_f32_16x16x32_bf16 v[64:67], v[228:231], v[8:11], v[64:67]
    s_waitcnt lgkmcnt(0)
    s_cmp_lg_u32 s39, s2
    s_cbranch_scc1 A0h1_loop
    s_cmp_eq_u32 s39, 3
    s_cbranch_scc1 A0h1_last
    v_mfma_f32_16x16x32_bf16 v[0:3], a[192:195], v[160:163], v[40:43]
    v_exp_f32 v27, v27
    v_mfma_f32_16x16x32_bf16 v[0:3], a[196:199], v[164:167], v[0:3]
    v_cvt_pk_bf16_f32 v24, v24, v25
    v_cvt_pk_bf16_f32 v25, v26, v27
    v_mfma_f32_16x16x32_bf16 v[0:3], a[200:203], v[168:171], v[0:3]
    v_exp_f32 v28, v28
    v_mfma_f32_16x16x32_bf16 v[0:3], a[204:207], v[172:175], v[0:3]
    v_exp_f32 v29, v29
    v_mfma_f32_16x16x32_bf16 v[4:7], a[208:211], v[160:163], v[40:43]
    v_exp_f32 v30, v30
    v_mfma_f32_16x16x32_bf16 v[4:7], a[212:215], v[164:167], v[4:7]
    v_exp_f32 v31, v31
    v_mfma_f32_16x16x32_bf16 v[4:7], a[216:219], v[168:171], v[4:7]
    v_exp_f32 v0, v0
    v_mfma_f32_16x16x32_bf16 v[4:7], a[220:223], v[172:175], v[4:7]
    v_exp_f32 v1, v1
    v_mfma_f32_16x16x32_bf16 a[64:67], a[224:227], v[16:19], a[64:67]
    v_exp_f32 v2, v2
    v_mfma_f32_16x16x32_bf16 a[68:71], a[228:231], v[16:19], a[68:71]
    v_exp_f32 v3, v3
    v_mfma_f32_16x16x32_bf16 a[72:75], a[232:235], v[16:19], a[72:75]
    s_waitcnt vmcnt(16) lgkmcnt(0)
    s_barrier
    v_mfma_f32_16x16x32_bf16 a[76:79], a[236:239], v[16:19], a[76:79]
    s_add_u32 s38, s74, s3
    s_add_u32 m0, s38, 0
    s_xor_b32 s87, s85, s86
    v_mfma_f32_16x16x32_bf16 a[80:83], a[240:243], v[16:19], a[80:83]
    s_add_u32 s74, s74, s44
    s_add_u32 s85, s85, 4096
    v_cvt_pk_bf16_f32 v0, v0, v1
    v_mfma_f32_16x16x32_bf16 a[84:87], a[244:247], v[16:19], a[84:87]
    buffer_load_dwordx4 v220, s[20:23], s87 offen nt lds
    v_mfma_f32_16x16x32_bf16 a[88:91], a[248:251], v[16:19], a[88:91]
    s_add_u32 m0, s38, 4096
    s_xor_b32 s87, s85, s86
    s_add_u32 s85, s85, 4096
    v_mfma_f32_16x16x32_bf16 a[92:95], a[252:255], v[16:19], a[92:95]
    s_cmp_eq_u32 s74, 0x18000
    s_cselect_b32 s44, s45, s46
    v_cvt_pk_bf16_f32 v1, v2, v3
    v_mfma_f32_16x16x32_bf16 v[68:71], v[228:231], v[16:19], v[68:71]
    buffer_load_dwordx4 v220, s[20:23], s87 offen nt lds
    v_exp_f32 v4, v4
    v_mfma_f32_16x16x32_bf16 v[8:11], a[192:195], v[176:179], v[44:47]
    s_add_u32 m0, s38, 8192
    v_exp_f32 v5, v5
    v_mfma_f32_16x16x32_bf16 v[8:11], a[196:199], v[180:183], v[8:11]
    s_xor_b32 s87, s85, s86
    v_exp_f32 v6, v6
    v_mfma_f32_16x16x32_bf16 v[8:11], a[200:203], v[184:187], v[8:11]
    s_add_u32 s85, s85, 4096
    v_exp_f32 v7, v7
    v_mfma_f32_16x16x32_bf16 v[8:11], a[204:207], v[188:191], v[8:11]
    v_cvt_pk_bf16_f32 v2, v4, v5
    v_cvt_pk_bf16_f32 v3, v6, v7
    v_mfma_f32_16x16x32_bf16 v[12:15], a[208:211], v[176:179], v[44:47]
    v_cvt_pk_bf16_f32 v26, v28, v29
    v_cvt_pk_bf16_f32 v27, v30, v31
    v_mfma_f32_16x16x32_bf16 v[12:15], a[212:215], v[180:183], v[12:15]
    buffer_load_dwordx4 v220, s[20:23], s87 offen nt lds
    v_mfma_f32_16x16x32_bf16 v[12:15], a[216:219], v[184:187], v[12:15]
    s_add_u32 m0, s38, 12288
    v_exp_f32 v8, v8
    v_mfma_f32_16x16x32_bf16 v[12:15], a[220:223], v[188:191], v[12:15]
    s_xor_b32 s87, s85, s86
    v_exp_f32 v9, v9
    v_mfma_f32_16x16x32_bf16 a[96:99], a[224:227], v[24:27], a[96:99]
    s_add_u32 s85, s85, 4096
    ds_read_b64_tr_b16 a[224:225], v212 offset:16384
    ds_read_b64_tr_b16 a[226:227], v212 offset:20480
    v_mfma_f32_16x16x32_bf16 a[100:103], a[228:231], v[24:27], a[100:103]
    v_exp_f32 v10, v10
    v_mfma_f32_16x16x32_bf16 a[104:107], a[232:235], v[24:27], a[104:107]
    ds_read_b64_tr_b16 a[228:229], v213 offset:16384
    ds_read_b64_tr_b16 a[230:231], v213 offset:20480
    v_mfma_f32_16x16x32_bf16 a[108:111], a[236:239], v[24:27], a[108:111]
    buffer_load_dwordx4 v220, s[20:23], s87 offen nt lds
    v_mfma_f32_16x16x32_bf16 a[112:115], a[240:243], v[24:27], a[112:115]
    s_add_u32 m0, s38, 16384
    ds_read_b64_tr_b16 a[232:233], v214 offset:16384
    ds_read_b64_tr_b16 a[234:235], v214 offset:20480
    v_mfma_f32_16x16x32_bf16 a[116:119], a[244:247], v[24:27], a[116:119]
    s_xor_b32 s87, s37, s86
    s_add_u32 s37, s37, 4096
    buffer_load_dwordx4 v224, s[24:27], s87 offen nt lds
    v_mfma_f32_16x16x32_bf16 a[120:123], a[248:251], v[24:27], a[120:123]
    s_add_u32 m0, s38, 20480
    ds_read_b64_tr_b16 a[236:237], v215 offset:16384
    ds_read_b64_tr_b16 a[238:239], v215 offset:20480
    v_mfma_f32_16x16x32_bf16 a[124:127], a[252:255], v[24:27], a[124:127]
    s_xor_b32 s87, s37, s86
    v_exp_f32 v11, v11
    v_mfma_f32_16x16x32_bf16 v[72:75], v[228:231], v[24:27], v[72:75]
    s_add_u32 s37, s37, 4096
    ds_read_b64_tr_b16 a[240:241], v216 offset:16384
    ds_read_b64_tr_b16 a[242:243], v216 offset:20480
    v_mfma_f32_16x16x32_bf16 v[16:19], a[192:195], v[192:195], v[48:51]
    buffer_load_dwordx4 v224, s[24:27], s87 offen nt lds
    v_cvt_pk_bf16_f32 v8, v8, v9
    v_cvt_pk_bf16_f32 v9, v10, v11
    v_mfma_f32_16x16x32_bf16 v[16:19], a[196:199], v[196:199], v[16:19]
    s_add_u32 m0, s38, 24576
    ds_read_b64_tr_b16 a[244:245], v217 offset:16384
    ds_read_b64_tr_b16 a[246:247], v217 offset:20480
    v_mfma_f32_16x16x32_bf16 v[16:19], a[200:203], v[200:203], v[16:19]
    s_xor_b32 s87, s37, s86
    v_exp_f32 v12, v12
    v_mfma_f32_16x16x32_bf16 v[16:19], a[204:207], v[204:207], v[16:19]
    s_add_u32 s37, s37, 4096
    ds_read_b64_tr_b16 a[248:249], v218 offset:16384
    ds_read_b64_tr_b16 a[250:251], v218 offset:20480
    v_mfma_f32_16x16x32_bf16 v[20:23], a[208:211], v[192:195], v[48:51]
    buffer_load_dwordx4 v224, s[24:27], s87 offen nt lds
    v_exp_f32 v13, v13
    v_mfma_f32_16x16x32_bf16 v[20:23], a[212:215], v[196:199], v[20:23]
    s_add_u32 m0, s38, 28672
    ds_read_b64_tr_b16 a[252:253], v219 offset:16384
    ds_read_b64_tr_b16 a[254:255], v219 offset:20480
    v_mfma_f32_16x16x32_bf16 v[20:23], a[216:219], v[200:203], v[20:23]
    s_xor_b32 s87, s37, s86
    v_exp_f32 v14, v14
    v_mfma_f32_16x16x32_bf16 v[20:23], a[220:223], v[204:207], v[20:23]
    s_waitcnt lgkmcnt(6)
    v_exp_f32 v15, v15
    v_mfma_f32_16x16x32_bf16 a[0:3], a[224:227], v[0:3], a[0:3]
    s_add_u32 s37, s37, 4096
    v_cvt_pk_bf16_f32 v10, v12, v13
    v_cvt_pk_bf16_f32 v11, v14, v15
    v_mfma_f32_16x16x32_bf16 a[4:7], a[228:231], v[0:3], a[4:7]
    v_exp_f32 v16, v16
    v_mfma_f32_16x16x32_bf16 a[8:11], a[232:235], v[0:3], a[8:11]
    v_exp_f32 v17, v17
    v_mfma_f32_16x16x32_bf16 a[12:15], a[236:239], v[0:3], a[12:15]
    buffer_load_dwordx4 v224, s[24:27], s87 offen nt lds
    v_mfma_f32_16x16x32_bf16 a[16:19], a[240:243], v[0:3], a[16:19]
    s_waitcnt lgkmcnt(2)
    v_mfma_f32_16x16x32_bf16 a[20:23], a[244:247], v[0:3], a[20:23]
    v_exp_f32 v18, v18
    v_mfma_f32_16x16x32_bf16 a[24:27], a[248:251], v[0:3], a[24:27]
    s_waitcnt lgkmcnt(0)
    v_exp_f32 v19, v19
    v_mfma_f32_16x16x32_bf16 a[28:31], a[252:255], v[0:3], a[28:31]
    v_cvt_pk_bf16_f32 v16, v16, v17
    v_cvt_pk_bf16_f32 v17, v18, v19
    v_mfma_f32_16x16x32_bf16 v[60:63], v[228:231], v[0:3], v[60:63]
    v_exp_f32 v20, v20
    v_mfma_f32_16x16x32_bf16 v[24:27], a[192:195], a[160:163], v[52:55]
    v_exp_f32 v21, v21
    v_mfma_f32_16x16x32_bf16 v[24:27], a[196:199], a[164:167], v[24:27]
    v_exp_f32 v22, v22
    v_mfma_f32_16x16x32_bf16 v[24:27], a[200:203], a[168:171], v[24:27]
    v_exp_f32 v23, v23
    v_mfma_f32_16x16x32_bf16 v[24:27], a[204:207], a[172:175], v[24:27]
    v_cvt_pk_bf16_f32 v18, v20, v21
    v_cvt_pk_bf16_f32 v19, v22, v23
    v_mfma_f32_16x16x32_bf16 v[28:31], a[208:211], a[160:163], v[52:55]
    v_mfma_f32_16x16x32_bf16 v[28:31], a[212:215], a[164:167], v[28:31]
    v_mfma_f32_16x16x32_bf16 v[28:31], a[216:219], a[168:171], v[28:31]
    v_exp_f32 v24, v24
    v_mfma_f32_16x16x32_bf16 v[28:31], a[220:223], a[172:175], v[28:31]
    v_exp_f32 v25, v25
    v_mfma_f32_16x16x32_bf16 a[32:35], a[224:227], v[8:11], a[32:35]
    v_exp_f32 v26, v26
    v_mfma_f32_16x16x32_bf16 a[36:39], a[228:231], v[8:11], a[36:39]
    v_exp_f32 v27, v27
    v_mfma_f32_16x16x32_bf16 a[40:43], a[232:235], v[8:11], a[40:43]
    v_cvt_pk_bf16_f32 v24, v24, v25
    v_cvt_pk_bf16_f32 v25, v26, v27
    v_mfma_f32_16x16x32_bf16 a[44:47], a[236:239], v[8:11], a[44:47]
    v_mfma_f32_16x16x32_bf16 a[48:51], a[240:243], v[8:11], a[48:51]
    v_mfma_f32_16x16x32_bf16 a[52:55], a[244:247], v[8:11], a[52:55]
    v_exp_f32 v28, v28
    v_mfma_f32_16x16x32_bf16 a[56:59], a[248:251], v[8:11], a[56:59]
    v_exp_f32 v29, v29
    v_mfma_f32_16x16x32_bf16 a[60:63], a[252:255], v[8:11], a[60:63]
    v_exp_f32 v30, v30
    v_mfma_f32_16x16x32_bf16 v[64:67], v[228:231], v[8:11], v[64:67]
    v_exp_f32 v31, v31
    v_mfma_f32_16x16x32_bf16 v[32:35], a[192:195], a[176:179], v[56:59]
    v_cvt_pk_bf16_f32 v26, v28, v29
    v_cvt_pk_bf16_f32 v27, v30, v31
    v_mfma_f32_16x16x32_bf16 v[32:35], a[196:199], a[180:183], v[32:35]
    ds_read_b128 a[192:195], v208 offset:0
    ds_read_b128 a[196:199], v209 offset:0
    v_mfma_f32_16x16x32_bf16 v[32:35], a[200:203], a[184:187], v[32:35]
    v_mfma_f32_16x16x32_bf16 v[32:35], a[204:207], a[188:191], v[32:35]
    ds_read_b128 a[200:203], v210 offset:0
    ds_read_b128 a[204:207], v211 offset:0
    v_mfma_f32_16x16x32_bf16 v[36:39], a[208:211], a[176:179], v[56:59]
    v_mfma_f32_16x16x32_bf16 v[36:39], a[212:215], a[180:183], v[36:39]
    ds_read_b128 a[208:211], v208 offset:4096
    ds_read_b128 a[212:215], v209 offset:4096
    v_mfma_f32_16x16x32_bf16 v[36:39], a[216:219], a[184:187], v[36:39]
    v_exp_f32 v32, v32
    v_mfma_f32_16x16x32_bf16 v[36:39], a[220:223], a[188:191], v[36:39]
    ds_read_b128 a[216:219], v210 offset:4096
    ds_read_b128 a[220:223], v211 offset:4096
    v_mfma_f32_16x16x32_bf16 a[64:67], a[224:227], v[16:19], a[64:67]
    v_exp_f32 v33, v33
    v_mfma_f32_16x16x32_bf16 a[68:71], a[228:231], v[16:19], a[68:71]
    v_exp_f32 v34, v34
    v_mfma_f32_16x16x32_bf16 a[72:75], a[232:235], v[16:19], a[72:75]
    v_exp_f32 v35, v35
    v_mfma_f32_16x16x32_bf16 a[76:79], a[236:239], v[16:19], a[76:79]
    v_mfma_f32_16x16x32_bf16 a[80:83], a[240:243], v[16:19], a[80:83]
    v_mfma_f32_16x16x32_bf16 a[84:87], a[244:247], v[16:19], a[84:87]
    v_cvt_pk_bf16_f32 v32, v32, v33
    v_cvt_pk_bf16_f32 v33, v34, v35
    v_mfma_f32_16x16x32_bf16 a[88:91], a[248:251], v[16:19], a[88:91]
    v_exp_f32 v36, v36
    v_mfma_f32_16x16x32_bf16 a[92:95], a[252:255], v[16:19], a[92:95]
    v_exp_f32 v37, v37
    v_mfma_f32_16x16x32_bf16 v[68:71], v[228:231], v[16:19], v[68:71]
    s_waitcnt lgkmcnt(0)
    v_exp_f32 v38, v38
    v_mfma_f32_16x16x32_bf16 v[0:3], a[192:195], v[160:163], v[40:43]
    v_exp_f32 v39, v39
    v_mfma_f32_16x16x32_bf16 v[0:3], a[196:199], v[164:167], v[0:3]
    v_cvt_pk_bf16_f32 v34, v36, v37
    v_cvt_pk_bf16_f32 v35, v38, v39
    v_mfma_f32_16x16x32_bf16 v[0:3], a[200:203], v[168:171], v[0:3]
    v_mfma_f32_16x16x32_bf16 v[0:3], a[204:207], v[172:175], v[0:3]
    v_mfma_f32_16x16x32_bf16 v[4:7], a[208:211], v[160:163], v[40:43]
    v_mfma_f32_16x16x32_bf16 v[4:7], a[212:215], v[164:167], v[4:7]
    v_mfma_f32_16x16x32_bf16 v[4:7], a[216:219], v[168:171], v[4:7]
    v_exp_f32 v0, v0
    v_mfma_f32_16x16x32_bf16 v[4:7], a[220:223], v[172:175], v[4:7]
    v_exp_f32 v1, v1
    v_mfma_f32_16x16x32_bf16 a[96:99], a[224:227], v[24:27], a[96:99]
    v_exp_f32 v2, v2
    v_mfma_f32_16x16x32_bf16 a[100:103], a[228:231], v[24:27], a[100:103]
    v_exp_f32 v3, v3
    v_mfma_f32_16x16x32_bf16 a[104:107], a[232:235], v[24:27], a[104:107]
    v_cvt_pk_bf16_f32 v0, v0, v1
    v_cvt_pk_bf16_f32 v1, v2, v3
    v_mfma_f32_16x16x32_bf16 a[108:111], a[236:239], v[24:27], a[108:111]
    v_mfma_f32_16x16x32_bf16 a[112:115], a[240:243], v[24:27], a[112:115]
    v_mfma_f32_16x16x32_bf16 a[116:119], a[244:247], v[24:27], a[116:119]
    v_exp_f32 v4, v4
    v_mfma_f32_16x16x32_bf16 a[120:123], a[248:251], v[24:27], a[120:123]
    v_exp_f32 v5, v5
    v_mfma_f32_16x16x32_bf16 a[124:127], a[252:255], v[24:27], a[124:127]
    s_lshl_b32 s67, s36, 19
    v_exp_f32 v6, v6
    v_mfma_f32_16x16x32_bf16 v[72:75], v[228:231], v[24:27], v[72:75]
    s_add_u32 s67, s67, s70
    v_exp_f32 v7, v7
    v_mfma_f32_16x16x32_bf16 v[8:11], a[192:195], v[176:179], v[44:47]
    s_add_u32 s66, s67, 0
    v_cvt_pk_bf16_f32 v2, v4, v5
    v_cvt_pk_bf16_f32 v3, v6, v7
    v_mfma_f32_16x16x32_bf16 v[8:11], a[196:199], v[180:183], v[8:11]
    buffer_store_dwordx4 v[80:83], v233, s[12:15], s66 offen offset:0
    v_mfma_f32_16x16x32_bf16 v[8:11], a[200:203], v[184:187], v[8:11]
    buffer_store_dwordx4 v[84:87], v233, s[12:15], s66 offen offset:1024
    v_mfma_f32_16x16x32_bf16 v[8:11], a[204:207], v[188:191], v[8:11]
    v_mfma_f32_16x16x32_bf16 v[12:15], a[208:211], v[176:179], v[44:47]
    v_mfma_f32_16x16x32_bf16 v[12:15], a[212:215], v[180:183], v[12:15]
    v_mfma_f32_16x16x32_bf16 v[12:15], a[216:219], v[184:187], v[12:15]
    buffer_store_dwordx4 v[88:91], v233, s[12:15], s66 offen offset:2048
    v_exp_f32 v8, v8
    v_mfma_f32_16x16x32_bf16 v[12:15], a[220:223], v[188:191], v[12:15]
    v_exp_f32 v9, v9
    v_mfma_f32_16x16x32_bf16 a[128:131], a[224:227], v[32:35], a[128:131]
    ds_read_b64_tr_b16 a[224:225], v212 offset:24576
    ds_read_b64_tr_b16 a[226:227], v212 offset:28672
    v_mfma_f32_16x16x32_bf16 a[132:135], a[228:231], v[32:35], a[132:135]
    v_exp_f32 v10, v10
    v_mfma_f32_16x16x32_bf16 a[136:139], a[232:235], v[32:35], a[136:139]
    ds_read_b64_tr_b16 a[228:229], v213 offset:24576
    ds_read_b64_tr_b16 a[230:231], v213 offset:28672
    v_mfma_f32_16x16x32_bf16 a[140:143], a[236:239], v[32:35], a[140:143]
    buffer_store_dwordx4 v[92:95], v233, s[12:15], s66 offen offset:3072
    v_mfma_f32_16x16x32_bf16 a[144:147], a[240:243], v[32:35], a[144:147]
    s_add_u32 s66, s67, 131072
    ds_read_b64_tr_b16 a[232:233], v214 offset:24576
    ds_read_b64_tr_b16 a[234:235], v214 offset:28672
    v_mfma_f32_16x16x32_bf16 a[148:151], a[244:247], v[32:35], a[148:151]
    v_mfma_f32_16x16x32_bf16 a[152:155], a[248:251], v[32:35], a[152:155]
    ds_read_b64_tr_b16 a[236:237], v215 offset:24576
    ds_read_b64_tr_b16 a[238:239], v215 offset:28672
    buffer_store_dwordx4 v[96:99], v233, s[12:15], s66 offen offset:0
    v_mfma_f32_16x16x32_bf16 a[156:159], a[252:255], v[32:35], a[156:159]
    v_add_u32 v212, s44, v212
    v_add_u32 v213, s44, v213
    v_mfma_f32_16x16x32_bf16 v[76:79], v[228:231], v[32:35], v[76:79]
    ds_read_b64_tr_b16 a[240:241], v216 offset:24576
    ds_read_b64_tr_b16 a[242:243], v216 offset:28672
    v_mfma_f32_16x16x32_bf16 v[16:19], a[192:195], v[192:195], v[48:51]
    v_add_u32 v214, s44, v214
    v_add_u32 v215, s44, v215
    v_mfma_f32_16x16x32_bf16 v[16:19], a[196:199], v[196:199], v[16:19]
    ds_read_b64_tr_b16 a[244:245], v217 offset:24576
    ds_read_b64_tr_b16 a[246:247], v217 offset:28672
    buffer_store_dwordx4 v[100:103], v233, s[12:15], s66 offen offset:1024
    v_mfma_f32_16x16x32_bf16 v[16:19], a[200:203], v[200:203], v[16:19]
    v_add_u32 v216, s44, v216
    v_add_u32 v217, s44, v217
    v_mfma_f32_16x16x32_bf16 v[16:19], a[204:207], v[204:207], v[16:19]
    ds_read_b64_tr_b16 a[248:249], v218 offset:24576
    ds_read_b64_tr_b16 a[250:251], v218 offset:28672
    v_mfma_f32_16x16x32_bf16 v[20:23], a[208:211], v[192:195], v[48:51]
    v_exp_f32 v11, v11
    v_mfma_f32_16x16x32_bf16 v[20:23], a[212:215], v[196:199], v[20:23]
    ds_read_b64_tr_b16 a[252:253], v219 offset:24576
    ds_read_b64_tr_b16 a[254:255], v219 offset:28672
    buffer_store_dwordx4 v[104:107], v233, s[12:15], s66 offen offset:2048
    v_mfma_f32_16x16x32_bf16 v[20:23], a[216:219], v[200:203], v[20:23]
    v_add_u32 v218, s44, v218
    v_add_u32 v219, s44, v219
    v_mfma_f32_16x16x32_bf16 v[20:23], a[220:223], v[204:207], v[20:23]
    s_waitcnt lgkmcnt(6)
    v_cvt_pk_bf16_f32 v8, v8, v9
    v_cvt_pk_bf16_f32 v9, v10, v11
    v_mfma_f32_16x16x32_bf16 a[0:3], a[224:227], v[0:3], a[0:3]
    v_exp_f32 v12, v12
    v_mfma_f32_16x16x32_bf16 a[4:7], a[228:231], v[0:3], a[4:7]
    v_exp_f32 v13, v13
    v_mfma_f32_16x16x32_bf16 a[8:11], a[232:235], v[0:3], a[8:11]
    v_exp_f32 v14, v14
    v_mfma_f32_16x16x32_bf16 a[12:15], a[236:239], v[0:3], a[12:15]
    buffer_store_dwordx4 v[108:111], v233, s[12:15], s66 offen offset:3072
    v_mfma_f32_16x16x32_bf16 a[16:19], a[240:243], v[0:3], a[16:19]
    s_waitcnt lgkmcnt(2)
    v_exp_f32 v15, v15
    v_mfma_f32_16x16x32_bf16 a[20:23], a[244:247], v[0:3], a[20:23]
    s_add_u32 s66, s67, 262144
    v_cvt_pk_bf16_f32 v10, v12, v13
    v_cvt_pk_bf16_f32 v11, v14, v15
    v_mfma_f32_16x16x32_bf16 a[24:27], a[248:251], v[0:3], a[24:27]
    s_waitcnt lgkmcnt(0)
    v_exp_f32 v16, v16
    v_mfma_f32_16x16x32_bf16 a[28:31], a[252:255], v[0:3], a[28:31]
    buffer_store_dwordx4 v[112:115], v233, s[12:15], s66 offen offset:0
    v_exp_f32 v17, v17
    v_mfma_f32_16x16x32_bf16 v[60:63], v[228:231], v[0:3], v[60:63]
    v_exp_f32 v18, v18
    v_mfma_f32_16x16x32_bf16 v[24:27], a[192:195], a[160:163], v[52:55]
    buffer_store_dwordx4 v[116:119], v233, s[12:15], s66 offen offset:1024
    v_exp_f32 v19, v19
    v_mfma_f32_16x16x32_bf16 v[24:27], a[196:199], a[164:167], v[24:27]
    ds_read_b128 a[192:195], v208 offset:8192
    ds_read_b128 a[196:199], v209 offset:8192
    v_mfma_f32_16x16x32_bf16 v[24:27], a[200:203], a[168:171], v[24:27]
    v_cvt_pk_bf16_f32 v16, v16, v17
    v_cvt_pk_bf16_f32 v17, v18, v19
    v_mfma_f32_16x16x32_bf16 v[24:27], a[204:207], a[172:175], v[24:27]
    ds_read_b128 a[200:203], v210 offset:8192
    ds_read_b128 a[204:207], v211 offset:8192
    v_mfma_f32_16x16x32_bf16 v[28:31], a[208:211], a[160:163], v[52:55]
    buffer_store_dwordx4 v[120:123], v233, s[12:15], s66 offen offset:2048
    v_exp_f32 v20, v20
    v_mfma_f32_16x16x32_bf16 v[28:31], a[212:215], a[164:167], v[28:31]
    ds_read_b128 a[208:211], v208 offset:12288
    ds_read_b128 a[212:215], v209 offset:12288
    v_mfma_f32_16x16x32_bf16 v[28:31], a[216:219], a[168:171], v[28:31]
    v_add_u32 v208, s44, v208
    v_add_u32 v209, s44, v209
    v_mfma_f32_16x16x32_bf16 v[28:31], a[220:223], a[172:175], v[28:31]
    ds_read_b128 a[216:219], v210 offset:12288
    ds_read_b128 a[220:223], v211 offset:12288
    v_mfma_f32_16x16x32_bf16 a[32:35], a[224:227], v[8:11], a[32:35]
    buffer_store_dwordx4 v[124:127], v233, s[12:15], s66 offen offset:3072
    v_add_u32 v210, s44, v210
    v_add_u32 v211, s44, v211
    v_mfma_f32_16x16x32_bf16 a[36:39], a[228:231], v[8:11], a[36:39]
    v_exp_f32 v21, v21
    v_mfma_f32_16x16x32_bf16 a[40:43], a[232:235], v[8:11], a[40:43]
    v_exp_f32 v22, v22
    v_mfma_f32_16x16x32_bf16 a[44:47], a[236:239], v[8:11], a[44:47]
    v_exp_f32 v23, v23
    v_mfma_f32_16x16x32_bf16 a[48:51], a[240:243], v[8:11], a[48:51]
    v_cvt_pk_bf16_f32 v18, v20, v21
    v_cvt_pk_bf16_f32 v19, v22, v23
    v_mfma_f32_16x16x32_bf16 a[52:55], a[244:247], v[8:11], a[52:55]
    v_exp_f32 v24, v24
    v_mfma_f32_16x16x32_bf16 a[56:59], a[248:251], v[8:11], a[56:59]
    v_exp_f32 v25, v25
    v_mfma_f32_16x16x32_bf16 a[60:63], a[252:255], v[8:11], a[60:63]
    v_exp_f32 v26, v26
    v_mfma_f32_16x16x32_bf16 v[64:67], v[228:231], v[8:11], v[64:67]
    s_waitcnt lgkmcnt(0)
    v_mfma_f32_16x16x32_bf16 v[0:3], a[192:195], v[160:163], v[40:43]
    s_add_u32 s66, s67, 393216
    v_exp_f32 v27, v27
    v_mfma_f32_16x16x32_bf16 v[0:3], a[196:199], v[164:167], v[0:3]
    buffer_store_dwordx4 v[128:131], v233, s[12:15], s66 offen offset:0
    v_cvt_pk_bf16_f32 v24, v24, v25
    v_cvt_pk_bf16_f32 v25, v26, v27
    v_mfma_f32_16x16x32_bf16 v[0:3], a[200:203], v[168:171], v[0:3]
    v_exp_f32 v28, v28
    v_mfma_f32_16x16x32_bf16 v[0:3], a[204:207], v[172:175], v[0:3]
    v_exp_f32 v29, v29
    v_mfma_f32_16x16x32_bf16 v[4:7], a[208:211], v[160:163], v[40:43]
    buffer_store_dwordx4 v[132:135], v233, s[12:15], s66 offen offset:1024
    v_exp_f32 v30, v30
    v_mfma_f32_16x16x32_bf16 v[4:7], a[212:215], v[164:167], v[4:7]
    v_exp_f32 v31, v31
    v_mfma_f32_16x16x32_bf16 v[4:7], a[216:219], v[168:171], v[4:7]
    v_exp_f32 v0, v0
    v_mfma_f32_16x16x32_bf16 v[4:7], a[220:223], v[172:175], v[4:7]
    v_exp_f32 v1, v1
    v_mfma_f32_16x16x32_bf16 a[64:67], a[224:227], v[16:19], a[64:67]
    buffer_store_dwordx4 v[136:139], v233, s[12:15], s66 offen offset:2048
    v_exp_f32 v2, v2
    v_mfma_f32_16x16x32_bf16 a[68:71], a[228:231], v[16:19], a[68:71]
    v_exp_f32 v3, v3
    v_mfma_f32_16x16x32_bf16 a[72:75], a[232:235], v[16:19], a[72:75]
    s_waitcnt vmcnt(28) lgkmcnt(0)
    s_barrier
    v_mfma_f32_16x16x32_bf16 a[76:79], a[236:239], v[16:19], a[76:79]
    s_add_u32 s38, s74, s3
    v_mfma_f32_16x16x32_bf16 a[80:83], a[240:243], v[16:19], a[80:83]
    s_add_u32 s74, s74, s44
    v_cvt_pk_bf16_f32 v0, v0, v1
    v_mfma_f32_16x16x32_bf16 a[84:87], a[244:247], v[16:19], a[84:87]
    buffer_store_dwordx4 v[140:143], v233, s[12:15], s66 offen offset:3072
    v_mfma_f32_16x16x32_bf16 a[88:91], a[248:251], v[16:19], a[88:91]
    s_lshr_b32 s66, s36, 1
    s_lshl_b32 s66, s66, 17
    s_add_u32 s66, s66, s70
    v_mfma_f32_16x16x32_bf16 a[92:95], a[252:255], v[16:19], a[92:95]
    s_cmp_eq_u32 s74, 0x18000
    s_cselect_b32 s44, s45, s46
    v_cvt_pk_bf16_f32 v1, v2, v3
    v_mfma_f32_16x16x32_bf16 v[68:71], v[228:231], v[16:19], v[68:71]
    s_add_u32 s66, s66, 2097152
    v_exp_f32 v4, v4
    v_mfma_f32_16x16x32_bf16 v[8:11], a[192:195], v[176:179], v[44:47]
    buffer_store_dwordx4 v[144:147], v233, s[12:15], s66 offen offset:0
    v_exp_f32 v5, v5
    v_mfma_f32_16x16x32_bf16 v[8:11], a[196:199], v[180:183], v[8:11]
    v_exp_f32 v6, v6
    v_mfma_f32_16x16x32_bf16 v[8:11], a[200:203], v[184:187], v[8:11]
    v_exp_f32 v7, v7
    v_mfma_f32_16x16x32_bf16 v[8:11], a[204:207], v[188:191], v[8:11]
    v_cvt_pk_bf16_f32 v2, v4, v5
    v_cvt_pk_bf16_f32 v3, v6, v7
    v_mfma_f32_16x16x32_bf16 v[12:15], a[208:211], v[176:179], v[44:47]
    v_cvt_pk_bf16_f32 v26, v28, v29
    v_cvt_pk_bf16_f32 v27, v30, v31
    v_mfma_f32_16x16x32_bf16 v[12:15], a[212:215], v[180:183], v[12:15]
    buffer_store_dwordx4 v[148:151], v233, s[12:15], s66 offen offset:1024
    v_mfma_f32_16x16x32_bf16 v[12:15], a[216:219], v[184:187], v[12:15]
    v_exp_f32 v8, v8
    v_mfma_f32_16x16x32_bf16 v[12:15], a[220:223], v[188:191], v[12:15]
    v_exp_f32 v9, v9
    v_mfma_f32_16x16x32_bf16 a[96:99], a[224:227], v[24:27], a[96:99]
    s_add_u32 m0, s38, 0
    ds_read_b64_tr_b16 a[224:225], v212 offset:16384
    ds_read_b64_tr_b16 a[226:227], v212 offset:20480
    v_mfma_f32_16x16x32_bf16 a[100:103], a[228:231], v[24:27], a[100:103]
    s_xor_b32 s87, s85, s86
    v_exp_f32 v10, v10
    v_mfma_f32_16x16x32_bf16 a[104:107], a[232:235], v[24:27], a[104:107]
    s_add_u32 s85, s85, 4096
    ds_read_b64_tr_b16 a[228:229], v213 offset:16384
    ds_read_b64_tr_b16 a[230:231], v213 offset:20480
    v_mfma_f32_16x16x32_bf16 a[108:111], a[236:239], v[24:27], a[108:111]
    buffer_load_dwordx4 v220, s[20:23], s87 offen nt lds
    v_mfma_f32_16x16x32_bf16 a[112:115], a[240:243], v[24:27], a[112:115]
    s_add_u32 m0, s38, 4096
    ds_read_b64_tr_b16 a[232:233], v214 offset:16384
    ds_read_b64_tr_b16 a[234:235], v214 offset:20480
    v_mfma_f32_16x16x32_bf16 a[116:119], a[244:247], v[24:27], a[116:119]
    s_xor_b32 s87, s85, s86
    s_add_u32 s85, s85, 4096
    v_mfma_f32_16x16x32_bf16 a[120:123], a[248:251], v[24:27], a[120:123]
    ds_read_b64_tr_b16 a[236:237], v215 offset:16384
    ds_read_b64_tr_b16 a[238:239], v215 offset:20480
    v_mfma_f32_16x16x32_bf16 a[124:127], a[252:255], v[24:27], a[124:127]
    v_exp_f32 v11, v11
    v_mfma_f32_16x16x32_bf16 v[72:75], v[228:231], v[24:27], v[72:75]
    ds_read_b64_tr_b16 a[240:241], v216 offset:16384
    ds_read_b64_tr_b16 a[242:243], v216 offset:20480
    v_mfma_f32_16x16x32_bf16 v[16:19], a[192:195], v[192:195], v[48:51]
    v_cvt_pk_bf16_f32 v8, v8, v9
    v_cvt_pk_bf16_f32 v9, v10, v11
    v_mfma_f32_16x16x32_bf16 v[16:19], a[196:199], v[196:199], v[16:19]
    ds_read_b64_tr_b16 a[244:245], v217 offset:16384
    ds_read_b64_tr_b16 a[246:247], v217 offset:20480
    v_mfma_f32_16x16x32_bf16 v[16:19], a[200:203], v[200:203], v[16:19]
    v_exp_f32 v12, v12
    v_mfma_f32_16x16x32_bf16 v[16:19], a[204:207], v[204:207], v[16:19]
    ds_read_b64_tr_b16 a[248:249], v218 offset:16384
    ds_read_b64_tr_b16 a[250:251], v218 offset:20480
    v_mfma_f32_16x16x32_bf16 v[20:23], a[208:211], v[192:195], v[48:51]
    v_exp_f32 v13, v13
    v_mfma_f32_16x16x32_bf16 v[20:23], a[212:215], v[196:199], v[20:23]
    ds_read_b64_tr_b16 a[252:253], v219 offset:16384
    ds_read_b64_tr_b16 a[254:255], v219 offset:20480
    v_mfma_f32_16x16x32_bf16 v[20:23], a[216:219], v[200:203], v[20:23]
    v_exp_f32 v14, v14
    v_mfma_f32_16x16x32_bf16 v[20:23], a[220:223], v[204:207], v[20:23]
    s_waitcnt lgkmcnt(6)
    v_exp_f32 v15, v15
    v_mfma_f32_16x16x32_bf16 a[0:3], a[224:227], v[0:3], a[0:3]
    v_cvt_pk_bf16_f32 v10, v12, v13
    v_cvt_pk_bf16_f32 v11, v14, v15
    v_mfma_f32_16x16x32_bf16 a[4:7], a[228:231], v[0:3], a[4:7]
    v_exp_f32 v16, v16
    v_mfma_f32_16x16x32_bf16 a[8:11], a[232:235], v[0:3], a[8:11]
    v_exp_f32 v17, v17
    v_mfma_f32_16x16x32_bf16 a[12:15], a[236:239], v[0:3], a[12:15]
    buffer_load_dwordx4 v220, s[20:23], s87 offen nt lds
    v_mfma_f32_16x16x32_bf16 a[16:19], a[240:243], v[0:3], a[16:19]
    s_waitcnt lgkmcnt(2)
    s_add_u32 m0, s38, 8192
    s_xor_b32 s87, s85, s86
    v_mfma_f32_16x16x32_bf16 a[20:23], a[244:247], v[0:3], a[20:23]
    s_add_u32 s85, s85, 4096
    v_exp_f32 v18, v18
    v_mfma_f32_16x16x32_bf16 a[24:27], a[248:251], v[0:3], a[24:27]
    s_waitcnt lgkmcnt(0)
    v_exp_f32 v19, v19
    v_mfma_f32_16x16x32_bf16 a[28:31], a[252:255], v[0:3], a[28:31]
    v_cvt_pk_bf16_f32 v16, v16, v17
    v_cvt_pk_bf16_f32 v17, v18, v19
    v_mfma_f32_16x16x32_bf16 v[60:63], v[228:231], v[0:3], v[60:63]
    v_exp_f32 v20, v20
    v_mfma_f32_16x16x32_bf16 v[24:27], a[192:195], a[160:163], v[52:55]
    v_exp_f32 v21, v21
    v_mfma_f32_16x16x32_bf16 v[24:27], a[196:199], a[164:167], v[24:27]
    v_exp_f32 v22, v22
    v_mfma_f32_16x16x32_bf16 v[24:27], a[200:203], a[168:171], v[24:27]
    v_exp_f32 v23, v23
    v_mfma_f32_16x16x32_bf16 v[24:27], a[204:207], a[172:175], v[24:27]
    v_cvt_pk_bf16_f32 v18, v20, v21
    v_cvt_pk_bf16_f32 v19, v22, v23
    v_mfma_f32_16x16x32_bf16 v[28:31], a[208:211], a[160:163], v[52:55]
    buffer_load_dwordx4 v220, s[20:23], s87 offen nt lds
    v_mfma_f32_16x16x32_bf16 v[28:31], a[212:215], a[164:167], v[28:31]
    s_add_u32 m0, s38, 12288
    s_xor_b32 s87, s85, s86
    s_add_u32 s85, s85, 4096
    v_mfma_f32_16x16x32_bf16 v[28:31], a[216:219], a[168:171], v[28:31]
    v_exp_f32 v24, v24
    v_mfma_f32_16x16x32_bf16 v[28:31], a[220:223], a[172:175], v[28:31]
    v_exp_f32 v25, v25
    v_mfma_f32_16x16x32_bf16 a[32:35], a[224:227], v[8:11], a[32:35]
    v_exp_f32 v26, v26
    v_mfma_f32_16x16x32_bf16 a[36:39], a[228:231], v[8:11], a[36:39]
    v_exp_f32 v27, v27
    v_mfma_f32_16x16x32_bf16 a[40:43], a[232:235], v[8:11], a[40:43]
    v_cvt_pk_bf16_f32 v24, v24, v25
    v_cvt_pk_bf16_f32 v25, v26, v27
    v_mfma_f32_16x16x32_bf16 a[44:47], a[236:239], v[8:11], a[44:47]
    v_mfma_f32_16x16x32_bf16 a[48:51], a[240:243], v[8:11], a[48:51]
    v_mfma_f32_16x16x32_bf16 a[52:55], a[244:247], v[8:11], a[52:55]
    v_exp_f32 v28, v28
    v_mfma_f32_16x16x32_bf16 a[56:59], a[248:251], v[8:11], a[56:59]
    v_exp_f32 v29, v29
    v_mfma_f32_16x16x32_bf16 a[60:63], a[252:255], v[8:11], a[60:63]
    v_exp_f32 v30, v30
    v_mfma_f32_16x16x32_bf16 v[64:67], v[228:231], v[8:11], v[64:67]
    v_exp_f32 v31, v31
    v_mfma_f32_16x16x32_bf16 v[32:35], a[192:195], a[176:179], v[56:59]
    v_cvt_pk_bf16_f32 v26, v28, v29
    v_cvt_pk_bf16_f32 v27, v30, v31
    v_mfma_f32_16x16x32_bf16 v[32:35], a[196:199], a[180:183], v[32:35]
    ds_read_b128 a[192:195], v208 offset:0
    ds_read_b128 a[196:199], v209 offset:0
    v_mfma_f32_16x16x32_bf16 v[32:35], a[200:203], a[184:187], v[32:35]
    buffer_load_dwordx4 v220, s[20:23], s87 offen nt lds
    v_mfma_f32_16x16x32_bf16 v[32:35], a[204:207], a[188:191], v[32:35]
    s_add_u32 m0, s38, 16384
    ds_read_b128 a[200:203], v210 offset:0
    ds_read_b128 a[204:207], v211 offset:0
    v_mfma_f32_16x16x32_bf16 v[36:39], a[208:211], a[176:179], v[56:59]
    s_xor_b32 s87, s37, s86
    s_add_u32 s37, s37, 4096
    v_mfma_f32_16x16x32_bf16 v[36:39], a[212:215], a[180:183], v[36:39]
    ds_read_b128 a[208:211], v208 offset:4096
    ds_read_b128 a[212:215], v209 offset:4096
    v_mfma_f32_16x16x32_bf16 v[36:39], a[216:219], a[184:187], v[36:39]
    v_exp_f32 v32, v32
    v_mfma_f32_16x16x32_bf16 v[36:39], a[220:223], a[188:191], v[36:39]
    ds_read_b128 a[216:219], v210 offset:4096
    ds_read_b128 a[220:223], v211 offset:4096
    v_mfma_f32_16x16x32_bf16 a[64:67], a[224:227], v[16:19], a[64:67]
    v_exp_f32 v33, v33
    v_mfma_f32_16x16x32_bf16 a[68:71], a[228:231], v[16:19], a[68:71]
    v_exp_f32 v34, v34
    v_mfma_f32_16x16x32_bf16 a[72:75], a[232:235], v[16:19], a[72:75]
    v_exp_f32 v35, v35
    v_mfma_f32_16x16x32_bf16 a[76:79], a[236:239], v[16:19], a[76:79]
    v_mfma_f32_16x16x32_bf16 a[80:83], a[240:243], v[16:19], a[80:83]
    v_mfma_f32_16x16x32_bf16 a[84:87], a[244:247], v[16:19], a[84:87]
    v_cvt_pk_bf16_f32 v32, v32, v33
    v_cvt_pk_bf16_f32 v33, v34, v35
    v_mfma_f32_16x16x32_bf16 a[88:91], a[248:251], v[16:19], a[88:91]
    v_exp_f32 v36, v36
    v_mfma_f32_16x16x32_bf16 a[92:95], a[252:255], v[16:19], a[92:95]
    v_exp_f32 v37, v37
    v_mfma_f32_16x16x32_bf16 v[68:71], v[228:231], v[16:19], v[68:71]
    s_waitcnt lgkmcnt(0)
    v_exp_f32 v38, v38
    v_mfma_f32_16x16x32_bf16 v[0:3], a[192:195], v[160:163], v[40:43]
    v_exp_f32 v39, v39
    v_mfma_f32_16x16x32_bf16 v[0:3], a[196:199], v[164:167], v[0:3]
    v_cvt_pk_bf16_f32 v34, v36, v37
    v_cvt_pk_bf16_f32 v35, v38, v39
    v_mfma_f32_16x16x32_bf16 v[0:3], a[200:203], v[168:171], v[0:3]
    buffer_load_dwordx4 v224, s[24:27], s87 offen nt lds
    v_mfma_f32_16x16x32_bf16 v[0:3], a[204:207], v[172:175], v[0:3]
    s_add_u32 m0, s38, 20480
    s_xor_b32 s87, s37, s86
    s_add_u32 s37, s37, 4096
    v_mfma_f32_16x16x32_bf16 v[4:7], a[208:211], v[160:163], v[40:43]
    v_mfma_f32_16x16x32_bf16 v[4:7], a[212:215], v[164:167], v[4:7]
    v_mfma_f32_16x16x32_bf16 v[4:7], a[216:219], v[168:171], v[4:7]
    v_exp_f32 v0, v0
    v_mfma_f32_16x16x32_bf16 v[4:7], a[220:223], v[172:175], v[4:7]
    v_exp_f32 v1, v1
    v_mfma_f32_16x16x32_bf16 a[96:99], a[224:227], v[24:27], a[96:99]
    v_exp_f32 v2, v2
    v_mfma_f32_16x16x32_bf16 a[100:103], a[228:231], v[24:27], a[100:103]
    v_exp_f32 v3, v3
    v_mfma_f32_16x16x32_bf16 a[104:107], a[232:235], v[24:27], a[104:107]
    v_cvt_pk_bf16_f32 v0, v0, v1
    v_cvt_pk_bf16_f32 v1, v2, v3
    v_mfma_f32_16x16x32_bf16 a[108:111], a[236:239], v[24:27], a[108:111]
    buffer_load_dwordx4 v224, s[24:27], s87 offen nt lds
    v_mfma_f32_16x16x32_bf16 a[112:115], a[240:243], v[24:27], a[112:115]
    s_add_u32 m0, s38, 24576
    s_xor_b32 s87, s37, s86
    s_add_u32 s37, s37, 4096
    v_mfma_f32_16x16x32_bf16 a[116:119], a[244:247], v[24:27], a[116:119]
    v_exp_f32 v4, v4
    v_mfma_f32_16x16x32_bf16 a[120:123], a[248:251], v[24:27], a[120:123]
    v_exp_f32 v5, v5
    v_mfma_f32_16x16x32_bf16 a[124:127], a[252:255], v[24:27], a[124:127]
    v_exp_f32 v6, v6
    v_mfma_f32_16x16x32_bf16 v[72:75], v[228:231], v[24:27], v[72:75]
    v_exp_f32 v7, v7
    v_mfma_f32_16x16x32_bf16 v[8:11], a[192:195], v[176:179], v[44:47]
    v_cvt_pk_bf16_f32 v2, v4, v5
    v_cvt_pk_bf16_f32 v3, v6, v7
    v_mfma_f32_16x16x32_bf16 v[8:11], a[196:199], v[180:183], v[8:11]
    v_mfma_f32_16x16x32_bf16 v[8:11], a[200:203], v[184:187], v[8:11]
    v_mfma_f32_16x16x32_bf16 v[8:11], a[204:207], v[188:191], v[8:11]
    v_mfma_f32_16x16x32_bf16 v[12:15], a[208:211], v[176:179], v[44:47]
    v_mfma_f32_16x16x32_bf16 v[12:15], a[212:215], v[180:183], v[12:15]
    v_mfma_f32_16x16x32_bf16 v[12:15], a[216:219], v[184:187], v[12:15]
    v_exp_f32 v8, v8
    v_mfma_f32_16x16x32_bf16 v[12:15], a[220:223], v[188:191], v[12:15]
    v_exp_f32 v9, v9
    v_mfma_f32_16x16x32_bf16 a[128:131], a[224:227], v[32:35], a[128:131]
    ds_read_b64_tr_b16 a[224:225], v212 offset:24576
    ds_read_b64_tr_b16 a[226:227], v212 offset:28672
    v_mfma_f32_16x16x32_bf16 a[132:135], a[228:231], v[32:35], a[132:135]
    v_exp_f32 v10, v10
    v_mfma_f32_16x16x32_bf16 a[136:139], a[232:235], v[32:35], a[136:139]
    ds_read_b64_tr_b16 a[228:229], v213 offset:24576
    ds_read_b64_tr_b16 a[230:231], v213 offset:28672
    v_mfma_f32_16x16x32_bf16 a[140:143], a[236:239], v[32:35], a[140:143]
    buffer_load_dwordx4 v224, s[24:27], s87 offen nt lds
    v_mfma_f32_16x16x32_bf16 a[144:147], a[240:243], v[32:35], a[144:147]
    s_add_u32 m0, s38, 28672
    ds_read_b64_tr_b16 a[232:233], v214 offset:24576
    ds_read_b64_tr_b16 a[234:235], v214 offset:28672
    v_mfma_f32_16x16x32_bf16 a[148:151], a[244:247], v[32:35], a[148:151]
    s_xor_b32 s87, s37, s86
    s_add_u32 s37, s37, 4096
    v_mfma_f32_16x16x32_bf16 a[152:155], a[248:251], v[32:35], a[152:155]
    ds_read_b64_tr_b16 a[236:237], v215 offset:24576
    ds_read_b64_tr_b16 a[238:239], v215 offset:28672
    v_mfma_f32_16x16x32_bf16 a[156:159], a[252:255], v[32:35], a[156:159]
    v_add_u32 v212, s44, v212
    v_add_u32 v213, s44, v213
    v_mfma_f32_16x16x32_bf16 v[76:79], v[228:231], v[32:35], v[76:79]
    ds_read_b64_tr_b16 a[240:241], v216 offset:24576
    ds_read_b64_tr_b16 a[242:243], v216 offset:28672
    v_mfma_f32_16x16x32_bf16 v[16:19], a[192:195], v[192:195], v[48:51]
    v_add_u32 v214, s44, v214
    v_add_u32 v215, s44, v215
    v_mfma_f32_16x16x32_bf16 v[16:19], a[196:199], v[196:199], v[16:19]
    s_waitcnt vmcnt(7)
    s_barrier
    s_cmp_lg_u32 s36, 0
    s_cbranch_scc1 A0h1_arr
    s_lshl_b32 s64, s42, 3
    s_lshl_b64 s[62:63], 1, s64
    v_mov_b32 v226, s62
    v_mov_b32 v227, s63
    s_mov_b64 exec, 1
    global_atomic_add_x2 v239, v[226:227], s[48:49] offset:16
    s_mov_b64 exec, -1
A0h1_arr:
    ds_read_b64_tr_b16 a[244:245], v217 offset:24576
    ds_read_b64_tr_b16 a[246:247], v217 offset:28672
    v_mfma_f32_16x16x32_bf16 v[16:19], a[200:203], v[200:203], v[16:19]
    v_add_u32 v216, s44, v216
    v_add_u32 v217, s44, v217
    v_mfma_f32_16x16x32_bf16 v[16:19], a[204:207], v[204:207], v[16:19]
    ds_read_b64_tr_b16 a[248:249], v218 offset:24576
    ds_read_b64_tr_b16 a[250:251], v218 offset:28672
    v_mfma_f32_16x16x32_bf16 v[20:23], a[208:211], v[192:195], v[48:51]
    v_exp_f32 v11, v11
    v_mfma_f32_16x16x32_bf16 v[20:23], a[212:215], v[196:199], v[20:23]
    ds_read_b64_tr_b16 a[252:253], v219 offset:24576
    ds_read_b64_tr_b16 a[254:255], v219 offset:28672
    v_mfma_f32_16x16x32_bf16 v[20:23], a[216:219], v[200:203], v[20:23]
    v_add_u32 v218, s44, v218
    v_add_u32 v219, s44, v219
    v_mfma_f32_16x16x32_bf16 v[20:23], a[220:223], v[204:207], v[20:23]
    s_waitcnt lgkmcnt(6)
    v_cvt_pk_bf16_f32 v8, v8, v9
    v_cvt_pk_bf16_f32 v9, v10, v11
    v_mfma_f32_16x16x32_bf16 a[0:3], a[224:227], v[0:3], a[0:3]
    v_exp_f32 v12, v12
    v_mfma_f32_16x16x32_bf16 a[4:7], a[228:231], v[0:3], a[4:7]
    v_exp_f32 v13, v13
    v_mfma_f32_16x16x32_bf16 a[8:11], a[232:235], v[0:3], a[8:11]
    v_exp_f32 v14, v14
    v_mfma_f32_16x16x32_bf16 a[12:15], a[236:239], v[0:3], a[12:15]
    buffer_load_dwordx4 v224, s[24:27], s87 offen nt lds
    v_mfma_f32_16x16x32_bf16 a[16:19], a[240:243], v[0:3], a[16:19]
    s_waitcnt lgkmcnt(2)
    v_exp_f32 v15, v15
    v_mfma_f32_16x16x32_bf16 a[20:23], a[244:247], v[0:3], a[20:23]
    v_cvt_pk_bf16_f32 v10, v12, v13
    v_cvt_pk_bf16_f32 v11, v14, v15
    v_mfma_f32_16x16x32_bf16 a[24:27], a[248:251], v[0:3], a[24:27]
    s_waitcnt lgkmcnt(0)
    v_exp_f32 v16, v16
    v_mfma_f32_16x16x32_bf16 a[28:31], a[252:255], v[0:3], a[28:31]
    v_exp_f32 v17, v17
    v_mfma_f32_16x16x32_bf16 v[60:63], v[228:231], v[0:3], v[60:63]
    v_exp_f32 v18, v18
    v_mfma_f32_16x16x32_bf16 v[24:27], a[192:195], a[160:163], v[52:55]
    v_exp_f32 v19, v19
    v_mfma_f32_16x16x32_bf16 v[24:27], a[196:199], a[164:167], v[24:27]
    ds_read_b128 a[192:195], v208 offset:8192
    ds_read_b128 a[196:199], v209 offset:8192
    v_mfma_f32_16x16x32_bf16 v[24:27], a[200:203], a[168:171], v[24:27]
    v_cvt_pk_bf16_f32 v16, v16, v17
    v_cvt_pk_bf16_f32 v17, v18, v19
    v_mfma_f32_16x16x32_bf16 v[24:27], a[204:207], a[172:175], v[24:27]
    ds_read_b128 a[200:203], v210 offset:8192
    ds_read_b128 a[204:207], v211 offset:8192
    v_mfma_f32_16x16x32_bf16 v[28:31], a[208:211], a[160:163], v[52:55]
    v_exp_f32 v20, v20
    v_mfma_f32_16x16x32_bf16 v[28:31], a[212:215], a[164:167], v[28:31]
    ds_read_b128 a[208:211], v208 offset:12288
    ds_read_b128 a[212:215], v209 offset:12288
    v_mfma_f32_16x16x32_bf16 v[28:31], a[216:219], a[168:171], v[28:31]
    v_add_u32 v208, s44, v208
    v_add_u32 v209, s44, v209
    v_mfma_f32_16x16x32_bf16 v[28:31], a[220:223], a[172:175], v[28:31]
    ds_read_b128 a[216:219], v210 offset:12288
    ds_read_b128 a[220:223], v211 offset:12288
    v_mfma_f32_16x16x32_bf16 a[32:35], a[224:227], v[8:11], a[32:35]
    v_add_u32 v210, s44, v210
    v_add_u32 v211, s44, v211
    v_mfma_f32_16x16x32_bf16 a[36:39], a[228:231], v[8:11], a[36:39]
    v_exp_f32 v21, v21
    v_mfma_f32_16x16x32_bf16 a[40:43], a[232:235], v[8:11], a[40:43]
    v_exp_f32 v22, v22
    v_mfma_f32_16x16x32_bf16 a[44:47], a[236:239], v[8:11], a[44:47]
    v_exp_f32 v23, v23
    v_mfma_f32_16x16x32_bf16 a[48:51], a[240:243], v[8:11], a[48:51]
    v_cvt_pk_bf16_f32 v18, v20, v21
    v_cvt_pk_bf16_f32 v19, v22, v23
    v_mfma_f32_16x16x32_bf16 a[52:55], a[244:247], v[8:11], a[52:55]
    v_exp_f32 v24, v24
    v_mfma_f32_16x16x32_bf16 a[56:59], a[248:251], v[8:11], a[56:59]
    v_exp_f32 v25, v25
    v_mfma_f32_16x16x32_bf16 a[60:63], a[252:255], v[8:11], a[60:63]
    v_exp_f32 v26, v26
    v_mfma_f32_16x16x32_bf16 v[64:67], v[228:231], v[8:11], v[64:67]
    s_waitcnt lgkmcnt(0)
    s_sub_u32 s39, s39, 2
    s_mov_b32 s2, 3
    s_branch A0h1_loop
A0h1_last:
    v_mfma_f32_16x16x32_bf16 v[0:3], a[192:195], v[160:163], v[40:43]
    v_exp_f32 v27, v27
    v_mfma_f32_16x16x32_bf16 v[0:3], a[196:199], v[164:167], v[0:3]
    v_cvt_pk_bf16_f32 v24, v24, v25
    v_cvt_pk_bf16_f32 v25, v26, v27
    v_mfma_f32_16x16x32_bf16 v[0:3], a[200:203], v[168:171], v[0:3]
    v_exp_f32 v28, v28
    v_mfma_f32_16x16x32_bf16 v[0:3], a[204:207], v[172:175], v[0:3]
    v_exp_f32 v29, v29
    v_mfma_f32_16x16x32_bf16 v[4:7], a[208:211], v[160:163], v[40:43]
    v_exp_f32 v30, v30
    v_mfma_f32_16x16x32_bf16 v[4:7], a[212:215], v[164:167], v[4:7]
    v_exp_f32 v31, v31
    v_mfma_f32_16x16x32_bf16 v[4:7], a[216:219], v[168:171], v[4:7]
    v_exp_f32 v0, v0
    v_mfma_f32_16x16x32_bf16 v[4:7], a[220:223], v[172:175], v[4:7]
    v_exp_f32 v1, v1
    v_mfma_f32_16x16x32_bf16 a[64:67], a[224:227], v[16:19], a[64:67]
    v_exp_f32 v2, v2
    v_mfma_f32_16x16x32_bf16 a[68:71], a[228:231], v[16:19], a[68:71]
    v_exp_f32 v3, v3
    v_mfma_f32_16x16x32_bf16 a[72:75], a[232:235], v[16:19], a[72:75]
    s_waitcnt vmcnt(16) lgkmcnt(0)
    s_barrier
    v_mfma_f32_16x16x32_bf16 a[76:79], a[236:239], v[16:19], a[76:79]
    s_add_u32 s38, s74, s3
    v_mfma_f32_16x16x32_bf16 a[80:83], a[240:243], v[16:19], a[80:83]
    s_add_u32 s74, s74, s44
    v_cvt_pk_bf16_f32 v0, v0, v1
    v_mov_b32 v221, v234
    v_mfma_f32_16x16x32_bf16 a[84:87], a[244:247], v[16:19], a[84:87]
    v_xor_b32 v222, 128, v234
    v_mfma_f32_16x16x32_bf16 a[88:91], a[248:251], v[16:19], a[88:91]
    v_add_u32 v223, 6144, v234
    v_mfma_f32_16x16x32_bf16 a[92:95], a[252:255], v[16:19], a[92:95]
    s_cmp_eq_u32 s74, 0x18000
    s_cselect_b32 s44, s45, s46
    v_cvt_pk_bf16_f32 v1, v2, v3
    v_add_u32 v225, 9216, v222
    v_mfma_f32_16x16x32_bf16 v[68:71], v[228:231], v[16:19], v[68:71]
    v_exp_f32 v4, v4
    v_mfma_f32_16x16x32_bf16 v[8:11], a[192:195], v[176:179], v[44:47]
    v_exp_f32 v5, v5
    v_mfma_f32_16x16x32_bf16 v[8:11], a[196:199], v[180:183], v[8:11]
    v_exp_f32 v6, v6
    v_mfma_f32_16x16x32_bf16 v[8:11], a[200:203], v[184:187], v[8:11]
    v_exp_f32 v7, v7
    v_mfma_f32_16x16x32_bf16 v[8:11], a[204:207], v[188:191], v[8:11]
    v_cvt_pk_bf16_f32 v2, v4, v5
    v_cvt_pk_bf16_f32 v3, v6, v7
    v_mfma_f32_16x16x32_bf16 v[12:15], a[208:211], v[176:179], v[44:47]
    v_cvt_pk_bf16_f32 v26, v28, v29
    v_cvt_pk_bf16_f32 v27, v30, v31
    v_mfma_f32_16x16x32_bf16 v[12:15], a[212:215], v[180:183], v[12:15]
    v_add_u32 v222, 3072, v222
    v_mfma_f32_16x16x32_bf16 v[12:15], a[216:219], v[184:187], v[12:15]
    v_exp_f32 v8, v8
    v_mfma_f32_16x16x32_bf16 v[12:15], a[220:223], v[188:191], v[12:15]
    v_exp_f32 v9, v9
    v_mfma_f32_16x16x32_bf16 a[96:99], a[224:227], v[24:27], a[96:99]
    ds_read_b64_tr_b16 a[224:225], v212 offset:16384
    ds_read_b64_tr_b16 a[226:227], v212 offset:20480
    v_mfma_f32_16x16x32_bf16 a[100:103], a[228:231], v[24:27], a[100:103]
    v_exp_f32 v10, v10
    v_mfma_f32_16x16x32_bf16 a[104:107], a[232:235], v[24:27], a[104:107]
    ds_read_b64_tr_b16 a[228:229], v213 offset:16384
    ds_read_b64_tr_b16 a[230:231], v213 offset:20480
    v_mfma_f32_16x16x32_bf16 a[108:111], a[236:239], v[24:27], a[108:111]
    global_load_dwordx2 v[226:227], v239, s[48:49] offset:16 sc1
    v_mfma_f32_16x16x32_bf16 a[112:115], a[240:243], v[24:27], a[112:115]
    s_add_u32 m0, s81, 131072
    ds_read_b64_tr_b16 a[232:233], v214 offset:16384
    ds_read_b64_tr_b16 a[234:235], v214 offset:20480
    v_mfma_f32_16x16x32_bf16 a[116:119], a[244:247], v[24:27], a[116:119]
    s_xor_b32 s87, s80, 0
    buffer_load_dwordx4 v221, s[32:35], s87 offen offset:0  lds
    v_mfma_f32_16x16x32_bf16 a[120:123], a[248:251], v[24:27], a[120:123]
    ds_read_b64_tr_b16 a[236:237], v215 offset:16384
    ds_read_b64_tr_b16 a[238:239], v215 offset:20480
    buffer_load_dwordx4 v222, s[32:35], s87 offen offset:1024  lds
    v_mfma_f32_16x16x32_bf16 a[124:127], a[252:255], v[24:27], a[124:127]
    v_exp_f32 v11, v11
    v_mfma_f32_16x16x32_bf16 v[72:75], v[228:231], v[24:27], v[72:75]
    ds_read_b64_tr_b16 a[240:241], v216 offset:16384
    ds_read_b64_tr_b16 a[242:243], v216 offset:20480
    buffer_load_dwordx4 v223, s[32:35], s87 offen offset:2048  lds
    v_mfma_f32_16x16x32_bf16 v[16:19], a[192:195], v[192:195], v[48:51]
    v_cvt_pk_bf16_f32 v8, v8, v9
    v_cvt_pk_bf16_f32 v9, v10, v11
    v_mfma_f32_16x16x32_bf16 v[16:19], a[196:199], v[196:199], v[16:19]
    ds_read_b64_tr_b16 a[244:245], v217 offset:16384
    ds_read_b64_tr_b16 a[246:247], v217 offset:20480
    v_mfma_f32_16x16x32_bf16 v[16:19], a[200:203], v[200:203], v[16:19]
    v_exp_f32 v12, v12
    v_mfma_f32_16x16x32_bf16 v[16:19], a[204:207], v[204:207], v[16:19]
    ds_read_b64_tr_b16 a[248:249], v218 offset:16384
    ds_read_b64_tr_b16 a[250:251], v218 offset:20480
    v_mfma_f32_16x16x32_bf16 v[20:23], a[208:211], v[192:195], v[48:51]
    v_exp_f32 v13, v13
    v_mfma_f32_16x16x32_bf16 v[20:23], a[212:215], v[196:199], v[20:23]
    ds_read_b64_tr_b16 a[252:253], v219 offset:16384
    ds_read_b64_tr_b16 a[254:255], v219 offset:20480
    v_mfma_f32_16x16x32_bf16 v[20:23], a[216:219], v[200:203], v[20:23]
    v_exp_f32 v14, v14
    v_mfma_f32_16x16x32_bf16 v[20:23], a[220:223], v[204:207], v[20:23]
    s_waitcnt lgkmcnt(6)
    v_exp_f32 v15, v15
    v_mfma_f32_16x16x32_bf16 a[0:3], a[224:227], v[0:3], a[0:3]
    v_cvt_pk_bf16_f32 v10, v12, v13
    v_cvt_pk_bf16_f32 v11, v14, v15
    v_mfma_f32_16x16x32_bf16 a[4:7], a[228:231], v[0:3], a[4:7]
    v_exp_f32 v16, v16
    v_mfma_f32_16x16x32_bf16 a[8:11], a[232:235], v[0:3], a[8:11]
    v_exp_f32 v17, v17
    v_mfma_f32_16x16x32_bf16 a[12:15], a[236:239], v[0:3], a[12:15]
    buffer_load_dwordx4 v225, s[32:35], s87 offen offset:3072  lds
    v_mfma_f32_16x16x32_bf16 a[16:19], a[240:243], v[0:3], a[16:19]
    s_waitcnt lgkmcnt(2)
    s_add_u32 m0, s81, 135168
    s_xor_b32 s87, s80, 16384
    v_mfma_f32_16x16x32_bf16 a[20:23], a[244:247], v[0:3], a[20:23]
    buffer_load_dwordx4 v221, s[32:35], s87 offen offset:0  lds
    v_exp_f32 v18, v18
    v_mfma_f32_16x16x32_bf16 a[24:27], a[248:251], v[0:3], a[24:27]
    s_waitcnt lgkmcnt(0)
    v_exp_f32 v19, v19
    v_mfma_f32_16x16x32_bf16 a[28:31], a[252:255], v[0:3], a[28:31]
    v_cvt_pk_bf16_f32 v16, v16, v17
    v_cvt_pk_bf16_f32 v17, v18, v19
    v_mfma_f32_16x16x32_bf16 v[60:63], v[228:231], v[0:3], v[60:63]
    v_exp_f32 v20, v20
    v_mfma_f32_16x16x32_bf16 v[24:27], a[192:195], a[160:163], v[52:55]
    v_exp_f32 v21, v21
    v_mfma_f32_16x16x32_bf16 v[24:27], a[196:199], a[164:167], v[24:27]
    v_exp_f32 v22, v22
    v_mfma_f32_16x16x32_bf16 v[24:27], a[200:203], a[168:171], v[24:27]
    v_exp_f32 v23, v23
    v_mfma_f32_16x16x32_bf16 v[24:27], a[204:207], a[172:175], v[24:27]
    v_cvt_pk_bf16_f32 v18, v20, v21
    v_cvt_pk_bf16_f32 v19, v22, v23
    v_mfma_f32_16x16x32_bf16 v[28:31], a[208:211], a[160:163], v[52:55]
    buffer_load_dwordx4 v222, s[32:35], s87 offen offset:1024  lds
    v_mfma_f32_16x16x32_bf16 v[28:31], a[212:215], a[164:167], v[28:31]
    v_mfma_f32_16x16x32_bf16 v[28:31], a[216:219], a[168:171], v[28:31]
    v_exp_f32 v24, v24
    v_mfma_f32_16x16x32_bf16 v[28:31], a[220:223], a[172:175], v[28:31]
    v_exp_f32 v25, v25
    v_mfma_f32_16x16x32_bf16 a[32:35], a[224:227], v[8:11], a[32:35]
    v_exp_f32 v26, v26
    v_mfma_f32_16x16x32_bf16 a[36:39], a[228:231], v[8:11], a[36:39]
    v_exp_f32 v27, v27
    v_mfma_f32_16x16x32_bf16 a[40:43], a[232:235], v[8:11], a[40:43]
    v_cvt_pk_bf16_f32 v24, v24, v25
    v_cvt_pk_bf16_f32 v25, v26, v27
    v_mfma_f32_16x16x32_bf16 a[44:47], a[236:239], v[8:11], a[44:47]
    buffer_load_dwordx4 v223, s[32:35], s87 offen offset:2048  lds
    v_mfma_f32_16x16x32_bf16 a[48:51], a[240:243], v[8:11], a[48:51]
    v_mfma_f32_16x16x32_bf16 a[52:55], a[244:247], v[8:11], a[52:55]
    v_exp_f32 v28, v28
    v_mfma_f32_16x16x32_bf16 a[56:59], a[248:251], v[8:11], a[56:59]
    v_exp_f32 v29, v29
    v_mfma_f32_16x16x32_bf16 a[60:63], a[252:255], v[8:11], a[60:63]
    v_exp_f32 v30, v30
    v_mfma_f32_16x16x32_bf16 v[64:67], v[228:231], v[8:11], v[64:67]
    v_exp_f32 v31, v31
    v_mfma_f32_16x16x32_bf16 v[32:35], a[192:195], a[176:179], v[56:59]
    v_cvt_pk_bf16_f32 v26, v28, v29
    v_cvt_pk_bf16_f32 v27, v30, v31
    v_mfma_f32_16x16x32_bf16 v[32:35], a[196:199], a[180:183], v[32:35]
    ds_read_b128 a[192:195], v208 offset:0
    ds_read_b128 a[196:199], v209 offset:0
    v_mfma_f32_16x16x32_bf16 v[32:35], a[200:203], a[184:187], v[32:35]
    buffer_load_dwordx4 v225, s[32:35], s87 offen offset:3072  lds
    v_mfma_f32_16x16x32_bf16 v[32:35], a[204:207], a[188:191], v[32:35]
    s_add_u32 m0, s81, 0
    ds_read_b128 a[200:203], v210 offset:0
    ds_read_b128 a[204:207], v211 offset:0
    v_mfma_f32_16x16x32_bf16 v[36:39], a[208:211], a[176:179], v[56:59]
    s_xor_b32 s87, s80, 32768
    v_mfma_f32_16x16x32_bf16 v[36:39], a[212:215], a[180:183], v[36:39]
    ds_read_b128 a[208:211], v208 offset:4096
    ds_read_b128 a[212:215], v209 offset:4096
    v_mfma_f32_16x16x32_bf16 v[36:39], a[216:219], a[184:187], v[36:39]
    v_exp_f32 v32, v32
    v_mfma_f32_16x16x32_bf16 v[36:39], a[220:223], a[188:191], v[36:39]
    ds_read_b128 a[216:219], v210 offset:4096
    ds_read_b128 a[220:223], v211 offset:4096
    v_mfma_f32_16x16x32_bf16 a[64:67], a[224:227], v[16:19], a[64:67]
    v_exp_f32 v33, v33
    v_mfma_f32_16x16x32_bf16 a[68:71], a[228:231], v[16:19], a[68:71]
    v_exp_f32 v34, v34
    v_mfma_f32_16x16x32_bf16 a[72:75], a[232:235], v[16:19], a[72:75]
    v_exp_f32 v35, v35
    v_mfma_f32_16x16x32_bf16 a[76:79], a[236:239], v[16:19], a[76:79]
    buffer_load_dwordx4 v221, s[32:35], s87 offen offset:0  lds
    v_mfma_f32_16x16x32_bf16 a[80:83], a[240:243], v[16:19], a[80:83]
    v_mfma_f32_16x16x32_bf16 a[84:87], a[244:247], v[16:19], a[84:87]
    v_cvt_pk_bf16_f32 v32, v32, v33
    v_cvt_pk_bf16_f32 v33, v34, v35
    v_mfma_f32_16x16x32_bf16 a[88:91], a[248:251], v[16:19], a[88:91]
    v_exp_f32 v36, v36
    v_mfma_f32_16x16x32_bf16 a[92:95], a[252:255], v[16:19], a[92:95]
    v_exp_f32 v37, v37
    v_mfma_f32_16x16x32_bf16 v[68:71], v[228:231], v[16:19], v[68:71]
    s_waitcnt lgkmcnt(0)
    v_exp_f32 v38, v38
    v_mfma_f32_16x16x32_bf16 v[0:3], a[192:195], v[160:163], v[40:43]
    v_exp_f32 v39, v39
    v_mfma_f32_16x16x32_bf16 v[0:3], a[196:199], v[164:167], v[0:3]
    v_cvt_pk_bf16_f32 v34, v36, v37
    v_cvt_pk_bf16_f32 v35, v38, v39
    v_mfma_f32_16x16x32_bf16 v[0:3], a[200:203], v[168:171], v[0:3]
    buffer_load_dwordx4 v222, s[32:35], s87 offen offset:1024  lds
    v_mfma_f32_16x16x32_bf16 v[0:3], a[204:207], v[172:175], v[0:3]
    v_mfma_f32_16x16x32_bf16 v[4:7], a[208:211], v[160:163], v[40:43]
    buffer_load_dwordx4 v223, s[32:35], s87 offen offset:2048  lds
    v_mfma_f32_16x16x32_bf16 v[4:7], a[212:215], v[164:167], v[4:7]
    v_mfma_f32_16x16x32_bf16 v[4:7], a[216:219], v[168:171], v[4:7]
    v_exp_f32 v0, v0
    v_mfma_f32_16x16x32_bf16 v[4:7], a[220:223], v[172:175], v[4:7]
    v_exp_f32 v1, v1
    v_mfma_f32_16x16x32_bf16 a[96:99], a[224:227], v[24:27], a[96:99]
    v_exp_f32 v2, v2
    v_mfma_f32_16x16x32_bf16 a[100:103], a[228:231], v[24:27], a[100:103]
    v_exp_f32 v3, v3
    v_mfma_f32_16x16x32_bf16 a[104:107], a[232:235], v[24:27], a[104:107]
    v_cvt_pk_bf16_f32 v0, v0, v1
    v_cvt_pk_bf16_f32 v1, v2, v3
    v_mfma_f32_16x16x32_bf16 a[108:111], a[236:239], v[24:27], a[108:111]
    buffer_load_dwordx4 v225, s[32:35], s87 offen offset:3072  lds
    v_mfma_f32_16x16x32_bf16 a[112:115], a[240:243], v[24:27], a[112:115]
    s_add_u32 m0, s81, 4096
    s_xor_b32 s87, s80, 49152
    v_mfma_f32_16x16x32_bf16 a[116:119], a[244:247], v[24:27], a[116:119]
    v_exp_f32 v4, v4
    v_mfma_f32_16x16x32_bf16 a[120:123], a[248:251], v[24:27], a[120:123]
    v_exp_f32 v5, v5
    v_mfma_f32_16x16x32_bf16 a[124:127], a[252:255], v[24:27], a[124:127]
    v_exp_f32 v6, v6
    v_mfma_f32_16x16x32_bf16 v[72:75], v[228:231], v[24:27], v[72:75]
    v_exp_f32 v7, v7
    v_mfma_f32_16x16x32_bf16 v[8:11], a[192:195], v[176:179], v[44:47]
    v_cvt_pk_bf16_f32 v2, v4, v5
    v_cvt_pk_bf16_f32 v3, v6, v7
    v_mfma_f32_16x16x32_bf16 v[8:11], a[196:199], v[180:183], v[8:11]
    buffer_load_dwordx4 v221, s[32:35], s87 offen offset:0  lds
    v_mfma_f32_16x16x32_bf16 v[8:11], a[200:203], v[184:187], v[8:11]
    v_mfma_f32_16x16x32_bf16 v[8:11], a[204:207], v[188:191], v[8:11]
    v_mfma_f32_16x16x32_bf16 v[12:15], a[208:211], v[176:179], v[44:47]
    v_mfma_f32_16x16x32_bf16 v[12:15], a[212:215], v[180:183], v[12:15]
    v_mfma_f32_16x16x32_bf16 v[12:15], a[216:219], v[184:187], v[12:15]
    v_exp_f32 v8, v8
    v_mfma_f32_16x16x32_bf16 v[12:15], a[220:223], v[188:191], v[12:15]
    v_exp_f32 v9, v9
    v_mfma_f32_16x16x32_bf16 a[128:131], a[224:227], v[32:35], a[128:131]
    ds_read_b64_tr_b16 a[224:225], v212 offset:24576
    ds_read_b64_tr_b16 a[226:227], v212 offset:28672
    v_mfma_f32_16x16x32_bf16 a[132:135], a[228:231], v[32:35], a[132:135]
    v_exp_f32 v10, v10
    v_mfma_f32_16x16x32_bf16 a[136:139], a[232:235], v[32:35], a[136:139]
    ds_read_b64_tr_b16 a[228:229], v213 offset:24576
    ds_read_b64_tr_b16 a[230:231], v213 offset:28672
    v_mfma_f32_16x16x32_bf16 a[140:143], a[236:239], v[32:35], a[140:143]
    buffer_load_dwordx4 v222, s[32:35], s87 offen offset:1024  lds
    v_mfma_f32_16x16x32_bf16 a[144:147], a[240:243], v[32:35], a[144:147]
    ds_read_b64_tr_b16 a[232:233], v214 offset:24576
    ds_read_b64_tr_b16 a[234:235], v214 offset:28672
    v_mfma_f32_16x16x32_bf16 a[148:151], a[244:247], v[32:35], a[148:151]
    v_mfma_f32_16x16x32_bf16 a[152:155], a[248:251], v[32:35], a[152:155]
    ds_read_b64_tr_b16 a[236:237], v215 offset:24576
    ds_read_b64_tr_b16 a[238:239], v215 offset:28672
    v_mfma_f32_16x16x32_bf16 a[156:159], a[252:255], v[32:35], a[156:159]
    buffer_load_dwordx4 v223, s[32:35], s87 offen offset:2048  lds
    v_add_u32 v212, s44, v212
    v_add_u32 v213, s44, v213
    v_mfma_f32_16x16x32_bf16 v[76:79], v[228:231], v[32:35], v[76:79]
    ds_read_b64_tr_b16 a[240:241], v216 offset:24576
    ds_read_b64_tr_b16 a[242:243], v216 offset:28672
    v_mfma_f32_16x16x32_bf16 v[16:19], a[192:195], v[192:195], v[48:51]
    v_add_u32 v214, s44, v214
    v_add_u32 v215, s44, v215
    v_mfma_f32_16x16x32_bf16 v[16:19], a[196:199], v[196:199], v[16:19]
    ds_read_b64_tr_b16 a[244:245], v217 offset:24576
    ds_read_b64_tr_b16 a[246:247], v217 offset:28672
    v_mfma_f32_16x16x32_bf16 v[16:19], a[200:203], v[200:203], v[16:19]
    v_add_u32 v216, s44, v216
    v_add_u32 v217, s44, v217
    v_mfma_f32_16x16x32_bf16 v[16:19], a[204:207], v[204:207], v[16:19]
    ds_read_b64_tr_b16 a[248:249], v218 offset:24576
    ds_read_b64_tr_b16 a[250:251], v218 offset:28672
    v_mfma_f32_16x16x32_bf16 v[20:23], a[208:211], v[192:195], v[48:51]
    v_exp_f32 v11, v11
    v_mfma_f32_16x16x32_bf16 v[20:23], a[212:215], v[196:199], v[20:23]
    ds_read_b64_tr_b16 a[252:253], v219 offset:24576
    ds_read_b64_tr_b16 a[254:255], v219 offset:28672
    v_mfma_f32_16x16x32_bf16 v[20:23], a[216:219], v[200:203], v[20:23]
    v_add_u32 v218, s44, v218
    v_add_u32 v219, s44, v219
    v_mfma_f32_16x16x32_bf16 v[20:23], a[220:223], v[204:207], v[20:23]
    s_waitcnt lgkmcnt(6)
    v_cvt_pk_bf16_f32 v8, v8, v9
    v_cvt_pk_bf16_f32 v9, v10, v11
    v_mfma_f32_16x16x32_bf16 a[0:3], a[224:227], v[0:3], a[0:3]
    v_exp_f32 v12, v12
    v_mfma_f32_16x16x32_bf16 a[4:7], a[228:231], v[0:3], a[4:7]
    v_exp_f32 v13, v13
    v_mfma_f32_16x16x32_bf16 a[8:11], a[232:235], v[0:3], a[8:11]
    v_exp_f32 v14, v14
    v_mfma_f32_16x16x32_bf16 a[12:15], a[236:239], v[0:3], a[12:15]
    buffer_load_dwordx4 v225, s[32:35], s87 offen offset:3072  lds
    v_mfma_f32_16x16x32_bf16 a[16:19], a[240:243], v[0:3], a[16:19]
    s_waitcnt lgkmcnt(2)
    v_exp_f32 v15, v15
    v_mfma_f32_16x16x32_bf16 a[20:23], a[244:247], v[0:3], a[20:23]
    v_cvt_pk_bf16_f32 v10, v12, v13
    v_cvt_pk_bf16_f32 v11, v14, v15
    v_mfma_f32_16x16x32_bf16 a[24:27], a[248:251], v[0:3], a[24:27]
    s_waitcnt lgkmcnt(0)
    v_exp_f32 v16, v16
    v_mfma_f32_16x16x32_bf16 a[28:31], a[252:255], v[0:3], a[28:31]
    v_exp_f32 v17, v17
    v_mfma_f32_16x16x32_bf16 v[60:63], v[228:231], v[0:3], v[60:63]
    v_exp_f32 v18, v18
    v_mfma_f32_16x16x32_bf16 v[24:27], a[192:195], a[160:163], v[52:55]
    v_exp_f32 v19, v19
    v_mfma_f32_16x16x32_bf16 v[24:27], a[196:199], a[164:167], v[24:27]
    ds_read_b128 a[192:195], v208 offset:8192
    ds_read_b128 a[196:199], v209 offset:8192
    v_mfma_f32_16x16x32_bf16 v[24:27], a[200:203], a[168:171], v[24:27]
    v_cvt_pk_bf16_f32 v16, v16, v17
    v_cvt_pk_bf16_f32 v17, v18, v19
    v_mfma_f32_16x16x32_bf16 v[24:27], a[204:207], a[172:175], v[24:27]
    ds_read_b128 a[200:203], v210 offset:8192
    ds_read_b128 a[204:207], v211 offset:8192
    v_mfma_f32_16x16x32_bf16 v[28:31], a[208:211], a[160:163], v[52:55]
    v_exp_f32 v20, v20
    v_mfma_f32_16x16x32_bf16 v[28:31], a[212:215], a[164:167], v[28:31]
    ds_read_b128 a[208:211], v208 offset:12288
    ds_read_b128 a[212:215], v209 offset:12288
    v_mfma_f32_16x16x32_bf16 v[28:31], a[216:219], a[168:171], v[28:31]
    v_add_u32 v208, s44, v208
    v_add_u32 v209, s44, v209
    v_mfma_f32_16x16x32_bf16 v[28:31], a[220:223], a[172:175], v[28:31]
    ds_read_b128 a[216:219], v210 offset:12288
    ds_read_b128 a[220:223], v211 offset:12288
    v_mfma_f32_16x16x32_bf16 a[32:35], a[224:227], v[8:11], a[32:35]
    v_add_u32 v210, s44, v210
    v_add_u32 v211, s44, v211
    v_mfma_f32_16x16x32_bf16 a[36:39], a[228:231], v[8:11], a[36:39]
    v_exp_f32 v21, v21
    v_mfma_f32_16x16x32_bf16 a[40:43], a[232:235], v[8:11], a[40:43]
    v_exp_f32 v22, v22
    v_mfma_f32_16x16x32_bf16 a[44:47], a[236:239], v[8:11], a[44:47]
    v_exp_f32 v23, v23
    v_mfma_f32_16x16x32_bf16 a[48:51], a[240:243], v[8:11], a[48:51]
    v_cvt_pk_bf16_f32 v18, v20, v21
    v_cvt_pk_bf16_f32 v19, v22, v23
    v_mfma_f32_16x16x32_bf16 a[52:55], a[244:247], v[8:11], a[52:55]
    v_exp_f32 v24, v24
    v_mfma_f32_16x16x32_bf16 a[56:59], a[248:251], v[8:11], a[56:59]
    v_exp_f32 v25, v25
    v_mfma_f32_16x16x32_bf16 a[60:63], a[252:255], v[8:11], a[60:63]
    v_exp_f32 v26, v26
    v_mfma_f32_16x16x32_bf16 v[64:67], v[228:231], v[8:11], v[64:67]
    s_waitcnt lgkmcnt(0)
    v_mfma_f32_16x16x32_bf16 v[0:3], a[192:195], v[160:163], v[40:43]
    v_exp_f32 v27, v27
    v_mfma_f32_16x16x32_bf16 v[0:3], a[196:199], v[164:167], v[0:3]
    v_cvt_pk_bf16_f32 v24, v24, v25
    v_cvt_pk_bf16_f32 v25, v26, v27
    v_mfma_f32_16x16x32_bf16 v[0:3], a[200:203], v[168:171], v[0:3]
    v_exp_f32 v28, v28
    v_mfma_f32_16x16x32_bf16 v[0:3], a[204:207], v[172:175], v[0:3]
    v_exp_f32 v29, v29
    v_mfma_f32_16x16x32_bf16 v[4:7], a[208:211], v[160:163], v[40:43]
    v_exp_f32 v30, v30
    v_mfma_f32_16x16x32_bf16 v[4:7], a[212:215], v[164:167], v[4:7]
    v_exp_f32 v31, v31
    v_mfma_f32_16x16x32_bf16 v[4:7], a[216:219], v[168:171], v[4:7]
    v_exp_f32 v0, v0
    v_mfma_f32_16x16x32_bf16 v[4:7], a[220:223], v[172:175], v[4:7]
    v_exp_f32 v1, v1
    v_mfma_f32_16x16x32_bf16 a[64:67], a[224:227], v[16:19], a[64:67]
    v_exp_f32 v2, v2
    v_mfma_f32_16x16x32_bf16 a[68:71], a[228:231], v[16:19], a[68:71]
    v_exp_f32 v3, v3
    v_mfma_f32_16x16x32_bf16 a[72:75], a[232:235], v[16:19], a[72:75]
    s_waitcnt vmcnt(25) lgkmcnt(0)
    s_barrier
    v_mfma_f32_16x16x32_bf16 a[76:79], a[236:239], v[16:19], a[76:79]
    s_add_u32 s38, s74, s3
    v_mfma_f32_16x16x32_bf16 a[80:83], a[240:243], v[16:19], a[80:83]
    s_add_u32 s74, s74, s44
    v_cvt_pk_bf16_f32 v0, v0, v1
    s_waitcnt vmcnt(16)
    s_mov_b32 s65, 0x20000
A0h1_p0:
    v_readfirstlane_b32 s62, v226
    v_readfirstlane_b32 s63, v227
    s_add_u32 s64, s62, s63
    s_mul_i32 s64, s64, 0x01010101
    s_lshr_b32 s64, s64, 24
    s_cmp_ge_u32 s64, 16
    s_cbranch_scc1 A0h1_p1
    s_sub_u32 s65, s65, 1
    s_cmp_eq_u32 s65, 0
    s_cbranch_scc1 A0h1_p1
    s_sleep 8
    global_load_dwordx2 v[226:227], v239, s[48:49] offset:16 sc1
    s_waitcnt vmcnt(0)
    s_branch A0h1_p0
A0h1_p1:
    s_lshl_b32 s65, s42, 3
    s_lshr_b64 s[62:63], s[62:63], s65
    s_and_b32 s62, s62, 0xff
    s_cmp_ge_u32 s62, 16
    s_cselect_b32 s40, 0, 1
    s_cselect_b32 s14, s30, 0
    v_mfma_f32_16x16x32_bf16 a[84:87], a[244:247], v[16:19], a[84:87]
    v_xor_b32 v252, 0, v238
    v_mfma_f32_16x16x32_bf16 a[88:91], a[248:251], v[16:19], a[88:91]
    buffer_load_dwordx4 v[80:83], v252, s[12:15], s51 offen sc1
    v_mfma_f32_16x16x32_bf16 a[92:95], a[252:255], v[16:19], a[92:95]
    s_cmp_eq_u32 s74, 0x18000
    s_cselect_b32 s44, s45, s46
    v_cvt_pk_bf16_f32 v1, v2, v3
    v_mfma_f32_16x16x32_bf16 v[68:71], v[228:231], v[16:19], v[68:71]
    v_exp_f32 v4, v4
    v_mfma_f32_16x16x32_bf16 v[8:11], a[192:195], v[176:179], v[44:47]
    v_exp_f32 v5, v5
    v_mfma_f32_16x16x32_bf16 v[8:11], a[196:199], v[180:183], v[8:11]
    v_exp_f32 v6, v6
    v_mfma_f32_16x16x32_bf16 v[8:11], a[200:203], v[184:187], v[8:11]
    v_exp_f32 v7, v7
    v_mfma_f32_16x16x32_bf16 v[8:11], a[204:207], v[188:191], v[8:11]
    v_cvt_pk_bf16_f32 v2, v4, v5
    v_cvt_pk_bf16_f32 v3, v6, v7
    v_mfma_f32_16x16x32_bf16 v[12:15], a[208:211], v[176:179], v[44:47]
    v_cvt_pk_bf16_f32 v26, v28, v29
    v_cvt_pk_bf16_f32 v27, v30, v31
    v_mfma_f32_16x16x32_bf16 v[12:15], a[212:215], v[180:183], v[12:15]
    buffer_load_dwordx4 v[84:87], v252, s[12:15], s52 offen sc1
    v_mfma_f32_16x16x32_bf16 v[12:15], a[216:219], v[184:187], v[12:15]
    v_exp_f32 v8, v8
    v_mfma_f32_16x16x32_bf16 v[12:15], a[220:223], v[188:191], v[12:15]
    v_exp_f32 v9, v9
    v_mfma_f32_16x16x32_bf16 a[96:99], a[224:227], v[24:27], a[96:99]
    ds_read_b64_tr_b16 a[224:225], v212 offset:16384
    ds_read_b64_tr_b16 a[226:227], v212 offset:20480
    v_mfma_f32_16x16x32_bf16 a[100:103], a[228:231], v[24:27], a[100:103]
    v_exp_f32 v10, v10
    v_mfma_f32_16x16x32_bf16 a[104:107], a[232:235], v[24:27], a[104:107]
    ds_read_b64_tr_b16 a[228:229], v213 offset:16384
    ds_read_b64_tr_b16 a[230:231], v213 offset:20480
    v_mfma_f32_16x16x32_bf16 a[108:111], a[236:239], v[24:27], a[108:111]
    buffer_load_dwordx4 v[88:91], v252, s[12:15], s53 offen sc1
    v_mfma_f32_16x16x32_bf16 a[112:115], a[240:243], v[24:27], a[112:115]
    ds_read_b64_tr_b16 a[232:233], v214 offset:16384
    ds_read_b64_tr_b16 a[234:235], v214 offset:20480
    v_mfma_f32_16x16x32_bf16 a[116:119], a[244:247], v[24:27], a[116:119]
    v_mfma_f32_16x16x32_bf16 a[120:123], a[248:251], v[24:27], a[120:123]
    ds_read_b64_tr_b16 a[236:237], v215 offset:16384
    ds_read_b64_tr_b16 a[238:239], v215 offset:20480
    v_mfma_f32_16x16x32_bf16 a[124:127], a[252:255], v[24:27], a[124:127]
    v_exp_f32 v11, v11
    v_mfma_f32_16x16x32_bf16 v[72:75], v[228:231], v[24:27], v[72:75]
    ds_read_b64_tr_b16 a[240:241], v216 offset:16384
    ds_read_b64_tr_b16 a[242:243], v216 offset:20480
    v_mfma_f32_16x16x32_bf16 v[16:19], a[192:195], v[192:195], v[48:51]
    buffer_load_dwordx4 v[92:95], v252, s[12:15], s54 offen sc1
    v_cvt_pk_bf16_f32 v8, v8, v9
    v_cvt_pk_bf16_f32 v9, v10, v11
    v_mfma_f32_16x16x32_bf16 v[16:19], a[196:199], v[196:199], v[16:19]
    ds_read_b64_tr_b16 a[244:245], v217 offset:16384
    ds_read_b64_tr_b16 a[246:247], v217 offset:20480
    v_mfma_f32_16x16x32_bf16 v[16:19], a[200:203], v[200:203], v[16:19]
    v_exp_f32 v12, v12
    v_mfma_f32_16x16x32_bf16 v[16:19], a[204:207], v[204:207], v[16:19]
    ds_read_b64_tr_b16 a[248:249], v218 offset:16384
    ds_read_b64_tr_b16 a[250:251], v218 offset:20480
    v_mfma_f32_16x16x32_bf16 v[20:23], a[208:211], v[192:195], v[48:51]
    v_exp_f32 v13, v13
    v_mfma_f32_16x16x32_bf16 v[20:23], a[212:215], v[196:199], v[20:23]
    ds_read_b64_tr_b16 a[252:253], v219 offset:16384
    ds_read_b64_tr_b16 a[254:255], v219 offset:20480
    v_mfma_f32_16x16x32_bf16 v[20:23], a[216:219], v[200:203], v[20:23]
    v_exp_f32 v14, v14
    v_mfma_f32_16x16x32_bf16 v[20:23], a[220:223], v[204:207], v[20:23]
    s_waitcnt lgkmcnt(6)
    v_exp_f32 v15, v15
    v_mfma_f32_16x16x32_bf16 a[0:3], a[224:227], v[0:3], a[0:3]
    v_cvt_pk_bf16_f32 v10, v12, v13
    v_cvt_pk_bf16_f32 v11, v14, v15
    v_mfma_f32_16x16x32_bf16 a[4:7], a[228:231], v[0:3], a[4:7]
    v_exp_f32 v16, v16
    v_mfma_f32_16x16x32_bf16 a[8:11], a[232:235], v[0:3], a[8:11]
    v_exp_f32 v17, v17
    v_mfma_f32_16x16x32_bf16 a[12:15], a[236:239], v[0:3], a[12:15]
    buffer_load_dwordx4 v[96:99], v252, s[12:15], s55 offen sc1
    v_mfma_f32_16x16x32_bf16 a[16:19], a[240:243], v[0:3], a[16:19]
    s_waitcnt lgkmcnt(2)
    v_mfma_f32_16x16x32_bf16 a[20:23], a[244:247], v[0:3], a[20:23]
    v_exp_f32 v18, v18
    v_mfma_f32_16x16x32_bf16 a[24:27], a[248:251], v[0:3], a[24:27]
    s_waitcnt lgkmcnt(0)
    v_exp_f32 v19, v19
    v_mfma_f32_16x16x32_bf16 a[28:31], a[252:255], v[0:3], a[28:31]
    buffer_load_dwordx4 v[100:103], v252, s[12:15], s56 offen sc1
    v_cvt_pk_bf16_f32 v16, v16, v17
    v_cvt_pk_bf16_f32 v17, v18, v19
    v_mfma_f32_16x16x32_bf16 v[60:63], v[228:231], v[0:3], v[60:63]
    v_exp_f32 v20, v20
    v_mfma_f32_16x16x32_bf16 v[24:27], a[192:195], a[160:163], v[52:55]
    v_exp_f32 v21, v21
    v_mfma_f32_16x16x32_bf16 v[24:27], a[196:199], a[164:167], v[24:27]
    v_exp_f32 v22, v22
    v_mfma_f32_16x16x32_bf16 v[24:27], a[200:203], a[168:171], v[24:27]
    v_exp_f32 v23, v23
    v_mfma_f32_16x16x32_bf16 v[24:27], a[204:207], a[172:175], v[24:27]
    v_cvt_pk_bf16_f32 v18, v20, v21
    v_cvt_pk_bf16_f32 v19, v22, v23
    v_mfma_f32_16x16x32_bf16 v[28:31], a[208:211], a[160:163], v[52:55]
    buffer_load_dwordx4 v[104:107], v252, s[12:15], s57 offen sc1
    v_mfma_f32_16x16x32_bf16 v[28:31], a[212:215], a[164:167], v[28:31]
    v_mfma_f32_16x16x32_bf16 v[28:31], a[216:219], a[168:171], v[28:31]
    v_exp_f32 v24, v24
    v_mfma_f32_16x16x32_bf16 v[28:31], a[220:223], a[172:175], v[28:31]
    v_exp_f32 v25, v25
    v_mfma_f32_16x16x32_bf16 a[32:35], a[224:227], v[8:11], a[32:35]
    v_exp_f32 v26, v26
    v_mfma_f32_16x16x32_bf16 a[36:39], a[228:231], v[8:11], a[36:39]
    v_exp_f32 v27, v27
    v_mfma_f32_16x16x32_bf16 a[40:43], a[232:235], v[8:11], a[40:43]
    v_cvt_pk_bf16_f32 v24, v24, v25
    v_cvt_pk_bf16_f32 v25, v26, v27
    v_mfma_f32_16x16x32_bf16 a[44:47], a[236:239], v[8:11], a[44:47]
    buffer_load_dwordx4 v[108:111], v252, s[12:15], s58 offen sc1
    v_mfma_f32_16x16x32_bf16 a[48:51], a[240:243], v[8:11], a[48:51]
    v_mfma_f32_16x16x32_bf16 a[52:55], a[244:247], v[8:11], a[52:55]
    v_exp_f32 v28, v28
    v_mfma_f32_16x16x32_bf16 a[56:59], a[248:251], v[8:11], a[56:59]
    v_exp_f32 v29, v29
    v_mfma_f32_16x16x32_bf16 a[60:63], a[252:255], v[8:11], a[60:63]
    v_exp_f32 v30, v30
    v_mfma_f32_16x16x32_bf16 v[64:67], v[228:231], v[8:11], v[64:67]
    v_exp_f32 v31, v31
    v_mfma_f32_16x16x32_bf16 v[32:35], a[192:195], a[176:179], v[56:59]
    v_cvt_pk_bf16_f32 v26, v28, v29
    v_cvt_pk_bf16_f32 v27, v30, v31
    v_mfma_f32_16x16x32_bf16 v[32:35], a[196:199], a[180:183], v[32:35]
    ds_read_b128 a[192:195], v208 offset:0
    ds_read_b128 a[196:199], v209 offset:0
    v_mfma_f32_16x16x32_bf16 v[32:35], a[200:203], a[184:187], v[32:35]
    buffer_load_dwordx4 v[112:115], v252, s[12:15], s59 offen sc1
    v_mfma_f32_16x16x32_bf16 v[32:35], a[204:207], a[188:191], v[32:35]
    s_add_u32 m0, s81, 32768
    ds_read_b128 a[200:203], v210 offset:0
    ds_read_b128 a[204:207], v211 offset:0
    v_mfma_f32_16x16x32_bf16 v[36:39], a[208:211], a[176:179], v[56:59]
    s_xor_b32 s87, s80, 65536
    v_mfma_f32_16x16x32_bf16 v[36:39], a[212:215], a[180:183], v[36:39]
    ds_read_b128 a[208:211], v208 offset:4096
    ds_read_b128 a[212:215], v209 offset:4096
    v_mfma_f32_16x16x32_bf16 v[36:39], a[216:219], a[184:187], v[36:39]
    v_exp_f32 v32, v32
    v_mfma_f32_16x16x32_bf16 v[36:39], a[220:223], a[188:191], v[36:39]
    ds_read_b128 a[216:219], v210 offset:4096
    ds_read_b128 a[220:223], v211 offset:4096
    v_mfma_f32_16x16x32_bf16 a[64:67], a[224:227], v[16:19], a[64:67]
    v_exp_f32 v33, v33
    v_mfma_f32_16x16x32_bf16 a[68:71], a[228:231], v[16:19], a[68:71]
    v_exp_f32 v34, v34
    v_mfma_f32_16x16x32_bf16 a[72:75], a[232:235], v[16:19], a[72:75]
    v_exp_f32 v35, v35
    v_mfma_f32_16x16x32_bf16 a[76:79], a[236:239], v[16:19], a[76:79]
    buffer_load_dwordx4 v221, s[32:35], s87 offen offset:0  lds
    v_mfma_f32_16x16x32_bf16 a[80:83], a[240:243], v[16:19], a[80:83]
    v_mfma_f32_16x16x32_bf16 a[84:87], a[244:247], v[16:19], a[84:87]
    v_cvt_pk_bf16_f32 v32, v32, v33
    v_cvt_pk_bf16_f32 v33, v34, v35
    v_mfma_f32_16x16x32_bf16 a[88:91], a[248:251], v[16:19], a[88:91]
    v_exp_f32 v36, v36
    v_mfma_f32_16x16x32_bf16 a[92:95], a[252:255], v[16:19], a[92:95]
    v_exp_f32 v37, v37
    v_mfma_f32_16x16x32_bf16 v[68:71], v[228:231], v[16:19], v[68:71]
    s_waitcnt lgkmcnt(0)
    v_exp_f32 v38, v38
    v_mfma_f32_16x16x32_bf16 v[0:3], a[192:195], v[160:163], v[40:43]
    v_exp_f32 v39, v39
    v_mfma_f32_16x16x32_bf16 v[0:3], a[196:199], v[164:167], v[0:3]
    v_cvt_pk_bf16_f32 v34, v36, v37
    v_cvt_pk_bf16_f32 v35, v38, v39
    v_mfma_f32_16x16x32_bf16 v[0:3], a[200:203], v[168:171], v[0:3]
    buffer_load_dwordx4 v222, s[32:35], s87 offen offset:1024  lds
    v_mfma_f32_16x16x32_bf16 v[0:3], a[204:207], v[172:175], v[0:3]
    v_mfma_f32_16x16x32_bf16 v[4:7], a[208:211], v[160:163], v[40:43]
    v_mfma_f32_16x16x32_bf16 v[4:7], a[212:215], v[164:167], v[4:7]
    buffer_load_dwordx4 v223, s[32:35], s87 offen offset:2048  lds
    v_mfma_f32_16x16x32_bf16 v[4:7], a[216:219], v[168:171], v[4:7]
    v_exp_f32 v0, v0
    v_mfma_f32_16x16x32_bf16 v[4:7], a[220:223], v[172:175], v[4:7]
    v_exp_f32 v1, v1
    v_mfma_f32_16x16x32_bf16 a[96:99], a[224:227], v[24:27], a[96:99]
    v_exp_f32 v2, v2
    v_mfma_f32_16x16x32_bf16 a[100:103], a[228:231], v[24:27], a[100:103]
    v_exp_f32 v3, v3
    v_mfma_f32_16x16x32_bf16 a[104:107], a[232:235], v[24:27], a[104:107]
    v_cvt_pk_bf16_f32 v0, v0, v1
    v_cvt_pk_bf16_f32 v1, v2, v3
    v_mfma_f32_16x16x32_bf16 a[108:111], a[236:239], v[24:27], a[108:111]
    v_mfma_f32_16x16x32_bf16 a[112:115], a[240:243], v[24:27], a[112:115]
    buffer_load_dwordx4 v225, s[32:35], s87 offen offset:3072  lds
    v_mfma_f32_16x16x32_bf16 a[116:119], a[244:247], v[24:27], a[116:119]
    s_add_u32 m0, s81, 36864
    v_exp_f32 v4, v4
    v_mfma_f32_16x16x32_bf16 a[120:123], a[248:251], v[24:27], a[120:123]
    s_xor_b32 s87, s80, 81920
    v_exp_f32 v5, v5
    v_mfma_f32_16x16x32_bf16 a[124:127], a[252:255], v[24:27], a[124:127]
    v_exp_f32 v6, v6
    v_mfma_f32_16x16x32_bf16 v[72:75], v[228:231], v[24:27], v[72:75]
    v_exp_f32 v7, v7
    v_mfma_f32_16x16x32_bf16 v[8:11], a[192:195], v[176:179], v[44:47]
    v_cvt_pk_bf16_f32 v2, v4, v5
    v_cvt_pk_bf16_f32 v3, v6, v7
    v_mfma_f32_16x16x32_bf16 v[8:11], a[196:199], v[180:183], v[8:11]
    v_mfma_f32_16x16x32_bf16 v[8:11], a[200:203], v[184:187], v[8:11]
    buffer_load_dwordx4 v221, s[32:35], s87 offen offset:0  lds
    v_mfma_f32_16x16x32_bf16 v[8:11], a[204:207], v[188:191], v[8:11]
    v_mfma_f32_16x16x32_bf16 v[12:15], a[208:211], v[176:179], v[44:47]
    v_mfma_f32_16x16x32_bf16 v[12:15], a[212:215], v[180:183], v[12:15]
    v_mfma_f32_16x16x32_bf16 v[12:15], a[216:219], v[184:187], v[12:15]
    v_exp_f32 v8, v8
    v_mfma_f32_16x16x32_bf16 v[12:15], a[220:223], v[188:191], v[12:15]
    v_exp_f32 v9, v9
    v_mfma_f32_16x16x32_bf16 a[128:131], a[224:227], v[32:35], a[128:131]
    ds_read_b64_tr_b16 a[224:225], v212 offset:24576
    ds_read_b64_tr_b16 a[226:227], v212 offset:28672
    v_mfma_f32_16x16x32_bf16 a[132:135], a[228:231], v[32:35], a[132:135]
    v_exp_f32 v10, v10
    v_mfma_f32_16x16x32_bf16 a[136:139], a[232:235], v[32:35], a[136:139]
    ds_read_b64_tr_b16 a[228:229], v213 offset:24576
    ds_read_b64_tr_b16 a[230:231], v213 offset:28672
    v_mfma_f32_16x16x32_bf16 a[140:143], a[236:239], v[32:35], a[140:143]
    buffer_load_dwordx4 v222, s[32:35], s87 offen offset:1024  lds
    v_mfma_f32_16x16x32_bf16 a[144:147], a[240:243], v[32:35], a[144:147]
    ds_read_b64_tr_b16 a[232:233], v214 offset:24576
    ds_read_b64_tr_b16 a[234:235], v214 offset:28672
    v_mfma_f32_16x16x32_bf16 a[148:151], a[244:247], v[32:35], a[148:151]
    v_mfma_f32_16x16x32_bf16 a[152:155], a[248:251], v[32:35], a[152:155]
    ds_read_b64_tr_b16 a[236:237], v215 offset:24576
    ds_read_b64_tr_b16 a[238:239], v215 offset:28672
    v_mfma_f32_16x16x32_bf16 a[156:159], a[252:255], v[32:35], a[156:159]
    v_add_u32 v212, s44, v212
    v_add_u32 v213, s44, v213
    v_mfma_f32_16x16x32_bf16 v[76:79], v[228:231], v[32:35], v[76:79]
    ds_read_b64_tr_b16 a[240:241], v216 offset:24576
    ds_read_b64_tr_b16 a[242:243], v216 offset:28672
    buffer_load_dwordx4 v223, s[32:35], s87 offen offset:2048  lds
    v_mfma_f32_16x16x32_bf16 v[16:19], a[192:195], v[192:195], v[48:51]
    v_add_u32 v214, s44, v214
    v_add_u32 v215, s44, v215
    v_mfma_f32_16x16x32_bf16 v[16:19], a[196:199], v[196:199], v[16:19]
    ds_read_b64_tr_b16 a[244:245], v217 offset:24576
    ds_read_b64_tr_b16 a[246:247], v217 offset:28672
    v_mfma_f32_16x16x32_bf16 v[16:19], a[200:203], v[200:203], v[16:19]
    v_add_u32 v216, s44, v216
    v_add_u32 v217, s44, v217
    v_mfma_f32_16x16x32_bf16 v[16:19], a[204:207], v[204:207], v[16:19]
    ds_read_b64_tr_b16 a[248:249], v218 offset:24576
    ds_read_b64_tr_b16 a[250:251], v218 offset:28672
    v_mfma_f32_16x16x32_bf16 v[20:23], a[208:211], v[192:195], v[48:51]
    v_exp_f32 v11, v11
    v_mfma_f32_16x16x32_bf16 v[20:23], a[212:215], v[196:199], v[20:23]
    ds_read_b64_tr_b16 a[252:253], v219 offset:24576
    ds_read_b64_tr_b16 a[254:255], v219 offset:28672
    v_mfma_f32_16x16x32_bf16 v[20:23], a[216:219], v[200:203], v[20:23]
    v_add_u32 v218, s44, v218
    v_add_u32 v219, s44, v219
    v_mfma_f32_16x16x32_bf16 v[20:23], a[220:223], v[204:207], v[20:23]
    s_waitcnt lgkmcnt(6)
    v_cvt_pk_bf16_f32 v8, v8, v9
    v_cvt_pk_bf16_f32 v9, v10, v11
    v_mfma_f32_16x16x32_bf16 a[0:3], a[224:227], v[0:3], a[0:3]
    v_exp_f32 v12, v12
    v_mfma_f32_16x16x32_bf16 a[4:7], a[228:231], v[0:3], a[4:7]
    v_exp_f32 v13, v13
    v_mfma_f32_16x16x32_bf16 a[8:11], a[232:235], v[0:3], a[8:11]
    v_exp_f32 v14, v14
    v_mfma_f32_16x16x32_bf16 a[12:15], a[236:239], v[0:3], a[12:15]
    buffer_load_dwordx4 v225, s[32:35], s87 offen offset:3072  lds
    v_mfma_f32_16x16x32_bf16 a[16:19], a[240:243], v[0:3], a[16:19]
    s_waitcnt lgkmcnt(2)
    v_exp_f32 v15, v15
    v_mfma_f32_16x16x32_bf16 a[20:23], a[244:247], v[0:3], a[20:23]
    v_cvt_pk_bf16_f32 v10, v12, v13
    v_cvt_pk_bf16_f32 v11, v14, v15
    v_mfma_f32_16x16x32_bf16 a[24:27], a[248:251], v[0:3], a[24:27]
    s_waitcnt lgkmcnt(0)
    v_exp_f32 v16, v16
    v_mfma_f32_16x16x32_bf16 a[28:31], a[252:255], v[0:3], a[28:31]
    v_exp_f32 v17, v17
    v_mfma_f32_16x16x32_bf16 v[60:63], v[228:231], v[0:3], v[60:63]
    v_exp_f32 v18, v18
    v_mfma_f32_16x16x32_bf16 v[24:27], a[192:195], a[160:163], v[52:55]
    v_exp_f32 v19, v19
    v_mfma_f32_16x16x32_bf16 v[24:27], a[196:199], a[164:167], v[24:27]
    ds_read_b128 a[192:195], v208 offset:8192
    ds_read_b128 a[196:199], v209 offset:8192
    v_mfma_f32_16x16x32_bf16 v[24:27], a[200:203], a[168:171], v[24:27]
    v_cvt_pk_bf16_f32 v16, v16, v17
    v_cvt_pk_bf16_f32 v17, v18, v19
    v_mfma_f32_16x16x32_bf16 v[24:27], a[204:207], a[172:175], v[24:27]
    ds_read_b128 a[200:203], v210 offset:8192
    ds_read_b128 a[204:207], v211 offset:8192
    v_mfma_f32_16x16x32_bf16 v[28:31], a[208:211], a[160:163], v[52:55]
    v_exp_f32 v20, v20
    v_mfma_f32_16x16x32_bf16 v[28:31], a[212:215], a[164:167], v[28:31]
    ds_read_b128 a[208:211], v208 offset:12288
    ds_read_b128 a[212:215], v209 offset:12288
    v_mfma_f32_16x16x32_bf16 v[28:31], a[216:219], a[168:171], v[28:31]
    v_add_u32 v208, s44, v208
    v_add_u32 v209, s44, v209
    v_mfma_f32_16x16x32_bf16 v[28:31], a[220:223], a[172:175], v[28:31]
    ds_read_b128 a[216:219], v210 offset:12288
    ds_read_b128 a[220:223], v211 offset:12288
    v_mfma_f32_16x16x32_bf16 a[32:35], a[224:227], v[8:11], a[32:35]
    v_add_u32 v210, s44, v210
    v_add_u32 v211, s44, v211
    v_mfma_f32_16x16x32_bf16 a[36:39], a[228:231], v[8:11], a[36:39]
    v_exp_f32 v21, v21
    v_mfma_f32_16x16x32_bf16 a[40:43], a[232:235], v[8:11], a[40:43]
    v_exp_f32 v22, v22
    v_mfma_f32_16x16x32_bf16 a[44:47], a[236:239], v[8:11], a[44:47]
    v_exp_f32 v23, v23
    v_mfma_f32_16x16x32_bf16 a[48:51], a[240:243], v[8:11], a[48:51]
    v_cvt_pk_bf16_f32 v18, v20, v21
    v_cvt_pk_bf16_f32 v19, v22, v23
    v_mfma_f32_16x16x32_bf16 a[52:55], a[244:247], v[8:11], a[52:55]
    v_exp_f32 v24, v24
    v_mfma_f32_16x16x32_bf16 a[56:59], a[248:251], v[8:11], a[56:59]
    v_exp_f32 v25, v25
    v_mfma_f32_16x16x32_bf16 a[60:63], a[252:255], v[8:11], a[60:63]
    v_exp_f32 v26, v26
    v_mfma_f32_16x16x32_bf16 v[64:67], v[228:231], v[8:11], v[64:67]
    s_waitcnt lgkmcnt(0)
    v_mfma_f32_16x16x32_bf16 v[0:3], a[192:195], v[160:163], v[40:43]
    v_exp_f32 v27, v27
    v_mfma_f32_16x16x32_bf16 v[0:3], a[196:199], v[164:167], v[0:3]
    v_cvt_pk_bf16_f32 v24, v24, v25
    v_cvt_pk_bf16_f32 v25, v26, v27
    v_mfma_f32_16x16x32_bf16 v[0:3], a[200:203], v[168:171], v[0:3]
    v_exp_f32 v28, v28
    v_mfma_f32_16x16x32_bf16 v[0:3], a[204:207], v[172:175], v[0:3]
    v_exp_f32 v29, v29
    v_mfma_f32_16x16x32_bf16 v[4:7], a[208:211], v[160:163], v[40:43]
    v_exp_f32 v30, v30
    v_mfma_f32_16x16x32_bf16 v[4:7], a[212:215], v[164:167], v[4:7]
    v_exp_f32 v31, v31
    v_mfma_f32_16x16x32_bf16 v[4:7], a[216:219], v[168:171], v[4:7]
    v_exp_f32 v0, v0
    v_mfma_f32_16x16x32_bf16 v[4:7], a[220:223], v[172:175], v[4:7]
    v_exp_f32 v1, v1
    v_mfma_f32_16x16x32_bf16 a[64:67], a[224:227], v[16:19], a[64:67]
    v_exp_f32 v2, v2
    v_mfma_f32_16x16x32_bf16 a[68:71], a[228:231], v[16:19], a[68:71]
    v_exp_f32 v3, v3
    v_mfma_f32_16x16x32_bf16 a[72:75], a[232:235], v[16:19], a[72:75]
    s_waitcnt vmcnt(34) lgkmcnt(0)
    s_barrier
    v_mfma_f32_16x16x32_bf16 a[76:79], a[236:239], v[16:19], a[76:79]
    s_add_u32 s38, s74, s3
    v_mfma_f32_16x16x32_bf16 a[80:83], a[240:243], v[16:19], a[80:83]
    s_add_u32 s74, s74, s44
    v_cvt_pk_bf16_f32 v0, v0, v1
    v_xor_b32 v253, 1024, v238
    v_mfma_f32_16x16x32_bf16 a[84:87], a[244:247], v[16:19], a[84:87]
    buffer_load_dwordx4 v[116:119], v253, s[12:15], s51 offen sc1
    v_mfma_f32_16x16x32_bf16 a[88:91], a[248:251], v[16:19], a[88:91]
    v_mfma_f32_16x16x32_bf16 a[92:95], a[252:255], v[16:19], a[92:95]
    s_cmp_eq_u32 s74, 0x18000
    s_cselect_b32 s44, s45, s46
    v_cvt_pk_bf16_f32 v1, v2, v3
    v_mfma_f32_16x16x32_bf16 v[68:71], v[228:231], v[16:19], v[68:71]
    v_exp_f32 v4, v4
    v_mfma_f32_16x16x32_bf16 v[8:11], a[192:195], v[176:179], v[44:47]
    v_exp_f32 v5, v5
    v_mfma_f32_16x16x32_bf16 v[8:11], a[196:199], v[180:183], v[8:11]
    v_exp_f32 v6, v6
    v_mfma_f32_16x16x32_bf16 v[8:11], a[200:203], v[184:187], v[8:11]
    v_exp_f32 v7, v7
    v_mfma_f32_16x16x32_bf16 v[8:11], a[204:207], v[188:191], v[8:11]
    v_cvt_pk_bf16_f32 v2, v4, v5
    v_cvt_pk_bf16_f32 v3, v6, v7
    v_mfma_f32_16x16x32_bf16 v[12:15], a[208:211], v[176:179], v[44:47]
    v_cvt_pk_bf16_f32 v26, v28, v29
    v_cvt_pk_bf16_f32 v27, v30, v31
    v_mfma_f32_16x16x32_bf16 v[12:15], a[212:215], v[180:183], v[12:15]
    buffer_load_dwordx4 v[120:123], v253, s[12:15], s52 offen sc1
    v_mfma_f32_16x16x32_bf16 v[12:15], a[216:219], v[184:187], v[12:15]
    v_exp_f32 v8, v8
    v_mfma_f32_16x16x32_bf16 v[12:15], a[220:223], v[188:191], v[12:15]
    v_exp_f32 v9, v9
    v_mfma_f32_16x16x32_bf16 a[96:99], a[224:227], v[24:27], a[96:99]
    ds_read_b64_tr_b16 a[224:225], v212 offset:16384
    ds_read_b64_tr_b16 a[226:227], v212 offset:20480
    v_mfma_f32_16x16x32_bf16 a[100:103], a[228:231], v[24:27], a[100:103]
    v_exp_f32 v10, v10
    v_mfma_f32_16x16x32_bf16 a[104:107], a[232:235], v[24:27], a[104:107]
    ds_read_b64_tr_b16 a[228:229], v213 offset:16384
    ds_read_b64_tr_b16 a[230:231], v213 offset:20480
    v_mfma_f32_16x16x32_bf16 a[108:111], a[236:239], v[24:27], a[108:111]
    buffer_load_dwordx4 v[124:127], v253, s[12:15], s53 offen sc1
    v_mfma_f32_16x16x32_bf16 a[112:115], a[240:243], v[24:27], a[112:115]
    ds_read_b64_tr_b16 a[232:233], v214 offset:16384
    ds_read_b64_tr_b16 a[234:235], v214 offset:20480
    v_mfma_f32_16x16x32_bf16 a[116:119], a[244:247], v[24:27], a[116:119]
    buffer_load_dwordx4 v[128:131], v253, s[12:15], s54 offen sc1
    v_mfma_f32_16x16x32_bf16 a[120:123], a[248:251], v[24:27], a[120:123]
    ds_read_b64_tr_b16 a[236:237], v215 offset:16384
    ds_read_b64_tr_b16 a[238:239], v215 offset:20480
    v_mfma_f32_16x16x32_bf16 a[124:127], a[252:255], v[24:27], a[124:127]
    v_exp_f32 v11, v11
    v_mfma_f32_16x16x32_bf16 v[72:75], v[228:231], v[24:27], v[72:75]
    ds_read_b64_tr_b16 a[240:241], v216 offset:16384
    ds_read_b64_tr_b16 a[242:243], v216 offset:20480
    v_mfma_f32_16x16x32_bf16 v[16:19], a[192:195], v[192:195], v[48:51]
    v_cvt_pk_bf16_f32 v8, v8, v9
    v_cvt_pk_bf16_f32 v9, v10, v11
    v_mfma_f32_16x16x32_bf16 v[16:19], a[196:199], v[196:199], v[16:19]
    ds_read_b64_tr_b16 a[244:245], v217 offset:16384
    ds_read_b64_tr_b16 a[246:247], v217 offset:20480
    v_mfma_f32_16x16x32_bf16 v[16:19], a[200:203], v[200:203], v[16:19]
    buffer_load_dwordx4 v[132:135], v253, s[12:15], s55 offen sc1
    v_exp_f32 v12, v12
    v_mfma_f32_16x16x32_bf16 v[16:19], a[204:207], v[204:207], v[16:19]
    ds_read_b64_tr_b16 a[248:249], v218 offset:16384
    ds_read_b64_tr_b16 a[250:251], v218 offset:20480
    v_mfma_f32_16x16x32_bf16 v[20:23], a[208:211], v[192:195], v[48:51]
    v_exp_f32 v13, v13
    v_mfma_f32_16x16x32_bf16 v[20:23], a[212:215], v[196:199], v[20:23]
    ds_read_b64_tr_b16 a[252:253], v219 offset:16384
    ds_read_b64_tr_b16 a[254:255], v219 offset:20480
    v_mfma_f32_16x16x32_bf16 v[20:23], a[216:219], v[200:203], v[20:23]
    v_exp_f32 v14, v14
    v_mfma_f32_16x16x32_bf16 v[20:23], a[220:223], v[204:207], v[20:23]
    s_waitcnt lgkmcnt(6)
    v_exp_f32 v15, v15
    v_mfma_f32_16x16x32_bf16 a[0:3], a[224:227], v[0:3], a[0:3]
    v_cvt_pk_bf16_f32 v10, v12, v13
    v_cvt_pk_bf16_f32 v11, v14, v15
    v_mfma_f32_16x16x32_bf16 a[4:7], a[228:231], v[0:3], a[4:7]
    v_exp_f32 v16, v16
    v_mfma_f32_16x16x32_bf16 a[8:11], a[232:235], v[0:3], a[8:11]
    v_exp_f32 v17, v17
    v_mfma_f32_16x16x32_bf16 a[12:15], a[236:239], v[0:3], a[12:15]
    buffer_load_dwordx4 v[136:139], v253, s[12:15], s56 offen sc1
    v_mfma_f32_16x16x32_bf16 a[16:19], a[240:243], v[0:3], a[16:19]
    s_waitcnt lgkmcnt(2)
    v_mfma_f32_16x16x32_bf16 a[20:23], a[244:247], v[0:3], a[20:23]
    v_exp_f32 v18, v18
    v_mfma_f32_16x16x32_bf16 a[24:27], a[248:251], v[0:3], a[24:27]
    s_waitcnt lgkmcnt(0)
    v_exp_f32 v19, v19
    v_mfma_f32_16x16x32_bf16 a[28:31], a[252:255], v[0:3], a[28:31]
    buffer_load_dwordx4 v[140:143], v253, s[12:15], s57 offen sc1
    v_cvt_pk_bf16_f32 v16, v16, v17
    v_cvt_pk_bf16_f32 v17, v18, v19
    v_mfma_f32_16x16x32_bf16 v[60:63], v[228:231], v[0:3], v[60:63]
    v_exp_f32 v20, v20
    v_mfma_f32_16x16x32_bf16 v[24:27], a[192:195], a[160:163], v[52:55]
    v_exp_f32 v21, v21
    v_mfma_f32_16x16x32_bf16 v[24:27], a[196:199], a[164:167], v[24:27]
    v_exp_f32 v22, v22
    v_mfma_f32_16x16x32_bf16 v[24:27], a[200:203], a[168:171], v[24:27]
    v_exp_f32 v23, v23
    v_mfma_f32_16x16x32_bf16 v[24:27], a[204:207], a[172:175], v[24:27]
    v_cvt_pk_bf16_f32 v18, v20, v21
    v_cvt_pk_bf16_f32 v19, v22, v23
    v_mfma_f32_16x16x32_bf16 v[28:31], a[208:211], a[160:163], v[52:55]
    buffer_load_dwordx4 v[144:147], v253, s[12:15], s58 offen sc1
    v_mfma_f32_16x16x32_bf16 v[28:31], a[212:215], a[164:167], v[28:31]
    v_mfma_f32_16x16x32_bf16 v[28:31], a[216:219], a[168:171], v[28:31]
    v_exp_f32 v24, v24
    v_mfma_f32_16x16x32_bf16 v[28:31], a[220:223], a[172:175], v[28:31]
    v_exp_f32 v25, v25
    v_mfma_f32_16x16x32_bf16 a[32:35], a[224:227], v[8:11], a[32:35]
    v_exp_f32 v26, v26
    v_mfma_f32_16x16x32_bf16 a[36:39], a[228:231], v[8:11], a[36:39]
    v_exp_f32 v27, v27
    v_mfma_f32_16x16x32_bf16 a[40:43], a[232:235], v[8:11], a[40:43]
    v_cvt_pk_bf16_f32 v24, v24, v25
    v_cvt_pk_bf16_f32 v25, v26, v27
    v_mfma_f32_16x16x32_bf16 a[44:47], a[236:239], v[8:11], a[44:47]
    buffer_load_dwordx4 v[148:151], v253, s[12:15], s59 offen sc1
    v_mfma_f32_16x16x32_bf16 a[48:51], a[240:243], v[8:11], a[48:51]
    s_add_u32 m0, s81, 65536
    s_xor_b32 s87, s80, 98304
    v_mfma_f32_16x16x32_bf16 a[52:55], a[244:247], v[8:11], a[52:55]
    v_exp_f32 v28, v28
    v_mfma_f32_16x16x32_bf16 a[56:59], a[248:251], v[8:11], a[56:59]
    v_exp_f32 v29, v29
    v_mfma_f32_16x16x32_bf16 a[60:63], a[252:255], v[8:11], a[60:63]
    v_exp_f32 v30, v30
    v_mfma_f32_16x16x32_bf16 v[64:67], v[228:231], v[8:11], v[64:67]
    v_exp_f32 v31, v31
    v_mfma_f32_16x16x32_bf16 v[32:35], a[192:195], a[176:179], v[56:59]
    v_cvt_pk_bf16_f32 v26, v28, v29
    v_cvt_pk_bf16_f32 v27, v30, v31
    v_mfma_f32_16x16x32_bf16 v[32:35], a[196:199], a[180:183], v[32:35]
    ds_read_b128 a[192:195], v208 offset:0
    ds_read_b128 a[196:199], v209 offset:0
    v_mfma_f32_16x16x32_bf16 v[32:35], a[200:203], a[184:187], v[32:35]
    buffer_load_dwordx4 v221, s[32:35], s87 offen offset:0  lds
    v_mfma_f32_16x16x32_bf16 v[32:35], a[204:207], a[188:191], v[32:35]
    ds_read_b128 a[200:203], v210 offset:0
    ds_read_b128 a[204:207], v211 offset:0
    v_mfma_f32_16x16x32_bf16 v[36:39], a[208:211], a[176:179], v[56:59]
    buffer_load_dwordx4 v222, s[32:35], s87 offen offset:1024  lds
    v_mfma_f32_16x16x32_bf16 v[36:39], a[212:215], a[180:183], v[36:39]
    ds_read_b128 a[208:211], v208 offset:4096
    ds_read_b128 a[212:215], v209 offset:4096
    v_mfma_f32_16x16x32_bf16 v[36:39], a[216:219], a[184:187], v[36:39]
    v_exp_f32 v32, v32
    v_mfma_f32_16x16x32_bf16 v[36:39], a[220:223], a[188:191], v[36:39]
    ds_read_b128 a[216:219], v210 offset:4096
    ds_read_b128 a[220:223], v211 offset:4096
    v_mfma_f32_16x16x32_bf16 a[64:67], a[224:227], v[16:19], a[64:67]
    v_exp_f32 v33, v33
    v_mfma_f32_16x16x32_bf16 a[68:71], a[228:231], v[16:19], a[68:71]
    v_exp_f32 v34, v34
    v_mfma_f32_16x16x32_bf16 a[72:75], a[232:235], v[16:19], a[72:75]
    v_exp_f32 v35, v35
    v_mfma_f32_16x16x32_bf16 a[76:79], a[236:239], v[16:19], a[76:79]
    buffer_load_dwordx4 v223, s[32:35], s87 offen offset:2048  lds
    v_mfma_f32_16x16x32_bf16 a[80:83], a[240:243], v[16:19], a[80:83]
    v_mfma_f32_16x16x32_bf16 a[84:87], a[244:247], v[16:19], a[84:87]
    v_cvt_pk_bf16_f32 v32, v32, v33
    v_cvt_pk_bf16_f32 v33, v34, v35
    v_mfma_f32_16x16x32_bf16 a[88:91], a[248:251], v[16:19], a[88:91]
    v_exp_f32 v36, v36
    v_mfma_f32_16x16x32_bf16 a[92:95], a[252:255], v[16:19], a[92:95]
    v_exp_f32 v37, v37
    v_mfma_f32_16x16x32_bf16 v[68:71], v[228:231], v[16:19], v[68:71]
    s_waitcnt lgkmcnt(0)
    v_exp_f32 v38, v38
    v_mfma_f32_16x16x32_bf16 v[0:3], a[192:195], v[160:163], v[40:43]
    v_exp_f32 v39, v39
    v_mfma_f32_16x16x32_bf16 v[0:3], a[196:199], v[164:167], v[0:3]
    v_cvt_pk_bf16_f32 v34, v36, v37
    v_cvt_pk_bf16_f32 v35, v38, v39
    v_mfma_f32_16x16x32_bf16 v[0:3], a[200:203], v[168:171], v[0:3]
    buffer_load_dwordx4 v225, s[32:35], s87 offen offset:3072  lds
    v_mfma_f32_16x16x32_bf16 v[0:3], a[204:207], v[172:175], v[0:3]
    s_add_u32 m0, s81, 69632
    s_xor_b32 s87, s80, 114688
    v_mfma_f32_16x16x32_bf16 v[4:7], a[208:211], v[160:163], v[40:43]
    v_mfma_f32_16x16x32_bf16 v[4:7], a[212:215], v[164:167], v[4:7]
    buffer_load_dwordx4 v221, s[32:35], s87 offen offset:0  lds
    v_mfma_f32_16x16x32_bf16 v[4:7], a[216:219], v[168:171], v[4:7]
    v_exp_f32 v0, v0
    v_mfma_f32_16x16x32_bf16 v[4:7], a[220:223], v[172:175], v[4:7]
    v_exp_f32 v1, v1
    v_mfma_f32_16x16x32_bf16 a[96:99], a[224:227], v[24:27], a[96:99]
    v_exp_f32 v2, v2
    v_mfma_f32_16x16x32_bf16 a[100:103], a[228:231], v[24:27], a[100:103]
    v_exp_f32 v3, v3
    v_mfma_f32_16x16x32_bf16 a[104:107], a[232:235], v[24:27], a[104:107]
    v_cvt_pk_bf16_f32 v0, v0, v1
    v_cvt_pk_bf16_f32 v1, v2, v3
    v_mfma_f32_16x16x32_bf16 a[108:111], a[236:239], v[24:27], a[108:111]
    buffer_load_dwordx4 v222, s[32:35], s87 offen offset:1024  lds
    v_mfma_f32_16x16x32_bf16 a[112:115], a[240:243], v[24:27], a[112:115]
    v_mfma_f32_16x16x32_bf16 a[116:119], a[244:247], v[24:27], a[116:119]
    v_exp_f32 v4, v4
    v_mfma_f32_16x16x32_bf16 a[120:123], a[248:251], v[24:27], a[120:123]
    v_exp_f32 v5, v5
    v_mfma_f32_16x16x32_bf16 a[124:127], a[252:255], v[24:27], a[124:127]
    v_exp_f32 v6, v6
    v_mfma_f32_16x16x32_bf16 v[72:75], v[228:231], v[24:27], v[72:75]
    v_exp_f32 v7, v7
    v_mfma_f32_16x16x32_bf16 v[8:11], a[192:195], v[176:179], v[44:47]
    v_cvt_pk_bf16_f32 v2, v4, v5
    v_cvt_pk_bf16_f32 v3, v6, v7
    v_mfma_f32_16x16x32_bf16 v[8:11], a[196:199], v[180:183], v[8:11]
    buffer_load_dwordx4 v223, s[32:35], s87 offen offset:2048  lds
    v_mfma_f32_16x16x32_bf16 v[8:11], a[200:203], v[184:187], v[8:11]
    v_mfma_f32_16x16x32_bf16 v[8:11], a[204:207], v[188:191], v[8:11]
    v_mfma_f32_16x16x32_bf16 v[12:15], a[208:211], v[176:179], v[44:47]
    v_mfma_f32_16x16x32_bf16 v[12:15], a[212:215], v[180:183], v[12:15]
    v_mfma_f32_16x16x32_bf16 v[12:15], a[216:219], v[184:187], v[12:15]
    v_exp_f32 v8, v8
    v_mfma_f32_16x16x32_bf16 v[12:15], a[220:223], v[188:191], v[12:15]
    v_exp_f32 v9, v9
    v_mfma_f32_16x16x32_bf16 a[128:131], a[224:227], v[32:35], a[128:131]
    ds_read_b64_tr_b16 a[224:225], v212 offset:24576
    ds_read_b64_tr_b16 a[226:227], v212 offset:28672
    v_mfma_f32_16x16x32_bf16 a[132:135], a[228:231], v[32:35], a[132:135]
    v_exp_f32 v10, v10
    v_mfma_f32_16x16x32_bf16 a[136:139], a[232:235], v[32:35], a[136:139]
    ds_read_b64_tr_b16 a[228:229], v213 offset:24576
    ds_read_b64_tr_b16 a[230:231], v213 offset:28672
    v_mfma_f32_16x16x32_bf16 a[140:143], a[236:239], v[32:35], a[140:143]
    buffer_load_dwordx4 v225, s[32:35], s87 offen offset:3072  lds
    v_mfma_f32_16x16x32_bf16 a[144:147], a[240:243], v[32:35], a[144:147]
    ds_read_b64_tr_b16 a[232:233], v214 offset:24576
    ds_read_b64_tr_b16 a[234:235], v214 offset:28672
    v_mfma_f32_16x16x32_bf16 a[148:151], a[244:247], v[32:35], a[148:151]
    v_mfma_f32_16x16x32_bf16 a[152:155], a[248:251], v[32:35], a[152:155]
    ds_read_b64_tr_b16 a[236:237], v215 offset:24576
    ds_read_b64_tr_b16 a[238:239], v215 offset:28672
    v_mfma_f32_16x16x32_bf16 a[156:159], a[252:255], v[32:35], a[156:159]
    v_add_u32 v212, s44, v212
    v_add_u32 v213, s44, v213
    v_mfma_f32_16x16x32_bf16 v[76:79], v[228:231], v[32:35], v[76:79]
    ds_read_b64_tr_b16 a[240:241], v216 offset:24576
    ds_read_b64_tr_b16 a[242:243], v216 offset:28672
    v_mfma_f32_16x16x32_bf16 v[16:19], a[192:195], v[192:195], v[48:51]
    v_add_u32 v214, s44, v214
    v_add_u32 v215, s44, v215
    v_mfma_f32_16x16x32_bf16 v[16:19], a[196:199], v[196:199], v[16:19]
    ds_read_b64_tr_b16 a[244:245], v217 offset:24576
    ds_read_b64_tr_b16 a[246:247], v217 offset:28672
    v_mfma_f32_16x16x32_bf16 v[16:19], a[200:203], v[200:203], v[16:19]
    v_add_u32 v216, s44, v216
    v_add_u32 v217, s44, v217
    v_mfma_f32_16x16x32_bf16 v[16:19], a[204:207], v[204:207], v[16:19]
    ds_read_b64_tr_b16 a[248:249], v218 offset:24576
    ds_read_b64_tr_b16 a[250:251], v218 offset:28672
    v_mfma_f32_16x16x32_bf16 v[20:23], a[208:211], v[192:195], v[48:51]
    v_exp_f32 v11, v11
    v_mfma_f32_16x16x32_bf16 v[20:23], a[212:215], v[196:199], v[20:23]
    ds_read_b64_tr_b16 a[252:253], v219 offset:24576
    ds_read_b64_tr_b16 a[254:255], v219 offset:28672
    v_mfma_f32_16x16x32_bf16 v[20:23], a[216:219], v[200:203], v[20:23]
    v_add_u32 v218, s44, v218
    v_add_u32 v219, s44, v219
    v_mfma_f32_16x16x32_bf16 v[20:23], a[220:223], v[204:207], v[20:23]
    s_waitcnt lgkmcnt(6)
    v_cvt_pk_bf16_f32 v8, v8, v9
    v_cvt_pk_bf16_f32 v9, v10, v11
    v_mfma_f32_16x16x32_bf16 a[0:3], a[224:227], v[0:3], a[0:3]
    v_exp_f32 v12, v12
    v_mfma_f32_16x16x32_bf16 a[4:7], a[228:231], v[0:3], a[4:7]
    v_exp_f32 v13, v13
    v_mfma_f32_16x16x32_bf16 a[8:11], a[232:235], v[0:3], a[8:11]
    v_exp_f32 v14, v14
    v_mfma_f32_16x16x32_bf16 a[12:15], a[236:239], v[0:3], a[12:15]
    v_mfma_f32_16x16x32_bf16 a[16:19], a[240:243], v[0:3], a[16:19]
    s_waitcnt lgkmcnt(2)
    v_exp_f32 v15, v15
    v_mfma_f32_16x16x32_bf16 a[20:23], a[244:247], v[0:3], a[20:23]
    v_cvt_pk_bf16_f32 v10, v12, v13
    v_cvt_pk_bf16_f32 v11, v14, v15
    v_mfma_f32_16x16x32_bf16 a[24:27], a[248:251], v[0:3], a[24:27]
    s_waitcnt lgkmcnt(0)
    v_exp_f32 v16, v16
    v_mfma_f32_16x16x32_bf16 a[28:31], a[252:255], v[0:3], a[28:31]
    v_exp_f32 v17, v17
    v_mfma_f32_16x16x32_bf16 v[60:63], v[228:231], v[0:3], v[60:63]
    v_exp_f32 v18, v18
    v_mfma_f32_16x16x32_bf16 v[24:27], a[192:195], a[160:163], v[52:55]
    v_exp_f32 v19, v19
    v_mfma_f32_16x16x32_bf16 v[24:27], a[196:199], a[164:167], v[24:27]
    ds_read_b128 a[192:195], v208 offset:8192
    ds_read_b128 a[196:199], v209 offset:8192
    v_mfma_f32_16x16x32_bf16 v[24:27], a[200:203], a[168:171], v[24:27]
    v_cvt_pk_bf16_f32 v16, v16, v17
    v_cvt_pk_bf16_f32 v17, v18, v19
    v_mfma_f32_16x16x32_bf16 v[24:27], a[204:207], a[172:175], v[24:27]
    ds_read_b128 a[200:203], v210 offset:8192
    ds_read_b128 a[204:207], v211 offset:8192
    v_mfma_f32_16x16x32_bf16 v[28:31], a[208:211], a[160:163], v[52:55]
    v_exp_f32 v20, v20
    v_mfma_f32_16x16x32_bf16 v[28:31], a[212:215], a[164:167], v[28:31]
    ds_read_b128 a[208:211], v208 offset:12288
    ds_read_b128 a[212:215], v209 offset:12288
    v_mfma_f32_16x16x32_bf16 v[28:31], a[216:219], a[168:171], v[28:31]
    v_add_u32 v208, s44, v208
    v_add_u32 v209, s44, v209
    v_mfma_f32_16x16x32_bf16 v[28:31], a[220:223], a[172:175], v[28:31]
    ds_read_b128 a[216:219], v210 offset:12288
    ds_read_b128 a[220:223], v211 offset:12288
    v_mfma_f32_16x16x32_bf16 a[32:35], a[224:227], v[8:11], a[32:35]
    v_add_u32 v210, s44, v210
    v_add_u32 v211, s44, v211
    v_mfma_f32_16x16x32_bf16 a[36:39], a[228:231], v[8:11], a[36:39]
    v_exp_f32 v21, v21
    v_mfma_f32_16x16x32_bf16 a[40:43], a[232:235], v[8:11], a[40:43]
    v_exp_f32 v22, v22
    v_mfma_f32_16x16x32_bf16 a[44:47], a[236:239], v[8:11], a[44:47]
    v_exp_f32 v23, v23
    v_mfma_f32_16x16x32_bf16 a[48:51], a[240:243], v[8:11], a[48:51]
    v_cvt_pk_bf16_f32 v18, v20, v21
    v_cvt_pk_bf16_f32 v19, v22, v23
    v_mfma_f32_16x16x32_bf16 a[52:55], a[244:247], v[8:11], a[52:55]
    v_exp_f32 v24, v24
    v_mfma_f32_16x16x32_bf16 a[56:59], a[248:251], v[8:11], a[56:59]
    v_exp_f32 v25, v25
    v_mfma_f32_16x16x32_bf16 a[60:63], a[252:255], v[8:11], a[60:63]
    v_exp_f32 v26, v26
    v_mfma_f32_16x16x32_bf16 v[64:67], v[228:231], v[8:11], v[64:67]
    s_waitcnt lgkmcnt(0)
    s_lshl_b32 s67, s36, 19
    s_add_u32 s67, s67, s70
    s_add_u32 s67, s67, 4096
    s_nop 1
    v_mfma_f32_16x16x32_bf16 a[64:67], a[224:227], v[16:19], a[64:67]
    v_exp_f32 v27, v27
    v_cvt_pk_bf16_f32 v24, v24, v25
    v_mfma_f32_16x16x32_bf16 a[68:71], a[228:231], v[16:19], a[68:71]
    v_cvt_pk_bf16_f32 v25, v26, v27
    v_exp_f32 v28, v28
    v_mfma_f32_16x16x32_bf16 a[72:75], a[232:235], v[16:19], a[72:75]
    v_exp_f32 v29, v29
    v_exp_f32 v30, v30
    v_mfma_f32_16x16x32_bf16 a[76:79], a[236:239], v[16:19], a[76:79]
    v_exp_f32 v31, v31
    v_cvt_pk_bf16_f32 v26, v28, v29
    v_mfma_f32_16x16x32_bf16 a[80:83], a[240:243], v[16:19], a[80:83]
    v_cvt_pk_bf16_f32 v27, v30, v31
    v_rcp_f32 v240, v60
    v_mfma_f32_16x16x32_bf16 a[84:87], a[244:247], v[16:19], a[84:87]
    s_add_u32 s66, s67, 0
    v_mov_b32 v241, v240
    v_mfma_f32_16x16x32_bf16 a[88:91], a[248:251], v[16:19], a[88:91]
    v_accvgpr_read_b32 v40, a0
    v_accvgpr_read_b32 v41, a1
    v_mfma_f32_16x16x32_bf16 a[92:95], a[252:255], v[16:19], a[92:95]
    v_accvgpr_read_b32 v42, a2
    v_mfma_f32_16x16x32_bf16 v[68:71], v[228:231], v[16:19], v[68:71]
    v_mfma_f32_16x16x32_bf16 a[96:99], a[224:227], v[24:27], a[96:99]
    v_accvgpr_read_b32 v43, a3
    v_accvgpr_read_b32 v44, a4
    v_accvgpr_read_b32 v45, a5
    v_accvgpr_read_b32 v46, a6
    v_accvgpr_read_b32 v47, a7
    v_mfma_f32_16x16x32_bf16 a[100:103], a[228:231], v[24:27], a[100:103]
    v_mul_f32 v40, v40, v240
    v_mul_f32 v41, v41, v240
    v_mul_f32 v42, v42, v240
    v_mul_f32 v43, v43, v240
    v_mul_f32 v44, v44, v240
    v_mfma_f32_16x16x32_bf16 a[104:107], a[232:235], v[24:27], a[104:107]
    v_mul_f32 v45, v45, v240
    v_mul_f32 v46, v46, v240
    v_mul_f32 v47, v47, v240
    v_cvt_pk_bf16_f32 v40, v40, v41
    v_cvt_pk_bf16_f32 v41, v42, v43
    v_mfma_f32_16x16x32_bf16 a[108:111], a[236:239], v[24:27], a[108:111]
    v_cvt_pk_bf16_f32 v42, v44, v45
    v_cvt_pk_bf16_f32 v43, v46, v47
    buffer_store_dwordx4 v[40:43], v233, s[28:31], s66 offen offset:0
    v_accvgpr_read_b32 v48, a8
    v_accvgpr_read_b32 v49, a9
    v_mfma_f32_16x16x32_bf16 a[112:115], a[240:243], v[24:27], a[112:115]
    v_accvgpr_read_b32 v50, a10
    v_accvgpr_read_b32 v51, a11
    v_accvgpr_read_b32 v52, a12
    v_accvgpr_read_b32 v53, a13
    v_accvgpr_read_b32 v54, a14
    v_mfma_f32_16x16x32_bf16 a[116:119], a[244:247], v[24:27], a[116:119]
    v_accvgpr_read_b32 v55, a15
    v_mul_f32 v48, v48, v240
    v_mul_f32 v49, v49, v240
    v_mul_f32 v50, v50, v240
    v_mul_f32 v51, v51, v240
    v_mfma_f32_16x16x32_bf16 a[120:123], a[248:251], v[24:27], a[120:123]
    v_mul_f32 v52, v52, v240
    v_mul_f32 v53, v53, v240
    v_mul_f32 v54, v54, v240
    v_mul_f32 v55, v55, v240
    v_cvt_pk_bf16_f32 v48, v48, v49
    v_mfma_f32_16x16x32_bf16 a[124:127], a[252:255], v[24:27], a[124:127]
    v_cvt_pk_bf16_f32 v49, v50, v51
    v_cvt_pk_bf16_f32 v50, v52, v53
    v_cvt_pk_bf16_f32 v51, v54, v55
    buffer_store_dwordx4 v[48:51], v233, s[28:31], s66 offen offset:1024
    v_mfma_f32_16x16x32_bf16 v[72:75], v[228:231], v[24:27], v[72:75]
    v_accvgpr_read_b32 v40, a16
    v_accvgpr_read_b32 v41, a17
    v_accvgpr_read_b32 v42, a18
    v_accvgpr_read_b32 v43, a19
    v_accvgpr_read_b32 v44, a20
    v_accvgpr_read_b32 v45, a21
    v_accvgpr_read_b32 v46, a22
    v_accvgpr_read_b32 v47, a23
    v_pk_mul_f32 v[40:41], v[40:41], v[240:241]
    v_pk_mul_f32 v[42:43], v[42:43], v[240:241]
    v_pk_mul_f32 v[44:45], v[44:45], v[240:241]
    v_pk_mul_f32 v[46:47], v[46:47], v[240:241]
    v_cvt_pk_bf16_f32 v40, v40, v41
    v_cvt_pk_bf16_f32 v41, v42, v43
    v_cvt_pk_bf16_f32 v42, v44, v45
    v_cvt_pk_bf16_f32 v43, v46, v47
    buffer_store_dwordx4 v[40:43], v233, s[28:31], s66 offen offset:2048
    v_accvgpr_read_b32 v48, a24
    v_accvgpr_read_b32 v49, a25
    v_accvgpr_read_b32 v50, a26
    v_accvgpr_read_b32 v51, a27
    v_accvgpr_read_b32 v52, a28
    v_accvgpr_read_b32 v53, a29
    v_accvgpr_read_b32 v54, a30
    v_accvgpr_read_b32 v55, a31
    v_pk_mul_f32 v[48:49], v[48:49], v[240:241]
    v_pk_mul_f32 v[50:51], v[50:51], v[240:241]
    v_pk_mul_f32 v[52:53], v[52:53], v[240:241]
    v_pk_mul_f32 v[54:55], v[54:55], v[240:241]
    v_cvt_pk_bf16_f32 v48, v48, v49
    v_cvt_pk_bf16_f32 v49, v50, v51
    v_cvt_pk_bf16_f32 v50, v52, v53
    v_cvt_pk_bf16_f32 v51, v54, v55
    buffer_store_dwordx4 v[48:51], v233, s[28:31], s66 offen offset:3072
    v_rcp_f32 v240, v64
    s_add_u32 s66, s67, 131072
    v_mov_b32 v241, v240
    v_accvgpr_read_b32 v40, a32
    v_accvgpr_read_b32 v41, a33
    v_accvgpr_read_b32 v42, a34
    v_accvgpr_read_b32 v43, a35
    v_accvgpr_read_b32 v44, a36
    v_accvgpr_read_b32 v45, a37
    v_accvgpr_read_b32 v46, a38
    v_accvgpr_read_b32 v47, a39
    v_pk_mul_f32 v[40:41], v[40:41], v[240:241]
    v_pk_mul_f32 v[42:43], v[42:43], v[240:241]
    v_pk_mul_f32 v[44:45], v[44:45], v[240:241]
    v_pk_mul_f32 v[46:47], v[46:47], v[240:241]
    v_cvt_pk_bf16_f32 v40, v40, v41
    v_cvt_pk_bf16_f32 v41, v42, v43
    v_cvt_pk_bf16_f32 v42, v44, v45
    v_cvt_pk_bf16_f32 v43, v46, v47
    buffer_store_dwordx4 v[40:43], v233, s[28:31], s66 offen offset:0
    v_accvgpr_read_b32 v48, a40
    v_accvgpr_read_b32 v49, a41
    v_accvgpr_read_b32 v50, a42
    v_accvgpr_read_b32 v51, a43
    v_accvgpr_read_b32 v52, a44
    v_accvgpr_read_b32 v53, a45
    v_accvgpr_read_b32 v54, a46
    v_accvgpr_read_b32 v55, a47
    v_pk_mul_f32 v[48:49], v[48:49], v[240:241]
    v_pk_mul_f32 v[50:51], v[50:51], v[240:241]
    v_pk_mul_f32 v[52:53], v[52:53], v[240:241]
    v_pk_mul_f32 v[54:55], v[54:55], v[240:241]
    v_cvt_pk_bf16_f32 v48, v48, v49
    v_cvt_pk_bf16_f32 v49, v50, v51
    v_cvt_pk_bf16_f32 v50, v52, v53
    v_cvt_pk_bf16_f32 v51, v54, v55
    buffer_store_dwordx4 v[48:51], v233, s[28:31], s66 offen offset:1024
    v_accvgpr_read_b32 v40, a48
    v_accvgpr_read_b32 v41, a49
    v_accvgpr_read_b32 v42, a50
    v_accvgpr_read_b32 v43, a51
    v_accvgpr_read_b32 v44, a52
    v_accvgpr_read_b32 v45, a53
    v_accvgpr_read_b32 v46, a54
    v_accvgpr_read_b32 v47, a55
    v_pk_mul_f32 v[40:41], v[40:41], v[240:241]
    v_pk_mul_f32 v[42:43], v[42:43], v[240:241]
    v_pk_mul_f32 v[44:45], v[44:45], v[240:241]
    v_pk_mul_f32 v[46:47], v[46:47], v[240:241]
    v_cvt_pk_bf16_f32 v40, v40, v41
    v_cvt_pk_bf16_f32 v41, v42, v43
    v_cvt_pk_bf16_f32 v42, v44, v45
    v_cvt_pk_bf16_f32 v43, v46, v47
    buffer_store_dwordx4 v[40:43], v233, s[28:31], s66 offen offset:2048
    v_accvgpr_read_b32 v48, a56
    v_accvgpr_read_b32 v49, a57
    v_accvgpr_read_b32 v50, a58
    v_accvgpr_read_b32 v51, a59
    v_accvgpr_read_b32 v52, a60
    v_accvgpr_read_b32 v53, a61
    v_accvgpr_read_b32 v54, a62
    v_accvgpr_read_b32 v55, a63
    v_pk_mul_f32 v[48:49], v[48:49], v[240:241]
    v_pk_mul_f32 v[50:51], v[50:51], v[240:241]
    v_pk_mul_f32 v[52:53], v[52:53], v[240:241]
    v_pk_mul_f32 v[54:55], v[54:55], v[240:241]
    v_cvt_pk_bf16_f32 v48, v48, v49
    v_cvt_pk_bf16_f32 v49, v50, v51
    v_cvt_pk_bf16_f32 v50, v52, v53
    v_cvt_pk_bf16_f32 v51, v54, v55
    buffer_store_dwordx4 v[48:51], v233, s[28:31], s66 offen offset:3072
    v_add_f32 v246, v60, v64
    v_add_f32 v247, v68, v72
    v_mov_b32 v244, v56
    v_mov_b32 v245, v76
    v_add_f32 v246, v246, v247
    s_lshl_b32 s60, s36, 10
    s_add_u32 s60, s60, s74
    v_add_f32 v246, v246, v76
    v_add_u32 v242, s60, v233
    s_add_u32 s60, s47, s74
    v_add_u32 v243, s60, v233
    s_waitcnt lgkmcnt(0)
    s_barrier
    ds_write_b128 v242, v[244:247]
    ds_write_b128 v243, a[144:147] offset:4096
    ds_write_b128 v243, a[148:151] offset:5120
    ds_write_b128 v243, a[152:155] offset:6144
    ds_write_b128 v243, a[156:159] offset:7168
    v_rcp_f32 v240, v68
    s_add_u32 s66, s67, 262144
    v_mov_b32 v241, v240
    v_accvgpr_read_b32 v40, a64
    v_accvgpr_read_b32 v41, a65
    v_accvgpr_read_b32 v42, a66
    v_accvgpr_read_b32 v43, a67
    v_accvgpr_read_b32 v44, a68
    v_accvgpr_read_b32 v45, a69
    v_accvgpr_read_b32 v46, a70
    v_accvgpr_read_b32 v47, a71
    v_pk_mul_f32 v[40:41], v[40:41], v[240:241]
    v_pk_mul_f32 v[42:43], v[42:43], v[240:241]
    v_pk_mul_f32 v[44:45], v[44:45], v[240:241]
    v_pk_mul_f32 v[46:47], v[46:47], v[240:241]
    v_cvt_pk_bf16_f32 v40, v40, v41
    v_cvt_pk_bf16_f32 v41, v42, v43
    v_cvt_pk_bf16_f32 v42, v44, v45
    v_cvt_pk_bf16_f32 v43, v46, v47
    buffer_store_dwordx4 v[40:43], v233, s[28:31], s66 offen offset:0
    v_accvgpr_read_b32 v48, a72
    v_accvgpr_read_b32 v49, a73
    v_accvgpr_read_b32 v50, a74
    v_accvgpr_read_b32 v51, a75
    v_accvgpr_read_b32 v52, a76
    v_accvgpr_read_b32 v53, a77
    v_accvgpr_read_b32 v54, a78
    v_accvgpr_read_b32 v55, a79
    v_pk_mul_f32 v[48:49], v[48:49], v[240:241]
    v_pk_mul_f32 v[50:51], v[50:51], v[240:241]
    v_pk_mul_f32 v[52:53], v[52:53], v[240:241]
    v_pk_mul_f32 v[54:55], v[54:55], v[240:241]
    v_cvt_pk_bf16_f32 v48, v48, v49
    v_cvt_pk_bf16_f32 v49, v50, v51
    v_cvt_pk_bf16_f32 v50, v52, v53
    v_cvt_pk_bf16_f32 v51, v54, v55
    buffer_store_dwordx4 v[48:51], v233, s[28:31], s66 offen offset:1024
    v_accvgpr_read_b32 v40, a80
    v_accvgpr_read_b32 v41, a81
    v_accvgpr_read_b32 v42, a82
    v_accvgpr_read_b32 v43, a83
    v_accvgpr_read_b32 v44, a84
    v_accvgpr_read_b32 v45, a85
    v_accvgpr_read_b32 v46, a86
    v_accvgpr_read_b32 v47, a87
    v_pk_mul_f32 v[40:41], v[40:41], v[240:241]
    v_pk_mul_f32 v[42:43], v[42:43], v[240:241]
    v_pk_mul_f32 v[44:45], v[44:45], v[240:241]
    v_pk_mul_f32 v[46:47], v[46:47], v[240:241]
    v_cvt_pk_bf16_f32 v40, v40, v41
    v_cvt_pk_bf16_f32 v41, v42, v43
    v_cvt_pk_bf16_f32 v42, v44, v45
    v_cvt_pk_bf16_f32 v43, v46, v47
    buffer_store_dwordx4 v[40:43], v233, s[28:31], s66 offen offset:2048
    v_accvgpr_read_b32 v48, a88
    v_accvgpr_read_b32 v49, a89
    v_accvgpr_read_b32 v50, a90
    v_accvgpr_read_b32 v51, a91
    v_accvgpr_read_b32 v52, a92
    v_accvgpr_read_b32 v53, a93
    v_accvgpr_read_b32 v54, a94
    v_accvgpr_read_b32 v55, a95
    v_pk_mul_f32 v[48:49], v[48:49], v[240:241]
    v_pk_mul_f32 v[50:51], v[50:51], v[240:241]
    v_pk_mul_f32 v[52:53], v[52:53], v[240:241]
    v_pk_mul_f32 v[54:55], v[54:55], v[240:241]
    v_cvt_pk_bf16_f32 v48, v48, v49
    v_cvt_pk_bf16_f32 v49, v50, v51
    v_cvt_pk_bf16_f32 v50, v52, v53
    v_cvt_pk_bf16_f32 v51, v54, v55
    buffer_store_dwordx4 v[48:51], v233, s[28:31], s66 offen offset:3072
    v_xor_b32 v243, 4096, v243
    v_xor_b32 v242, 1024, v242
    s_waitcnt lgkmcnt(0)
    s_barrier
    ds_read_b128 v[248:251], v242
    v_xor_b32 v242, 2048, v242
    ds_read_b32 v0, v242 offset:8
    v_xor_b32 v242, 1024, v242
    ds_read_b32 v1, v242 offset:8
    ds_read_b128 v[8:11], v243 offset:4096
    ds_read_b128 v[12:15], v243 offset:5120
    ds_read_b128 v[16:19], v243 offset:6144
    ds_read_b128 v[20:23], v243 offset:7168
    v_rcp_f32 v240, v72
    s_add_u32 s66, s67, 393216
    v_mov_b32 v241, v240
    v_accvgpr_read_b32 v40, a96
    v_accvgpr_read_b32 v41, a97
    v_accvgpr_read_b32 v42, a98
    v_accvgpr_read_b32 v43, a99
    v_accvgpr_read_b32 v44, a100
    v_accvgpr_read_b32 v45, a101
    v_accvgpr_read_b32 v46, a102
    v_accvgpr_read_b32 v47, a103
    v_pk_mul_f32 v[40:41], v[40:41], v[240:241]
    v_pk_mul_f32 v[42:43], v[42:43], v[240:241]
    v_pk_mul_f32 v[44:45], v[44:45], v[240:241]
    v_pk_mul_f32 v[46:47], v[46:47], v[240:241]
    v_accvgpr_read_b32 v48, a104
    v_accvgpr_read_b32 v49, a105
    v_accvgpr_read_b32 v50, a106
    v_accvgpr_read_b32 v51, a107
    v_accvgpr_read_b32 v52, a108
    v_accvgpr_read_b32 v53, a109
    v_accvgpr_read_b32 v54, a110
    v_accvgpr_read_b32 v55, a111
    v_pk_mul_f32 v[48:49], v[48:49], v[240:241]
    v_pk_mul_f32 v[50:51], v[50:51], v[240:241]
    v_pk_mul_f32 v[52:53], v[52:53], v[240:241]
    v_pk_mul_f32 v[54:55], v[54:55], v[240:241]
    s_waitcnt lgkmcnt(4)
    v_add_f32 v0, v0, v1
    v_add_f32 v1, v246, v250
    v_add_f32 v0, v0, v1
    v_cmp_nge_f32 vcc, s43, v0
    s_cbranch_vccnz A0h1_redo
A0h1_ok:
    v_min_f32 v0, v244, v248
    v_sub_f32 v244, v0, v244
    v_sub_f32 v248, v0, v248
    v_exp_f32 v244, v244
    v_exp_f32 v248, v248
    s_nop 0
    v_mul_f32 v0, v244, v245
    v_fmac_f32 v0, v248, v249
    v_rcp_f32 v0, v0
    s_nop 0
    v_mul_f32 v244, v244, v0
    v_mul_f32 v248, v248, v0
    v_mov_b32 v245, v244
    v_mov_b32 v249, v248
    v_accvgpr_read_b32 v24, a128
    v_accvgpr_read_b32 v25, a129
    v_accvgpr_read_b32 v26, a130
    v_accvgpr_read_b32 v27, a131
    v_accvgpr_read_b32 v28, a132
    v_accvgpr_read_b32 v29, a133
    v_accvgpr_read_b32 v30, a134
    v_accvgpr_read_b32 v31, a135
    v_accvgpr_read_b32 v32, a136
    v_accvgpr_read_b32 v33, a137
    v_accvgpr_read_b32 v34, a138
    v_accvgpr_read_b32 v35, a139
    v_accvgpr_read_b32 v36, a140
    v_accvgpr_read_b32 v37, a141
    v_accvgpr_read_b32 v38, a142
    v_accvgpr_read_b32 v39, a143
    v_pk_mul_f32 v[24:25], v[24:25], v[244:245]
    v_pk_mul_f32 v[26:27], v[26:27], v[244:245]
    v_pk_mul_f32 v[28:29], v[28:29], v[244:245]
    v_pk_mul_f32 v[30:31], v[30:31], v[244:245]
    v_pk_mul_f32 v[32:33], v[32:33], v[244:245]
    v_pk_mul_f32 v[34:35], v[34:35], v[244:245]
    v_pk_mul_f32 v[36:37], v[36:37], v[244:245]
    v_pk_mul_f32 v[38:39], v[38:39], v[244:245]
    s_waitcnt lgkmcnt(0)
    v_pk_fma_f32 v[24:25], v[8:9], v[248:249], v[24:25]
    v_pk_fma_f32 v[26:27], v[10:11], v[248:249], v[26:27]
    v_pk_fma_f32 v[28:29], v[12:13], v[248:249], v[28:29]
    v_pk_fma_f32 v[30:31], v[14:15], v[248:249], v[30:31]
    v_pk_fma_f32 v[32:33], v[16:17], v[248:249], v[32:33]
    v_pk_fma_f32 v[34:35], v[18:19], v[248:249], v[34:35]
    v_pk_fma_f32 v[36:37], v[20:21], v[248:249], v[36:37]
    v_pk_fma_f32 v[38:39], v[22:23], v[248:249], v[38:39]
    v_cvt_pk_bf16_f32 v24, v24, v25
    v_cvt_pk_bf16_f32 v25, v26, v27
    v_cvt_pk_bf16_f32 v26, v28, v29
    v_cvt_pk_bf16_f32 v27, v30, v31
    v_cvt_pk_bf16_f32 v28, v32, v33
    v_cvt_pk_bf16_f32 v29, v34, v35
    v_cvt_pk_bf16_f32 v30, v36, v37
    v_cvt_pk_bf16_f32 v31, v38, v39
    s_lshr_b32 s60, s36, 1
    s_lshl_b32 s60, s60, 17
    s_add_u32 s60, s60, s70
    s_add_u32 s60, s60, 2101248
    buffer_store_dwordx4 v[24:27], v233, s[28:31], s60 offen offset:0
    buffer_store_dwordx4 v[28:31], v233, s[28:31], s60 offen offset:1024
    v_cvt_pk_bf16_f32 v40, v40, v41
    v_cvt_pk_bf16_f32 v41, v42, v43
    v_cvt_pk_bf16_f32 v42, v44, v45
    v_cvt_pk_bf16_f32 v43, v46, v47
    buffer_store_dwordx4 v[40:43], v233, s[28:31], s66 offen offset:0
    v_cvt_pk_bf16_f32 v48, v48, v49
    v_cvt_pk_bf16_f32 v49, v50, v51
    v_cvt_pk_bf16_f32 v50, v52, v53
    v_cvt_pk_bf16_f32 v51, v54, v55
    buffer_store_dwordx4 v[48:51], v233, s[28:31], s66 offen offset:1024
    v_accvgpr_read_b32 v40, a112
    v_accvgpr_read_b32 v41, a113
    v_accvgpr_read_b32 v42, a114
    v_accvgpr_read_b32 v43, a115
    v_accvgpr_read_b32 v44, a116
    v_accvgpr_read_b32 v45, a117
    v_accvgpr_read_b32 v46, a118
    v_accvgpr_read_b32 v47, a119
    v_pk_mul_f32 v[40:41], v[40:41], v[240:241]
    v_pk_mul_f32 v[42:43], v[42:43], v[240:241]
    v_pk_mul_f32 v[44:45], v[44:45], v[240:241]
    v_pk_mul_f32 v[46:47], v[46:47], v[240:241]
    v_cvt_pk_bf16_f32 v40, v40, v41
    v_cvt_pk_bf16_f32 v41, v42, v43
    v_cvt_pk_bf16_f32 v42, v44, v45
    v_cvt_pk_bf16_f32 v43, v46, v47
    buffer_store_dwordx4 v[40:43], v233, s[28:31], s66 offen offset:2048
    v_accvgpr_read_b32 v48, a120
    v_accvgpr_read_b32 v49, a121
    v_accvgpr_read_b32 v50, a122
    v_accvgpr_read_b32 v51, a123
    v_accvgpr_read_b32 v52, a124
    v_accvgpr_read_b32 v53, a125
    v_accvgpr_read_b32 v54, a126
    v_accvgpr_read_b32 v55, a127
    v_pk_mul_f32 v[48:49], v[48:49], v[240:241]
    v_pk_mul_f32 v[50:51], v[50:51], v[240:241]
    v_pk_mul_f32 v[52:53], v[52:53], v[240:241]
    v_pk_mul_f32 v[54:55], v[54:55], v[240:241]
    v_cvt_pk_bf16_f32 v48, v48, v49
    v_cvt_pk_bf16_f32 v49, v50, v51
    v_cvt_pk_bf16_f32 v50, v52, v53
    v_cvt_pk_bf16_f32 v51, v54, v55
    buffer_store_dwordx4 v[48:51], v233, s[28:31], s66 offen offset:3072
    s_and_b32 s61, s50, 1
    s_lshl_b32 s61, s61, 2
    s_or_b32 s61, s61, s36
    s_lshl_b32 s61, s61, 5
    s_add_u32 s60, s81, 131072
    v_add_u32 v212, s60, v235
    v_xor_b32 v212, s61, v212
    v_xor_b32 v213, 32, v212
    v_xor_b32 v214, 64, v212
    v_xor_b32 v215, 96, v212
    v_xor_b32 v216, 128, v212
    v_xor_b32 v217, 160, v212
    v_xor_b32 v218, 192, v212
    v_xor_b32 v219, 224, v212
    s_cmp_lg_u32 s40, 0
    s_cbranch_scc1 OP_slow
    s_waitcnt vmcnt(18)
    s_branch OP_main
A0h1_redo:
    s_cmp_lg_u32 s41, 1
    s_cbranch_scc1 A0h1_ok
    s_mov_b32 s41, 2
    s_branch MP1
A0h1_enter:
    v_mov_b32 v16, 0
    v_mov_b32 v17, 0
    v_mov_b32 v18, 0
    v_mov_b32 v19, 0
    v_mov_b32 v20, 0
    v_mov_b32 v21, 0
    v_mov_b32 v22, 0
    v_mov_b32 v23, 0
    v_mov_b32 v24, 0
    v_mov_b32 v25, 0
    v_mov_b32 v26, 0
    v_mov_b32 v27, 0xff800000
    v_mov_b32 v28, 0xff800000
    v_mov_b32 v29, 0xff800000
    v_mov_b32 v30, 0xff800000
    v_mov_b32 v31, 0xff800000
    s_mov_b32 s39, 16
    s_mov_b32 s2, 3
    s_branch A0h1_loop
A1h1_head:
    s_mov_b32 s39, 16
    s_mov_b32 s2, 7
    s_waitcnt lgkmcnt(0)
    v_mfma_f32_16x16x32_bf16 v[0:3], a[192:195], v[160:163], 0
    v_exp_f32 v38, v38
    v_mfma_f32_16x16x32_bf16 v[0:3], a[196:199], v[164:167], v[0:3]
    v_exp_f32 v39, v39
    v_mfma_f32_16x16x32_bf16 v[0:3], a[200:203], v[168:171], v[0:3]
    v_cvt_pk_bf16_f32 v34, v36, v37
    v_cvt_pk_bf16_f32 v35, v38, v39
    v_mfma_f32_16x16x32_bf16 v[0:3], a[204:207], v[172:175], v[0:3]
    v_mov_b32 v152, v56
    v_mfma_f32_16x16x32_bf16 v[4:7], a[208:211], v[160:163], 0
    s_lshl_b32 s60, s36, 10
    s_add_u32 s60, s60, 139264
    v_add_u32 v237, s60, v233
    v_mfma_f32_16x16x32_bf16 v[4:7], a[212:215], v[164:167], v[4:7]
    s_add_u32 s60, s47, 139264
    v_add_u32 v223, s60, v233
    v_mfma_f32_16x16x32_bf16 v[4:7], a[216:219], v[168:171], v[4:7]
    v_mfma_f32_16x16x32_bf16 v[4:7], a[220:223], v[172:175], v[4:7]
    v_mfma_f32_16x16x32_bf16 a[96:99], a[224:227], v[24:27], a[96:99]
    v_mfma_f32_16x16x32_bf16 a[100:103], a[228:231], v[24:27], a[100:103]
    v_mfma_f32_16x16x32_bf16 a[104:107], a[232:235], v[24:27], a[104:107]
    s_waitcnt vmcnt(9) lgkmcnt(0)
    s_barrier
    v_mfma_f32_16x16x32_bf16 a[108:111], a[236:239], v[24:27], a[108:111]
    s_add_u32 s38, s74, s3
    s_add_u32 m0, s3, 65536
    s_xor_b32 s87, s85, s86
    v_max3_f32 v240, v0, v1, v2
    v_mfma_f32_16x16x32_bf16 a[112:115], a[240:243], v[24:27], a[112:115]
    s_add_u32 s85, s85, 4096
    s_add_u32 s74, s74, s44
    v_max3_f32 v241, v3, v4, v5
    v_max3_f32 v240, v240, v6, v7
    v_mfma_f32_16x16x32_bf16 a[116:119], a[244:247], v[24:27], a[116:119]
    buffer_load_dwordx4 v220, s[20:23], s87 offen nt lds
    v_max_f32 v240, v240, v241
    v_mfma_f32_16x16x32_bf16 a[120:123], a[248:251], v[24:27], a[120:123]
    s_add_u32 m0, s3, 69632
    s_xor_b32 s87, s85, s86
    s_add_u32 s85, s85, 4096
    v_rcp_f32 v244, v60
    v_rcp_f32 v245, v60
    v_mfma_f32_16x16x32_bf16 a[124:127], a[252:255], v[24:27], a[124:127]
    s_cmp_eq_u32 s74, 0x18000
    s_cselect_b32 s44, s45, s46
    v_mov_b32 v241, v240
    s_nop 1
    v_permlane32_swap_b32 v240, v241
    v_max_f32 v240, v240, v241
    v_mfma_f32_16x16x32_bf16 v[72:75], v[228:231], v[24:27], v[72:75]
    v_mov_b32 v241, v240
    s_nop 1
    v_permlane16_swap_b32 v240, v241
    v_max_f32 v240, v240, v241
    v_mfma_f32_16x16x32_bf16 v[8:11], a[192:195], v[176:179], 0
    v_sub_f32 v0, v0, v240
    v_sub_f32 v1, v1, v240
    v_sub_f32 v2, v2, v240
    v_accvgpr_read_b32 v246, a0
    v_accvgpr_read_b32 v247, a1
    v_accvgpr_read_b32 v248, a2
    v_accvgpr_read_b32 v249, a3
    v_accvgpr_read_b32 v250, a4
    v_accvgpr_read_b32 v251, a5
    v_accvgpr_read_b32 v252, a6
    v_accvgpr_read_b32 v253, a7
    v_pk_mul_f32 v[246:247], v[246:247], v[244:245]
    v_pk_mul_f32 v[248:249], v[248:249], v[244:245]
    v_pk_mul_f32 v[250:251], v[250:251], v[244:245]
    v_pk_mul_f32 v[252:253], v[252:253], v[244:245]
    v_mfma_f32_16x16x32_bf16 v[8:11], a[196:199], v[180:183], v[8:11]
    v_sub_f32 v3, v3, v240
    v_sub_f32 v4, v4, v240
    v_sub_f32 v5, v5, v240
    v_cvt_pk_bf16_f32 v80, v246, v247
    v_cvt_pk_bf16_f32 v81, v248, v249
    v_mfma_f32_16x16x32_bf16 v[8:11], a[200:203], v[184:187], v[8:11]
    buffer_load_dwordx4 v220, s[20:23], s87 offen nt lds
    v_sub_f32 v6, v6, v240
    v_cvt_pk_bf16_f32 v82, v250, v251
    v_cvt_pk_bf16_f32 v83, v252, v253
    v_mfma_f32_16x16x32_bf16 v[8:11], a[204:207], v[188:191], v[8:11]
    s_add_u32 m0, s3, 73728
    s_xor_b32 s87, s85, s86
    s_add_u32 s85, s85, 4096
    v_sub_f32 v7, v7, v240
    v_accvgpr_read_b32 v246, a8
    v_accvgpr_read_b32 v247, a9
    v_accvgpr_read_b32 v248, a10
    v_accvgpr_read_b32 v249, a11
    v_accvgpr_read_b32 v250, a12
    v_accvgpr_read_b32 v251, a13
    v_accvgpr_read_b32 v252, a14
    v_accvgpr_read_b32 v253, a15
    v_pk_mul_f32 v[246:247], v[246:247], v[244:245]
    v_pk_mul_f32 v[248:249], v[248:249], v[244:245]
    v_pk_mul_f32 v[250:251], v[250:251], v[244:245]
    v_pk_mul_f32 v[252:253], v[252:253], v[244:245]
    v_mfma_f32_16x16x32_bf16 v[12:15], a[208:211], v[176:179], 0
    v_sub_f32 v40, 0, v240
    v_sub_f32 v41, 0, v240
    v_sub_f32 v42, 0, v240
    v_cvt_pk_bf16_f32 v84, v246, v247
    v_cvt_pk_bf16_f32 v85, v248, v249
    v_mfma_f32_16x16x32_bf16 v[12:15], a[212:215], v[180:183], v[12:15]
    v_sub_f32 v43, 0, v240
    v_exp_f32 v0, v0
    v_cvt_pk_bf16_f32 v86, v250, v251
    v_cvt_pk_bf16_f32 v87, v252, v253
    v_mfma_f32_16x16x32_bf16 v[12:15], a[216:219], v[184:187], v[12:15]
    v_exp_f32 v1, v1
    v_accvgpr_read_b32 v246, a16
    v_accvgpr_read_b32 v247, a17
    v_accvgpr_read_b32 v248, a18
    v_accvgpr_read_b32 v249, a19
    v_accvgpr_read_b32 v250, a20
    v_accvgpr_read_b32 v251, a21
    v_accvgpr_read_b32 v252, a22
    v_accvgpr_read_b32 v253, a23
    v_pk_mul_f32 v[246:247], v[246:247], v[244:245]
    v_pk_mul_f32 v[248:249], v[248:249], v[244:245]
    v_pk_mul_f32 v[250:251], v[250:251], v[244:245]
    v_pk_mul_f32 v[252:253], v[252:253], v[244:245]
    v_mfma_f32_16x16x32_bf16 v[12:15], a[220:223], v[188:191], v[12:15]
    v_exp_f32 v2, v2
    v_cvt_pk_bf16_f32 v88, v246, v247
    v_cvt_pk_bf16_f32 v89, v248, v249
    v_cvt_pk_bf16_f32 v90, v250, v251
    v_cvt_pk_bf16_f32 v91, v252, v253
    v_mfma_f32_16x16x32_bf16 a[128:131], a[224:227], v[32:35], a[128:131]
    ds_read_b64_tr_b16 a[224:225], v212 offset:16384
    ds_read_b64_tr_b16 a[226:227], v212 offset:20480
    v_accvgpr_read_b32 v246, a24
    v_accvgpr_read_b32 v247, a25
    v_accvgpr_read_b32 v248, a26
    v_accvgpr_read_b32 v249, a27
    v_accvgpr_read_b32 v250, a28
    v_accvgpr_read_b32 v251, a29
    v_accvgpr_read_b32 v252, a30
    v_accvgpr_read_b32 v253, a31
    v_pk_mul_f32 v[246:247], v[246:247], v[244:245]
    v_pk_mul_f32 v[248:249], v[248:249], v[244:245]
    v_pk_mul_f32 v[250:251], v[250:251], v[244:245]
    v_pk_mul_f32 v[252:253], v[252:253], v[244:245]
    v_mfma_f32_16x16x32_bf16 a[132:135], a[228:231], v[32:35], a[132:135]
    v_exp_f32 v3, v3
    v_cvt_pk_bf16_f32 v0, v0, v1
    v_cvt_pk_bf16_f32 v92, v246, v247
    v_cvt_pk_bf16_f32 v93, v248, v249
    v_mfma_f32_16x16x32_bf16 a[136:139], a[232:235], v[32:35], a[136:139]
    ds_read_b64_tr_b16 a[228:229], v213 offset:16384
    ds_read_b64_tr_b16 a[230:231], v213 offset:20480
    v_cvt_pk_bf16_f32 v1, v2, v3
    v_max3_f32 v242, v8, v9, v10
    v_cvt_pk_bf16_f32 v94, v250, v251
    v_cvt_pk_bf16_f32 v95, v252, v253
    v_mfma_f32_16x16x32_bf16 a[140:143], a[236:239], v[32:35], a[140:143]
    buffer_load_dwordx4 v220, s[20:23], s87 offen nt lds
    v_max3_f32 v243, v11, v12, v13
    v_max3_f32 v242, v242, v14, v15
    v_mfma_f32_16x16x32_bf16 a[144:147], a[240:243], v[32:35], a[144:147]
    s_add_u32 m0, s3, 77824
    ds_read_b64_tr_b16 a[232:233], v214 offset:16384
    ds_read_b64_tr_b16 a[234:235], v214 offset:20480
    v_max_f32 v242, v242, v243
    v_rcp_f32 v244, v64
    v_rcp_f32 v245, v64
    v_mfma_f32_16x16x32_bf16 a[148:151], a[244:247], v[32:35], a[148:151]
    s_xor_b32 s87, s85, s86
    s_add_u32 s85, s85, 4096
    v_exp_f32 v4, v4
    v_accvgpr_read_b32 v246, a32
    v_accvgpr_read_b32 v247, a33
    v_accvgpr_read_b32 v248, a34
    v_accvgpr_read_b32 v249, a35
    v_accvgpr_read_b32 v250, a36
    v_accvgpr_read_b32 v251, a37
    v_accvgpr_read_b32 v252, a38
    v_accvgpr_read_b32 v253, a39
    v_pk_mul_f32 v[246:247], v[246:247], v[244:245]
    v_pk_mul_f32 v[248:249], v[248:249], v[244:245]
    v_pk_mul_f32 v[250:251], v[250:251], v[244:245]
    v_pk_mul_f32 v[252:253], v[252:253], v[244:245]
    v_mfma_f32_16x16x32_bf16 a[152:155], a[248:251], v[32:35], a[152:155]
    ds_read_b64_tr_b16 a[236:237], v215 offset:16384
    ds_read_b64_tr_b16 a[238:239], v215 offset:20480
    v_mov_b32 v243, v242
    s_nop 1
    v_permlane32_swap_b32 v242, v243
    v_max_f32 v242, v242, v243
    v_mfma_f32_16x16x32_bf16 a[156:159], a[252:255], v[32:35], a[156:159]
    v_exp_f32 v5, v5
    v_mov_b32 v243, v242
    s_nop 1
    v_permlane16_swap_b32 v242, v243
    v_max_f32 v242, v242, v243
    v_mfma_f32_16x16x32_bf16 v[76:79], v[228:231], v[32:35], v[76:79]
    ds_read_b64_tr_b16 a[240:241], v216 offset:16384
    ds_read_b64_tr_b16 a[242:243], v216 offset:20480
    v_sub_f32 v8, v8, v242
    v_sub_f32 v9, v9, v242
    v_cvt_pk_bf16_f32 v96, v246, v247
    v_cvt_pk_bf16_f32 v97, v248, v249
    v_mfma_f32_16x16x32_bf16 v[16:19], a[192:195], v[192:195], 0
    v_exp_f32 v6, v6
    v_sub_f32 v10, v10, v242
    v_sub_f32 v11, v11, v242
    v_cvt_pk_bf16_f32 v98, v250, v251
    v_cvt_pk_bf16_f32 v99, v252, v253
    v_mfma_f32_16x16x32_bf16 v[16:19], a[196:199], v[196:199], v[16:19]
    ds_read_b64_tr_b16 a[244:245], v217 offset:16384
    ds_read_b64_tr_b16 a[246:247], v217 offset:20480
    v_sub_f32 v12, v12, v242
    v_sub_f32 v13, v13, v242
    v_accvgpr_read_b32 v246, a40
    v_accvgpr_read_b32 v247, a41
    v_accvgpr_read_b32 v248, a42
    v_accvgpr_read_b32 v249, a43
    v_accvgpr_read_b32 v250, a44
    v_accvgpr_read_b32 v251, a45
    v_accvgpr_read_b32 v252, a46
    v_accvgpr_read_b32 v253, a47
    v_pk_mul_f32 v[246:247], v[246:247], v[244:245]
    v_pk_mul_f32 v[248:249], v[248:249], v[244:245]
    v_pk_mul_f32 v[250:251], v[250:251], v[244:245]
    v_pk_mul_f32 v[252:253], v[252:253], v[244:245]
    v_mfma_f32_16x16x32_bf16 v[16:19], a[200:203], v[200:203], v[16:19]
    buffer_load_dwordx4 v220, s[20:23], s87 offen nt lds
    v_sub_f32 v14, v14, v242
    v_sub_f32 v15, v15, v242
    v_cvt_pk_bf16_f32 v100, v246, v247
    v_cvt_pk_bf16_f32 v101, v248, v249
    v_mfma_f32_16x16x32_bf16 v[16:19], a[204:207], v[204:207], v[16:19]
    s_add_u32 m0, s3, 81920
    ds_read_b64_tr_b16 a[248:249], v218 offset:16384
    ds_read_b64_tr_b16 a[250:251], v218 offset:20480
    v_sub_f32 v44, 0, v242
    v_sub_f32 v45, 0, v242
    v_cvt_pk_bf16_f32 v102, v250, v251
    v_cvt_pk_bf16_f32 v103, v252, v253
    v_mfma_f32_16x16x32_bf16 v[20:23], a[208:211], v[192:195], 0
    s_xor_b32 s87, s37, s86
    s_add_u32 s37, s37, 4096
    v_exp_f32 v7, v7
    v_sub_f32 v46, 0, v242
    v_accvgpr_read_b32 v246, a48
    v_accvgpr_read_b32 v247, a49
    v_accvgpr_read_b32 v248, a50
    v_accvgpr_read_b32 v249, a51
    v_accvgpr_read_b32 v250, a52
    v_accvgpr_read_b32 v251, a53
    v_accvgpr_read_b32 v252, a54
    v_accvgpr_read_b32 v253, a55
    v_pk_mul_f32 v[246:247], v[246:247], v[244:245]
    v_pk_mul_f32 v[248:249], v[248:249], v[244:245]
    v_pk_mul_f32 v[250:251], v[250:251], v[244:245]
    v_pk_mul_f32 v[252:253], v[252:253], v[244:245]
    v_mfma_f32_16x16x32_bf16 v[20:23], a[212:215], v[196:199], v[20:23]
    ds_read_b64_tr_b16 a[252:253], v219 offset:16384
    ds_read_b64_tr_b16 a[254:255], v219 offset:20480
    v_cvt_pk_bf16_f32 v2, v4, v5
    v_sub_f32 v47, 0, v242
    v_cvt_pk_bf16_f32 v104, v246, v247
    v_cvt_pk_bf16_f32 v105, v248, v249
    v_mfma_f32_16x16x32_bf16 v[20:23], a[216:219], v[200:203], v[20:23]
    v_cvt_pk_bf16_f32 v3, v6, v7
    v_exp_f32 v8, v8
    v_add_f32 v154, v60, v64
    v_add_f32 v155, v68, v72
    v_cvt_pk_bf16_f32 v106, v250, v251
    v_cvt_pk_bf16_f32 v107, v252, v253
    v_mfma_f32_16x16x32_bf16 v[20:23], a[220:223], v[204:207], v[20:23]
    s_waitcnt lgkmcnt(6)
    v_exp_f32 v9, v9
    v_exp_f32 v10, v10
    v_accvgpr_read_b32 v246, a56
    v_accvgpr_read_b32 v247, a57
    v_accvgpr_read_b32 v248, a58
    v_accvgpr_read_b32 v249, a59
    v_accvgpr_read_b32 v250, a60
    v_accvgpr_read_b32 v251, a61
    v_accvgpr_read_b32 v252, a62
    v_accvgpr_read_b32 v253, a63
    v_pk_mul_f32 v[246:247], v[246:247], v[244:245]
    v_pk_mul_f32 v[248:249], v[248:249], v[244:245]
    v_pk_mul_f32 v[250:251], v[250:251], v[244:245]
    v_pk_mul_f32 v[252:253], v[252:253], v[244:245]
    v_mfma_f32_16x16x32_bf16 a[0:3], a[224:227], v[0:3], 0
    v_exp_f32 v11, v11
    v_cvt_pk_bf16_f32 v8, v8, v9
    v_cvt_pk_bf16_f32 v9, v10, v11
    v_cvt_pk_bf16_f32 v108, v246, v247
    v_cvt_pk_bf16_f32 v109, v248, v249
    v_mfma_f32_16x16x32_bf16 a[4:7], a[228:231], v[0:3], 0
    buffer_load_dwordx4 v224, s[24:27], s87 offen nt lds
    v_exp_f32 v12, v12
    v_cvt_pk_bf16_f32 v110, v250, v251
    v_cvt_pk_bf16_f32 v111, v252, v253
    v_mfma_f32_16x16x32_bf16 a[8:11], a[232:235], v[0:3], 0
    s_add_u32 m0, s3, 86016
    s_xor_b32 s87, s37, s86
    s_add_u32 s37, s37, 4096
    v_exp_f32 v13, v13
    v_mfma_f32_16x16x32_bf16 a[12:15], a[236:239], v[0:3], 0
    v_exp_f32 v14, v14
    v_exp_f32 v15, v15
    v_mfma_f32_16x16x32_bf16 a[16:19], a[240:243], v[0:3], 0
    s_waitcnt lgkmcnt(2)
    v_cvt_pk_bf16_f32 v10, v12, v13
    v_cvt_pk_bf16_f32 v11, v14, v15
    v_max3_f32 v240, v16, v17, v18
    v_mov_b32 v153, v76
    v_add_f32 v154, v154, v155
    v_mfma_f32_16x16x32_bf16 a[20:23], a[244:247], v[0:3], 0
    v_max3_f32 v241, v19, v20, v21
    v_max3_f32 v240, v240, v22, v23
    v_max_f32 v240, v240, v241
    v_add_f32 v154, v154, v76
    ds_write_b128 v237, v[152:155]
    v_mfma_f32_16x16x32_bf16 a[24:27], a[248:251], v[0:3], 0
    s_waitcnt lgkmcnt(1)
    v_mov_b32 v241, v240
    s_nop 1
    v_permlane32_swap_b32 v240, v241
    v_max_f32 v240, v240, v241
    v_mfma_f32_16x16x32_bf16 a[28:31], a[252:255], v[0:3], 0
    v_mov_b32 v241, v240
    s_nop 1
    v_permlane16_swap_b32 v240, v241
    v_max_f32 v240, v240, v241
    v_mfma_f32_16x16x32_bf16 v[60:63], v[228:231], v[0:3], 0
    v_sub_f32 v16, v16, v240
    v_sub_f32 v17, v17, v240
    v_sub_f32 v18, v18, v240
    ds_write_b128 v223, a[128:131] offset:4096
    ds_write_b128 v223, a[132:135] offset:5120
    v_mfma_f32_16x16x32_bf16 v[24:27], a[192:195], a[160:163], 0
    buffer_load_dwordx4 v224, s[24:27], s87 offen nt lds
    v_sub_f32 v19, v19, v240
    ds_write_b128 v223, a[136:139] offset:6144
    ds_write_b128 v223, a[140:143] offset:7168
    v_mfma_f32_16x16x32_bf16 v[24:27], a[196:199], a[164:167], v[24:27]
    s_add_u32 m0, s3, 90112
    ds_read_b128 a[192:195], v208 offset:0
    ds_read_b128 a[196:199], v209 offset:0
    v_sub_f32 v20, v20, v240
    v_xor_b32 v223, 4096, v223
    v_xor_b32 v237, 1024, v237
    v_mfma_f32_16x16x32_bf16 v[24:27], a[200:203], a[168:171], v[24:27]
    s_xor_b32 s87, s37, s86
    s_add_u32 s37, s37, 4096
    v_sub_f32 v21, v21, v240
    v_sub_f32 v22, v22, v240
    v_mfma_f32_16x16x32_bf16 v[24:27], a[204:207], a[172:175], v[24:27]
    ds_read_b128 a[200:203], v210 offset:0
    ds_read_b128 a[204:207], v211 offset:0
    v_sub_f32 v23, v23, v240
    v_mfma_f32_16x16x32_bf16 v[28:31], a[208:211], a[160:163], 0
    v_sub_f32 v48, 0, v240
    v_sub_f32 v49, 0, v240
    v_sub_f32 v50, 0, v240
    v_mfma_f32_16x16x32_bf16 v[28:31], a[212:215], a[164:167], v[28:31]
    ds_read_b128 a[208:211], v208 offset:4096
    ds_read_b128 a[212:215], v209 offset:4096
    v_sub_f32 v51, 0, v240
    v_mfma_f32_16x16x32_bf16 v[28:31], a[216:219], a[168:171], v[28:31]
    v_exp_f32 v16, v16
    v_mfma_f32_16x16x32_bf16 v[28:31], a[220:223], a[172:175], v[28:31]
    ds_read_b128 a[216:219], v210 offset:4096
    ds_read_b128 a[220:223], v211 offset:4096
    s_waitcnt lgkmcnt(8)
    s_barrier
    v_mfma_f32_16x16x32_bf16 a[32:35], a[224:227], v[8:11], 0
    buffer_load_dwordx4 v224, s[24:27], s87 offen nt lds
    ds_read_b128 v[156:159], v237
    v_xor_b32 v237, 2048, v237
    v_mfma_f32_16x16x32_bf16 a[36:39], a[228:231], v[8:11], 0
    s_add_u32 m0, s3, 94208
    s_xor_b32 s87, s37, s86
    s_add_u32 s37, s37, 4096
    ds_read_b32 v221, v237 offset:8
    v_xor_b32 v237, 1024, v237
    v_mfma_f32_16x16x32_bf16 a[40:43], a[232:235], v[8:11], 0
    v_exp_f32 v17, v17
    v_max3_f32 v242, v24, v25, v26
    ds_read_b32 v222, v237 offset:8
    v_mfma_f32_16x16x32_bf16 a[44:47], a[236:239], v[8:11], 0
    v_exp_f32 v18, v18
    v_max3_f32 v243, v27, v28, v29
    ds_read_b128 v[144:147], v223 offset:4096
    v_mfma_f32_16x16x32_bf16 a[48:51], a[240:243], v[8:11], 0
    v_exp_f32 v19, v19
    v_cvt_pk_bf16_f32 v16, v16, v17
    ds_read_b128 v[148:151], v223 offset:5120
    v_mfma_f32_16x16x32_bf16 a[52:55], a[244:247], v[8:11], 0
    v_cvt_pk_bf16_f32 v17, v18, v19
    v_exp_f32 v20, v20
    v_rcp_f32 v244, v68
    v_rcp_f32 v245, v68
    v_mfma_f32_16x16x32_bf16 a[56:59], a[248:251], v[8:11], 0
    v_exp_f32 v21, v21
    v_max3_f32 v242, v242, v30, v31
    v_accvgpr_read_b32 v246, a64
    v_accvgpr_read_b32 v247, a65
    v_accvgpr_read_b32 v248, a66
    v_accvgpr_read_b32 v249, a67
    v_accvgpr_read_b32 v250, a68
    v_accvgpr_read_b32 v251, a69
    v_accvgpr_read_b32 v252, a70
    v_accvgpr_read_b32 v253, a71
    v_pk_mul_f32 v[246:247], v[246:247], v[244:245]
    v_pk_mul_f32 v[248:249], v[248:249], v[244:245]
    v_pk_mul_f32 v[250:251], v[250:251], v[244:245]
    v_pk_mul_f32 v[252:253], v[252:253], v[244:245]
    v_mfma_f32_16x16x32_bf16 a[60:63], a[252:255], v[8:11], 0
    v_exp_f32 v22, v22
    v_max_f32 v242, v242, v243
    v_cvt_pk_bf16_f32 v112, v246, v247
    v_cvt_pk_bf16_f32 v113, v248, v249
    v_cvt_pk_bf16_f32 v114, v250, v251
    v_cvt_pk_bf16_f32 v115, v252, v253
    v_mfma_f32_16x16x32_bf16 v[64:67], v[228:231], v[8:11], 0
    s_waitcnt lgkmcnt(4)
    v_exp_f32 v23, v23
    v_cvt_pk_bf16_f32 v18, v20, v21
    v_accvgpr_read_b32 v246, a72
    v_accvgpr_read_b32 v247, a73
    v_accvgpr_read_b32 v248, a74
    v_accvgpr_read_b32 v249, a75
    v_accvgpr_read_b32 v250, a76
    v_accvgpr_read_b32 v251, a77
    v_accvgpr_read_b32 v252, a78
    v_accvgpr_read_b32 v253, a79
    v_pk_mul_f32 v[246:247], v[246:247], v[244:245]
    v_pk_mul_f32 v[248:249], v[248:249], v[244:245]
    v_pk_mul_f32 v[250:251], v[250:251], v[244:245]
    v_pk_mul_f32 v[252:253], v[252:253], v[244:245]
    v_mfma_f32_16x16x32_bf16 v[0:3], a[192:195], v[160:163], v[40:43]
    buffer_load_dwordx4 v224, s[24:27], s87 offen nt lds
    v_cvt_pk_bf16_f32 v19, v22, v23
    s_waitcnt lgkmcnt(2)
    v_add_f32 v221, v221, v222
    v_add_f32 v222, v154, v158
    v_cvt_pk_bf16_f32 v116, v246, v247
    v_cvt_pk_bf16_f32 v117, v248, v249
    v_mfma_f32_16x16x32_bf16 v[0:3], a[196:199], v[164:167], v[0:3]
    s_add_u32 m0, s38, 0
    s_xor_b32 s87, s85, s86
    s_add_u32 s85, s85, 4096
    v_add_f32 v221, v221, v222
    v_cmp_nge_f32 vcc, s43, v221
    s_cbranch_vccnz A1s_redo
A1s_ok:
    v_min_f32 v221, v152, v156
    v_sub_f32 v152, v221, v152
    v_mfma_f32_16x16x32_bf16 v[0:3], a[200:203], v[168:171], v[0:3]
    v_mov_b32 v243, v242
    s_nop 1
    v_permlane32_swap_b32 v242, v243
    v_max_f32 v242, v242, v243
    v_cvt_pk_bf16_f32 v118, v250, v251
    v_cvt_pk_bf16_f32 v119, v252, v253
    v_mfma_f32_16x16x32_bf16 v[0:3], a[204:207], v[172:175], v[0:3]
    v_mov_b32 v243, v242
    s_nop 1
    v_permlane16_swap_b32 v242, v243
    v_max_f32 v242, v242, v243
    v_accvgpr_read_b32 v246, a80
    v_accvgpr_read_b32 v247, a81
    v_accvgpr_read_b32 v248, a82
    v_accvgpr_read_b32 v249, a83
    v_accvgpr_read_b32 v250, a84
    v_accvgpr_read_b32 v251, a85
    v_accvgpr_read_b32 v252, a86
    v_accvgpr_read_b32 v253, a87
    v_pk_mul_f32 v[246:247], v[246:247], v[244:245]
    v_pk_mul_f32 v[248:249], v[248:249], v[244:245]
    v_pk_mul_f32 v[250:251], v[250:251], v[244:245]
    v_pk_mul_f32 v[252:253], v[252:253], v[244:245]
    v_mfma_f32_16x16x32_bf16 v[4:7], a[208:211], v[160:163], v[40:43]
    v_sub_f32 v24, v24, v242
    v_sub_f32 v25, v25, v242
    v_sub_f32 v26, v26, v242
    v_sub_f32 v156, v221, v156
    v_exp_f32 v152, v152
    v_mfma_f32_16x16x32_bf16 v[4:7], a[212:215], v[164:167], v[4:7]
    v_sub_f32 v27, v27, v242
    v_sub_f32 v28, v28, v242
    v_sub_f32 v29, v29, v242
    v_exp_f32 v156, v156
    v_mul_f32 v221, v152, v153
    v_mfma_f32_16x16x32_bf16 v[4:7], a[216:219], v[168:171], v[4:7]
    v_sub_f32 v30, v30, v242
    v_sub_f32 v31, v31, v242
    v_sub_f32 v52, 0, v242
    v_fmac_f32 v221, v156, v157
    v_rcp_f32 v221, v221
    s_nop 0
    v_mfma_f32_16x16x32_bf16 v[4:7], a[220:223], v[172:175], v[4:7]
    buffer_load_dwordx4 v220, s[20:23], s87 offen nt lds
    v_sub_f32 v53, 0, v242
    v_mul_f32 v222, v152, v221
    v_mul_f32 v225, v156, v221
    ds_read_b128 v[152:155], v223 offset:6144
    ds_read_b128 v[156:159], v223 offset:7168
    v_mfma_f32_16x16x32_bf16 a[64:67], a[224:227], v[16:19], 0
    s_add_u32 m0, s38, 4096
    s_xor_b32 s87, s85, s86
    s_add_u32 s85, s85, 4096
    v_sub_f32 v54, 0, v242
    v_cvt_pk_bf16_f32 v120, v246, v247
    v_cvt_pk_bf16_f32 v121, v248, v249
    v_cvt_pk_bf16_f32 v122, v250, v251
    v_cvt_pk_bf16_f32 v123, v252, v253
    v_mfma_f32_16x16x32_bf16 a[68:71], a[228:231], v[16:19], 0
    v_sub_f32 v55, 0, v242
    v_exp_f32 v24, v24
    v_accvgpr_read_b32 v246, a88
    v_accvgpr_read_b32 v247, a89
    v_accvgpr_read_b32 v248, a90
    v_accvgpr_read_b32 v249, a91
    v_accvgpr_read_b32 v250, a92
    v_accvgpr_read_b32 v251, a93
    v_accvgpr_read_b32 v252, a94
    v_accvgpr_read_b32 v253, a95
    v_pk_mul_f32 v[246:247], v[246:247], v[244:245]
    v_pk_mul_f32 v[248:249], v[248:249], v[244:245]
    v_pk_mul_f32 v[250:251], v[250:251], v[244:245]
    v_pk_mul_f32 v[252:253], v[252:253], v[244:245]
    v_mfma_f32_16x16x32_bf16 a[72:75], a[232:235], v[16:19], 0
    v_exp_f32 v25, v25
    v_exp_f32 v0, v0
    v_cvt_pk_bf16_f32 v124, v246, v247
    v_cvt_pk_bf16_f32 v125, v248, v249
    v_mfma_f32_16x16x32_bf16 a[76:79], a[236:239], v[16:19], 0
    v_exp_f32 v26, v26
    v_exp_f32 v1, v1
    v_cvt_pk_bf16_f32 v126, v250, v251
    v_cvt_pk_bf16_f32 v127, v252, v253
    v_mfma_f32_16x16x32_bf16 a[80:83], a[240:243], v[16:19], 0
    v_exp_f32 v27, v27
    v_cvt_pk_bf16_f32 v24, v24, v25
    v_mfma_f32_16x16x32_bf16 a[84:87], a[244:247], v[16:19], 0
    v_cvt_pk_bf16_f32 v25, v26, v27
    v_exp_f32 v28, v28
    v_mfma_f32_16x16x32_bf16 a[88:91], a[248:251], v[16:19], 0
    v_exp_f32 v29, v29
    v_exp_f32 v2, v2
    v_mfma_f32_16x16x32_bf16 a[92:95], a[252:255], v[16:19], 0
    buffer_load_dwordx4 v220, s[20:23], s87 offen nt lds
    v_exp_f32 v3, v3
    v_mfma_f32_16x16x32_bf16 v[68:71], v[228:231], v[16:19], 0
    s_add_u32 m0, s38, 8192
    s_xor_b32 s87, s85, s86
    s_add_u32 s85, s85, 4096
    v_cvt_pk_bf16_f32 v0, v0, v1
    v_cvt_pk_bf16_f32 v1, v2, v3
    v_mfma_f32_16x16x32_bf16 v[8:11], a[192:195], v[176:179], v[44:47]
    v_exp_f32 v30, v30
    v_exp_f32 v4, v4
    v_mfma_f32_16x16x32_bf16 v[8:11], a[196:199], v[180:183], v[8:11]
    v_exp_f32 v31, v31
    v_cvt_pk_bf16_f32 v26, v28, v29
    v_mfma_f32_16x16x32_bf16 v[8:11], a[200:203], v[184:187], v[8:11]
    v_cvt_pk_bf16_f32 v27, v30, v31
    v_exp_f32 v5, v5
    v_mfma_f32_16x16x32_bf16 v[8:11], a[204:207], v[188:191], v[8:11]
    v_exp_f32 v6, v6
    v_exp_f32 v7, v7
    v_mfma_f32_16x16x32_bf16 v[12:15], a[208:211], v[176:179], v[44:47]
    v_cvt_pk_bf16_f32 v2, v4, v5
    v_cvt_pk_bf16_f32 v3, v6, v7
    v_rcp_f32 v244, v72
    v_rcp_f32 v245, v72
    v_mfma_f32_16x16x32_bf16 v[12:15], a[212:215], v[180:183], v[12:15]
    v_accvgpr_read_b32 v246, a96
    v_accvgpr_read_b32 v247, a97
    v_accvgpr_read_b32 v248, a98
    v_accvgpr_read_b32 v249, a99
    v_accvgpr_read_b32 v250, a100
    v_accvgpr_read_b32 v251, a101
    v_accvgpr_read_b32 v252, a102
    v_accvgpr_read_b32 v253, a103
    v_pk_mul_f32 v[246:247], v[246:247], v[244:245]
    v_pk_mul_f32 v[248:249], v[248:249], v[244:245]
    v_pk_mul_f32 v[250:251], v[250:251], v[244:245]
    v_pk_mul_f32 v[252:253], v[252:253], v[244:245]
    v_mfma_f32_16x16x32_bf16 v[12:15], a[216:219], v[184:187], v[12:15]
    buffer_load_dwordx4 v220, s[20:23], s87 offen nt lds
    v_cvt_pk_bf16_f32 v128, v246, v247
    v_cvt_pk_bf16_f32 v129, v248, v249
    v_cvt_pk_bf16_f32 v130, v250, v251
    v_cvt_pk_bf16_f32 v131, v252, v253
    v_mfma_f32_16x16x32_bf16 v[12:15], a[220:223], v[188:191], v[12:15]
    s_add_u32 m0, s38, 12288
    s_xor_b32 s87, s85, s86
    s_add_u32 s85, s85, 4096
    v_accvgpr_read_b32 v246, a104
    v_accvgpr_read_b32 v247, a105
    v_accvgpr_read_b32 v248, a106
    v_accvgpr_read_b32 v249, a107
    v_accvgpr_read_b32 v250, a108
    v_accvgpr_read_b32 v251, a109
    v_accvgpr_read_b32 v252, a110
    v_accvgpr_read_b32 v253, a111
    v_pk_mul_f32 v[246:247], v[246:247], v[244:245]
    v_pk_mul_f32 v[248:249], v[248:249], v[244:245]
    v_pk_mul_f32 v[250:251], v[250:251], v[244:245]
    v_pk_mul_f32 v[252:253], v[252:253], v[244:245]
    v_mfma_f32_16x16x32_bf16 a[96:99], a[224:227], v[24:27], 0
    ds_read_b64_tr_b16 a[224:225], v212 offset:24576
    ds_read_b64_tr_b16 a[226:227], v212 offset:28672
    v_cvt_pk_bf16_f32 v132, v246, v247
    v_cvt_pk_bf16_f32 v133, v248, v249
    v_cvt_pk_bf16_f32 v134, v250, v251
    v_cvt_pk_bf16_f32 v135, v252, v253
    v_mfma_f32_16x16x32_bf16 a[100:103], a[228:231], v[24:27], 0
    v_exp_f32 v8, v8
    v_accvgpr_read_b32 v246, a112
    v_accvgpr_read_b32 v247, a113
    v_accvgpr_read_b32 v248, a114
    v_accvgpr_read_b32 v249, a115
    v_accvgpr_read_b32 v250, a116
    v_accvgpr_read_b32 v251, a117
    v_accvgpr_read_b32 v252, a118
    v_accvgpr_read_b32 v253, a119
    v_pk_mul_f32 v[246:247], v[246:247], v[244:245]
    v_pk_mul_f32 v[248:249], v[248:249], v[244:245]
    v_pk_mul_f32 v[250:251], v[250:251], v[244:245]
    v_pk_mul_f32 v[252:253], v[252:253], v[244:245]
    v_mfma_f32_16x16x32_bf16 a[104:107], a[232:235], v[24:27], 0
    ds_read_b64_tr_b16 a[228:229], v213 offset:24576
    ds_read_b64_tr_b16 a[230:231], v213 offset:28672
    v_cvt_pk_bf16_f32 v136, v246, v247
    v_cvt_pk_bf16_f32 v137, v248, v249
    v_cvt_pk_bf16_f32 v138, v250, v251
    v_cvt_pk_bf16_f32 v139, v252, v253
    v_mfma_f32_16x16x32_bf16 a[108:111], a[236:239], v[24:27], 0
    v_add_u32 v212, s44, v212
    v_add_u32 v213, s44, v213
    v_accvgpr_read_b32 v246, a120
    v_accvgpr_read_b32 v247, a121
    v_accvgpr_read_b32 v248, a122
    v_accvgpr_read_b32 v249, a123
    v_accvgpr_read_b32 v250, a124
    v_accvgpr_read_b32 v251, a125
    v_accvgpr_read_b32 v252, a126
    v_accvgpr_read_b32 v253, a127
    v_pk_mul_f32 v[246:247], v[246:247], v[244:245]
    v_pk_mul_f32 v[248:249], v[248:249], v[244:245]
    v_pk_mul_f32 v[250:251], v[250:251], v[244:245]
    v_pk_mul_f32 v[252:253], v[252:253], v[244:245]
    v_mfma_f32_16x16x32_bf16 a[112:115], a[240:243], v[24:27], 0
    ds_read_b64_tr_b16 a[232:233], v214 offset:24576
    ds_read_b64_tr_b16 a[234:235], v214 offset:28672
    v_cvt_pk_bf16_f32 v140, v246, v247
    v_cvt_pk_bf16_f32 v141, v248, v249
    v_cvt_pk_bf16_f32 v142, v250, v251
    v_cvt_pk_bf16_f32 v143, v252, v253
    v_mfma_f32_16x16x32_bf16 a[116:119], a[244:247], v[24:27], 0
    v_exp_f32 v9, v9
    v_accvgpr_read_b32 v246, a144
    v_accvgpr_read_b32 v247, a145
    v_mfma_f32_16x16x32_bf16 a[120:123], a[248:251], v[24:27], 0
    ds_read_b64_tr_b16 a[236:237], v215 offset:24576
    ds_read_b64_tr_b16 a[238:239], v215 offset:28672
    v_accvgpr_read_b32 v248, a146
    v_accvgpr_read_b32 v249, a147
    v_mfma_f32_16x16x32_bf16 a[124:127], a[252:255], v[24:27], 0
    buffer_load_dwordx4 v220, s[20:23], s87 offen nt lds
    v_accvgpr_read_b32 v250, a148
    v_accvgpr_read_b32 v251, a149
    v_mfma_f32_16x16x32_bf16 v[72:75], v[228:231], v[24:27], 0
    s_add_u32 m0, s38, 16384
    ds_read_b64_tr_b16 a[240:241], v216 offset:24576
    ds_read_b64_tr_b16 a[242:243], v216 offset:28672
    v_accvgpr_read_b32 v252, a150
    v_accvgpr_read_b32 v253, a151
    v_mfma_f32_16x16x32_bf16 v[16:19], a[192:195], v[192:195], v[48:51]
    s_xor_b32 s87, s37, s86
    s_add_u32 s37, s37, 4096
    v_mul_f32 v246, v246, v222
    v_mul_f32 v247, v247, v222
    v_mfma_f32_16x16x32_bf16 v[16:19], a[196:199], v[196:199], v[16:19]
    ds_read_b64_tr_b16 a[244:245], v217 offset:24576
    ds_read_b64_tr_b16 a[246:247], v217 offset:28672
    v_mul_f32 v248, v248, v222
    v_mul_f32 v249, v249, v222
    v_mfma_f32_16x16x32_bf16 v[16:19], a[200:203], v[200:203], v[16:19]
    v_add_u32 v214, s44, v214
    v_add_u32 v215, s44, v215
    v_mul_f32 v250, v250, v222
    v_mul_f32 v251, v251, v222
    v_mfma_f32_16x16x32_bf16 v[16:19], a[204:207], v[204:207], v[16:19]
    ds_read_b64_tr_b16 a[248:249], v218 offset:24576
    ds_read_b64_tr_b16 a[250:251], v218 offset:28672
    v_mul_f32 v252, v252, v222
    v_mul_f32 v253, v253, v222
    v_mfma_f32_16x16x32_bf16 v[20:23], a[208:211], v[192:195], v[48:51]
    v_add_u32 v216, s44, v216
    v_add_u32 v217, s44, v217
    s_waitcnt lgkmcnt(15)
    v_fmac_f32 v246, v144, v225
    v_fmac_f32 v247, v145, v225
    v_mfma_f32_16x16x32_bf16 v[20:23], a[212:215], v[196:199], v[20:23]
    ds_read_b64_tr_b16 a[252:253], v219 offset:24576
    ds_read_b64_tr_b16 a[254:255], v219 offset:28672
    v_fmac_f32 v248, v146, v225
    v_fmac_f32 v249, v147, v225
    v_mfma_f32_16x16x32_bf16 v[20:23], a[216:219], v[200:203], v[20:23]
    buffer_load_dwordx4 v224, s[24:27], s87 offen nt lds
    v_fmac_f32 v250, v148, v225
    v_fmac_f32 v251, v149, v225
    v_mfma_f32_16x16x32_bf16 v[20:23], a[220:223], v[204:207], v[20:23]
    s_waitcnt lgkmcnt(6)
    s_add_u32 m0, s38, 20480
    s_xor_b32 s87, s37, s86
    v_fmac_f32 v252, v150, v225
    v_fmac_f32 v253, v151, v225
    v_mfma_f32_16x16x32_bf16 a[0:3], a[224:227], v[0:3], a[0:3]
    s_add_u32 s37, s37, 4096
    v_add_u32 v218, s44, v218
    v_add_u32 v219, s44, v219
    v_cvt_pk_bf16_f32 v144, v246, v247
    v_cvt_pk_bf16_f32 v145, v248, v249
    v_mfma_f32_16x16x32_bf16 a[4:7], a[228:231], v[0:3], a[4:7]
    v_exp_f32 v10, v10
    v_cvt_pk_bf16_f32 v146, v250, v251
    v_cvt_pk_bf16_f32 v147, v252, v253
    v_mfma_f32_16x16x32_bf16 a[8:11], a[232:235], v[0:3], a[8:11]
    v_exp_f32 v11, v11
    v_accvgpr_read_b32 v246, a152
    v_accvgpr_read_b32 v247, a153
    v_mfma_f32_16x16x32_bf16 a[12:15], a[236:239], v[0:3], a[12:15]
    v_cvt_pk_bf16_f32 v8, v8, v9
    v_cvt_pk_bf16_f32 v9, v10, v11
    v_accvgpr_read_b32 v248, a154
    v_accvgpr_read_b32 v249, a155
    v_mfma_f32_16x16x32_bf16 a[16:19], a[240:243], v[0:3], a[16:19]
    s_waitcnt lgkmcnt(2)
    v_exp_f32 v12, v12
    v_accvgpr_read_b32 v250, a156
    v_accvgpr_read_b32 v251, a157
    v_mfma_f32_16x16x32_bf16 a[20:23], a[244:247], v[0:3], a[20:23]
    buffer_load_dwordx4 v224, s[24:27], s87 offen nt lds
    v_accvgpr_read_b32 v252, a158
    v_accvgpr_read_b32 v253, a159
    v_mfma_f32_16x16x32_bf16 a[24:27], a[248:251], v[0:3], a[24:27]
    s_waitcnt lgkmcnt(0)
    s_add_u32 m0, s38, 24576
    s_xor_b32 s87, s37, s86
    v_mul_f32 v246, v246, v222
    v_mul_f32 v247, v247, v222
    v_mfma_f32_16x16x32_bf16 a[28:31], a[252:255], v[0:3], a[28:31]
    s_add_u32 s37, s37, 4096
    v_exp_f32 v13, v13
    v_mul_f32 v248, v248, v222
    v_mul_f32 v249, v249, v222
    v_mfma_f32_16x16x32_bf16 v[60:63], v[228:231], v[0:3], v[60:63]
    v_exp_f32 v14, v14
    v_mul_f32 v250, v250, v222
    v_mul_f32 v251, v251, v222
    v_mfma_f32_16x16x32_bf16 v[24:27], a[192:195], a[160:163], v[52:55]
    v_exp_f32 v15, v15
    v_mul_f32 v252, v252, v222
    v_mul_f32 v253, v253, v222
    v_mfma_f32_16x16x32_bf16 v[24:27], a[196:199], a[164:167], v[24:27]
    v_cvt_pk_bf16_f32 v10, v12, v13
    v_cvt_pk_bf16_f32 v11, v14, v15
    v_fmac_f32 v246, v152, v225
    v_fmac_f32 v247, v153, v225
    v_mfma_f32_16x16x32_bf16 v[24:27], a[200:203], a[168:171], v[24:27]
    v_exp_f32 v16, v16
    v_fmac_f32 v248, v154, v225
    v_fmac_f32 v249, v155, v225
    v_mfma_f32_16x16x32_bf16 v[24:27], a[204:207], a[172:175], v[24:27]
    v_exp_f32 v17, v17
    v_fmac_f32 v250, v156, v225
    v_fmac_f32 v251, v157, v225
    v_mfma_f32_16x16x32_bf16 v[28:31], a[208:211], a[160:163], v[52:55]
    buffer_load_dwordx4 v224, s[24:27], s87 offen nt lds
    v_fmac_f32 v252, v158, v225
    v_fmac_f32 v253, v159, v225
    v_mfma_f32_16x16x32_bf16 v[28:31], a[212:215], a[164:167], v[28:31]
    s_add_u32 m0, s38, 28672
    s_xor_b32 s87, s37, s86
    s_add_u32 s37, s37, 4096
    v_cvt_pk_bf16_f32 v148, v246, v247
    v_cvt_pk_bf16_f32 v149, v248, v249
    v_mfma_f32_16x16x32_bf16 v[28:31], a[216:219], a[168:171], v[28:31]
    v_exp_f32 v18, v18
    v_cvt_pk_bf16_f32 v150, v250, v251
    v_cvt_pk_bf16_f32 v151, v252, v253
    v_mfma_f32_16x16x32_bf16 v[28:31], a[220:223], a[172:175], v[28:31]
    v_exp_f32 v19, v19
    v_accvgpr_write_b32 a128, 0
    v_accvgpr_write_b32 a129, 0
    s_mov_b32 s41, 1
    v_mfma_f32_16x16x32_bf16 a[32:35], a[224:227], v[8:11], a[32:35]
    v_cvt_pk_bf16_f32 v16, v16, v17
    v_cvt_pk_bf16_f32 v17, v18, v19
    v_accvgpr_write_b32 a130, 0
    v_accvgpr_write_b32 a131, 0
    s_mov_b32 s12, s28
    v_mfma_f32_16x16x32_bf16 a[36:39], a[228:231], v[8:11], a[36:39]
    v_exp_f32 v20, v20
    v_accvgpr_write_b32 a132, 0
    v_accvgpr_write_b32 a133, 0
    s_mov_b32 s13, s29
    v_mfma_f32_16x16x32_bf16 a[40:43], a[232:235], v[8:11], a[40:43]
    v_exp_f32 v21, v21
    v_accvgpr_write_b32 a134, 0
    v_accvgpr_write_b32 a135, 0
    s_mov_b32 s14, s30
    v_mfma_f32_16x16x32_bf16 a[44:47], a[236:239], v[8:11], a[44:47]
    v_exp_f32 v22, v22
    v_accvgpr_write_b32 a136, 0
    v_accvgpr_write_b32 a137, 0
    s_lshl_b32 s81, s36, 13
    v_mfma_f32_16x16x32_bf16 a[48:51], a[240:243], v[8:11], a[48:51]
    buffer_load_dwordx4 v224, s[24:27], s87 offen nt lds
    v_accvgpr_write_b32 a138, 0
    v_accvgpr_write_b32 a139, 0
    v_mfma_f32_16x16x32_bf16 a[52:55], a[244:247], v[8:11], a[52:55]
    v_exp_f32 v23, v23
    v_accvgpr_write_b32 a140, 0
    v_accvgpr_write_b32 a141, 0
    s_lshr_b32 s60, s50, 3
    v_mfma_f32_16x16x32_bf16 a[56:59], a[248:251], v[8:11], a[56:59]
    v_cvt_pk_bf16_f32 v18, v20, v21
    v_cvt_pk_bf16_f32 v19, v22, v23
    v_accvgpr_write_b32 a142, 0
    v_accvgpr_write_b32 a143, 0
    s_lshr_b32 s61, s50, 1
    v_mfma_f32_16x16x32_bf16 a[60:63], a[252:255], v[8:11], a[60:63]
    v_exp_f32 v24, v24
    v_accvgpr_write_b32 a144, 0
    v_accvgpr_write_b32 a145, 0
    s_xor_b32 s60, s60, s61
    v_mfma_f32_16x16x32_bf16 v[64:67], v[228:231], v[8:11], v[64:67]
    v_exp_f32 v25, v25
    v_accvgpr_write_b32 a146, 0
    v_accvgpr_write_b32 a147, 0
    s_and_b32 s60, s60, 0
    v_mfma_f32_16x16x32_bf16 v[32:35], a[192:195], a[176:179], 0
    v_exp_f32 v26, v26
    v_accvgpr_write_b32 a148, 0
    v_accvgpr_write_b32 a149, 0
    s_and_b32 s61, s50, 1
    v_mfma_f32_16x16x32_bf16 v[32:35], a[196:199], a[180:183], v[32:35]
    ds_read_b128 a[192:195], v208 offset:8192
    ds_read_b128 a[196:199], v209 offset:8192
    v_accvgpr_write_b32 a150, 0
    v_accvgpr_write_b32 a151, 0
    s_lshl_b32 s61, s61, 2
    v_mfma_f32_16x16x32_bf16 v[32:35], a[200:203], a[184:187], v[32:35]
    v_exp_f32 v27, v27
    v_accvgpr_write_b32 a152, 0
    v_accvgpr_write_b32 a153, 0
    s_or_b32 s61, s61, s36
    v_mfma_f32_16x16x32_bf16 v[32:35], a[204:207], a[188:191], v[32:35]
    ds_read_b128 a[200:203], v210 offset:8192
    ds_read_b128 a[204:207], v211 offset:8192
    v_accvgpr_write_b32 a154, 0
    v_accvgpr_write_b32 a155, 0
    s_lshl_b32 s80, s61, 19
    v_mfma_f32_16x16x32_bf16 v[36:39], a[208:211], a[176:179], 0
    v_cvt_pk_bf16_f32 v24, v24, v25
    v_cvt_pk_bf16_f32 v25, v26, v27
    v_accvgpr_write_b32 a156, 0
    v_accvgpr_write_b32 a157, 0
    s_lshl_b32 s61, s60, 15
    v_mfma_f32_16x16x32_bf16 v[36:39], a[212:215], a[180:183], v[36:39]
    ds_read_b128 a[208:211], v208 offset:12288
    ds_read_b128 a[212:215], v209 offset:12288
    v_accvgpr_write_b32 a158, 0
    v_accvgpr_write_b32 a159, 0
    s_or_b32 s80, s80, s61
    v_mfma_f32_16x16x32_bf16 v[36:39], a[216:219], a[184:187], v[36:39]
    v_add_u32 v208, s44, v208
    v_add_u32 v209, s44, v209
    v_mov_b32 v76, 0
    s_lshl_b32 s61, s60, 10
    v_or_b32 v238, s61, v233
    v_mfma_f32_16x16x32_bf16 v[36:39], a[220:223], a[188:191], v[36:39]
    ds_read_b128 a[216:219], v210 offset:12288
    ds_read_b128 a[220:223], v211 offset:12288
    v_mov_b32 v77, 0
    v_mov_b32 v78, 0
    v_mfma_f32_16x16x32_bf16 a[64:67], a[224:227], v[16:19], a[64:67]
    v_add_u32 v210, s44, v210
    v_add_u32 v211, s44, v211
    v_mov_b32 v79, 0
    v_mfma_f32_16x16x32_bf16 a[68:71], a[228:231], v[16:19], a[68:71]
    s_sub_u32 s39, s39, 1
    v_exp_f32 v28, v28
    v_mfma_f32_16x16x32_bf16 a[72:75], a[232:235], v[16:19], a[72:75]
    v_exp_f32 v29, v29
    v_mfma_f32_16x16x32_bf16 a[76:79], a[236:239], v[16:19], a[76:79]
    v_exp_f32 v30, v30
    v_mfma_f32_16x16x32_bf16 a[80:83], a[240:243], v[16:19], a[80:83]
    v_exp_f32 v31, v31
    v_mfma_f32_16x16x32_bf16 a[84:87], a[244:247], v[16:19], a[84:87]
    v_cvt_pk_bf16_f32 v26, v28, v29
    v_cvt_pk_bf16_f32 v27, v30, v31
    v_mfma_f32_16x16x32_bf16 a[88:91], a[248:251], v[16:19], a[88:91]
    v_max3_f32 v240, v32, v33, v34
    v_max3_f32 v241, v35, v36, v37
    v_mfma_f32_16x16x32_bf16 a[92:95], a[252:255], v[16:19], a[92:95]
    v_max3_f32 v240, v240, v38, v39
    v_max_f32 v240, v240, v241
    v_mfma_f32_16x16x32_bf16 v[68:71], v[228:231], v[16:19], v[68:71]
    v_mov_b32 v241, v240
    s_nop 1
    v_permlane32_swap_b32 v240, v241
    v_max_f32 v240, v240, v241
    v_mov_b32 v241, v240
    s_nop 1
    v_permlane16_swap_b32 v240, v241
    v_max_f32 v240, v240, v241
    v_sub_f32 v32, v32, v240
    v_sub_f32 v33, v33, v240
    v_sub_f32 v34, v34, v240
    v_sub_f32 v35, v35, v240
    v_sub_f32 v36, v36, v240
    v_sub_f32 v37, v37, v240
    v_sub_f32 v38, v38, v240
    v_sub_f32 v39, v39, v240
    v_sub_f32 v56, 0, v240
    v_sub_f32 v57, 0, v240
    v_sub_f32 v58, 0, v240
    v_sub_f32 v59, 0, v240
    v_exp_f32 v32, v32
    v_exp_f32 v33, v33
    v_exp_f32 v34, v34
    v_exp_f32 v35, v35
    v_cvt_pk_bf16_f32 v32, v32, v33
    v_cvt_pk_bf16_f32 v33, v34, v35
    v_exp_f32 v36, v36
    v_exp_f32 v37, v37
    s_waitcnt lgkmcnt(0)
.p2align 6
A1h1_loop:
    v_mfma_f32_16x16x32_bf16 v[0:3], a[192:195], v[160:163], v[40:43]
    v_exp_f32 v38, v38
    v_mfma_f32_16x16x32_bf16 v[0:3], a[196:199], v[164:167], v[0:3]
    v_exp_f32 v39, v39
    v_mfma_f32_16x16x32_bf16 v[0:3], a[200:203], v[168:171], v[0:3]
    v_cvt_pk_bf16_f32 v34, v36, v37
    v_cvt_pk_bf16_f32 v35, v38, v39
    v_mfma_f32_16x16x32_bf16 v[0:3], a[204:207], v[172:175], v[0:3]
    v_mfma_f32_16x16x32_bf16 v[4:7], a[208:211], v[160:163], v[40:43]
    v_mfma_f32_16x16x32_bf16 v[4:7], a[212:215], v[164:167], v[4:7]
    v_mfma_f32_16x16x32_bf16 v[4:7], a[216:219], v[168:171], v[4:7]
    v_exp_f32 v0, v0
    v_mfma_f32_16x16x32_bf16 v[4:7], a[220:223], v[172:175], v[4:7]
    v_exp_f32 v1, v1
    v_mfma_f32_16x16x32_bf16 a[96:99], a[224:227], v[24:27], a[96:99]
    v_exp_f32 v2, v2
    v_mfma_f32_16x16x32_bf16 a[100:103], a[228:231], v[24:27], a[100:103]
    v_exp_f32 v3, v3
    v_mfma_f32_16x16x32_bf16 a[104:107], a[232:235], v[24:27], a[104:107]
    s_waitcnt vmcnt(16) lgkmcnt(0)
    s_barrier
    v_mfma_f32_16x16x32_bf16 a[108:111], a[236:239], v[24:27], a[108:111]
    s_add_u32 s38, s74, s3
    s_add_u32 m0, s38, 0
    s_xor_b32 s87, s85, s86
    v_mfma_f32_16x16x32_bf16 a[112:115], a[240:243], v[24:27], a[112:115]
    s_add_u32 s85, s85, 4096
    s_add_u32 s74, s74, s44
    v_cvt_pk_bf16_f32 v0, v0, v1
    v_mfma_f32_16x16x32_bf16 a[116:119], a[244:247], v[24:27], a[116:119]
    buffer_load_dwordx4 v220, s[20:23], s87 offen nt lds
    v_mfma_f32_16x16x32_bf16 a[120:123], a[248:251], v[24:27], a[120:123]
    s_add_u32 m0, s38, 4096
    s_xor_b32 s87, s85, s86
    s_add_u32 s85, s85, 4096
    v_mfma_f32_16x16x32_bf16 a[124:127], a[252:255], v[24:27], a[124:127]
    s_cmp_eq_u32 s74, 0x18000
    s_cselect_b32 s44, s45, s46
    v_cvt_pk_bf16_f32 v1, v2, v3
    v_mfma_f32_16x16x32_bf16 v[72:75], v[228:231], v[24:27], v[72:75]
    v_exp_f32 v4, v4
    v_mfma_f32_16x16x32_bf16 v[8:11], a[192:195], v[176:179], v[44:47]
    v_exp_f32 v5, v5
    v_mfma_f32_16x16x32_bf16 v[8:11], a[196:199], v[180:183], v[8:11]
    v_exp_f32 v6, v6
    v_mfma_f32_16x16x32_bf16 v[8:11], a[200:203], v[184:187], v[8:11]
    v_exp_f32 v7, v7
    v_mfma_f32_16x16x32_bf16 v[8:11], a[204:207], v[188:191], v[8:11]
    v_cvt_pk_bf16_f32 v2, v4, v5
    v_cvt_pk_bf16_f32 v3, v6, v7
    v_mfma_f32_16x16x32_bf16 v[12:15], a[208:211], v[176:179], v[44:47]
    v_mfma_f32_16x16x32_bf16 v[12:15], a[212:215], v[180:183], v[12:15]
    v_mfma_f32_16x16x32_bf16 v[12:15], a[216:219], v[184:187], v[12:15]
    v_exp_f32 v8, v8
    v_mfma_f32_16x16x32_bf16 v[12:15], a[220:223], v[188:191], v[12:15]
    v_exp_f32 v9, v9
    v_mfma_f32_16x16x32_bf16 a[128:131], a[224:227], v[32:35], a[128:131]
    ds_read_b64_tr_b16 a[224:225], v212 offset:16384
    ds_read_b64_tr_b16 a[226:227], v212 offset:20480
    v_mfma_f32_16x16x32_bf16 a[132:135], a[228:231], v[32:35], a[132:135]
    v_exp_f32 v10, v10
    v_mfma_f32_16x16x32_bf16 a[136:139], a[232:235], v[32:35], a[136:139]
    ds_read_b64_tr_b16 a[228:229], v213 offset:16384
    ds_read_b64_tr_b16 a[230:231], v213 offset:20480
    v_mfma_f32_16x16x32_bf16 a[140:143], a[236:239], v[32:35], a[140:143]
    buffer_load_dwordx4 v220, s[20:23], s87 offen nt lds
    v_mfma_f32_16x16x32_bf16 a[144:147], a[240:243], v[32:35], a[144:147]
    s_add_u32 m0, s38, 8192
    ds_read_b64_tr_b16 a[232:233], v214 offset:16384
    ds_read_b64_tr_b16 a[234:235], v214 offset:20480
    v_mfma_f32_16x16x32_bf16 a[148:151], a[244:247], v[32:35], a[148:151]
    s_xor_b32 s87, s85, s86
    s_add_u32 s85, s85, 4096
    v_mfma_f32_16x16x32_bf16 a[152:155], a[248:251], v[32:35], a[152:155]
    ds_read_b64_tr_b16 a[236:237], v215 offset:16384
    ds_read_b64_tr_b16 a[238:239], v215 offset:20480
    v_mfma_f32_16x16x32_bf16 a[156:159], a[252:255], v[32:35], a[156:159]
    v_exp_f32 v11, v11
    v_mfma_f32_16x16x32_bf16 v[76:79], v[228:231], v[32:35], v[76:79]
    ds_read_b64_tr_b16 a[240:241], v216 offset:16384
    ds_read_b64_tr_b16 a[242:243], v216 offset:20480
    v_mfma_f32_16x16x32_bf16 v[16:19], a[192:195], v[192:195], v[48:51]
    v_cvt_pk_bf16_f32 v8, v8, v9
    v_cvt_pk_bf16_f32 v9, v10, v11
    v_mfma_f32_16x16x32_bf16 v[16:19], a[196:199], v[196:199], v[16:19]
    ds_read_b64_tr_b16 a[244:245], v217 offset:16384
    ds_read_b64_tr_b16 a[246:247], v217 offset:20480
    v_mfma_f32_16x16x32_bf16 v[16:19], a[200:203], v[200:203], v[16:19]
    v_exp_f32 v12, v12
    v_mfma_f32_16x16x32_bf16 v[16:19], a[204:207], v[204:207], v[16:19]
    ds_read_b64_tr_b16 a[248:249], v218 offset:16384
    ds_read_b64_tr_b16 a[250:251], v218 offset:20480
    v_mfma_f32_16x16x32_bf16 v[20:23], a[208:211], v[192:195], v[48:51]
    v_exp_f32 v13, v13
    v_mfma_f32_16x16x32_bf16 v[20:23], a[212:215], v[196:199], v[20:23]
    ds_read_b64_tr_b16 a[252:253], v219 offset:16384
    ds_read_b64_tr_b16 a[254:255], v219 offset:20480
    v_mfma_f32_16x16x32_bf16 v[20:23], a[216:219], v[200:203], v[20:23]
    v_exp_f32 v14, v14
    v_mfma_f32_16x16x32_bf16 v[20:23], a[220:223], v[204:207], v[20:23]
    s_waitcnt lgkmcnt(6)
    v_exp_f32 v15, v15
    v_mfma_f32_16x16x32_bf16 a[0:3], a[224:227], v[0:3], a[0:3]
    v_cvt_pk_bf16_f32 v10, v12, v13
    v_cvt_pk_bf16_f32 v11, v14, v15
    v_mfma_f32_16x16x32_bf16 a[4:7], a[228:231], v[0:3], a[4:7]
    v_exp_f32 v16, v16
    v_mfma_f32_16x16x32_bf16 a[8:11], a[232:235], v[0:3], a[8:11]
    v_exp_f32 v17, v17
    v_mfma_f32_16x16x32_bf16 a[12:15], a[236:239], v[0:3], a[12:15]
    buffer_load_dwordx4 v220, s[20:23], s87 offen nt lds
    v_mfma_f32_16x16x32_bf16 a[16:19], a[240:243], v[0:3], a[16:19]
    s_waitcnt lgkmcnt(2)
    s_add_u32 m0, s38, 12288
    s_xor_b32 s87, s85, s86
    v_mfma_f32_16x16x32_bf16 a[20:23], a[244:247], v[0:3], a[20:23]
    s_add_u32 s85, s85, 4096
    v_exp_f32 v18, v18
    v_mfma_f32_16x16x32_bf16 a[24:27], a[248:251], v[0:3], a[24:27]
    s_waitcnt lgkmcnt(0)
    v_exp_f32 v19, v19
    v_mfma_f32_16x16x32_bf16 a[28:31], a[252:255], v[0:3], a[28:31]
    v_cvt_pk_bf16_f32 v16, v16, v17
    v_cvt_pk_bf16_f32 v17, v18, v19
    v_mfma_f32_16x16x32_bf16 v[60:63], v[228:231], v[0:3], v[60:63]
    v_exp_f32 v20, v20
    v_mfma_f32_16x16x32_bf16 v[24:27], a[192:195], a[160:163], v[52:55]
    v_exp_f32 v21, v21
    v_mfma_f32_16x16x32_bf16 v[24:27], a[196:199], a[164:167], v[24:27]
    ds_read_b128 a[192:195], v208 offset:0
    ds_read_b128 a[196:199], v209 offset:0
    v_mfma_f32_16x16x32_bf16 v[24:27], a[200:203], a[168:171], v[24:27]
    v_exp_f32 v22, v22
    v_mfma_f32_16x16x32_bf16 v[24:27], a[204:207], a[172:175], v[24:27]
    ds_read_b128 a[200:203], v210 offset:0
    ds_read_b128 a[204:207], v211 offset:0
    v_mfma_f32_16x16x32_bf16 v[28:31], a[208:211], a[160:163], v[52:55]
    v_exp_f32 v23, v23
    v_mfma_f32_16x16x32_bf16 v[28:31], a[212:215], a[164:167], v[28:31]
    ds_read_b128 a[208:211], v208 offset:4096
    ds_read_b128 a[212:215], v209 offset:4096
    v_mfma_f32_16x16x32_bf16 v[28:31], a[216:219], a[168:171], v[28:31]
    v_cvt_pk_bf16_f32 v18, v20, v21
    v_cvt_pk_bf16_f32 v19, v22, v23
    v_mfma_f32_16x16x32_bf16 v[28:31], a[220:223], a[172:175], v[28:31]
    ds_read_b128 a[216:219], v210 offset:4096
    ds_read_b128 a[220:223], v211 offset:4096
    v_mfma_f32_16x16x32_bf16 a[32:35], a[224:227], v[8:11], a[32:35]
    v_exp_f32 v24, v24
    v_mfma_f32_16x16x32_bf16 a[36:39], a[228:231], v[8:11], a[36:39]
    v_exp_f32 v25, v25
    v_mfma_f32_16x16x32_bf16 a[40:43], a[232:235], v[8:11], a[40:43]
    v_exp_f32 v26, v26
    v_mfma_f32_16x16x32_bf16 a[44:47], a[236:239], v[8:11], a[44:47]
    buffer_load_dwordx4 v220, s[20:23], s87 offen nt lds
    v_mfma_f32_16x16x32_bf16 a[48:51], a[240:243], v[8:11], a[48:51]
    s_add_u32 m0, s38, 16384
    s_xor_b32 s87, s37, s86
    s_add_u32 s37, s37, 4096
    v_mfma_f32_16x16x32_bf16 a[52:55], a[244:247], v[8:11], a[52:55]
    v_exp_f32 v27, v27
    v_mfma_f32_16x16x32_bf16 a[56:59], a[248:251], v[8:11], a[56:59]
    v_cvt_pk_bf16_f32 v24, v24, v25
    v_cvt_pk_bf16_f32 v25, v26, v27
    v_mfma_f32_16x16x32_bf16 a[60:63], a[252:255], v[8:11], a[60:63]
    v_exp_f32 v28, v28
    v_mfma_f32_16x16x32_bf16 v[64:67], v[228:231], v[8:11], v[64:67]
    s_waitcnt lgkmcnt(0)
    v_exp_f32 v29, v29
    v_mfma_f32_16x16x32_bf16 v[0:3], a[192:195], v[160:163], v[40:43]
    v_exp_f32 v30, v30
    v_mfma_f32_16x16x32_bf16 v[0:3], a[196:199], v[164:167], v[0:3]
    v_exp_f32 v31, v31
    v_mfma_f32_16x16x32_bf16 v[0:3], a[200:203], v[168:171], v[0:3]
    v_cvt_pk_bf16_f32 v26, v28, v29
    v_cvt_pk_bf16_f32 v27, v30, v31
    v_mfma_f32_16x16x32_bf16 v[0:3], a[204:207], v[172:175], v[0:3]
    v_mfma_f32_16x16x32_bf16 v[4:7], a[208:211], v[160:163], v[40:43]
    v_mfma_f32_16x16x32_bf16 v[4:7], a[212:215], v[164:167], v[4:7]
    v_mfma_f32_16x16x32_bf16 v[4:7], a[216:219], v[168:171], v[4:7]
    v_exp_f32 v0, v0
    v_mfma_f32_16x16x32_bf16 v[4:7], a[220:223], v[172:175], v[4:7]
    v_exp_f32 v1, v1
    v_mfma_f32_16x16x32_bf16 a[64:67], a[224:227], v[16:19], a[64:67]
    v_exp_f32 v2, v2
    v_mfma_f32_16x16x32_bf16 a[68:71], a[228:231], v[16:19], a[68:71]
    v_exp_f32 v3, v3
    v_mfma_f32_16x16x32_bf16 a[72:75], a[232:235], v[16:19], a[72:75]
    v_cvt_pk_bf16_f32 v0, v0, v1
    v_cvt_pk_bf16_f32 v1, v2, v3
    v_mfma_f32_16x16x32_bf16 a[76:79], a[236:239], v[16:19], a[76:79]
    buffer_load_dwordx4 v224, s[24:27], s87 offen nt lds
    v_mfma_f32_16x16x32_bf16 a[80:83], a[240:243], v[16:19], a[80:83]
    s_add_u32 m0, s38, 20480
    s_xor_b32 s87, s37, s86
    s_add_u32 s37, s37, 4096
    v_mfma_f32_16x16x32_bf16 a[84:87], a[244:247], v[16:19], a[84:87]
    v_exp_f32 v4, v4
    v_mfma_f32_16x16x32_bf16 a[88:91], a[248:251], v[16:19], a[88:91]
    v_exp_f32 v5, v5
    v_mfma_f32_16x16x32_bf16 a[92:95], a[252:255], v[16:19], a[92:95]
    v_exp_f32 v6, v6
    v_mfma_f32_16x16x32_bf16 v[68:71], v[228:231], v[16:19], v[68:71]
    v_exp_f32 v7, v7
    v_mfma_f32_16x16x32_bf16 v[8:11], a[192:195], v[176:179], v[44:47]
    v_cvt_pk_bf16_f32 v2, v4, v5
    v_cvt_pk_bf16_f32 v3, v6, v7
    v_mfma_f32_16x16x32_bf16 v[8:11], a[196:199], v[180:183], v[8:11]
    v_mfma_f32_16x16x32_bf16 v[8:11], a[200:203], v[184:187], v[8:11]
    v_mfma_f32_16x16x32_bf16 v[8:11], a[204:207], v[188:191], v[8:11]
    v_mfma_f32_16x16x32_bf16 v[12:15], a[208:211], v[176:179], v[44:47]
    v_mfma_f32_16x16x32_bf16 v[12:15], a[212:215], v[180:183], v[12:15]
    v_mfma_f32_16x16x32_bf16 v[12:15], a[216:219], v[184:187], v[12:15]
    v_exp_f32 v8, v8
    v_mfma_f32_16x16x32_bf16 v[12:15], a[220:223], v[188:191], v[12:15]
    v_exp_f32 v9, v9
    v_mfma_f32_16x16x32_bf16 a[96:99], a[224:227], v[24:27], a[96:99]
    ds_read_b64_tr_b16 a[224:225], v212 offset:24576
    ds_read_b64_tr_b16 a[226:227], v212 offset:28672
    v_mfma_f32_16x16x32_bf16 a[100:103], a[228:231], v[24:27], a[100:103]
    v_exp_f32 v10, v10
    v_mfma_f32_16x16x32_bf16 a[104:107], a[232:235], v[24:27], a[104:107]
    ds_read_b64_tr_b16 a[228:229], v213 offset:24576
    ds_read_b64_tr_b16 a[230:231], v213 offset:28672
    v_mfma_f32_16x16x32_bf16 a[108:111], a[236:239], v[24:27], a[108:111]
    buffer_load_dwordx4 v224, s[24:27], s87 offen nt lds
    v_mfma_f32_16x16x32_bf16 a[112:115], a[240:243], v[24:27], a[112:115]
    s_add_u32 m0, s38, 24576
    ds_read_b64_tr_b16 a[232:233], v214 offset:24576
    ds_read_b64_tr_b16 a[234:235], v214 offset:28672
    v_mfma_f32_16x16x32_bf16 a[116:119], a[244:247], v[24:27], a[116:119]
    s_xor_b32 s87, s37, s86
    s_add_u32 s37, s37, 4096
    v_mfma_f32_16x16x32_bf16 a[120:123], a[248:251], v[24:27], a[120:123]
    ds_read_b64_tr_b16 a[236:237], v215 offset:24576
    ds_read_b64_tr_b16 a[238:239], v215 offset:28672
    v_mfma_f32_16x16x32_bf16 a[124:127], a[252:255], v[24:27], a[124:127]
    v_add_u32 v212, s44, v212
    v_add_u32 v213, s44, v213
    v_mfma_f32_16x16x32_bf16 v[72:75], v[228:231], v[24:27], v[72:75]
    ds_read_b64_tr_b16 a[240:241], v216 offset:24576
    ds_read_b64_tr_b16 a[242:243], v216 offset:28672
    v_mfma_f32_16x16x32_bf16 v[16:19], a[192:195], v[192:195], v[48:51]
    v_add_u32 v214, s44, v214
    v_add_u32 v215, s44, v215
    v_mfma_f32_16x16x32_bf16 v[16:19], a[196:199], v[196:199], v[16:19]
    ds_read_b64_tr_b16 a[244:245], v217 offset:24576
    ds_read_b64_tr_b16 a[246:247], v217 offset:28672
    v_mfma_f32_16x16x32_bf16 v[16:19], a[200:203], v[200:203], v[16:19]
    v_add_u32 v216, s44, v216
    v_add_u32 v217, s44, v217
    v_mfma_f32_16x16x32_bf16 v[16:19], a[204:207], v[204:207], v[16:19]
    ds_read_b64_tr_b16 a[248:249], v218 offset:24576
    ds_read_b64_tr_b16 a[250:251], v218 offset:28672
    v_mfma_f32_16x16x32_bf16 v[20:23], a[208:211], v[192:195], v[48:51]
    v_exp_f32 v11, v11
    v_mfma_f32_16x16x32_bf16 v[20:23], a[212:215], v[196:199], v[20:23]
    ds_read_b64_tr_b16 a[252:253], v219 offset:24576
    ds_read_b64_tr_b16 a[254:255], v219 offset:28672
    v_mfma_f32_16x16x32_bf16 v[20:23], a[216:219], v[200:203], v[20:23]
    v_add_u32 v218, s44, v218
    v_add_u32 v219, s44, v219
    v_mfma_f32_16x16x32_bf16 v[20:23], a[220:223], v[204:207], v[20:23]
    s_waitcnt lgkmcnt(6)
    v_cvt_pk_bf16_f32 v8, v8, v9
    v_cvt_pk_bf16_f32 v9, v10, v11
    v_mfma_f32_16x16x32_bf16 a[0:3], a[224:227], v[0:3], a[0:3]
    v_exp_f32 v12, v12
    v_mfma_f32_16x16x32_bf16 a[4:7], a[228:231], v[0:3], a[4:7]
    v_exp_f32 v13, v13
    v_mfma_f32_16x16x32_bf16 a[8:11], a[232:235], v[0:3], a[8:11]
    v_exp_f32 v14, v14
    v_mfma_f32_16x16x32_bf16 a[12:15], a[236:239], v[0:3], a[12:15]
    buffer_load_dwordx4 v224, s[24:27], s87 offen nt lds
    v_mfma_f32_16x16x32_bf16 a[16:19], a[240:243], v[0:3], a[16:19]
    s_waitcnt lgkmcnt(2)
    s_add_u32 m0, s38, 28672
    s_xor_b32 s87, s37, s86
    v_mfma_f32_16x16x32_bf16 a[20:23], a[244:247], v[0:3], a[20:23]
    s_add_u32 s37, s37, 4096
    v_exp_f32 v15, v15
    v_mfma_f32_16x16x32_bf16 a[24:27], a[248:251], v[0:3], a[24:27]
    s_waitcnt lgkmcnt(0)
    v_cvt_pk_bf16_f32 v10, v12, v13
    v_cvt_pk_bf16_f32 v11, v14, v15
    v_mfma_f32_16x16x32_bf16 a[28:31], a[252:255], v[0:3], a[28:31]
    v_exp_f32 v16, v16
    v_mfma_f32_16x16x32_bf16 v[60:63], v[228:231], v[0:3], v[60:63]
    v_exp_f32 v17, v17
    v_mfma_f32_16x16x32_bf16 v[24:27], a[192:195], a[160:163], v[52:55]
    v_exp_f32 v18, v18
    v_mfma_f32_16x16x32_bf16 v[24:27], a[196:199], a[164:167], v[24:27]
    v_exp_f32 v19, v19
    v_mfma_f32_16x16x32_bf16 v[24:27], a[200:203], a[168:171], v[24:27]
    v_cvt_pk_bf16_f32 v16, v16, v17
    v_cvt_pk_bf16_f32 v17, v18, v19
    v_mfma_f32_16x16x32_bf16 v[24:27], a[204:207], a[172:175], v[24:27]
    v_exp_f32 v20, v20
    v_mfma_f32_16x16x32_bf16 v[28:31], a[208:211], a[160:163], v[52:55]
    v_exp_f32 v21, v21
    v_mfma_f32_16x16x32_bf16 v[28:31], a[212:215], a[164:167], v[28:31]
    v_exp_f32 v22, v22
    v_mfma_f32_16x16x32_bf16 v[28:31], a[216:219], a[168:171], v[28:31]
    v_exp_f32 v23, v23
    v_mfma_f32_16x16x32_bf16 v[28:31], a[220:223], a[172:175], v[28:31]
    v_cvt_pk_bf16_f32 v18, v20, v21
    v_cvt_pk_bf16_f32 v19, v22, v23
    v_mfma_f32_16x16x32_bf16 a[32:35], a[224:227], v[8:11], a[32:35]
    v_exp_f32 v24, v24
    v_mfma_f32_16x16x32_bf16 a[36:39], a[228:231], v[8:11], a[36:39]
    v_exp_f32 v25, v25
    v_mfma_f32_16x16x32_bf16 a[40:43], a[232:235], v[8:11], a[40:43]
    v_exp_f32 v26, v26
    v_mfma_f32_16x16x32_bf16 a[44:47], a[236:239], v[8:11], a[44:47]
    buffer_load_dwordx4 v224, s[24:27], s87 offen nt lds
    v_mfma_f32_16x16x32_bf16 a[48:51], a[240:243], v[8:11], a[48:51]
    v_exp_f32 v27, v27
    v_mfma_f32_16x16x32_bf16 a[52:55], a[244:247], v[8:11], a[52:55]
    v_cvt_pk_bf16_f32 v24, v24, v25
    v_cvt_pk_bf16_f32 v25, v26, v27
    v_mfma_f32_16x16x32_bf16 a[56:59], a[248:251], v[8:11], a[56:59]
    v_exp_f32 v28, v28
    v_mfma_f32_16x16x32_bf16 a[60:63], a[252:255], v[8:11], a[60:63]
    v_exp_f32 v29, v29
    v_mfma_f32_16x16x32_bf16 v[64:67], v[228:231], v[8:11], v[64:67]
    v_exp_f32 v30, v30
    v_mfma_f32_16x16x32_bf16 v[32:35], a[192:195], a[176:179], v[56:59]
    v_exp_f32 v31, v31
    v_mfma_f32_16x16x32_bf16 v[32:35], a[196:199], a[180:183], v[32:35]
    ds_read_b128 a[192:195], v208 offset:8192
    ds_read_b128 a[196:199], v209 offset:8192
    v_mfma_f32_16x16x32_bf16 v[32:35], a[200:203], a[184:187], v[32:35]
    v_cvt_pk_bf16_f32 v26, v28, v29
    v_cvt_pk_bf16_f32 v27, v30, v31
    v_mfma_f32_16x16x32_bf16 v[32:35], a[204:207], a[188:191], v[32:35]
    ds_read_b128 a[200:203], v210 offset:8192
    ds_read_b128 a[204:207], v211 offset:8192
    v_mfma_f32_16x16x32_bf16 v[36:39], a[208:211], a[176:179], v[56:59]
    v_mfma_f32_16x16x32_bf16 v[36:39], a[212:215], a[180:183], v[36:39]
    s_sub_u32 s39, s39, 1
    ds_read_b128 a[208:211], v208 offset:12288
    ds_read_b128 a[212:215], v209 offset:12288
    v_mfma_f32_16x16x32_bf16 v[36:39], a[216:219], a[184:187], v[36:39]
    v_add_u32 v208, s44, v208
    v_add_u32 v209, s44, v209
    v_mfma_f32_16x16x32_bf16 v[36:39], a[220:223], a[188:191], v[36:39]
    ds_read_b128 a[216:219], v210 offset:12288
    ds_read_b128 a[220:223], v211 offset:12288
    v_mfma_f32_16x16x32_bf16 a[64:67], a[224:227], v[16:19], a[64:67]
    v_add_u32 v210, s44, v210
    v_add_u32 v211, s44, v211
    v_mfma_f32_16x16x32_bf16 a[68:71], a[228:231], v[16:19], a[68:71]
    v_exp_f32 v32, v32
    v_mfma_f32_16x16x32_bf16 a[72:75], a[232:235], v[16:19], a[72:75]
    v_exp_f32 v33, v33
    v_mfma_f32_16x16x32_bf16 a[76:79], a[236:239], v[16:19], a[76:79]
    v_exp_f32 v34, v34
    v_mfma_f32_16x16x32_bf16 a[80:83], a[240:243], v[16:19], a[80:83]
    v_exp_f32 v35, v35
    v_mfma_f32_16x16x32_bf16 a[84:87], a[244:247], v[16:19], a[84:87]
    v_cvt_pk_bf16_f32 v32, v32, v33
    v_cvt_pk_bf16_f32 v33, v34, v35
    v_mfma_f32_16x16x32_bf16 a[88:91], a[248:251], v[16:19], a[88:91]
    v_exp_f32 v36, v36
    v_mfma_f32_16x16x32_bf16 a[92:95], a[252:255], v[16:19], a[92:95]
    v_exp_f32 v37, v37
    v_mfma_f32_16x16x32_bf16 v[68:71], v[228:231], v[16:19], v[68:71]
    s_waitcnt lgkmcnt(0)
    s_cmp_lg_u32 s39, s2
    s_cbranch_scc1 A1h1_loop
    s_cmp_eq_u32 s39, 3
    s_cbranch_scc1 A1h1_last
    v_mfma_f32_16x16x32_bf16 v[0:3], a[192:195], v[160:163], v[40:43]
    v_exp_f32 v38, v38
    v_mfma_f32_16x16x32_bf16 v[0:3], a[196:199], v[164:167], v[0:3]
    v_exp_f32 v39, v39
    v_mfma_f32_16x16x32_bf16 v[0:3], a[200:203], v[168:171], v[0:3]
    v_cvt_pk_bf16_f32 v34, v36, v37
    v_cvt_pk_bf16_f32 v35, v38, v39
    v_mfma_f32_16x16x32_bf16 v[0:3], a[204:207], v[172:175], v[0:3]
    v_mfma_f32_16x16x32_bf16 v[4:7], a[208:211], v[160:163], v[40:43]
    v_mfma_f32_16x16x32_bf16 v[4:7], a[212:215], v[164:167], v[4:7]
    v_mfma_f32_16x16x32_bf16 v[4:7], a[216:219], v[168:171], v[4:7]
    v_exp_f32 v0, v0
    v_mfma_f32_16x16x32_bf16 v[4:7], a[220:223], v[172:175], v[4:7]
    v_exp_f32 v1, v1
    v_mfma_f32_16x16x32_bf16 a[96:99], a[224:227], v[24:27], a[96:99]
    v_exp_f32 v2, v2
    v_mfma_f32_16x16x32_bf16 a[100:103], a[228:231], v[24:27], a[100:103]
    v_exp_f32 v3, v3
    v_mfma_f32_16x16x32_bf16 a[104:107], a[232:235], v[24:27], a[104:107]
    s_waitcnt vmcnt(16) lgkmcnt(0)
    s_barrier
    v_mfma_f32_16x16x32_bf16 a[108:111], a[236:239], v[24:27], a[108:111]
    s_add_u32 s38, s74, s3
    s_add_u32 m0, s38, 0
    s_xor_b32 s87, s85, s86
    v_mfma_f32_16x16x32_bf16 a[112:115], a[240:243], v[24:27], a[112:115]
    s_add_u32 s74, s74, s44
    s_add_u32 s85, s85, 4096
    v_cvt_pk_bf16_f32 v0, v0, v1
    v_mfma_f32_16x16x32_bf16 a[116:119], a[244:247], v[24:27], a[116:119]
    buffer_load_dwordx4 v220, s[20:23], s87 offen nt lds
    v_mfma_f32_16x16x32_bf16 a[120:123], a[248:251], v[24:27], a[120:123]
    s_add_u32 m0, s38, 4096
    s_xor_b32 s87, s85, s86
    s_add_u32 s85, s85, 4096
    v_mfma_f32_16x16x32_bf16 a[124:127], a[252:255], v[24:27], a[124:127]
    s_cmp_eq_u32 s74, 0x18000
    s_cselect_b32 s44, s45, s46
    v_cvt_pk_bf16_f32 v1, v2, v3
    v_mfma_f32_16x16x32_bf16 v[72:75], v[228:231], v[24:27], v[72:75]
    buffer_load_dwordx4 v220, s[20:23], s87 offen nt lds
    v_exp_f32 v4, v4
    v_mfma_f32_16x16x32_bf16 v[8:11], a[192:195], v[176:179], v[44:47]
    s_add_u32 m0, s38, 8192
    v_exp_f32 v5, v5
    v_mfma_f32_16x16x32_bf16 v[8:11], a[196:199], v[180:183], v[8:11]
    s_xor_b32 s87, s85, s86
    v_exp_f32 v6, v6
    v_mfma_f32_16x16x32_bf16 v[8:11], a[200:203], v[184:187], v[8:11]
    s_add_u32 s85, s85, 4096
    v_exp_f32 v7, v7
    v_mfma_f32_16x16x32_bf16 v[8:11], a[204:207], v[188:191], v[8:11]
    v_cvt_pk_bf16_f32 v2, v4, v5
    v_cvt_pk_bf16_f32 v3, v6, v7
    v_mfma_f32_16x16x32_bf16 v[12:15], a[208:211], v[176:179], v[44:47]
    buffer_load_dwordx4 v220, s[20:23], s87 offen nt lds
    v_mfma_f32_16x16x32_bf16 v[12:15], a[212:215], v[180:183], v[12:15]
    s_add_u32 m0, s38, 12288
    s_xor_b32 s87, s85, s86
    s_add_u32 s85, s85, 4096
    v_mfma_f32_16x16x32_bf16 v[12:15], a[216:219], v[184:187], v[12:15]
    buffer_load_dwordx4 v220, s[20:23], s87 offen nt lds
    v_exp_f32 v8, v8
    v_mfma_f32_16x16x32_bf16 v[12:15], a[220:223], v[188:191], v[12:15]
    s_add_u32 m0, s38, 16384
    v_exp_f32 v9, v9
    v_mfma_f32_16x16x32_bf16 a[128:131], a[224:227], v[32:35], a[128:131]
    s_xor_b32 s87, s37, s86
    ds_read_b64_tr_b16 a[224:225], v212 offset:16384
    ds_read_b64_tr_b16 a[226:227], v212 offset:20480
    v_mfma_f32_16x16x32_bf16 a[132:135], a[228:231], v[32:35], a[132:135]
    s_add_u32 s37, s37, 4096
    v_exp_f32 v10, v10
    v_mfma_f32_16x16x32_bf16 a[136:139], a[232:235], v[32:35], a[136:139]
    ds_read_b64_tr_b16 a[228:229], v213 offset:16384
    ds_read_b64_tr_b16 a[230:231], v213 offset:20480
    v_mfma_f32_16x16x32_bf16 a[140:143], a[236:239], v[32:35], a[140:143]
    buffer_load_dwordx4 v224, s[24:27], s87 offen nt lds
    v_mfma_f32_16x16x32_bf16 a[144:147], a[240:243], v[32:35], a[144:147]
    s_add_u32 m0, s38, 20480
    ds_read_b64_tr_b16 a[232:233], v214 offset:16384
    ds_read_b64_tr_b16 a[234:235], v214 offset:20480
    v_mfma_f32_16x16x32_bf16 a[148:151], a[244:247], v[32:35], a[148:151]
    s_xor_b32 s87, s37, s86
    s_add_u32 s37, s37, 4096
    v_mfma_f32_16x16x32_bf16 a[152:155], a[248:251], v[32:35], a[152:155]
    ds_read_b64_tr_b16 a[236:237], v215 offset:16384
    ds_read_b64_tr_b16 a[238:239], v215 offset:20480
    buffer_load_dwordx4 v224, s[24:27], s87 offen nt lds
    v_mfma_f32_16x16x32_bf16 a[156:159], a[252:255], v[32:35], a[156:159]
    s_add_u32 m0, s38, 24576
    v_exp_f32 v11, v11
    v_mfma_f32_16x16x32_bf16 v[76:79], v[228:231], v[32:35], v[76:79]
    s_xor_b32 s87, s37, s86
    ds_read_b64_tr_b16 a[240:241], v216 offset:16384
    ds_read_b64_tr_b16 a[242:243], v216 offset:20480
    v_mfma_f32_16x16x32_bf16 v[16:19], a[192:195], v[192:195], v[48:51]
    s_add_u32 s37, s37, 4096
    v_cvt_pk_bf16_f32 v8, v8, v9
    v_cvt_pk_bf16_f32 v9, v10, v11
    v_mfma_f32_16x16x32_bf16 v[16:19], a[196:199], v[196:199], v[16:19]
    ds_read_b64_tr_b16 a[244:245], v217 offset:16384
    ds_read_b64_tr_b16 a[246:247], v217 offset:20480
    buffer_load_dwordx4 v224, s[24:27], s87 offen nt lds
    v_mfma_f32_16x16x32_bf16 v[16:19], a[200:203], v[200:203], v[16:19]
    s_add_u32 m0, s38, 28672
    v_exp_f32 v12, v12
    v_mfma_f32_16x16x32_bf16 v[16:19], a[204:207], v[204:207], v[16:19]
    s_xor_b32 s87, s37, s86
    ds_read_b64_tr_b16 a[248:249], v218 offset:16384
    ds_read_b64_tr_b16 a[250:251], v218 offset:20480
    v_mfma_f32_16x16x32_bf16 v[20:23], a[208:211], v[192:195], v[48:51]
    s_add_u32 s37, s37, 4096
    v_exp_f32 v13, v13
    v_mfma_f32_16x16x32_bf16 v[20:23], a[212:215], v[196:199], v[20:23]
    ds_read_b64_tr_b16 a[252:253], v219 offset:16384
    ds_read_b64_tr_b16 a[254:255], v219 offset:20480
    buffer_load_dwordx4 v224, s[24:27], s87 offen nt lds
    v_mfma_f32_16x16x32_bf16 v[20:23], a[216:219], v[200:203], v[20:23]
    v_exp_f32 v14, v14
    v_mfma_f32_16x16x32_bf16 v[20:23], a[220:223], v[204:207], v[20:23]
    s_waitcnt lgkmcnt(6)
    v_exp_f32 v15, v15
    v_mfma_f32_16x16x32_bf16 a[0:3], a[224:227], v[0:3], a[0:3]
    v_cvt_pk_bf16_f32 v10, v12, v13
    v_cvt_pk_bf16_f32 v11, v14, v15
    v_mfma_f32_16x16x32_bf16 a[4:7], a[228:231], v[0:3], a[4:7]
    v_exp_f32 v16, v16
    v_mfma_f32_16x16x32_bf16 a[8:11], a[232:235], v[0:3], a[8:11]
    v_exp_f32 v17, v17
    v_mfma_f32_16x16x32_bf16 a[12:15], a[236:239], v[0:3], a[12:15]
    v_mfma_f32_16x16x32_bf16 a[16:19], a[240:243], v[0:3], a[16:19]
    s_waitcnt lgkmcnt(2)
    v_mfma_f32_16x16x32_bf16 a[20:23], a[244:247], v[0:3], a[20:23]
    v_exp_f32 v18, v18
    v_mfma_f32_16x16x32_bf16 a[24:27], a[248:251], v[0:3], a[24:27]
    s_waitcnt lgkmcnt(0)
    v_exp_f32 v19, v19
    v_mfma_f32_16x16x32_bf16 a[28:31], a[252:255], v[0:3], a[28:31]
    v_cvt_pk_bf16_f32 v16, v16, v17
    v_cvt_pk_bf16_f32 v17, v18, v19
    v_mfma_f32_16x16x32_bf16 v[60:63], v[228:231], v[0:3], v[60:63]
    v_exp_f32 v20, v20
    v_mfma_f32_16x16x32_bf16 v[24:27], a[192:195], a[160:163], v[52:55]
    v_exp_f32 v21, v21
    v_mfma_f32_16x16x32_bf16 v[24:27], a[196:199], a[164:167], v[24:27]
    ds_read_b128 a[192:195], v208 offset:0
    ds_read_b128 a[196:199], v209 offset:0
    v_mfma_f32_16x16x32_bf16 v[24:27], a[200:203], a[168:171], v[24:27]
    v_exp_f32 v22, v22
    v_mfma_f32_16x16x32_bf16 v[24:27], a[204:207], a[172:175], v[24:27]
    ds_read_b128 a[200:203], v210 offset:0
    ds_read_b128 a[204:207], v211 offset:0
    v_mfma_f32_16x16x32_bf16 v[28:31], a[208:211], a[160:163], v[52:55]
    v_exp_f32 v23, v23
    v_mfma_f32_16x16x32_bf16 v[28:31], a[212:215], a[164:167], v[28:31]
    ds_read_b128 a[208:211], v208 offset:4096
    ds_read_b128 a[212:215], v209 offset:4096
    v_mfma_f32_16x16x32_bf16 v[28:31], a[216:219], a[168:171], v[28:31]
    v_cvt_pk_bf16_f32 v18, v20, v21
    v_cvt_pk_bf16_f32 v19, v22, v23
    v_mfma_f32_16x16x32_bf16 v[28:31], a[220:223], a[172:175], v[28:31]
    ds_read_b128 a[216:219], v210 offset:4096
    ds_read_b128 a[220:223], v211 offset:4096
    v_mfma_f32_16x16x32_bf16 a[32:35], a[224:227], v[8:11], a[32:35]
    v_exp_f32 v24, v24
    v_mfma_f32_16x16x32_bf16 a[36:39], a[228:231], v[8:11], a[36:39]
    v_exp_f32 v25, v25
    v_mfma_f32_16x16x32_bf16 a[40:43], a[232:235], v[8:11], a[40:43]
    v_exp_f32 v26, v26
    v_mfma_f32_16x16x32_bf16 a[44:47], a[236:239], v[8:11], a[44:47]
    v_mfma_f32_16x16x32_bf16 a[48:51], a[240:243], v[8:11], a[48:51]
    v_mfma_f32_16x16x32_bf16 a[52:55], a[244:247], v[8:11], a[52:55]
    v_exp_f32 v27, v27
    v_mfma_f32_16x16x32_bf16 a[56:59], a[248:251], v[8:11], a[56:59]
    v_cvt_pk_bf16_f32 v24, v24, v25
    v_cvt_pk_bf16_f32 v25, v26, v27
    v_mfma_f32_16x16x32_bf16 a[60:63], a[252:255], v[8:11], a[60:63]
    v_exp_f32 v28, v28
    v_mfma_f32_16x16x32_bf16 v[64:67], v[228:231], v[8:11], v[64:67]
    s_waitcnt lgkmcnt(0)
    v_exp_f32 v29, v29
    v_mfma_f32_16x16x32_bf16 v[0:3], a[192:195], v[160:163], v[40:43]
    v_exp_f32 v30, v30
    v_mfma_f32_16x16x32_bf16 v[0:3], a[196:199], v[164:167], v[0:3]
    v_exp_f32 v31, v31
    v_mfma_f32_16x16x32_bf16 v[0:3], a[200:203], v[168:171], v[0:3]
    v_cvt_pk_bf16_f32 v26, v28, v29
    v_cvt_pk_bf16_f32 v27, v30, v31
    v_mfma_f32_16x16x32_bf16 v[0:3], a[204:207], v[172:175], v[0:3]
    v_mfma_f32_16x16x32_bf16 v[4:7], a[208:211], v[160:163], v[40:43]
    v_mfma_f32_16x16x32_bf16 v[4:7], a[212:215], v[164:167], v[4:7]
    v_mfma_f32_16x16x32_bf16 v[4:7], a[216:219], v[168:171], v[4:7]
    v_exp_f32 v0, v0
    v_mfma_f32_16x16x32_bf16 v[4:7], a[220:223], v[172:175], v[4:7]
    v_exp_f32 v1, v1
    v_mfma_f32_16x16x32_bf16 a[64:67], a[224:227], v[16:19], a[64:67]
    v_exp_f32 v2, v2
    v_mfma_f32_16x16x32_bf16 a[68:71], a[228:231], v[16:19], a[68:71]
    v_exp_f32 v3, v3
    v_mfma_f32_16x16x32_bf16 a[72:75], a[232:235], v[16:19], a[72:75]
    v_cvt_pk_bf16_f32 v0, v0, v1
    v_cvt_pk_bf16_f32 v1, v2, v3
    v_mfma_f32_16x16x32_bf16 a[76:79], a[236:239], v[16:19], a[76:79]
    v_mfma_f32_16x16x32_bf16 a[80:83], a[240:243], v[16:19], a[80:83]
    v_mfma_f32_16x16x32_bf16 a[84:87], a[244:247], v[16:19], a[84:87]
    v_exp_f32 v4, v4
    v_mfma_f32_16x16x32_bf16 a[88:91], a[248:251], v[16:19], a[88:91]
    v_exp_f32 v5, v5
    v_mfma_f32_16x16x32_bf16 a[92:95], a[252:255], v[16:19], a[92:95]
    v_exp_f32 v6, v6
    v_mfma_f32_16x16x32_bf16 v[68:71], v[228:231], v[16:19], v[68:71]
    v_exp_f32 v7, v7
    v_mfma_f32_16x16x32_bf16 v[8:11], a[192:195], v[176:179], v[44:47]
    v_cvt_pk_bf16_f32 v2, v4, v5
    v_cvt_pk_bf16_f32 v3, v6, v7
    v_mfma_f32_16x16x32_bf16 v[8:11], a[196:199], v[180:183], v[8:11]
    v_mfma_f32_16x16x32_bf16 v[8:11], a[200:203], v[184:187], v[8:11]
    v_mfma_f32_16x16x32_bf16 v[8:11], a[204:207], v[188:191], v[8:11]
    v_mfma_f32_16x16x32_bf16 v[12:15], a[208:211], v[176:179], v[44:47]
    v_mfma_f32_16x16x32_bf16 v[12:15], a[212:215], v[180:183], v[12:15]
    v_mfma_f32_16x16x32_bf16 v[12:15], a[216:219], v[184:187], v[12:15]
    v_exp_f32 v8, v8
    v_mfma_f32_16x16x32_bf16 v[12:15], a[220:223], v[188:191], v[12:15]
    v_exp_f32 v9, v9
    v_mfma_f32_16x16x32_bf16 a[96:99], a[224:227], v[24:27], a[96:99]
    ds_read_b64_tr_b16 a[224:225], v212 offset:24576
    ds_read_b64_tr_b16 a[226:227], v212 offset:28672
    v_mfma_f32_16x16x32_bf16 a[100:103], a[228:231], v[24:27], a[100:103]
    v_exp_f32 v10, v10
    v_mfma_f32_16x16x32_bf16 a[104:107], a[232:235], v[24:27], a[104:107]
    ds_read_b64_tr_b16 a[228:229], v213 offset:24576
    ds_read_b64_tr_b16 a[230:231], v213 offset:28672
    v_mfma_f32_16x16x32_bf16 a[108:111], a[236:239], v[24:27], a[108:111]
    v_mfma_f32_16x16x32_bf16 a[112:115], a[240:243], v[24:27], a[112:115]
    ds_read_b64_tr_b16 a[232:233], v214 offset:24576
    ds_read_b64_tr_b16 a[234:235], v214 offset:28672
    v_mfma_f32_16x16x32_bf16 a[116:119], a[244:247], v[24:27], a[116:119]
    v_mfma_f32_16x16x32_bf16 a[120:123], a[248:251], v[24:27], a[120:123]
    ds_read_b64_tr_b16 a[236:237], v215 offset:24576
    ds_read_b64_tr_b16 a[238:239], v215 offset:28672
    v_mfma_f32_16x16x32_bf16 a[124:127], a[252:255], v[24:27], a[124:127]
    v_add_u32 v212, s44, v212
    v_add_u32 v213, s44, v213
    v_mfma_f32_16x16x32_bf16 v[72:75], v[228:231], v[24:27], v[72:75]
    ds_read_b64_tr_b16 a[240:241], v216 offset:24576
    ds_read_b64_tr_b16 a[242:243], v216 offset:28672
    v_mfma_f32_16x16x32_bf16 v[16:19], a[192:195], v[192:195], v[48:51]
    s_lshl_b32 s67, s36, 19
    v_add_u32 v214, s44, v214
    v_add_u32 v215, s44, v215
    v_mfma_f32_16x16x32_bf16 v[16:19], a[196:199], v[196:199], v[16:19]
    s_add_u32 s67, s67, s70
    ds_read_b64_tr_b16 a[244:245], v217 offset:24576
    ds_read_b64_tr_b16 a[246:247], v217 offset:28672
    v_mfma_f32_16x16x32_bf16 v[16:19], a[200:203], v[200:203], v[16:19]
    s_add_u32 s66, s67, 0
    v_add_u32 v216, s44, v216
    v_add_u32 v217, s44, v217
    v_mfma_f32_16x16x32_bf16 v[16:19], a[204:207], v[204:207], v[16:19]
    ds_read_b64_tr_b16 a[248:249], v218 offset:24576
    ds_read_b64_tr_b16 a[250:251], v218 offset:28672
    buffer_store_dwordx4 v[80:83], v233, s[12:15], s66 offen offset:0
    v_mfma_f32_16x16x32_bf16 v[20:23], a[208:211], v[192:195], v[48:51]
    buffer_store_dwordx4 v[84:87], v233, s[12:15], s66 offen offset:1024
    v_exp_f32 v11, v11
    v_mfma_f32_16x16x32_bf16 v[20:23], a[212:215], v[196:199], v[20:23]
    ds_read_b64_tr_b16 a[252:253], v219 offset:24576
    ds_read_b64_tr_b16 a[254:255], v219 offset:28672
    v_mfma_f32_16x16x32_bf16 v[20:23], a[216:219], v[200:203], v[20:23]
    v_add_u32 v218, s44, v218
    v_add_u32 v219, s44, v219
    v_mfma_f32_16x16x32_bf16 v[20:23], a[220:223], v[204:207], v[20:23]
    s_waitcnt lgkmcnt(6)
    v_cvt_pk_bf16_f32 v8, v8, v9
    v_cvt_pk_bf16_f32 v9, v10, v11
    v_mfma_f32_16x16x32_bf16 a[0:3], a[224:227], v[0:3], a[0:3]
    buffer_store_dwordx4 v[88:91], v233, s[12:15], s66 offen offset:2048
    v_exp_f32 v12, v12
    v_mfma_f32_16x16x32_bf16 a[4:7], a[228:231], v[0:3], a[4:7]
    v_exp_f32 v13, v13
    v_mfma_f32_16x16x32_bf16 a[8:11], a[232:235], v[0:3], a[8:11]
    v_exp_f32 v14, v14
    v_mfma_f32_16x16x32_bf16 a[12:15], a[236:239], v[0:3], a[12:15]
    v_mfma_f32_16x16x32_bf16 a[16:19], a[240:243], v[0:3], a[16:19]
    s_waitcnt lgkmcnt(2)
    buffer_store_dwordx4 v[92:95], v233, s[12:15], s66 offen offset:3072
    v_mfma_f32_16x16x32_bf16 a[20:23], a[244:247], v[0:3], a[20:23]
    s_add_u32 s66, s67, 131072
    v_exp_f32 v15, v15
    v_mfma_f32_16x16x32_bf16 a[24:27], a[248:251], v[0:3], a[24:27]
    s_waitcnt lgkmcnt(0)
    v_cvt_pk_bf16_f32 v10, v12, v13
    v_cvt_pk_bf16_f32 v11, v14, v15
    v_mfma_f32_16x16x32_bf16 a[28:31], a[252:255], v[0:3], a[28:31]
    v_exp_f32 v16, v16
    v_mfma_f32_16x16x32_bf16 v[60:63], v[228:231], v[0:3], v[60:63]
    buffer_store_dwordx4 v[96:99], v233, s[12:15], s66 offen offset:0
    v_exp_f32 v17, v17
    v_mfma_f32_16x16x32_bf16 v[24:27], a[192:195], a[160:163], v[52:55]
    v_exp_f32 v18, v18
    v_mfma_f32_16x16x32_bf16 v[24:27], a[196:199], a[164:167], v[24:27]
    v_exp_f32 v19, v19
    v_mfma_f32_16x16x32_bf16 v[24:27], a[200:203], a[168:171], v[24:27]
    v_cvt_pk_bf16_f32 v16, v16, v17
    v_cvt_pk_bf16_f32 v17, v18, v19
    v_mfma_f32_16x16x32_bf16 v[24:27], a[204:207], a[172:175], v[24:27]
    buffer_store_dwordx4 v[100:103], v233, s[12:15], s66 offen offset:1024
    v_exp_f32 v20, v20
    v_mfma_f32_16x16x32_bf16 v[28:31], a[208:211], a[160:163], v[52:55]
    v_exp_f32 v21, v21
    v_mfma_f32_16x16x32_bf16 v[28:31], a[212:215], a[164:167], v[28:31]
    v_exp_f32 v22, v22
    v_mfma_f32_16x16x32_bf16 v[28:31], a[216:219], a[168:171], v[28:31]
    v_exp_f32 v23, v23
    v_mfma_f32_16x16x32_bf16 v[28:31], a[220:223], a[172:175], v[28:31]
    buffer_store_dwordx4 v[104:107], v233, s[12:15], s66 offen offset:2048
    v_cvt_pk_bf16_f32 v18, v20, v21
    v_cvt_pk_bf16_f32 v19, v22, v23
    v_mfma_f32_16x16x32_bf16 a[32:35], a[224:227], v[8:11], a[32:35]
    v_exp_f32 v24, v24
    v_mfma_f32_16x16x32_bf16 a[36:39], a[228:231], v[8:11], a[36:39]
    v_exp_f32 v25, v25
    v_mfma_f32_16x16x32_bf16 a[40:43], a[232:235], v[8:11], a[40:43]
    v_exp_f32 v26, v26
    v_mfma_f32_16x16x32_bf16 a[44:47], a[236:239], v[8:11], a[44:47]
    buffer_store_dwordx4 v[108:111], v233, s[12:15], s66 offen offset:3072
    v_mfma_f32_16x16x32_bf16 a[48:51], a[240:243], v[8:11], a[48:51]
    s_add_u32 s66, s67, 262144
    v_exp_f32 v27, v27
    v_mfma_f32_16x16x32_bf16 a[52:55], a[244:247], v[8:11], a[52:55]
    v_cvt_pk_bf16_f32 v24, v24, v25
    v_cvt_pk_bf16_f32 v25, v26, v27
    v_mfma_f32_16x16x32_bf16 a[56:59], a[248:251], v[8:11], a[56:59]
    v_exp_f32 v28, v28
    v_mfma_f32_16x16x32_bf16 a[60:63], a[252:255], v[8:11], a[60:63]
    buffer_store_dwordx4 v[112:115], v233, s[12:15], s66 offen offset:0
    v_exp_f32 v29, v29
    v_mfma_f32_16x16x32_bf16 v[64:67], v[228:231], v[8:11], v[64:67]
    v_exp_f32 v30, v30
    v_mfma_f32_16x16x32_bf16 v[32:35], a[192:195], a[176:179], v[56:59]
    v_exp_f32 v31, v31
    v_mfma_f32_16x16x32_bf16 v[32:35], a[196:199], a[180:183], v[32:35]
    ds_read_b128 a[192:195], v208 offset:8192
    ds_read_b128 a[196:199], v209 offset:8192
    v_mfma_f32_16x16x32_bf16 v[32:35], a[200:203], a[184:187], v[32:35]
    v_cvt_pk_bf16_f32 v26, v28, v29
    v_cvt_pk_bf16_f32 v27, v30, v31
    v_mfma_f32_16x16x32_bf16 v[32:35], a[204:207], a[188:191], v[32:35]
    ds_read_b128 a[200:203], v210 offset:8192
    ds_read_b128 a[204:207], v211 offset:8192
    v_mfma_f32_16x16x32_bf16 v[36:39], a[208:211], a[176:179], v[56:59]
    buffer_store_dwordx4 v[116:119], v233, s[12:15], s66 offen offset:1024
    v_mfma_f32_16x16x32_bf16 v[36:39], a[212:215], a[180:183], v[36:39]
    ds_read_b128 a[208:211], v208 offset:12288
    ds_read_b128 a[212:215], v209 offset:12288
    v_mfma_f32_16x16x32_bf16 v[36:39], a[216:219], a[184:187], v[36:39]
    buffer_store_dwordx4 v[120:123], v233, s[12:15], s66 offen offset:2048
    v_add_u32 v208, s44, v208
    v_add_u32 v209, s44, v209
    v_mfma_f32_16x16x32_bf16 v[36:39], a[220:223], a[188:191], v[36:39]
    ds_read_b128 a[216:219], v210 offset:12288
    ds_read_b128 a[220:223], v211 offset:12288
    v_mfma_f32_16x16x32_bf16 a[64:67], a[224:227], v[16:19], a[64:67]
    v_add_u32 v210, s44, v210
    v_add_u32 v211, s44, v211
    v_mfma_f32_16x16x32_bf16 a[68:71], a[228:231], v[16:19], a[68:71]
    v_exp_f32 v32, v32
    v_mfma_f32_16x16x32_bf16 a[72:75], a[232:235], v[16:19], a[72:75]
    buffer_store_dwordx4 v[124:127], v233, s[12:15], s66 offen offset:3072
    v_exp_f32 v33, v33
    v_mfma_f32_16x16x32_bf16 a[76:79], a[236:239], v[16:19], a[76:79]
    v_exp_f32 v34, v34
    v_mfma_f32_16x16x32_bf16 a[80:83], a[240:243], v[16:19], a[80:83]
    v_exp_f32 v35, v35
    v_mfma_f32_16x16x32_bf16 a[84:87], a[244:247], v[16:19], a[84:87]
    v_cvt_pk_bf16_f32 v32, v32, v33
    v_cvt_pk_bf16_f32 v33, v34, v35
    v_mfma_f32_16x16x32_bf16 a[88:91], a[248:251], v[16:19], a[88:91]
    v_exp_f32 v36, v36
    v_mfma_f32_16x16x32_bf16 a[92:95], a[252:255], v[16:19], a[92:95]
    v_exp_f32 v37, v37
    v_mfma_f32_16x16x32_bf16 v[68:71], v[228:231], v[16:19], v[68:71]
    s_waitcnt lgkmcnt(0)
    v_mfma_f32_16x16x32_bf16 v[0:3], a[192:195], v[160:163], v[40:43]
    v_exp_f32 v38, v38
    v_mfma_f32_16x16x32_bf16 v[0:3], a[196:199], v[164:167], v[0:3]
    v_exp_f32 v39, v39
    v_mfma_f32_16x16x32_bf16 v[0:3], a[200:203], v[168:171], v[0:3]
    s_add_u32 s66, s67, 393216
    v_cvt_pk_bf16_f32 v34, v36, v37
    v_cvt_pk_bf16_f32 v35, v38, v39
    v_mfma_f32_16x16x32_bf16 v[0:3], a[204:207], v[172:175], v[0:3]
    buffer_store_dwordx4 v[128:131], v233, s[12:15], s66 offen offset:0
    v_mfma_f32_16x16x32_bf16 v[4:7], a[208:211], v[160:163], v[40:43]
    v_mfma_f32_16x16x32_bf16 v[4:7], a[212:215], v[164:167], v[4:7]
    v_mfma_f32_16x16x32_bf16 v[4:7], a[216:219], v[168:171], v[4:7]
    buffer_store_dwordx4 v[132:135], v233, s[12:15], s66 offen offset:1024
    v_exp_f32 v0, v0
    v_mfma_f32_16x16x32_bf16 v[4:7], a[220:223], v[172:175], v[4:7]
    v_exp_f32 v1, v1
    v_mfma_f32_16x16x32_bf16 a[96:99], a[224:227], v[24:27], a[96:99]
    v_exp_f32 v2, v2
    v_mfma_f32_16x16x32_bf16 a[100:103], a[228:231], v[24:27], a[100:103]
    v_exp_f32 v3, v3
    v_mfma_f32_16x16x32_bf16 a[104:107], a[232:235], v[24:27], a[104:107]
    s_waitcnt vmcnt(28) lgkmcnt(0)
    s_barrier
    v_mfma_f32_16x16x32_bf16 a[108:111], a[236:239], v[24:27], a[108:111]
    s_add_u32 s38, s74, s3
    buffer_store_dwordx4 v[136:139], v233, s[12:15], s66 offen offset:2048
    v_mfma_f32_16x16x32_bf16 a[112:115], a[240:243], v[24:27], a[112:115]
    s_add_u32 s74, s74, s44
    v_cvt_pk_bf16_f32 v0, v0, v1
    v_mfma_f32_16x16x32_bf16 a[116:119], a[244:247], v[24:27], a[116:119]
    v_mfma_f32_16x16x32_bf16 a[120:123], a[248:251], v[24:27], a[120:123]
    buffer_store_dwordx4 v[140:143], v233, s[12:15], s66 offen offset:3072
    v_mfma_f32_16x16x32_bf16 a[124:127], a[252:255], v[24:27], a[124:127]
    s_cmp_eq_u32 s74, 0x18000
    s_cselect_b32 s44, s45, s46
    v_cvt_pk_bf16_f32 v1, v2, v3
    v_mfma_f32_16x16x32_bf16 v[72:75], v[228:231], v[24:27], v[72:75]
    s_lshr_b32 s66, s36, 1
    v_exp_f32 v4, v4
    v_mfma_f32_16x16x32_bf16 v[8:11], a[192:195], v[176:179], v[44:47]
    s_lshl_b32 s66, s66, 17
    v_exp_f32 v5, v5
    v_mfma_f32_16x16x32_bf16 v[8:11], a[196:199], v[180:183], v[8:11]
    s_add_u32 s66, s66, s70
    v_exp_f32 v6, v6
    v_mfma_f32_16x16x32_bf16 v[8:11], a[200:203], v[184:187], v[8:11]
    s_add_u32 s66, s66, 2097152
    v_exp_f32 v7, v7
    v_mfma_f32_16x16x32_bf16 v[8:11], a[204:207], v[188:191], v[8:11]
    v_cvt_pk_bf16_f32 v2, v4, v5
    v_cvt_pk_bf16_f32 v3, v6, v7
    v_mfma_f32_16x16x32_bf16 v[12:15], a[208:211], v[176:179], v[44:47]
    buffer_store_dwordx4 v[144:147], v233, s[12:15], s66 offen offset:2048
    v_mfma_f32_16x16x32_bf16 v[12:15], a[212:215], v[180:183], v[12:15]
    buffer_store_dwordx4 v[148:151], v233, s[12:15], s66 offen offset:3072
    v_mfma_f32_16x16x32_bf16 v[12:15], a[216:219], v[184:187], v[12:15]
    v_exp_f32 v8, v8
    v_mfma_f32_16x16x32_bf16 v[12:15], a[220:223], v[188:191], v[12:15]
    v_exp_f32 v9, v9
    v_mfma_f32_16x16x32_bf16 a[128:131], a[224:227], v[32:35], a[128:131]
    s_add_u32 m0, s38, 0
    ds_read_b64_tr_b16 a[224:225], v212 offset:16384
    ds_read_b64_tr_b16 a[226:227], v212 offset:20480
    v_mfma_f32_16x16x32_bf16 a[132:135], a[228:231], v[32:35], a[132:135]
    s_xor_b32 s87, s85, s86
    v_exp_f32 v10, v10
    v_mfma_f32_16x16x32_bf16 a[136:139], a[232:235], v[32:35], a[136:139]
    s_add_u32 s85, s85, 4096
    ds_read_b64_tr_b16 a[228:229], v213 offset:16384
    ds_read_b64_tr_b16 a[230:231], v213 offset:20480
    v_mfma_f32_16x16x32_bf16 a[140:143], a[236:239], v[32:35], a[140:143]
    buffer_load_dwordx4 v220, s[20:23], s87 offen nt lds
    v_mfma_f32_16x16x32_bf16 a[144:147], a[240:243], v[32:35], a[144:147]
    s_add_u32 m0, s38, 4096
    ds_read_b64_tr_b16 a[232:233], v214 offset:16384
    ds_read_b64_tr_b16 a[234:235], v214 offset:20480
    v_mfma_f32_16x16x32_bf16 a[148:151], a[244:247], v[32:35], a[148:151]
    s_xor_b32 s87, s85, s86
    s_add_u32 s85, s85, 4096
    v_mfma_f32_16x16x32_bf16 a[152:155], a[248:251], v[32:35], a[152:155]
    ds_read_b64_tr_b16 a[236:237], v215 offset:16384
    ds_read_b64_tr_b16 a[238:239], v215 offset:20480
    v_mfma_f32_16x16x32_bf16 a[156:159], a[252:255], v[32:35], a[156:159]
    v_exp_f32 v11, v11
    v_mfma_f32_16x16x32_bf16 v[76:79], v[228:231], v[32:35], v[76:79]
    ds_read_b64_tr_b16 a[240:241], v216 offset:16384
    ds_read_b64_tr_b16 a[242:243], v216 offset:20480
    v_mfma_f32_16x16x32_bf16 v[16:19], a[192:195], v[192:195], v[48:51]
    v_cvt_pk_bf16_f32 v8, v8, v9
    v_cvt_pk_bf16_f32 v9, v10, v11
    v_mfma_f32_16x16x32_bf16 v[16:19], a[196:199], v[196:199], v[16:19]
    ds_read_b64_tr_b16 a[244:245], v217 offset:16384
    ds_read_b64_tr_b16 a[246:247], v217 offset:20480
    v_mfma_f32_16x16x32_bf16 v[16:19], a[200:203], v[200:203], v[16:19]
    v_exp_f32 v12, v12
    v_mfma_f32_16x16x32_bf16 v[16:19], a[204:207], v[204:207], v[16:19]
    ds_read_b64_tr_b16 a[248:249], v218 offset:16384
    ds_read_b64_tr_b16 a[250:251], v218 offset:20480
    v_mfma_f32_16x16x32_bf16 v[20:23], a[208:211], v[192:195], v[48:51]
    v_exp_f32 v13, v13
    v_mfma_f32_16x16x32_bf16 v[20:23], a[212:215], v[196:199], v[20:23]
    ds_read_b64_tr_b16 a[252:253], v219 offset:16384
    ds_read_b64_tr_b16 a[254:255], v219 offset:20480
    v_mfma_f32_16x16x32_bf16 v[20:23], a[216:219], v[200:203], v[20:23]
    v_exp_f32 v14, v14
    v_mfma_f32_16x16x32_bf16 v[20:23], a[220:223], v[204:207], v[20:23]
    s_waitcnt lgkmcnt(6)
    v_exp_f32 v15, v15
    v_mfma_f32_16x16x32_bf16 a[0:3], a[224:227], v[0:3], a[0:3]
    v_cvt_pk_bf16_f32 v10, v12, v13
    v_cvt_pk_bf16_f32 v11, v14, v15
    v_mfma_f32_16x16x32_bf16 a[4:7], a[228:231], v[0:3], a[4:7]
    v_exp_f32 v16, v16
    v_mfma_f32_16x16x32_bf16 a[8:11], a[232:235], v[0:3], a[8:11]
    v_exp_f32 v17, v17
    v_mfma_f32_16x16x32_bf16 a[12:15], a[236:239], v[0:3], a[12:15]
    buffer_load_dwordx4 v220, s[20:23], s87 offen nt lds
    v_mfma_f32_16x16x32_bf16 a[16:19], a[240:243], v[0:3], a[16:19]
    s_waitcnt lgkmcnt(2)
    s_add_u32 m0, s38, 8192
    s_xor_b32 s87, s85, s86
    v_mfma_f32_16x16x32_bf16 a[20:23], a[244:247], v[0:3], a[20:23]
    s_add_u32 s85, s85, 4096
    v_exp_f32 v18, v18
    v_mfma_f32_16x16x32_bf16 a[24:27], a[248:251], v[0:3], a[24:27]
    s_waitcnt lgkmcnt(0)
    v_exp_f32 v19, v19
    v_mfma_f32_16x16x32_bf16 a[28:31], a[252:255], v[0:3], a[28:31]
    v_cvt_pk_bf16_f32 v16, v16, v17
    v_cvt_pk_bf16_f32 v17, v18, v19
    v_mfma_f32_16x16x32_bf16 v[60:63], v[228:231], v[0:3], v[60:63]
    v_exp_f32 v20, v20
    v_mfma_f32_16x16x32_bf16 v[24:27], a[192:195], a[160:163], v[52:55]
    v_exp_f32 v21, v21
    v_mfma_f32_16x16x32_bf16 v[24:27], a[196:199], a[164:167], v[24:27]
    ds_read_b128 a[192:195], v208 offset:0
    ds_read_b128 a[196:199], v209 offset:0
    v_mfma_f32_16x16x32_bf16 v[24:27], a[200:203], a[168:171], v[24:27]
    buffer_load_dwordx4 v220, s[20:23], s87 offen nt lds
    v_exp_f32 v22, v22
    v_mfma_f32_16x16x32_bf16 v[24:27], a[204:207], a[172:175], v[24:27]
    s_add_u32 m0, s38, 12288
    ds_read_b128 a[200:203], v210 offset:0
    ds_read_b128 a[204:207], v211 offset:0
    v_mfma_f32_16x16x32_bf16 v[28:31], a[208:211], a[160:163], v[52:55]
    s_xor_b32 s87, s85, s86
    v_exp_f32 v23, v23
    v_mfma_f32_16x16x32_bf16 v[28:31], a[212:215], a[164:167], v[28:31]
    s_add_u32 s85, s85, 4096
    ds_read_b128 a[208:211], v208 offset:4096
    ds_read_b128 a[212:215], v209 offset:4096
    v_mfma_f32_16x16x32_bf16 v[28:31], a[216:219], a[168:171], v[28:31]
    v_cvt_pk_bf16_f32 v18, v20, v21
    v_cvt_pk_bf16_f32 v19, v22, v23
    v_mfma_f32_16x16x32_bf16 v[28:31], a[220:223], a[172:175], v[28:31]
    ds_read_b128 a[216:219], v210 offset:4096
    ds_read_b128 a[220:223], v211 offset:4096
    v_mfma_f32_16x16x32_bf16 a[32:35], a[224:227], v[8:11], a[32:35]
    v_exp_f32 v24, v24
    v_mfma_f32_16x16x32_bf16 a[36:39], a[228:231], v[8:11], a[36:39]
    v_exp_f32 v25, v25
    v_mfma_f32_16x16x32_bf16 a[40:43], a[232:235], v[8:11], a[40:43]
    v_exp_f32 v26, v26
    v_mfma_f32_16x16x32_bf16 a[44:47], a[236:239], v[8:11], a[44:47]
    v_mfma_f32_16x16x32_bf16 a[48:51], a[240:243], v[8:11], a[48:51]
    v_mfma_f32_16x16x32_bf16 a[52:55], a[244:247], v[8:11], a[52:55]
    v_exp_f32 v27, v27
    v_mfma_f32_16x16x32_bf16 a[56:59], a[248:251], v[8:11], a[56:59]
    v_cvt_pk_bf16_f32 v24, v24, v25
    v_cvt_pk_bf16_f32 v25, v26, v27
    v_mfma_f32_16x16x32_bf16 a[60:63], a[252:255], v[8:11], a[60:63]
    v_exp_f32 v28, v28
    v_mfma_f32_16x16x32_bf16 v[64:67], v[228:231], v[8:11], v[64:67]
    s_waitcnt lgkmcnt(0)
    v_exp_f32 v29, v29
    v_mfma_f32_16x16x32_bf16 v[0:3], a[192:195], v[160:163], v[40:43]
    v_exp_f32 v30, v30
    v_mfma_f32_16x16x32_bf16 v[0:3], a[196:199], v[164:167], v[0:3]
    v_exp_f32 v31, v31
    v_mfma_f32_16x16x32_bf16 v[0:3], a[200:203], v[168:171], v[0:3]
    v_cvt_pk_bf16_f32 v26, v28, v29
    v_cvt_pk_bf16_f32 v27, v30, v31
    v_mfma_f32_16x16x32_bf16 v[0:3], a[204:207], v[172:175], v[0:3]
    buffer_load_dwordx4 v220, s[20:23], s87 offen nt lds
    v_mfma_f32_16x16x32_bf16 v[4:7], a[208:211], v[160:163], v[40:43]
    s_add_u32 m0, s38, 16384
    s_xor_b32 s87, s37, s86
    s_add_u32 s37, s37, 4096
    v_mfma_f32_16x16x32_bf16 v[4:7], a[212:215], v[164:167], v[4:7]
    v_mfma_f32_16x16x32_bf16 v[4:7], a[216:219], v[168:171], v[4:7]
    v_exp_f32 v0, v0
    v_mfma_f32_16x16x32_bf16 v[4:7], a[220:223], v[172:175], v[4:7]
    v_exp_f32 v1, v1
    v_mfma_f32_16x16x32_bf16 a[64:67], a[224:227], v[16:19], a[64:67]
    v_exp_f32 v2, v2
    v_mfma_f32_16x16x32_bf16 a[68:71], a[228:231], v[16:19], a[68:71]
    v_exp_f32 v3, v3
    v_mfma_f32_16x16x32_bf16 a[72:75], a[232:235], v[16:19], a[72:75]
    v_cvt_pk_bf16_f32 v0, v0, v1
    v_cvt_pk_bf16_f32 v1, v2, v3
    v_mfma_f32_16x16x32_bf16 a[76:79], a[236:239], v[16:19], a[76:79]
    v_mfma_f32_16x16x32_bf16 a[80:83], a[240:243], v[16:19], a[80:83]
    v_mfma_f32_16x16x32_bf16 a[84:87], a[244:247], v[16:19], a[84:87]
    v_exp_f32 v4, v4
    v_mfma_f32_16x16x32_bf16 a[88:91], a[248:251], v[16:19], a[88:91]
    v_exp_f32 v5, v5
    v_mfma_f32_16x16x32_bf16 a[92:95], a[252:255], v[16:19], a[92:95]
    v_exp_f32 v6, v6
    v_mfma_f32_16x16x32_bf16 v[68:71], v[228:231], v[16:19], v[68:71]
    v_exp_f32 v7, v7
    v_mfma_f32_16x16x32_bf16 v[8:11], a[192:195], v[176:179], v[44:47]
    v_cvt_pk_bf16_f32 v2, v4, v5
    v_cvt_pk_bf16_f32 v3, v6, v7
    v_mfma_f32_16x16x32_bf16 v[8:11], a[196:199], v[180:183], v[8:11]
    buffer_load_dwordx4 v224, s[24:27], s87 offen nt lds
    v_mfma_f32_16x16x32_bf16 v[8:11], a[200:203], v[184:187], v[8:11]
    s_add_u32 m0, s38, 20480
    s_xor_b32 s87, s37, s86
    s_add_u32 s37, s37, 4096
    v_mfma_f32_16x16x32_bf16 v[8:11], a[204:207], v[188:191], v[8:11]
    v_mfma_f32_16x16x32_bf16 v[12:15], a[208:211], v[176:179], v[44:47]
    v_mfma_f32_16x16x32_bf16 v[12:15], a[212:215], v[180:183], v[12:15]
    v_mfma_f32_16x16x32_bf16 v[12:15], a[216:219], v[184:187], v[12:15]
    v_exp_f32 v8, v8
    v_mfma_f32_16x16x32_bf16 v[12:15], a[220:223], v[188:191], v[12:15]
    v_exp_f32 v9, v9
    v_mfma_f32_16x16x32_bf16 a[96:99], a[224:227], v[24:27], a[96:99]
    ds_read_b64_tr_b16 a[224:225], v212 offset:24576
    ds_read_b64_tr_b16 a[226:227], v212 offset:28672
    v_mfma_f32_16x16x32_bf16 a[100:103], a[228:231], v[24:27], a[100:103]
    v_exp_f32 v10, v10
    v_mfma_f32_16x16x32_bf16 a[104:107], a[232:235], v[24:27], a[104:107]
    ds_read_b64_tr_b16 a[228:229], v213 offset:24576
    ds_read_b64_tr_b16 a[230:231], v213 offset:28672
    v_mfma_f32_16x16x32_bf16 a[108:111], a[236:239], v[24:27], a[108:111]
    buffer_load_dwordx4 v224, s[24:27], s87 offen nt lds
    v_mfma_f32_16x16x32_bf16 a[112:115], a[240:243], v[24:27], a[112:115]
    s_add_u32 m0, s38, 24576
    ds_read_b64_tr_b16 a[232:233], v214 offset:24576
    ds_read_b64_tr_b16 a[234:235], v214 offset:28672
    v_mfma_f32_16x16x32_bf16 a[116:119], a[244:247], v[24:27], a[116:119]
    s_xor_b32 s87, s37, s86
    s_add_u32 s37, s37, 4096
    v_mfma_f32_16x16x32_bf16 a[120:123], a[248:251], v[24:27], a[120:123]
    ds_read_b64_tr_b16 a[236:237], v215 offset:24576
    ds_read_b64_tr_b16 a[238:239], v215 offset:28672
    v_mfma_f32_16x16x32_bf16 a[124:127], a[252:255], v[24:27], a[124:127]
    v_add_u32 v212, s44, v212
    v_add_u32 v213, s44, v213
    v_mfma_f32_16x16x32_bf16 v[72:75], v[228:231], v[24:27], v[72:75]
    ds_read_b64_tr_b16 a[240:241], v216 offset:24576
    ds_read_b64_tr_b16 a[242:243], v216 offset:28672
    v_mfma_f32_16x16x32_bf16 v[16:19], a[192:195], v[192:195], v[48:51]
    v_add_u32 v214, s44, v214
    v_add_u32 v215, s44, v215
    v_mfma_f32_16x16x32_bf16 v[16:19], a[196:199], v[196:199], v[16:19]
    ds_read_b64_tr_b16 a[244:245], v217 offset:24576
    ds_read_b64_tr_b16 a[246:247], v217 offset:28672
    v_mfma_f32_16x16x32_bf16 v[16:19], a[200:203], v[200:203], v[16:19]
    v_add_u32 v216, s44, v216
    v_add_u32 v217, s44, v217
    v_mfma_f32_16x16x32_bf16 v[16:19], a[204:207], v[204:207], v[16:19]
    ds_read_b64_tr_b16 a[248:249], v218 offset:24576
    ds_read_b64_tr_b16 a[250:251], v218 offset:28672
    v_mfma_f32_16x16x32_bf16 v[20:23], a[208:211], v[192:195], v[48:51]
    v_exp_f32 v11, v11
    v_mfma_f32_16x16x32_bf16 v[20:23], a[212:215], v[196:199], v[20:23]
    ds_read_b64_tr_b16 a[252:253], v219 offset:24576
    ds_read_b64_tr_b16 a[254:255], v219 offset:28672
    v_mfma_f32_16x16x32_bf16 v[20:23], a[216:219], v[200:203], v[20:23]
    v_add_u32 v218, s44, v218
    v_add_u32 v219, s44, v219
    v_mfma_f32_16x16x32_bf16 v[20:23], a[220:223], v[204:207], v[20:23]
    s_waitcnt lgkmcnt(6)
    v_cvt_pk_bf16_f32 v8, v8, v9
    v_cvt_pk_bf16_f32 v9, v10, v11
    v_mfma_f32_16x16x32_bf16 a[0:3], a[224:227], v[0:3], a[0:3]
    v_exp_f32 v12, v12
    v_mfma_f32_16x16x32_bf16 a[4:7], a[228:231], v[0:3], a[4:7]
    v_exp_f32 v13, v13
    v_mfma_f32_16x16x32_bf16 a[8:11], a[232:235], v[0:3], a[8:11]
    v_exp_f32 v14, v14
    v_mfma_f32_16x16x32_bf16 a[12:15], a[236:239], v[0:3], a[12:15]
    buffer_load_dwordx4 v224, s[24:27], s87 offen nt lds
    v_mfma_f32_16x16x32_bf16 a[16:19], a[240:243], v[0:3], a[16:19]
    s_waitcnt lgkmcnt(2)
    s_add_u32 m0, s38, 28672
    s_xor_b32 s87, s37, s86
    v_mfma_f32_16x16x32_bf16 a[20:23], a[244:247], v[0:3], a[20:23]
    s_add_u32 s37, s37, 4096
    v_exp_f32 v15, v15
    v_mfma_f32_16x16x32_bf16 a[24:27], a[248:251], v[0:3], a[24:27]
    s_waitcnt lgkmcnt(0)
    v_cvt_pk_bf16_f32 v10, v12, v13
    v_cvt_pk_bf16_f32 v11, v14, v15
    v_mfma_f32_16x16x32_bf16 a[28:31], a[252:255], v[0:3], a[28:31]
    v_exp_f32 v16, v16
    v_mfma_f32_16x16x32_bf16 v[60:63], v[228:231], v[0:3], v[60:63]
    v_exp_f32 v17, v17
    v_mfma_f32_16x16x32_bf16 v[24:27], a[192:195], a[160:163], v[52:55]
    v_exp_f32 v18, v18
    v_mfma_f32_16x16x32_bf16 v[24:27], a[196:199], a[164:167], v[24:27]
    s_waitcnt vmcnt(7)
    s_barrier
    s_cmp_lg_u32 s36, 0
    s_cbranch_scc1 A1h1_arr
    s_lshl_b32 s64, s42, 3
    s_lshl_b64 s[62:63], 1, s64
    v_mov_b32 v226, s62
    v_mov_b32 v227, s63
    s_mov_b64 exec, 1
    global_atomic_add_x2 v239, v[226:227], s[48:49] offset:16
    s_mov_b64 exec, -1
A1h1_arr:
    v_exp_f32 v19, v19
    v_mfma_f32_16x16x32_bf16 v[24:27], a[200:203], a[168:171], v[24:27]
    v_cvt_pk_bf16_f32 v16, v16, v17
    v_cvt_pk_bf16_f32 v17, v18, v19
    v_mfma_f32_16x16x32_bf16 v[24:27], a[204:207], a[172:175], v[24:27]
    v_exp_f32 v20, v20
    v_mfma_f32_16x16x32_bf16 v[28:31], a[208:211], a[160:163], v[52:55]
    v_exp_f32 v21, v21
    v_mfma_f32_16x16x32_bf16 v[28:31], a[212:215], a[164:167], v[28:31]
    v_exp_f32 v22, v22
    v_mfma_f32_16x16x32_bf16 v[28:31], a[216:219], a[168:171], v[28:31]
    v_exp_f32 v23, v23
    v_mfma_f32_16x16x32_bf16 v[28:31], a[220:223], a[172:175], v[28:31]
    v_cvt_pk_bf16_f32 v18, v20, v21
    v_cvt_pk_bf16_f32 v19, v22, v23
    v_mfma_f32_16x16x32_bf16 a[32:35], a[224:227], v[8:11], a[32:35]
    v_exp_f32 v24, v24
    v_mfma_f32_16x16x32_bf16 a[36:39], a[228:231], v[8:11], a[36:39]
    v_exp_f32 v25, v25
    v_mfma_f32_16x16x32_bf16 a[40:43], a[232:235], v[8:11], a[40:43]
    v_exp_f32 v26, v26
    v_mfma_f32_16x16x32_bf16 a[44:47], a[236:239], v[8:11], a[44:47]
    buffer_load_dwordx4 v224, s[24:27], s87 offen nt lds
    v_mfma_f32_16x16x32_bf16 a[48:51], a[240:243], v[8:11], a[48:51]
    v_exp_f32 v27, v27
    v_mfma_f32_16x16x32_bf16 a[52:55], a[244:247], v[8:11], a[52:55]
    v_cvt_pk_bf16_f32 v24, v24, v25
    v_cvt_pk_bf16_f32 v25, v26, v27
    v_mfma_f32_16x16x32_bf16 a[56:59], a[248:251], v[8:11], a[56:59]
    v_exp_f32 v28, v28
    v_mfma_f32_16x16x32_bf16 a[60:63], a[252:255], v[8:11], a[60:63]
    v_exp_f32 v29, v29
    v_mfma_f32_16x16x32_bf16 v[64:67], v[228:231], v[8:11], v[64:67]
    v_exp_f32 v30, v30
    v_mfma_f32_16x16x32_bf16 v[32:35], a[192:195], a[176:179], v[56:59]
    v_exp_f32 v31, v31
    v_mfma_f32_16x16x32_bf16 v[32:35], a[196:199], a[180:183], v[32:35]
    ds_read_b128 a[192:195], v208 offset:8192
    ds_read_b128 a[196:199], v209 offset:8192
    v_mfma_f32_16x16x32_bf16 v[32:35], a[200:203], a[184:187], v[32:35]
    v_cvt_pk_bf16_f32 v26, v28, v29
    v_cvt_pk_bf16_f32 v27, v30, v31
    v_mfma_f32_16x16x32_bf16 v[32:35], a[204:207], a[188:191], v[32:35]
    ds_read_b128 a[200:203], v210 offset:8192
    ds_read_b128 a[204:207], v211 offset:8192
    v_mfma_f32_16x16x32_bf16 v[36:39], a[208:211], a[176:179], v[56:59]
    v_mfma_f32_16x16x32_bf16 v[36:39], a[212:215], a[180:183], v[36:39]
    ds_read_b128 a[208:211], v208 offset:12288
    ds_read_b128 a[212:215], v209 offset:12288
    v_mfma_f32_16x16x32_bf16 v[36:39], a[216:219], a[184:187], v[36:39]
    v_add_u32 v208, s44, v208
    v_add_u32 v209, s44, v209
    v_mfma_f32_16x16x32_bf16 v[36:39], a[220:223], a[188:191], v[36:39]
    ds_read_b128 a[216:219], v210 offset:12288
    ds_read_b128 a[220:223], v211 offset:12288
    v_mfma_f32_16x16x32_bf16 a[64:67], a[224:227], v[16:19], a[64:67]
    v_add_u32 v210, s44, v210
    v_add_u32 v211, s44, v211
    v_mfma_f32_16x16x32_bf16 a[68:71], a[228:231], v[16:19], a[68:71]
    v_exp_f32 v32, v32
    v_mfma_f32_16x16x32_bf16 a[72:75], a[232:235], v[16:19], a[72:75]
    v_exp_f32 v33, v33
    v_mfma_f32_16x16x32_bf16 a[76:79], a[236:239], v[16:19], a[76:79]
    v_exp_f32 v34, v34
    v_mfma_f32_16x16x32_bf16 a[80:83], a[240:243], v[16:19], a[80:83]
    v_exp_f32 v35, v35
    v_mfma_f32_16x16x32_bf16 a[84:87], a[244:247], v[16:19], a[84:87]
    v_cvt_pk_bf16_f32 v32, v32, v33
    v_cvt_pk_bf16_f32 v33, v34, v35
    v_mfma_f32_16x16x32_bf16 a[88:91], a[248:251], v[16:19], a[88:91]
    v_exp_f32 v36, v36
    v_mfma_f32_16x16x32_bf16 a[92:95], a[252:255], v[16:19], a[92:95]
    v_exp_f32 v37, v37
    v_mfma_f32_16x16x32_bf16 v[68:71], v[228:231], v[16:19], v[68:71]
    s_waitcnt lgkmcnt(0)
    s_sub_u32 s39, s39, 2
    s_mov_b32 s2, 3
    s_branch A1h1_loop
A1h1_last:
    v_mfma_f32_16x16x32_bf16 v[0:3], a[192:195], v[160:163], v[40:43]
    v_exp_f32 v38, v38
    v_mfma_f32_16x16x32_bf16 v[0:3], a[196:199], v[164:167], v[0:3]
    v_exp_f32 v39, v39
    v_mfma_f32_16x16x32_bf16 v[0:3], a[200:203], v[168:171], v[0:3]
    v_cvt_pk_bf16_f32 v34, v36, v37
    v_cvt_pk_bf16_f32 v35, v38, v39
    v_mfma_f32_16x16x32_bf16 v[0:3], a[204:207], v[172:175], v[0:3]
    v_mfma_f32_16x16x32_bf16 v[4:7], a[208:211], v[160:163], v[40:43]
    v_mfma_f32_16x16x32_bf16 v[4:7], a[212:215], v[164:167], v[4:7]
    v_mfma_f32_16x16x32_bf16 v[4:7], a[216:219], v[168:171], v[4:7]
    v_exp_f32 v0, v0
    v_mfma_f32_16x16x32_bf16 v[4:7], a[220:223], v[172:175], v[4:7]
    v_exp_f32 v1, v1
    v_mfma_f32_16x16x32_bf16 a[96:99], a[224:227], v[24:27], a[96:99]
    v_exp_f32 v2, v2
    v_mfma_f32_16x16x32_bf16 a[100:103], a[228:231], v[24:27], a[100:103]
    v_exp_f32 v3, v3
    v_mfma_f32_16x16x32_bf16 a[104:107], a[232:235], v[24:27], a[104:107]
    s_waitcnt vmcnt(16) lgkmcnt(0)
    s_barrier
    v_mfma_f32_16x16x32_bf16 a[108:111], a[236:239], v[24:27], a[108:111]
    s_add_u32 s38, s74, s3
    v_mfma_f32_16x16x32_bf16 a[112:115], a[240:243], v[24:27], a[112:115]
    s_add_u32 s74, s74, s44
    v_cvt_pk_bf16_f32 v0, v0, v1
    v_mov_b32 v221, v234
    v_mfma_f32_16x16x32_bf16 a[116:119], a[244:247], v[24:27], a[116:119]
    v_xor_b32 v222, 128, v234
    v_mfma_f32_16x16x32_bf16 a[120:123], a[248:251], v[24:27], a[120:123]
    v_add_u32 v223, 6144, v234
    v_mfma_f32_16x16x32_bf16 a[124:127], a[252:255], v[24:27], a[124:127]
    s_cmp_eq_u32 s74, 0x18000
    s_cselect_b32 s44, s45, s46
    v_cvt_pk_bf16_f32 v1, v2, v3
    v_mfma_f32_16x16x32_bf16 v[72:75], v[228:231], v[24:27], v[72:75]
    v_exp_f32 v4, v4
    v_mfma_f32_16x16x32_bf16 v[8:11], a[192:195], v[176:179], v[44:47]
    v_exp_f32 v5, v5
    v_mfma_f32_16x16x32_bf16 v[8:11], a[196:199], v[180:183], v[8:11]
    v_exp_f32 v6, v6
    v_mfma_f32_16x16x32_bf16 v[8:11], a[200:203], v[184:187], v[8:11]
    v_exp_f32 v7, v7
    v_mfma_f32_16x16x32_bf16 v[8:11], a[204:207], v[188:191], v[8:11]
    v_cvt_pk_bf16_f32 v2, v4, v5
    v_cvt_pk_bf16_f32 v3, v6, v7
    v_mfma_f32_16x16x32_bf16 v[12:15], a[208:211], v[176:179], v[44:47]
    v_add_u32 v225, 9216, v222
    v_mfma_f32_16x16x32_bf16 v[12:15], a[212:215], v[180:183], v[12:15]
    v_add_u32 v222, 3072, v222
    v_mfma_f32_16x16x32_bf16 v[12:15], a[216:219], v[184:187], v[12:15]
    v_exp_f32 v8, v8
    v_mfma_f32_16x16x32_bf16 v[12:15], a[220:223], v[188:191], v[12:15]
    v_exp_f32 v9, v9
    v_mfma_f32_16x16x32_bf16 a[128:131], a[224:227], v[32:35], a[128:131]
    ds_read_b64_tr_b16 a[224:225], v212 offset:16384
    ds_read_b64_tr_b16 a[226:227], v212 offset:20480
    v_mfma_f32_16x16x32_bf16 a[132:135], a[228:231], v[32:35], a[132:135]
    v_exp_f32 v10, v10
    v_mfma_f32_16x16x32_bf16 a[136:139], a[232:235], v[32:35], a[136:139]
    ds_read_b64_tr_b16 a[228:229], v213 offset:16384
    ds_read_b64_tr_b16 a[230:231], v213 offset:20480
    v_mfma_f32_16x16x32_bf16 a[140:143], a[236:239], v[32:35], a[140:143]
    global_load_dwordx2 v[226:227], v239, s[48:49] offset:16 sc1
    v_mfma_f32_16x16x32_bf16 a[144:147], a[240:243], v[32:35], a[144:147]
    s_add_u32 m0, s81, 131072
    ds_read_b64_tr_b16 a[232:233], v214 offset:16384
    ds_read_b64_tr_b16 a[234:235], v214 offset:20480
    v_mfma_f32_16x16x32_bf16 a[148:151], a[244:247], v[32:35], a[148:151]
    s_xor_b32 s87, s80, 0
    buffer_load_dwordx4 v221, s[32:35], s87 offen offset:0  lds
    v_mfma_f32_16x16x32_bf16 a[152:155], a[248:251], v[32:35], a[152:155]
    ds_read_b64_tr_b16 a[236:237], v215 offset:16384
    ds_read_b64_tr_b16 a[238:239], v215 offset:20480
    buffer_load_dwordx4 v222, s[32:35], s87 offen offset:1024  lds
    v_mfma_f32_16x16x32_bf16 a[156:159], a[252:255], v[32:35], a[156:159]
    v_exp_f32 v11, v11
    v_mfma_f32_16x16x32_bf16 v[76:79], v[228:231], v[32:35], v[76:79]
    ds_read_b64_tr_b16 a[240:241], v216 offset:16384
    ds_read_b64_tr_b16 a[242:243], v216 offset:20480
    buffer_load_dwordx4 v223, s[32:35], s87 offen offset:2048  lds
    v_mfma_f32_16x16x32_bf16 v[16:19], a[192:195], v[192:195], v[48:51]
    v_cvt_pk_bf16_f32 v8, v8, v9
    v_cvt_pk_bf16_f32 v9, v10, v11
    v_mfma_f32_16x16x32_bf16 v[16:19], a[196:199], v[196:199], v[16:19]
    ds_read_b64_tr_b16 a[244:245], v217 offset:16384
    ds_read_b64_tr_b16 a[246:247], v217 offset:20480
    v_mfma_f32_16x16x32_bf16 v[16:19], a[200:203], v[200:203], v[16:19]
    v_exp_f32 v12, v12
    v_mfma_f32_16x16x32_bf16 v[16:19], a[204:207], v[204:207], v[16:19]
    ds_read_b64_tr_b16 a[248:249], v218 offset:16384
    ds_read_b64_tr_b16 a[250:251], v218 offset:20480
    v_mfma_f32_16x16x32_bf16 v[20:23], a[208:211], v[192:195], v[48:51]
    v_exp_f32 v13, v13
    v_mfma_f32_16x16x32_bf16 v[20:23], a[212:215], v[196:199], v[20:23]
    ds_read_b64_tr_b16 a[252:253], v219 offset:16384
    ds_read_b64_tr_b16 a[254:255], v219 offset:20480
    v_mfma_f32_16x16x32_bf16 v[20:23], a[216:219], v[200:203], v[20:23]
    v_exp_f32 v14, v14
    v_mfma_f32_16x16x32_bf16 v[20:23], a[220:223], v[204:207], v[20:23]
    s_waitcnt lgkmcnt(6)
    v_exp_f32 v15, v15
    v_mfma_f32_16x16x32_bf16 a[0:3], a[224:227], v[0:3], a[0:3]
    v_cvt_pk_bf16_f32 v10, v12, v13
    v_cvt_pk_bf16_f32 v11, v14, v15
    v_mfma_f32_16x16x32_bf16 a[4:7], a[228:231], v[0:3], a[4:7]
    v_exp_f32 v16, v16
    v_mfma_f32_16x16x32_bf16 a[8:11], a[232:235], v[0:3], a[8:11]
    v_exp_f32 v17, v17
    v_mfma_f32_16x16x32_bf16 a[12:15], a[236:239], v[0:3], a[12:15]
    buffer_load_dwordx4 v225, s[32:35], s87 offen offset:3072  lds
    v_mfma_f32_16x16x32_bf16 a[16:19], a[240:243], v[0:3], a[16:19]
    s_waitcnt lgkmcnt(2)
    s_add_u32 m0, s81, 135168
    s_xor_b32 s87, s80, 16384
    v_mfma_f32_16x16x32_bf16 a[20:23], a[244:247], v[0:3], a[20:23]
    buffer_load_dwordx4 v221, s[32:35], s87 offen offset:0  lds
    v_exp_f32 v18, v18
    v_mfma_f32_16x16x32_bf16 a[24:27], a[248:251], v[0:3], a[24:27]
    s_waitcnt lgkmcnt(0)
    v_exp_f32 v19, v19
    v_mfma_f32_16x16x32_bf16 a[28:31], a[252:255], v[0:3], a[28:31]
    v_cvt_pk_bf16_f32 v16, v16, v17
    v_cvt_pk_bf16_f32 v17, v18, v19
    v_mfma_f32_16x16x32_bf16 v[60:63], v[228:231], v[0:3], v[60:63]
    v_exp_f32 v20, v20
    v_mfma_f32_16x16x32_bf16 v[24:27], a[192:195], a[160:163], v[52:55]
    v_exp_f32 v21, v21
    v_mfma_f32_16x16x32_bf16 v[24:27], a[196:199], a[164:167], v[24:27]
    ds_read_b128 a[192:195], v208 offset:0
    ds_read_b128 a[196:199], v209 offset:0
    v_mfma_f32_16x16x32_bf16 v[24:27], a[200:203], a[168:171], v[24:27]
    v_exp_f32 v22, v22
    v_mfma_f32_16x16x32_bf16 v[24:27], a[204:207], a[172:175], v[24:27]
    ds_read_b128 a[200:203], v210 offset:0
    ds_read_b128 a[204:207], v211 offset:0
    buffer_load_dwordx4 v222, s[32:35], s87 offen offset:1024  lds
    v_mfma_f32_16x16x32_bf16 v[28:31], a[208:211], a[160:163], v[52:55]
    v_exp_f32 v23, v23
    v_mfma_f32_16x16x32_bf16 v[28:31], a[212:215], a[164:167], v[28:31]
    ds_read_b128 a[208:211], v208 offset:4096
    ds_read_b128 a[212:215], v209 offset:4096
    v_mfma_f32_16x16x32_bf16 v[28:31], a[216:219], a[168:171], v[28:31]
    v_cvt_pk_bf16_f32 v18, v20, v21
    v_cvt_pk_bf16_f32 v19, v22, v23
    v_mfma_f32_16x16x32_bf16 v[28:31], a[220:223], a[172:175], v[28:31]
    ds_read_b128 a[216:219], v210 offset:4096
    ds_read_b128 a[220:223], v211 offset:4096
    v_mfma_f32_16x16x32_bf16 a[32:35], a[224:227], v[8:11], a[32:35]
    v_exp_f32 v24, v24
    v_mfma_f32_16x16x32_bf16 a[36:39], a[228:231], v[8:11], a[36:39]
    v_exp_f32 v25, v25
    v_mfma_f32_16x16x32_bf16 a[40:43], a[232:235], v[8:11], a[40:43]
    v_exp_f32 v26, v26
    v_mfma_f32_16x16x32_bf16 a[44:47], a[236:239], v[8:11], a[44:47]
    buffer_load_dwordx4 v223, s[32:35], s87 offen offset:2048  lds
    v_mfma_f32_16x16x32_bf16 a[48:51], a[240:243], v[8:11], a[48:51]
    v_mfma_f32_16x16x32_bf16 a[52:55], a[244:247], v[8:11], a[52:55]
    v_exp_f32 v27, v27
    v_mfma_f32_16x16x32_bf16 a[56:59], a[248:251], v[8:11], a[56:59]
    v_cvt_pk_bf16_f32 v24, v24, v25
    v_cvt_pk_bf16_f32 v25, v26, v27
    v_mfma_f32_16x16x32_bf16 a[60:63], a[252:255], v[8:11], a[60:63]
    v_exp_f32 v28, v28
    v_mfma_f32_16x16x32_bf16 v[64:67], v[228:231], v[8:11], v[64:67]
    s_waitcnt lgkmcnt(0)
    v_exp_f32 v29, v29
    v_mfma_f32_16x16x32_bf16 v[0:3], a[192:195], v[160:163], v[40:43]
    v_exp_f32 v30, v30
    v_mfma_f32_16x16x32_bf16 v[0:3], a[196:199], v[164:167], v[0:3]
    v_exp_f32 v31, v31
    v_mfma_f32_16x16x32_bf16 v[0:3], a[200:203], v[168:171], v[0:3]
    v_cvt_pk_bf16_f32 v26, v28, v29
    v_cvt_pk_bf16_f32 v27, v30, v31
    v_mfma_f32_16x16x32_bf16 v[0:3], a[204:207], v[172:175], v[0:3]
    buffer_load_dwordx4 v225, s[32:35], s87 offen offset:3072  lds
    v_mfma_f32_16x16x32_bf16 v[4:7], a[208:211], v[160:163], v[40:43]
    s_add_u32 m0, s81, 0
    s_xor_b32 s87, s80, 32768
    v_mfma_f32_16x16x32_bf16 v[4:7], a[212:215], v[164:167], v[4:7]
    v_mfma_f32_16x16x32_bf16 v[4:7], a[216:219], v[168:171], v[4:7]
    v_exp_f32 v0, v0
    v_mfma_f32_16x16x32_bf16 v[4:7], a[220:223], v[172:175], v[4:7]
    v_exp_f32 v1, v1
    v_mfma_f32_16x16x32_bf16 a[64:67], a[224:227], v[16:19], a[64:67]
    v_exp_f32 v2, v2
    v_mfma_f32_16x16x32_bf16 a[68:71], a[228:231], v[16:19], a[68:71]
    v_exp_f32 v3, v3
    v_mfma_f32_16x16x32_bf16 a[72:75], a[232:235], v[16:19], a[72:75]
    v_cvt_pk_bf16_f32 v0, v0, v1
    v_cvt_pk_bf16_f32 v1, v2, v3
    v_mfma_f32_16x16x32_bf16 a[76:79], a[236:239], v[16:19], a[76:79]
    buffer_load_dwordx4 v221, s[32:35], s87 offen offset:0  lds
    v_mfma_f32_16x16x32_bf16 a[80:83], a[240:243], v[16:19], a[80:83]
    v_mfma_f32_16x16x32_bf16 a[84:87], a[244:247], v[16:19], a[84:87]
    v_exp_f32 v4, v4
    v_mfma_f32_16x16x32_bf16 a[88:91], a[248:251], v[16:19], a[88:91]
    v_exp_f32 v5, v5
    v_mfma_f32_16x16x32_bf16 a[92:95], a[252:255], v[16:19], a[92:95]
    v_exp_f32 v6, v6
    v_mfma_f32_16x16x32_bf16 v[68:71], v[228:231], v[16:19], v[68:71]
    v_exp_f32 v7, v7
    v_mfma_f32_16x16x32_bf16 v[8:11], a[192:195], v[176:179], v[44:47]
    v_cvt_pk_bf16_f32 v2, v4, v5
    v_cvt_pk_bf16_f32 v3, v6, v7
    v_mfma_f32_16x16x32_bf16 v[8:11], a[196:199], v[180:183], v[8:11]
    buffer_load_dwordx4 v222, s[32:35], s87 offen offset:1024  lds
    v_mfma_f32_16x16x32_bf16 v[8:11], a[200:203], v[184:187], v[8:11]
    v_mfma_f32_16x16x32_bf16 v[8:11], a[204:207], v[188:191], v[8:11]
    v_mfma_f32_16x16x32_bf16 v[12:15], a[208:211], v[176:179], v[44:47]
    buffer_load_dwordx4 v223, s[32:35], s87 offen offset:2048  lds
    v_mfma_f32_16x16x32_bf16 v[12:15], a[212:215], v[180:183], v[12:15]
    v_mfma_f32_16x16x32_bf16 v[12:15], a[216:219], v[184:187], v[12:15]
    v_exp_f32 v8, v8
    v_mfma_f32_16x16x32_bf16 v[12:15], a[220:223], v[188:191], v[12:15]
    v_exp_f32 v9, v9
    v_mfma_f32_16x16x32_bf16 a[96:99], a[224:227], v[24:27], a[96:99]
    ds_read_b64_tr_b16 a[224:225], v212 offset:24576
    ds_read_b64_tr_b16 a[226:227], v212 offset:28672
    v_mfma_f32_16x16x32_bf16 a[100:103], a[228:231], v[24:27], a[100:103]
    v_exp_f32 v10, v10
    v_mfma_f32_16x16x32_bf16 a[104:107], a[232:235], v[24:27], a[104:107]
    ds_read_b64_tr_b16 a[228:229], v213 offset:24576
    ds_read_b64_tr_b16 a[230:231], v213 offset:28672
    v_mfma_f32_16x16x32_bf16 a[108:111], a[236:239], v[24:27], a[108:111]
    buffer_load_dwordx4 v225, s[32:35], s87 offen offset:3072  lds
    v_mfma_f32_16x16x32_bf16 a[112:115], a[240:243], v[24:27], a[112:115]
    s_add_u32 m0, s81, 4096
    ds_read_b64_tr_b16 a[232:233], v214 offset:24576
    ds_read_b64_tr_b16 a[234:235], v214 offset:28672
    v_mfma_f32_16x16x32_bf16 a[116:119], a[244:247], v[24:27], a[116:119]
    s_xor_b32 s87, s80, 49152
    v_mfma_f32_16x16x32_bf16 a[120:123], a[248:251], v[24:27], a[120:123]
    ds_read_b64_tr_b16 a[236:237], v215 offset:24576
    ds_read_b64_tr_b16 a[238:239], v215 offset:28672
    v_mfma_f32_16x16x32_bf16 a[124:127], a[252:255], v[24:27], a[124:127]
    v_add_u32 v212, s44, v212
    v_add_u32 v213, s44, v213
    v_mfma_f32_16x16x32_bf16 v[72:75], v[228:231], v[24:27], v[72:75]
    ds_read_b64_tr_b16 a[240:241], v216 offset:24576
    ds_read_b64_tr_b16 a[242:243], v216 offset:28672
    v_mfma_f32_16x16x32_bf16 v[16:19], a[192:195], v[192:195], v[48:51]
    v_add_u32 v214, s44, v214
    v_add_u32 v215, s44, v215
    v_mfma_f32_16x16x32_bf16 v[16:19], a[196:199], v[196:199], v[16:19]
    ds_read_b64_tr_b16 a[244:245], v217 offset:24576
    ds_read_b64_tr_b16 a[246:247], v217 offset:28672
    buffer_load_dwordx4 v221, s[32:35], s87 offen offset:0  lds
    v_mfma_f32_16x16x32_bf16 v[16:19], a[200:203], v[200:203], v[16:19]
    v_add_u32 v216, s44, v216
    v_add_u32 v217, s44, v217
    v_mfma_f32_16x16x32_bf16 v[16:19], a[204:207], v[204:207], v[16:19]
    ds_read_b64_tr_b16 a[248:249], v218 offset:24576
    ds_read_b64_tr_b16 a[250:251], v218 offset:28672
    v_mfma_f32_16x16x32_bf16 v[20:23], a[208:211], v[192:195], v[48:51]
    v_exp_f32 v11, v11
    v_mfma_f32_16x16x32_bf16 v[20:23], a[212:215], v[196:199], v[20:23]
    ds_read_b64_tr_b16 a[252:253], v219 offset:24576
    ds_read_b64_tr_b16 a[254:255], v219 offset:28672
    v_mfma_f32_16x16x32_bf16 v[20:23], a[216:219], v[200:203], v[20:23]
    v_add_u32 v218, s44, v218
    v_add_u32 v219, s44, v219
    v_mfma_f32_16x16x32_bf16 v[20:23], a[220:223], v[204:207], v[20:23]
    s_waitcnt lgkmcnt(6)
    v_cvt_pk_bf16_f32 v8, v8, v9
    v_cvt_pk_bf16_f32 v9, v10, v11
    v_mfma_f32_16x16x32_bf16 a[0:3], a[224:227], v[0:3], a[0:3]
    v_exp_f32 v12, v12
    v_mfma_f32_16x16x32_bf16 a[4:7], a[228:231], v[0:3], a[4:7]
    v_exp_f32 v13, v13
    v_mfma_f32_16x16x32_bf16 a[8:11], a[232:235], v[0:3], a[8:11]
    v_exp_f32 v14, v14
    v_mfma_f32_16x16x32_bf16 a[12:15], a[236:239], v[0:3], a[12:15]
    buffer_load_dwordx4 v222, s[32:35], s87 offen offset:1024  lds
    v_mfma_f32_16x16x32_bf16 a[16:19], a[240:243], v[0:3], a[16:19]
    s_waitcnt lgkmcnt(2)
    v_mfma_f32_16x16x32_bf16 a[20:23], a[244:247], v[0:3], a[20:23]
    v_exp_f32 v15, v15
    v_mfma_f32_16x16x32_bf16 a[24:27], a[248:251], v[0:3], a[24:27]
    s_waitcnt lgkmcnt(0)
    v_cvt_pk_bf16_f32 v10, v12, v13
    v_cvt_pk_bf16_f32 v11, v14, v15
    v_mfma_f32_16x16x32_bf16 a[28:31], a[252:255], v[0:3], a[28:31]
    buffer_load_dwordx4 v223, s[32:35], s87 offen offset:2048  lds
    v_exp_f32 v16, v16
    v_mfma_f32_16x16x32_bf16 v[60:63], v[228:231], v[0:3], v[60:63]
    v_exp_f32 v17, v17
    v_mfma_f32_16x16x32_bf16 v[24:27], a[192:195], a[160:163], v[52:55]
    v_exp_f32 v18, v18
    v_mfma_f32_16x16x32_bf16 v[24:27], a[196:199], a[164:167], v[24:27]
    v_exp_f32 v19, v19
    v_mfma_f32_16x16x32_bf16 v[24:27], a[200:203], a[168:171], v[24:27]
    v_cvt_pk_bf16_f32 v16, v16, v17
    v_cvt_pk_bf16_f32 v17, v18, v19
    v_mfma_f32_16x16x32_bf16 v[24:27], a[204:207], a[172:175], v[24:27]
    v_exp_f32 v20, v20
    v_mfma_f32_16x16x32_bf16 v[28:31], a[208:211], a[160:163], v[52:55]
    v_exp_f32 v21, v21
    v_mfma_f32_16x16x32_bf16 v[28:31], a[212:215], a[164:167], v[28:31]
    v_exp_f32 v22, v22
    v_mfma_f32_16x16x32_bf16 v[28:31], a[216:219], a[168:171], v[28:31]
    v_exp_f32 v23, v23
    v_mfma_f32_16x16x32_bf16 v[28:31], a[220:223], a[172:175], v[28:31]
    v_cvt_pk_bf16_f32 v18, v20, v21
    v_cvt_pk_bf16_f32 v19, v22, v23
    v_mfma_f32_16x16x32_bf16 a[32:35], a[224:227], v[8:11], a[32:35]
    v_exp_f32 v24, v24
    v_mfma_f32_16x16x32_bf16 a[36:39], a[228:231], v[8:11], a[36:39]
    v_exp_f32 v25, v25
    v_mfma_f32_16x16x32_bf16 a[40:43], a[232:235], v[8:11], a[40:43]
    v_exp_f32 v26, v26
    v_mfma_f32_16x16x32_bf16 a[44:47], a[236:239], v[8:11], a[44:47]
    buffer_load_dwordx4 v225, s[32:35], s87 offen offset:3072  lds
    v_mfma_f32_16x16x32_bf16 a[48:51], a[240:243], v[8:11], a[48:51]
    v_exp_f32 v27, v27
    v_mfma_f32_16x16x32_bf16 a[52:55], a[244:247], v[8:11], a[52:55]
    v_cvt_pk_bf16_f32 v24, v24, v25
    v_cvt_pk_bf16_f32 v25, v26, v27
    v_mfma_f32_16x16x32_bf16 a[56:59], a[248:251], v[8:11], a[56:59]
    v_exp_f32 v28, v28
    v_mfma_f32_16x16x32_bf16 a[60:63], a[252:255], v[8:11], a[60:63]
    v_exp_f32 v29, v29
    v_mfma_f32_16x16x32_bf16 v[64:67], v[228:231], v[8:11], v[64:67]
    v_exp_f32 v30, v30
    v_mfma_f32_16x16x32_bf16 v[32:35], a[192:195], a[176:179], v[56:59]
    v_exp_f32 v31, v31
    v_mfma_f32_16x16x32_bf16 v[32:35], a[196:199], a[180:183], v[32:35]
    ds_read_b128 a[192:195], v208 offset:8192
    ds_read_b128 a[196:199], v209 offset:8192
    v_mfma_f32_16x16x32_bf16 v[32:35], a[200:203], a[184:187], v[32:35]
    v_cvt_pk_bf16_f32 v26, v28, v29
    v_cvt_pk_bf16_f32 v27, v30, v31
    v_mfma_f32_16x16x32_bf16 v[32:35], a[204:207], a[188:191], v[32:35]
    ds_read_b128 a[200:203], v210 offset:8192
    ds_read_b128 a[204:207], v211 offset:8192
    v_mfma_f32_16x16x32_bf16 v[36:39], a[208:211], a[176:179], v[56:59]
    v_mfma_f32_16x16x32_bf16 v[36:39], a[212:215], a[180:183], v[36:39]
    ds_read_b128 a[208:211], v208 offset:12288
    ds_read_b128 a[212:215], v209 offset:12288
    v_mfma_f32_16x16x32_bf16 v[36:39], a[216:219], a[184:187], v[36:39]
    v_add_u32 v208, s44, v208
    v_add_u32 v209, s44, v209
    v_mfma_f32_16x16x32_bf16 v[36:39], a[220:223], a[188:191], v[36:39]
    ds_read_b128 a[216:219], v210 offset:12288
    ds_read_b128 a[220:223], v211 offset:12288
    v_mfma_f32_16x16x32_bf16 a[64:67], a[224:227], v[16:19], a[64:67]
    v_add_u32 v210, s44, v210
    v_add_u32 v211, s44, v211
    v_mfma_f32_16x16x32_bf16 a[68:71], a[228:231], v[16:19], a[68:71]
    v_exp_f32 v32, v32
    v_mfma_f32_16x16x32_bf16 a[72:75], a[232:235], v[16:19], a[72:75]
    v_exp_f32 v33, v33
    v_mfma_f32_16x16x32_bf16 a[76:79], a[236:239], v[16:19], a[76:79]
    v_exp_f32 v34, v34
    v_mfma_f32_16x16x32_bf16 a[80:83], a[240:243], v[16:19], a[80:83]
    v_exp_f32 v35, v35
    v_mfma_f32_16x16x32_bf16 a[84:87], a[244:247], v[16:19], a[84:87]
    v_cvt_pk_bf16_f32 v32, v32, v33
    v_cvt_pk_bf16_f32 v33, v34, v35
    v_mfma_f32_16x16x32_bf16 a[88:91], a[248:251], v[16:19], a[88:91]
    v_exp_f32 v36, v36
    v_mfma_f32_16x16x32_bf16 a[92:95], a[252:255], v[16:19], a[92:95]
    v_exp_f32 v37, v37
    v_mfma_f32_16x16x32_bf16 v[68:71], v[228:231], v[16:19], v[68:71]
    s_waitcnt lgkmcnt(0)
    v_mfma_f32_16x16x32_bf16 v[0:3], a[192:195], v[160:163], v[40:43]
    v_exp_f32 v38, v38
    v_mfma_f32_16x16x32_bf16 v[0:3], a[196:199], v[164:167], v[0:3]
    v_exp_f32 v39, v39
    v_mfma_f32_16x16x32_bf16 v[0:3], a[200:203], v[168:171], v[0:3]
    v_cvt_pk_bf16_f32 v34, v36, v37
    v_cvt_pk_bf16_f32 v35, v38, v39
    v_mfma_f32_16x16x32_bf16 v[0:3], a[204:207], v[172:175], v[0:3]
    v_mfma_f32_16x16x32_bf16 v[4:7], a[208:211], v[160:163], v[40:43]
    v_mfma_f32_16x16x32_bf16 v[4:7], a[212:215], v[164:167], v[4:7]
    v_mfma_f32_16x16x32_bf16 v[4:7], a[216:219], v[168:171], v[4:7]
    v_exp_f32 v0, v0
    v_mfma_f32_16x16x32_bf16 v[4:7], a[220:223], v[172:175], v[4:7]
    v_exp_f32 v1, v1
    v_mfma_f32_16x16x32_bf16 a[96:99], a[224:227], v[24:27], a[96:99]
    v_exp_f32 v2, v2
    v_mfma_f32_16x16x32_bf16 a[100:103], a[228:231], v[24:27], a[100:103]
    v_exp_f32 v3, v3
    v_mfma_f32_16x16x32_bf16 a[104:107], a[232:235], v[24:27], a[104:107]
    s_waitcnt vmcnt(25) lgkmcnt(0)
    s_barrier
    v_mfma_f32_16x16x32_bf16 a[108:111], a[236:239], v[24:27], a[108:111]
    s_add_u32 s38, s74, s3
    v_mfma_f32_16x16x32_bf16 a[112:115], a[240:243], v[24:27], a[112:115]
    s_add_u32 s74, s74, s44
    v_cvt_pk_bf16_f32 v0, v0, v1
    s_waitcnt vmcnt(16)
    s_mov_b32 s65, 0x20000
A1h1_p0:
    v_readfirstlane_b32 s62, v226
    v_readfirstlane_b32 s63, v227
    s_add_u32 s64, s62, s63
    s_mul_i32 s64, s64, 0x01010101
    s_lshr_b32 s64, s64, 24
    s_cmp_ge_u32 s64, 16
    s_cbranch_scc1 A1h1_p1
    s_sub_u32 s65, s65, 1
    s_cmp_eq_u32 s65, 0
    s_cbranch_scc1 A1h1_p1
    s_sleep 8
    global_load_dwordx2 v[226:227], v239, s[48:49] offset:16 sc1
    s_waitcnt vmcnt(0)
    s_branch A1h1_p0
A1h1_p1:
    s_lshl_b32 s65, s42, 3
    s_lshr_b64 s[62:63], s[62:63], s65
    s_and_b32 s62, s62, 0xff
    s_cmp_ge_u32 s62, 16
    s_cselect_b32 s40, 0, 1
    s_cselect_b32 s14, s30, 0
    v_mfma_f32_16x16x32_bf16 a[116:119], a[244:247], v[24:27], a[116:119]
    v_xor_b32 v252, 0, v238
    v_mfma_f32_16x16x32_bf16 a[120:123], a[248:251], v[24:27], a[120:123]
    buffer_load_dwordx4 v[80:83], v252, s[12:15], s51 offen sc1
    v_mfma_f32_16x16x32_bf16 a[124:127], a[252:255], v[24:27], a[124:127]
    s_cmp_eq_u32 s74, 0x18000
    s_cselect_b32 s44, s45, s46
    v_cvt_pk_bf16_f32 v1, v2, v3
    v_mfma_f32_16x16x32_bf16 v[72:75], v[228:231], v[24:27], v[72:75]
    v_exp_f32 v4, v4
    v_mfma_f32_16x16x32_bf16 v[8:11], a[192:195], v[176:179], v[44:47]
    v_exp_f32 v5, v5
    v_mfma_f32_16x16x32_bf16 v[8:11], a[196:199], v[180:183], v[8:11]
    v_exp_f32 v6, v6
    v_mfma_f32_16x16x32_bf16 v[8:11], a[200:203], v[184:187], v[8:11]
    v_exp_f32 v7, v7
    v_mfma_f32_16x16x32_bf16 v[8:11], a[204:207], v[188:191], v[8:11]
    v_cvt_pk_bf16_f32 v2, v4, v5
    v_cvt_pk_bf16_f32 v3, v6, v7
    v_mfma_f32_16x16x32_bf16 v[12:15], a[208:211], v[176:179], v[44:47]
    buffer_load_dwordx4 v[84:87], v252, s[12:15], s52 offen sc1
    v_mfma_f32_16x16x32_bf16 v[12:15], a[212:215], v[180:183], v[12:15]
    v_mfma_f32_16x16x32_bf16 v[12:15], a[216:219], v[184:187], v[12:15]
    v_exp_f32 v8, v8
    v_mfma_f32_16x16x32_bf16 v[12:15], a[220:223], v[188:191], v[12:15]
    v_exp_f32 v9, v9
    v_mfma_f32_16x16x32_bf16 a[128:131], a[224:227], v[32:35], a[128:131]
    ds_read_b64_tr_b16 a[224:225], v212 offset:16384
    ds_read_b64_tr_b16 a[226:227], v212 offset:20480
    v_mfma_f32_16x16x32_bf16 a[132:135], a[228:231], v[32:35], a[132:135]
    v_exp_f32 v10, v10
    v_mfma_f32_16x16x32_bf16 a[136:139], a[232:235], v[32:35], a[136:139]
    ds_read_b64_tr_b16 a[228:229], v213 offset:16384
    ds_read_b64_tr_b16 a[230:231], v213 offset:20480
    v_mfma_f32_16x16x32_bf16 a[140:143], a[236:239], v[32:35], a[140:143]
    buffer_load_dwordx4 v[88:91], v252, s[12:15], s53 offen sc1
    v_mfma_f32_16x16x32_bf16 a[144:147], a[240:243], v[32:35], a[144:147]
    ds_read_b64_tr_b16 a[232:233], v214 offset:16384
    ds_read_b64_tr_b16 a[234:235], v214 offset:20480
    v_mfma_f32_16x16x32_bf16 a[148:151], a[244:247], v[32:35], a[148:151]
    v_mfma_f32_16x16x32_bf16 a[152:155], a[248:251], v[32:35], a[152:155]
    ds_read_b64_tr_b16 a[236:237], v215 offset:16384
    ds_read_b64_tr_b16 a[238:239], v215 offset:20480
    v_mfma_f32_16x16x32_bf16 a[156:159], a[252:255], v[32:35], a[156:159]
    v_exp_f32 v11, v11
    v_mfma_f32_16x16x32_bf16 v[76:79], v[228:231], v[32:35], v[76:79]
    ds_read_b64_tr_b16 a[240:241], v216 offset:16384
    ds_read_b64_tr_b16 a[242:243], v216 offset:20480
    v_mfma_f32_16x16x32_bf16 v[16:19], a[192:195], v[192:195], v[48:51]
    buffer_load_dwordx4 v[92:95], v252, s[12:15], s54 offen sc1
    v_cvt_pk_bf16_f32 v8, v8, v9
    v_cvt_pk_bf16_f32 v9, v10, v11
    v_mfma_f32_16x16x32_bf16 v[16:19], a[196:199], v[196:199], v[16:19]
    ds_read_b64_tr_b16 a[244:245], v217 offset:16384
    ds_read_b64_tr_b16 a[246:247], v217 offset:20480
    v_mfma_f32_16x16x32_bf16 v[16:19], a[200:203], v[200:203], v[16:19]
    v_exp_f32 v12, v12
    v_mfma_f32_16x16x32_bf16 v[16:19], a[204:207], v[204:207], v[16:19]
    ds_read_b64_tr_b16 a[248:249], v218 offset:16384
    ds_read_b64_tr_b16 a[250:251], v218 offset:20480
    v_mfma_f32_16x16x32_bf16 v[20:23], a[208:211], v[192:195], v[48:51]
    v_exp_f32 v13, v13
    v_mfma_f32_16x16x32_bf16 v[20:23], a[212:215], v[196:199], v[20:23]
    ds_read_b64_tr_b16 a[252:253], v219 offset:16384
    ds_read_b64_tr_b16 a[254:255], v219 offset:20480
    v_mfma_f32_16x16x32_bf16 v[20:23], a[216:219], v[200:203], v[20:23]
    v_exp_f32 v14, v14
    v_mfma_f32_16x16x32_bf16 v[20:23], a[220:223], v[204:207], v[20:23]
    s_waitcnt lgkmcnt(6)
    v_exp_f32 v15, v15
    v_mfma_f32_16x16x32_bf16 a[0:3], a[224:227], v[0:3], a[0:3]
    v_cvt_pk_bf16_f32 v10, v12, v13
    v_cvt_pk_bf16_f32 v11, v14, v15
    v_mfma_f32_16x16x32_bf16 a[4:7], a[228:231], v[0:3], a[4:7]
    v_exp_f32 v16, v16
    v_mfma_f32_16x16x32_bf16 a[8:11], a[232:235], v[0:3], a[8:11]
    v_exp_f32 v17, v17
    v_mfma_f32_16x16x32_bf16 a[12:15], a[236:239], v[0:3], a[12:15]
    buffer_load_dwordx4 v[96:99], v252, s[12:15], s55 offen sc1
    v_mfma_f32_16x16x32_bf16 a[16:19], a[240:243], v[0:3], a[16:19]
    s_waitcnt lgkmcnt(2)
    v_mfma_f32_16x16x32_bf16 a[20:23], a[244:247], v[0:3], a[20:23]
    v_exp_f32 v18, v18
    v_mfma_f32_16x16x32_bf16 a[24:27], a[248:251], v[0:3], a[24:27]
    s_waitcnt lgkmcnt(0)
    v_exp_f32 v19, v19
    v_mfma_f32_16x16x32_bf16 a[28:31], a[252:255], v[0:3], a[28:31]
    buffer_load_dwordx4 v[100:103], v252, s[12:15], s56 offen sc1
    v_cvt_pk_bf16_f32 v16, v16, v17
    v_cvt_pk_bf16_f32 v17, v18, v19
    v_mfma_f32_16x16x32_bf16 v[60:63], v[228:231], v[0:3], v[60:63]
    v_exp_f32 v20, v20
    v_mfma_f32_16x16x32_bf16 v[24:27], a[192:195], a[160:163], v[52:55]
    v_exp_f32 v21, v21
    v_mfma_f32_16x16x32_bf16 v[24:27], a[196:199], a[164:167], v[24:27]
    ds_read_b128 a[192:195], v208 offset:0
    ds_read_b128 a[196:199], v209 offset:0
    v_mfma_f32_16x16x32_bf16 v[24:27], a[200:203], a[168:171], v[24:27]
    v_exp_f32 v22, v22
    v_mfma_f32_16x16x32_bf16 v[24:27], a[204:207], a[172:175], v[24:27]
    ds_read_b128 a[200:203], v210 offset:0
    ds_read_b128 a[204:207], v211 offset:0
    v_mfma_f32_16x16x32_bf16 v[28:31], a[208:211], a[160:163], v[52:55]
    buffer_load_dwordx4 v[104:107], v252, s[12:15], s57 offen sc1
    v_exp_f32 v23, v23
    v_mfma_f32_16x16x32_bf16 v[28:31], a[212:215], a[164:167], v[28:31]
    ds_read_b128 a[208:211], v208 offset:4096
    ds_read_b128 a[212:215], v209 offset:4096
    v_mfma_f32_16x16x32_bf16 v[28:31], a[216:219], a[168:171], v[28:31]
    v_cvt_pk_bf16_f32 v18, v20, v21
    v_cvt_pk_bf16_f32 v19, v22, v23
    v_mfma_f32_16x16x32_bf16 v[28:31], a[220:223], a[172:175], v[28:31]
    ds_read_b128 a[216:219], v210 offset:4096
    ds_read_b128 a[220:223], v211 offset:4096
    v_mfma_f32_16x16x32_bf16 a[32:35], a[224:227], v[8:11], a[32:35]
    v_exp_f32 v24, v24
    v_mfma_f32_16x16x32_bf16 a[36:39], a[228:231], v[8:11], a[36:39]
    v_exp_f32 v25, v25
    v_mfma_f32_16x16x32_bf16 a[40:43], a[232:235], v[8:11], a[40:43]
    v_exp_f32 v26, v26
    v_mfma_f32_16x16x32_bf16 a[44:47], a[236:239], v[8:11], a[44:47]
    buffer_load_dwordx4 v[108:111], v252, s[12:15], s58 offen sc1
    v_mfma_f32_16x16x32_bf16 a[48:51], a[240:243], v[8:11], a[48:51]
    v_mfma_f32_16x16x32_bf16 a[52:55], a[244:247], v[8:11], a[52:55]
    v_exp_f32 v27, v27
    v_mfma_f32_16x16x32_bf16 a[56:59], a[248:251], v[8:11], a[56:59]
    v_cvt_pk_bf16_f32 v24, v24, v25
    v_cvt_pk_bf16_f32 v25, v26, v27
    v_mfma_f32_16x16x32_bf16 a[60:63], a[252:255], v[8:11], a[60:63]
    v_exp_f32 v28, v28
    v_mfma_f32_16x16x32_bf16 v[64:67], v[228:231], v[8:11], v[64:67]
    s_waitcnt lgkmcnt(0)
    v_exp_f32 v29, v29
    v_mfma_f32_16x16x32_bf16 v[0:3], a[192:195], v[160:163], v[40:43]
    v_exp_f32 v30, v30
    v_mfma_f32_16x16x32_bf16 v[0:3], a[196:199], v[164:167], v[0:3]
    v_exp_f32 v31, v31
    v_mfma_f32_16x16x32_bf16 v[0:3], a[200:203], v[168:171], v[0:3]
    v_cvt_pk_bf16_f32 v26, v28, v29
    v_cvt_pk_bf16_f32 v27, v30, v31
    v_mfma_f32_16x16x32_bf16 v[0:3], a[204:207], v[172:175], v[0:3]
    buffer_load_dwordx4 v[112:115], v252, s[12:15], s59 offen sc1
    v_mfma_f32_16x16x32_bf16 v[4:7], a[208:211], v[160:163], v[40:43]
    s_add_u32 m0, s81, 32768
    s_xor_b32 s87, s80, 65536
    v_mfma_f32_16x16x32_bf16 v[4:7], a[212:215], v[164:167], v[4:7]
    v_mfma_f32_16x16x32_bf16 v[4:7], a[216:219], v[168:171], v[4:7]
    v_exp_f32 v0, v0
    v_mfma_f32_16x16x32_bf16 v[4:7], a[220:223], v[172:175], v[4:7]
    v_exp_f32 v1, v1
    v_mfma_f32_16x16x32_bf16 a[64:67], a[224:227], v[16:19], a[64:67]
    v_exp_f32 v2, v2
    v_mfma_f32_16x16x32_bf16 a[68:71], a[228:231], v[16:19], a[68:71]
    v_exp_f32 v3, v3
    v_mfma_f32_16x16x32_bf16 a[72:75], a[232:235], v[16:19], a[72:75]
    v_cvt_pk_bf16_f32 v0, v0, v1
    v_cvt_pk_bf16_f32 v1, v2, v3
    v_mfma_f32_16x16x32_bf16 a[76:79], a[236:239], v[16:19], a[76:79]
    buffer_load_dwordx4 v221, s[32:35], s87 offen offset:0  lds
    v_mfma_f32_16x16x32_bf16 a[80:83], a[240:243], v[16:19], a[80:83]
    v_mfma_f32_16x16x32_bf16 a[84:87], a[244:247], v[16:19], a[84:87]
    v_exp_f32 v4, v4
    v_mfma_f32_16x16x32_bf16 a[88:91], a[248:251], v[16:19], a[88:91]
    v_exp_f32 v5, v5
    v_mfma_f32_16x16x32_bf16 a[92:95], a[252:255], v[16:19], a[92:95]
    v_exp_f32 v6, v6
    v_mfma_f32_16x16x32_bf16 v[68:71], v[228:231], v[16:19], v[68:71]
    v_exp_f32 v7, v7
    v_mfma_f32_16x16x32_bf16 v[8:11], a[192:195], v[176:179], v[44:47]
    v_cvt_pk_bf16_f32 v2, v4, v5
    v_cvt_pk_bf16_f32 v3, v6, v7
    v_mfma_f32_16x16x32_bf16 v[8:11], a[196:199], v[180:183], v[8:11]
    buffer_load_dwordx4 v222, s[32:35], s87 offen offset:1024  lds
    v_mfma_f32_16x16x32_bf16 v[8:11], a[200:203], v[184:187], v[8:11]
    v_mfma_f32_16x16x32_bf16 v[8:11], a[204:207], v[188:191], v[8:11]
    v_mfma_f32_16x16x32_bf16 v[12:15], a[208:211], v[176:179], v[44:47]
    v_mfma_f32_16x16x32_bf16 v[12:15], a[212:215], v[180:183], v[12:15]
    buffer_load_dwordx4 v223, s[32:35], s87 offen offset:2048  lds
    v_mfma_f32_16x16x32_bf16 v[12:15], a[216:219], v[184:187], v[12:15]
    v_exp_f32 v8, v8
    v_mfma_f32_16x16x32_bf16 v[12:15], a[220:223], v[188:191], v[12:15]
    v_exp_f32 v9, v9
    v_mfma_f32_16x16x32_bf16 a[96:99], a[224:227], v[24:27], a[96:99]
    ds_read_b64_tr_b16 a[224:225], v212 offset:24576
    ds_read_b64_tr_b16 a[226:227], v212 offset:28672
    v_mfma_f32_16x16x32_bf16 a[100:103], a[228:231], v[24:27], a[100:103]
    v_exp_f32 v10, v10
    v_mfma_f32_16x16x32_bf16 a[104:107], a[232:235], v[24:27], a[104:107]
    ds_read_b64_tr_b16 a[228:229], v213 offset:24576
    ds_read_b64_tr_b16 a[230:231], v213 offset:28672
    v_mfma_f32_16x16x32_bf16 a[108:111], a[236:239], v[24:27], a[108:111]
    v_mfma_f32_16x16x32_bf16 a[112:115], a[240:243], v[24:27], a[112:115]
    ds_read_b64_tr_b16 a[232:233], v214 offset:24576
    ds_read_b64_tr_b16 a[234:235], v214 offset:28672
    v_mfma_f32_16x16x32_bf16 a[116:119], a[244:247], v[24:27], a[116:119]
    buffer_load_dwordx4 v225, s[32:35], s87 offen offset:3072  lds
    v_mfma_f32_16x16x32_bf16 a[120:123], a[248:251], v[24:27], a[120:123]
    s_add_u32 m0, s81, 36864
    ds_read_b64_tr_b16 a[236:237], v215 offset:24576
    ds_read_b64_tr_b16 a[238:239], v215 offset:28672
    v_mfma_f32_16x16x32_bf16 a[124:127], a[252:255], v[24:27], a[124:127]
    s_xor_b32 s87, s80, 81920
    v_add_u32 v212, s44, v212
    v_add_u32 v213, s44, v213
    v_mfma_f32_16x16x32_bf16 v[72:75], v[228:231], v[24:27], v[72:75]
    ds_read_b64_tr_b16 a[240:241], v216 offset:24576
    ds_read_b64_tr_b16 a[242:243], v216 offset:28672
    v_mfma_f32_16x16x32_bf16 v[16:19], a[192:195], v[192:195], v[48:51]
    v_add_u32 v214, s44, v214
    v_add_u32 v215, s44, v215
    v_mfma_f32_16x16x32_bf16 v[16:19], a[196:199], v[196:199], v[16:19]
    ds_read_b64_tr_b16 a[244:245], v217 offset:24576
    ds_read_b64_tr_b16 a[246:247], v217 offset:28672
    v_mfma_f32_16x16x32_bf16 v[16:19], a[200:203], v[200:203], v[16:19]
    buffer_load_dwordx4 v221, s[32:35], s87 offen offset:0  lds
    v_add_u32 v216, s44, v216
    v_add_u32 v217, s44, v217
    v_mfma_f32_16x16x32_bf16 v[16:19], a[204:207], v[204:207], v[16:19]
    ds_read_b64_tr_b16 a[248:249], v218 offset:24576
    ds_read_b64_tr_b16 a[250:251], v218 offset:28672
    v_mfma_f32_16x16x32_bf16 v[20:23], a[208:211], v[192:195], v[48:51]
    v_exp_f32 v11, v11
    v_mfma_f32_16x16x32_bf16 v[20:23], a[212:215], v[196:199], v[20:23]
    ds_read_b64_tr_b16 a[252:253], v219 offset:24576
    ds_read_b64_tr_b16 a[254:255], v219 offset:28672
    v_mfma_f32_16x16x32_bf16 v[20:23], a[216:219], v[200:203], v[20:23]
    v_add_u32 v218, s44, v218
    v_add_u32 v219, s44, v219
    v_mfma_f32_16x16x32_bf16 v[20:23], a[220:223], v[204:207], v[20:23]
    s_waitcnt lgkmcnt(6)
    v_cvt_pk_bf16_f32 v8, v8, v9
    v_cvt_pk_bf16_f32 v9, v10, v11
    v_mfma_f32_16x16x32_bf16 a[0:3], a[224:227], v[0:3], a[0:3]
    v_exp_f32 v12, v12
    v_mfma_f32_16x16x32_bf16 a[4:7], a[228:231], v[0:3], a[4:7]
    v_exp_f32 v13, v13
    v_mfma_f32_16x16x32_bf16 a[8:11], a[232:235], v[0:3], a[8:11]
    v_exp_f32 v14, v14
    v_mfma_f32_16x16x32_bf16 a[12:15], a[236:239], v[0:3], a[12:15]
    buffer_load_dwordx4 v222, s[32:35], s87 offen offset:1024  lds
    v_mfma_f32_16x16x32_bf16 a[16:19], a[240:243], v[0:3], a[16:19]
    s_waitcnt lgkmcnt(2)
    v_mfma_f32_16x16x32_bf16 a[20:23], a[244:247], v[0:3], a[20:23]
    v_exp_f32 v15, v15
    v_mfma_f32_16x16x32_bf16 a[24:27], a[248:251], v[0:3], a[24:27]
    s_waitcnt lgkmcnt(0)
    v_cvt_pk_bf16_f32 v10, v12, v13
    v_cvt_pk_bf16_f32 v11, v14, v15
    v_mfma_f32_16x16x32_bf16 a[28:31], a[252:255], v[0:3], a[28:31]
    v_exp_f32 v16, v16
    v_mfma_f32_16x16x32_bf16 v[60:63], v[228:231], v[0:3], v[60:63]
    buffer_load_dwordx4 v223, s[32:35], s87 offen offset:2048  lds
    v_exp_f32 v17, v17
    v_mfma_f32_16x16x32_bf16 v[24:27], a[192:195], a[160:163], v[52:55]
    v_exp_f32 v18, v18
    v_mfma_f32_16x16x32_bf16 v[24:27], a[196:199], a[164:167], v[24:27]
    v_exp_f32 v19, v19
    v_mfma_f32_16x16x32_bf16 v[24:27], a[200:203], a[168:171], v[24:27]
    v_cvt_pk_bf16_f32 v16, v16, v17
    v_cvt_pk_bf16_f32 v17, v18, v19
    v_mfma_f32_16x16x32_bf16 v[24:27], a[204:207], a[172:175], v[24:27]
    v_exp_f32 v20, v20
    v_mfma_f32_16x16x32_bf16 v[28:31], a[208:211], a[160:163], v[52:55]
    v_exp_f32 v21, v21
    v_mfma_f32_16x16x32_bf16 v[28:31], a[212:215], a[164:167], v[28:31]
    v_exp_f32 v22, v22
    v_mfma_f32_16x16x32_bf16 v[28:31], a[216:219], a[168:171], v[28:31]
    v_exp_f32 v23, v23
    v_mfma_f32_16x16x32_bf16 v[28:31], a[220:223], a[172:175], v[28:31]
    v_cvt_pk_bf16_f32 v18, v20, v21
    v_cvt_pk_bf16_f32 v19, v22, v23
    v_mfma_f32_16x16x32_bf16 a[32:35], a[224:227], v[8:11], a[32:35]
    v_exp_f32 v24, v24
    v_mfma_f32_16x16x32_bf16 a[36:39], a[228:231], v[8:11], a[36:39]
    v_exp_f32 v25, v25
    v_mfma_f32_16x16x32_bf16 a[40:43], a[232:235], v[8:11], a[40:43]
    v_exp_f32 v26, v26
    v_mfma_f32_16x16x32_bf16 a[44:47], a[236:239], v[8:11], a[44:47]
    buffer_load_dwordx4 v225, s[32:35], s87 offen offset:3072  lds
    v_mfma_f32_16x16x32_bf16 a[48:51], a[240:243], v[8:11], a[48:51]
    v_exp_f32 v27, v27
    v_mfma_f32_16x16x32_bf16 a[52:55], a[244:247], v[8:11], a[52:55]
    v_cvt_pk_bf16_f32 v24, v24, v25
    v_cvt_pk_bf16_f32 v25, v26, v27
    v_mfma_f32_16x16x32_bf16 a[56:59], a[248:251], v[8:11], a[56:59]
    v_exp_f32 v28, v28
    v_mfma_f32_16x16x32_bf16 a[60:63], a[252:255], v[8:11], a[60:63]
    v_exp_f32 v29, v29
    v_mfma_f32_16x16x32_bf16 v[64:67], v[228:231], v[8:11], v[64:67]
    v_exp_f32 v30, v30
    v_mfma_f32_16x16x32_bf16 v[32:35], a[192:195], a[176:179], v[56:59]
    v_exp_f32 v31, v31
    v_mfma_f32_16x16x32_bf16 v[32:35], a[196:199], a[180:183], v[32:35]
    ds_read_b128 a[192:195], v208 offset:8192
    ds_read_b128 a[196:199], v209 offset:8192
    v_mfma_f32_16x16x32_bf16 v[32:35], a[200:203], a[184:187], v[32:35]
    v_cvt_pk_bf16_f32 v26, v28, v29
    v_cvt_pk_bf16_f32 v27, v30, v31
    v_mfma_f32_16x16x32_bf16 v[32:35], a[204:207], a[188:191], v[32:35]
    ds_read_b128 a[200:203], v210 offset:8192
    ds_read_b128 a[204:207], v211 offset:8192
    v_mfma_f32_16x16x32_bf16 v[36:39], a[208:211], a[176:179], v[56:59]
    v_mfma_f32_16x16x32_bf16 v[36:39], a[212:215], a[180:183], v[36:39]
    ds_read_b128 a[208:211], v208 offset:12288
    ds_read_b128 a[212:215], v209 offset:12288
    v_mfma_f32_16x16x32_bf16 v[36:39], a[216:219], a[184:187], v[36:39]
    v_add_u32 v208, s44, v208
    v_add_u32 v209, s44, v209
    v_mfma_f32_16x16x32_bf16 v[36:39], a[220:223], a[188:191], v[36:39]
    ds_read_b128 a[216:219], v210 offset:12288
    ds_read_b128 a[220:223], v211 offset:12288
    v_mfma_f32_16x16x32_bf16 a[64:67], a[224:227], v[16:19], a[64:67]
    v_add_u32 v210, s44, v210
    v_add_u32 v211, s44, v211
    v_mfma_f32_16x16x32_bf16 a[68:71], a[228:231], v[16:19], a[68:71]
    v_exp_f32 v32, v32
    v_mfma_f32_16x16x32_bf16 a[72:75], a[232:235], v[16:19], a[72:75]
    v_exp_f32 v33, v33
    v_mfma_f32_16x16x32_bf16 a[76:79], a[236:239], v[16:19], a[76:79]
    v_exp_f32 v34, v34
    v_mfma_f32_16x16x32_bf16 a[80:83], a[240:243], v[16:19], a[80:83]
    v_exp_f32 v35, v35
    v_mfma_f32_16x16x32_bf16 a[84:87], a[244:247], v[16:19], a[84:87]
    v_cvt_pk_bf16_f32 v32, v32, v33
    v_cvt_pk_bf16_f32 v33, v34, v35
    v_mfma_f32_16x16x32_bf16 a[88:91], a[248:251], v[16:19], a[88:91]
    v_exp_f32 v36, v36
    v_mfma_f32_16x16x32_bf16 a[92:95], a[252:255], v[16:19], a[92:95]
    v_exp_f32 v37, v37
    v_mfma_f32_16x16x32_bf16 v[68:71], v[228:231], v[16:19], v[68:71]
    s_waitcnt lgkmcnt(0)
    v_mfma_f32_16x16x32_bf16 v[0:3], a[192:195], v[160:163], v[40:43]
    v_exp_f32 v38, v38
    v_mfma_f32_16x16x32_bf16 v[0:3], a[196:199], v[164:167], v[0:3]
    v_exp_f32 v39, v39
    v_mfma_f32_16x16x32_bf16 v[0:3], a[200:203], v[168:171], v[0:3]
    v_cvt_pk_bf16_f32 v34, v36, v37
    v_cvt_pk_bf16_f32 v35, v38, v39
    v_mfma_f32_16x16x32_bf16 v[0:3], a[204:207], v[172:175], v[0:3]
    v_mfma_f32_16x16x32_bf16 v[4:7], a[208:211], v[160:163], v[40:43]
    v_mfma_f32_16x16x32_bf16 v[4:7], a[212:215], v[164:167], v[4:7]
    v_mfma_f32_16x16x32_bf16 v[4:7], a[216:219], v[168:171], v[4:7]
    v_exp_f32 v0, v0
    v_mfma_f32_16x16x32_bf16 v[4:7], a[220:223], v[172:175], v[4:7]
    v_exp_f32 v1, v1
    v_mfma_f32_16x16x32_bf16 a[96:99], a[224:227], v[24:27], a[96:99]
    v_exp_f32 v2, v2
    v_mfma_f32_16x16x32_bf16 a[100:103], a[228:231], v[24:27], a[100:103]
    v_exp_f32 v3, v3
    v_mfma_f32_16x16x32_bf16 a[104:107], a[232:235], v[24:27], a[104:107]
    s_waitcnt vmcnt(34) lgkmcnt(0)
    s_barrier
    v_mfma_f32_16x16x32_bf16 a[108:111], a[236:239], v[24:27], a[108:111]
    s_add_u32 s38, s74, s3
    v_mfma_f32_16x16x32_bf16 a[112:115], a[240:243], v[24:27], a[112:115]
    s_add_u32 s74, s74, s44
    v_cvt_pk_bf16_f32 v0, v0, v1
    v_xor_b32 v253, 1024, v238
    v_mfma_f32_16x16x32_bf16 a[116:119], a[244:247], v[24:27], a[116:119]
    buffer_load_dwordx4 v[116:119], v253, s[12:15], s51 offen sc1
    v_mfma_f32_16x16x32_bf16 a[120:123], a[248:251], v[24:27], a[120:123]
    v_mfma_f32_16x16x32_bf16 a[124:127], a[252:255], v[24:27], a[124:127]
    s_cmp_eq_u32 s74, 0x18000
    s_cselect_b32 s44, s45, s46
    v_cvt_pk_bf16_f32 v1, v2, v3
    v_mfma_f32_16x16x32_bf16 v[72:75], v[228:231], v[24:27], v[72:75]
    v_exp_f32 v4, v4
    v_mfma_f32_16x16x32_bf16 v[8:11], a[192:195], v[176:179], v[44:47]
    v_exp_f32 v5, v5
    v_mfma_f32_16x16x32_bf16 v[8:11], a[196:199], v[180:183], v[8:11]
    v_exp_f32 v6, v6
    v_mfma_f32_16x16x32_bf16 v[8:11], a[200:203], v[184:187], v[8:11]
    v_exp_f32 v7, v7
    v_mfma_f32_16x16x32_bf16 v[8:11], a[204:207], v[188:191], v[8:11]
    v_cvt_pk_bf16_f32 v2, v4, v5
    v_cvt_pk_bf16_f32 v3, v6, v7
    v_mfma_f32_16x16x32_bf16 v[12:15], a[208:211], v[176:179], v[44:47]
    buffer_load_dwordx4 v[120:123], v253, s[12:15], s52 offen sc1
    v_mfma_f32_16x16x32_bf16 v[12:15], a[212:215], v[180:183], v[12:15]
    v_mfma_f32_16x16x32_bf16 v[12:15], a[216:219], v[184:187], v[12:15]
    v_exp_f32 v8, v8
    v_mfma_f32_16x16x32_bf16 v[12:15], a[220:223], v[188:191], v[12:15]
    v_exp_f32 v9, v9
    v_mfma_f32_16x16x32_bf16 a[128:131], a[224:227], v[32:35], a[128:131]
    ds_read_b64_tr_b16 a[224:225], v212 offset:16384
    ds_read_b64_tr_b16 a[226:227], v212 offset:20480
    v_mfma_f32_16x16x32_bf16 a[132:135], a[228:231], v[32:35], a[132:135]
    v_exp_f32 v10, v10
    v_mfma_f32_16x16x32_bf16 a[136:139], a[232:235], v[32:35], a[136:139]
    ds_read_b64_tr_b16 a[228:229], v213 offset:16384
    ds_read_b64_tr_b16 a[230:231], v213 offset:20480
    v_mfma_f32_16x16x32_bf16 a[140:143], a[236:239], v[32:35], a[140:143]
    buffer_load_dwordx4 v[124:127], v253, s[12:15], s53 offen sc1
    v_mfma_f32_16x16x32_bf16 a[144:147], a[240:243], v[32:35], a[144:147]
    ds_read_b64_tr_b16 a[232:233], v214 offset:16384
    ds_read_b64_tr_b16 a[234:235], v214 offset:20480
    v_mfma_f32_16x16x32_bf16 a[148:151], a[244:247], v[32:35], a[148:151]
    buffer_load_dwordx4 v[128:131], v253, s[12:15], s54 offen sc1
    v_mfma_f32_16x16x32_bf16 a[152:155], a[248:251], v[32:35], a[152:155]
    ds_read_b64_tr_b16 a[236:237], v215 offset:16384
    ds_read_b64_tr_b16 a[238:239], v215 offset:20480
    v_mfma_f32_16x16x32_bf16 a[156:159], a[252:255], v[32:35], a[156:159]
    v_exp_f32 v11, v11
    v_mfma_f32_16x16x32_bf16 v[76:79], v[228:231], v[32:35], v[76:79]
    ds_read_b64_tr_b16 a[240:241], v216 offset:16384
    ds_read_b64_tr_b16 a[242:243], v216 offset:20480
    v_mfma_f32_16x16x32_bf16 v[16:19], a[192:195], v[192:195], v[48:51]
    v_cvt_pk_bf16_f32 v8, v8, v9
    v_cvt_pk_bf16_f32 v9, v10, v11
    v_mfma_f32_16x16x32_bf16 v[16:19], a[196:199], v[196:199], v[16:19]
    ds_read_b64_tr_b16 a[244:245], v217 offset:16384
    ds_read_b64_tr_b16 a[246:247], v217 offset:20480
    v_mfma_f32_16x16x32_bf16 v[16:19], a[200:203], v[200:203], v[16:19]
    buffer_load_dwordx4 v[132:135], v253, s[12:15], s55 offen sc1
    v_exp_f32 v12, v12
    v_mfma_f32_16x16x32_bf16 v[16:19], a[204:207], v[204:207], v[16:19]
    ds_read_b64_tr_b16 a[248:249], v218 offset:16384
    ds_read_b64_tr_b16 a[250:251], v218 offset:20480
    v_mfma_f32_16x16x32_bf16 v[20:23], a[208:211], v[192:195], v[48:51]
    v_exp_f32 v13, v13
    v_mfma_f32_16x16x32_bf16 v[20:23], a[212:215], v[196:199], v[20:23]
    ds_read_b64_tr_b16 a[252:253], v219 offset:16384
    ds_read_b64_tr_b16 a[254:255], v219 offset:20480
    v_mfma_f32_16x16x32_bf16 v[20:23], a[216:219], v[200:203], v[20:23]
    v_exp_f32 v14, v14
    v_mfma_f32_16x16x32_bf16 v[20:23], a[220:223], v[204:207], v[20:23]
    s_waitcnt lgkmcnt(6)
    v_exp_f32 v15, v15
    v_mfma_f32_16x16x32_bf16 a[0:3], a[224:227], v[0:3], a[0:3]
    v_cvt_pk_bf16_f32 v10, v12, v13
    v_cvt_pk_bf16_f32 v11, v14, v15
    v_mfma_f32_16x16x32_bf16 a[4:7], a[228:231], v[0:3], a[4:7]
    v_exp_f32 v16, v16
    v_mfma_f32_16x16x32_bf16 a[8:11], a[232:235], v[0:3], a[8:11]
    v_exp_f32 v17, v17
    v_mfma_f32_16x16x32_bf16 a[12:15], a[236:239], v[0:3], a[12:15]
    buffer_load_dwordx4 v[136:139], v253, s[12:15], s56 offen sc1
    v_mfma_f32_16x16x32_bf16 a[16:19], a[240:243], v[0:3], a[16:19]
    s_waitcnt lgkmcnt(2)
    v_mfma_f32_16x16x32_bf16 a[20:23], a[244:247], v[0:3], a[20:23]
    v_exp_f32 v18, v18
    v_mfma_f32_16x16x32_bf16 a[24:27], a[248:251], v[0:3], a[24:27]
    s_waitcnt lgkmcnt(0)
    v_exp_f32 v19, v19
    v_mfma_f32_16x16x32_bf16 a[28:31], a[252:255], v[0:3], a[28:31]
    buffer_load_dwordx4 v[140:143], v253, s[12:15], s57 offen sc1
    v_cvt_pk_bf16_f32 v16, v16, v17
    v_cvt_pk_bf16_f32 v17, v18, v19
    v_mfma_f32_16x16x32_bf16 v[60:63], v[228:231], v[0:3], v[60:63]
    v_exp_f32 v20, v20
    v_mfma_f32_16x16x32_bf16 v[24:27], a[192:195], a[160:163], v[52:55]
    v_exp_f32 v21, v21
    v_mfma_f32_16x16x32_bf16 v[24:27], a[196:199], a[164:167], v[24:27]
    ds_read_b128 a[192:195], v208 offset:0
    ds_read_b128 a[196:199], v209 offset:0
    v_mfma_f32_16x16x32_bf16 v[24:27], a[200:203], a[168:171], v[24:27]
    v_exp_f32 v22, v22
    v_mfma_f32_16x16x32_bf16 v[24:27], a[204:207], a[172:175], v[24:27]
    ds_read_b128 a[200:203], v210 offset:0
    ds_read_b128 a[204:207], v211 offset:0
    buffer_load_dwordx4 v[144:147], v253, s[12:15], s58 offen sc1
    v_mfma_f32_16x16x32_bf16 v[28:31], a[208:211], a[160:163], v[52:55]
    v_exp_f32 v23, v23
    v_mfma_f32_16x16x32_bf16 v[28:31], a[212:215], a[164:167], v[28:31]
    ds_read_b128 a[208:211], v208 offset:4096
    ds_read_b128 a[212:215], v209 offset:4096
    v_mfma_f32_16x16x32_bf16 v[28:31], a[216:219], a[168:171], v[28:31]
    v_cvt_pk_bf16_f32 v18, v20, v21
    v_cvt_pk_bf16_f32 v19, v22, v23
    v_mfma_f32_16x16x32_bf16 v[28:31], a[220:223], a[172:175], v[28:31]
    ds_read_b128 a[216:219], v210 offset:4096
    ds_read_b128 a[220:223], v211 offset:4096
    v_mfma_f32_16x16x32_bf16 a[32:35], a[224:227], v[8:11], a[32:35]
    v_exp_f32 v24, v24
    v_mfma_f32_16x16x32_bf16 a[36:39], a[228:231], v[8:11], a[36:39]
    v_exp_f32 v25, v25
    v_mfma_f32_16x16x32_bf16 a[40:43], a[232:235], v[8:11], a[40:43]
    v_exp_f32 v26, v26
    v_mfma_f32_16x16x32_bf16 a[44:47], a[236:239], v[8:11], a[44:47]
    buffer_load_dwordx4 v[148:151], v253, s[12:15], s59 offen sc1
    v_mfma_f32_16x16x32_bf16 a[48:51], a[240:243], v[8:11], a[48:51]
    s_add_u32 m0, s81, 65536
    s_xor_b32 s87, s80, 98304
    v_mfma_f32_16x16x32_bf16 a[52:55], a[244:247], v[8:11], a[52:55]
    v_exp_f32 v27, v27
    v_mfma_f32_16x16x32_bf16 a[56:59], a[248:251], v[8:11], a[56:59]
    v_cvt_pk_bf16_f32 v24, v24, v25
    v_cvt_pk_bf16_f32 v25, v26, v27
    v_mfma_f32_16x16x32_bf16 a[60:63], a[252:255], v[8:11], a[60:63]
    v_exp_f32 v28, v28
    v_mfma_f32_16x16x32_bf16 v[64:67], v[228:231], v[8:11], v[64:67]
    s_waitcnt lgkmcnt(0)
    v_exp_f32 v29, v29
    v_mfma_f32_16x16x32_bf16 v[0:3], a[192:195], v[160:163], v[40:43]
    v_exp_f32 v30, v30
    v_mfma_f32_16x16x32_bf16 v[0:3], a[196:199], v[164:167], v[0:3]
    v_exp_f32 v31, v31
    v_mfma_f32_16x16x32_bf16 v[0:3], a[200:203], v[168:171], v[0:3]
    v_cvt_pk_bf16_f32 v26, v28, v29
    v_cvt_pk_bf16_f32 v27, v30, v31
    v_mfma_f32_16x16x32_bf16 v[0:3], a[204:207], v[172:175], v[0:3]
    buffer_load_dwordx4 v221, s[32:35], s87 offen offset:0  lds
    v_mfma_f32_16x16x32_bf16 v[4:7], a[208:211], v[160:163], v[40:43]
    buffer_load_dwordx4 v222, s[32:35], s87 offen offset:1024  lds
    v_mfma_f32_16x16x32_bf16 v[4:7], a[212:215], v[164:167], v[4:7]
    v_mfma_f32_16x16x32_bf16 v[4:7], a[216:219], v[168:171], v[4:7]
    v_exp_f32 v0, v0
    v_mfma_f32_16x16x32_bf16 v[4:7], a[220:223], v[172:175], v[4:7]
    v_exp_f32 v1, v1
    v_mfma_f32_16x16x32_bf16 a[64:67], a[224:227], v[16:19], a[64:67]
    v_exp_f32 v2, v2
    v_mfma_f32_16x16x32_bf16 a[68:71], a[228:231], v[16:19], a[68:71]
    v_exp_f32 v3, v3
    v_mfma_f32_16x16x32_bf16 a[72:75], a[232:235], v[16:19], a[72:75]
    v_cvt_pk_bf16_f32 v0, v0, v1
    v_cvt_pk_bf16_f32 v1, v2, v3
    v_mfma_f32_16x16x32_bf16 a[76:79], a[236:239], v[16:19], a[76:79]
    buffer_load_dwordx4 v223, s[32:35], s87 offen offset:2048  lds
    v_mfma_f32_16x16x32_bf16 a[80:83], a[240:243], v[16:19], a[80:83]
    v_mfma_f32_16x16x32_bf16 a[84:87], a[244:247], v[16:19], a[84:87]
    v_exp_f32 v4, v4
    v_mfma_f32_16x16x32_bf16 a[88:91], a[248:251], v[16:19], a[88:91]
    v_exp_f32 v5, v5
    v_mfma_f32_16x16x32_bf16 a[92:95], a[252:255], v[16:19], a[92:95]
    v_exp_f32 v6, v6
    v_mfma_f32_16x16x32_bf16 v[68:71], v[228:231], v[16:19], v[68:71]
    v_exp_f32 v7, v7
    v_mfma_f32_16x16x32_bf16 v[8:11], a[192:195], v[176:179], v[44:47]
    v_cvt_pk_bf16_f32 v2, v4, v5
    v_cvt_pk_bf16_f32 v3, v6, v7
    v_mfma_f32_16x16x32_bf16 v[8:11], a[196:199], v[180:183], v[8:11]
    buffer_load_dwordx4 v225, s[32:35], s87 offen offset:3072  lds
    v_mfma_f32_16x16x32_bf16 v[8:11], a[200:203], v[184:187], v[8:11]
    s_add_u32 m0, s81, 69632
    s_xor_b32 s87, s80, 114688
    v_mfma_f32_16x16x32_bf16 v[8:11], a[204:207], v[188:191], v[8:11]
    v_mfma_f32_16x16x32_bf16 v[12:15], a[208:211], v[176:179], v[44:47]
    v_mfma_f32_16x16x32_bf16 v[12:15], a[212:215], v[180:183], v[12:15]
    buffer_load_dwordx4 v221, s[32:35], s87 offen offset:0  lds
    v_mfma_f32_16x16x32_bf16 v[12:15], a[216:219], v[184:187], v[12:15]
    v_exp_f32 v8, v8
    v_mfma_f32_16x16x32_bf16 v[12:15], a[220:223], v[188:191], v[12:15]
    v_exp_f32 v9, v9
    v_mfma_f32_16x16x32_bf16 a[96:99], a[224:227], v[24:27], a[96:99]
    ds_read_b64_tr_b16 a[224:225], v212 offset:24576
    ds_read_b64_tr_b16 a[226:227], v212 offset:28672
    v_mfma_f32_16x16x32_bf16 a[100:103], a[228:231], v[24:27], a[100:103]
    v_exp_f32 v10, v10
    v_mfma_f32_16x16x32_bf16 a[104:107], a[232:235], v[24:27], a[104:107]
    ds_read_b64_tr_b16 a[228:229], v213 offset:24576
    ds_read_b64_tr_b16 a[230:231], v213 offset:28672
    v_mfma_f32_16x16x32_bf16 a[108:111], a[236:239], v[24:27], a[108:111]
    buffer_load_dwordx4 v222, s[32:35], s87 offen offset:1024  lds
    v_mfma_f32_16x16x32_bf16 a[112:115], a[240:243], v[24:27], a[112:115]
    ds_read_b64_tr_b16 a[232:233], v214 offset:24576
    ds_read_b64_tr_b16 a[234:235], v214 offset:28672
    v_mfma_f32_16x16x32_bf16 a[116:119], a[244:247], v[24:27], a[116:119]
    v_mfma_f32_16x16x32_bf16 a[120:123], a[248:251], v[24:27], a[120:123]
    ds_read_b64_tr_b16 a[236:237], v215 offset:24576
    ds_read_b64_tr_b16 a[238:239], v215 offset:28672
    v_mfma_f32_16x16x32_bf16 a[124:127], a[252:255], v[24:27], a[124:127]
    v_add_u32 v212, s44, v212
    v_add_u32 v213, s44, v213
    v_mfma_f32_16x16x32_bf16 v[72:75], v[228:231], v[24:27], v[72:75]
    ds_read_b64_tr_b16 a[240:241], v216 offset:24576
    ds_read_b64_tr_b16 a[242:243], v216 offset:28672
    v_mfma_f32_16x16x32_bf16 v[16:19], a[192:195], v[192:195], v[48:51]
    buffer_load_dwordx4 v223, s[32:35], s87 offen offset:2048  lds
    v_add_u32 v214, s44, v214
    v_add_u32 v215, s44, v215
    v_mfma_f32_16x16x32_bf16 v[16:19], a[196:199], v[196:199], v[16:19]
    ds_read_b64_tr_b16 a[244:245], v217 offset:24576
    ds_read_b64_tr_b16 a[246:247], v217 offset:28672
    v_mfma_f32_16x16x32_bf16 v[16:19], a[200:203], v[200:203], v[16:19]
    v_add_u32 v216, s44, v216
    v_add_u32 v217, s44, v217
    v_mfma_f32_16x16x32_bf16 v[16:19], a[204:207], v[204:207], v[16:19]
    ds_read_b64_tr_b16 a[248:249], v218 offset:24576
    ds_read_b64_tr_b16 a[250:251], v218 offset:28672
    v_mfma_f32_16x16x32_bf16 v[20:23], a[208:211], v[192:195], v[48:51]
    v_exp_f32 v11, v11
    v_mfma_f32_16x16x32_bf16 v[20:23], a[212:215], v[196:199], v[20:23]
    ds_read_b64_tr_b16 a[252:253], v219 offset:24576
    ds_read_b64_tr_b16 a[254:255], v219 offset:28672
    v_mfma_f32_16x16x32_bf16 v[20:23], a[216:219], v[200:203], v[20:23]
    v_add_u32 v218, s44, v218
    v_add_u32 v219, s44, v219
    v_mfma_f32_16x16x32_bf16 v[20:23], a[220:223], v[204:207], v[20:23]
    s_waitcnt lgkmcnt(6)
    v_cvt_pk_bf16_f32 v8, v8, v9
    v_cvt_pk_bf16_f32 v9, v10, v11
    v_mfma_f32_16x16x32_bf16 a[0:3], a[224:227], v[0:3], a[0:3]
    v_exp_f32 v12, v12
    v_mfma_f32_16x16x32_bf16 a[4:7], a[228:231], v[0:3], a[4:7]
    v_exp_f32 v13, v13
    v_mfma_f32_16x16x32_bf16 a[8:11], a[232:235], v[0:3], a[8:11]
    v_exp_f32 v14, v14
    v_mfma_f32_16x16x32_bf16 a[12:15], a[236:239], v[0:3], a[12:15]
    buffer_load_dwordx4 v225, s[32:35], s87 offen offset:3072  lds
    v_mfma_f32_16x16x32_bf16 a[16:19], a[240:243], v[0:3], a[16:19]
    s_waitcnt lgkmcnt(2)
    v_mfma_f32_16x16x32_bf16 a[20:23], a[244:247], v[0:3], a[20:23]
    v_exp_f32 v15, v15
    v_mfma_f32_16x16x32_bf16 a[24:27], a[248:251], v[0:3], a[24:27]
    s_waitcnt lgkmcnt(0)
    v_cvt_pk_bf16_f32 v10, v12, v13
    v_cvt_pk_bf16_f32 v11, v14, v15
    v_mfma_f32_16x16x32_bf16 a[28:31], a[252:255], v[0:3], a[28:31]
    v_exp_f32 v16, v16
    v_mfma_f32_16x16x32_bf16 v[60:63], v[228:231], v[0:3], v[60:63]
    v_exp_f32 v17, v17
    v_mfma_f32_16x16x32_bf16 v[24:27], a[192:195], a[160:163], v[52:55]
    v_exp_f32 v18, v18
    v_mfma_f32_16x16x32_bf16 v[24:27], a[196:199], a[164:167], v[24:27]
    v_exp_f32 v19, v19
    v_mfma_f32_16x16x32_bf16 v[24:27], a[200:203], a[168:171], v[24:27]
    v_cvt_pk_bf16_f32 v16, v16, v17
    v_cvt_pk_bf16_f32 v17, v18, v19
    v_mfma_f32_16x16x32_bf16 v[24:27], a[204:207], a[172:175], v[24:27]
    v_exp_f32 v20, v20
    v_mfma_f32_16x16x32_bf16 v[28:31], a[208:211], a[160:163], v[52:55]
    v_exp_f32 v21, v21
    v_mfma_f32_16x16x32_bf16 v[28:31], a[212:215], a[164:167], v[28:31]
    v_exp_f32 v22, v22
    v_mfma_f32_16x16x32_bf16 v[28:31], a[216:219], a[168:171], v[28:31]
    v_exp_f32 v23, v23
    v_mfma_f32_16x16x32_bf16 v[28:31], a[220:223], a[172:175], v[28:31]
    v_cvt_pk_bf16_f32 v18, v20, v21
    v_cvt_pk_bf16_f32 v19, v22, v23
    v_mfma_f32_16x16x32_bf16 a[32:35], a[224:227], v[8:11], a[32:35]
    v_exp_f32 v24, v24
    v_mfma_f32_16x16x32_bf16 a[36:39], a[228:231], v[8:11], a[36:39]
    v_exp_f32 v25, v25
    v_mfma_f32_16x16x32_bf16 a[40:43], a[232:235], v[8:11], a[40:43]
    v_exp_f32 v26, v26
    v_mfma_f32_16x16x32_bf16 a[44:47], a[236:239], v[8:11], a[44:47]
    v_mfma_f32_16x16x32_bf16 a[48:51], a[240:243], v[8:11], a[48:51]
    v_exp_f32 v27, v27
    v_mfma_f32_16x16x32_bf16 a[52:55], a[244:247], v[8:11], a[52:55]
    v_cvt_pk_bf16_f32 v24, v24, v25
    v_cvt_pk_bf16_f32 v25, v26, v27
    v_mfma_f32_16x16x32_bf16 a[56:59], a[248:251], v[8:11], a[56:59]
    v_exp_f32 v28, v28
    v_mfma_f32_16x16x32_bf16 a[60:63], a[252:255], v[8:11], a[60:63]
    v_exp_f32 v29, v29
    v_mfma_f32_16x16x32_bf16 v[64:67], v[228:231], v[8:11], v[64:67]
    v_exp_f32 v30, v30
    v_mfma_f32_16x16x32_bf16 v[32:35], a[192:195], a[176:179], v[56:59]
    v_exp_f32 v31, v31
    v_mfma_f32_16x16x32_bf16 v[32:35], a[196:199], a[180:183], v[32:35]
    ds_read_b128 a[192:195], v208 offset:8192
    ds_read_b128 a[196:199], v209 offset:8192
    v_mfma_f32_16x16x32_bf16 v[32:35], a[200:203], a[184:187], v[32:35]
    v_cvt_pk_bf16_f32 v26, v28, v29
    v_cvt_pk_bf16_f32 v27, v30, v31
    v_mfma_f32_16x16x32_bf16 v[32:35], a[204:207], a[188:191], v[32:35]
    ds_read_b128 a[200:203], v210 offset:8192
    ds_read_b128 a[204:207], v211 offset:8192
    v_mfma_f32_16x16x32_bf16 v[36:39], a[208:211], a[176:179], v[56:59]
    v_mfma_f32_16x16x32_bf16 v[36:39], a[212:215], a[180:183], v[36:39]
    ds_read_b128 a[208:211], v208 offset:12288
    ds_read_b128 a[212:215], v209 offset:12288
    v_mfma_f32_16x16x32_bf16 v[36:39], a[216:219], a[184:187], v[36:39]
    v_add_u32 v208, s44, v208
    v_add_u32 v209, s44, v209
    v_mfma_f32_16x16x32_bf16 v[36:39], a[220:223], a[188:191], v[36:39]
    ds_read_b128 a[216:219], v210 offset:12288
    ds_read_b128 a[220:223], v211 offset:12288
    v_mfma_f32_16x16x32_bf16 a[64:67], a[224:227], v[16:19], a[64:67]
    v_add_u32 v210, s44, v210
    v_add_u32 v211, s44, v211
    v_mfma_f32_16x16x32_bf16 a[68:71], a[228:231], v[16:19], a[68:71]
    v_exp_f32 v32, v32
    v_mfma_f32_16x16x32_bf16 a[72:75], a[232:235], v[16:19], a[72:75]
    v_exp_f32 v33, v33
    v_mfma_f32_16x16x32_bf16 a[76:79], a[236:239], v[16:19], a[76:79]
    v_exp_f32 v34, v34
    v_mfma_f32_16x16x32_bf16 a[80:83], a[240:243], v[16:19], a[80:83]
    v_exp_f32 v35, v35
    v_mfma_f32_16x16x32_bf16 a[84:87], a[244:247], v[16:19], a[84:87]
    v_cvt_pk_bf16_f32 v32, v32, v33
    v_cvt_pk_bf16_f32 v33, v34, v35
    v_mfma_f32_16x16x32_bf16 a[88:91], a[248:251], v[16:19], a[88:91]
    v_exp_f32 v36, v36
    v_mfma_f32_16x16x32_bf16 a[92:95], a[252:255], v[16:19], a[92:95]
    v_exp_f32 v37, v37
    v_mfma_f32_16x16x32_bf16 v[68:71], v[228:231], v[16:19], v[68:71]
    s_waitcnt lgkmcnt(0)
    s_lshl_b32 s67, s36, 19
    s_add_u32 s67, s67, s70
    s_add_u32 s67, s67, 4096
    s_nop 1
    v_mfma_f32_16x16x32_bf16 a[96:99], a[224:227], v[24:27], a[96:99]
    v_exp_f32 v38, v38
    v_exp_f32 v39, v39
    v_mfma_f32_16x16x32_bf16 a[100:103], a[228:231], v[24:27], a[100:103]
    v_cvt_pk_bf16_f32 v34, v36, v37
    v_cvt_pk_bf16_f32 v35, v38, v39
    v_mfma_f32_16x16x32_bf16 a[104:107], a[232:235], v[24:27], a[104:107]
    v_rcp_f32 v240, v60
    s_add_u32 s66, s67, 0
    v_mfma_f32_16x16x32_bf16 a[108:111], a[236:239], v[24:27], a[108:111]
    v_mov_b32 v241, v240
    v_accvgpr_read_b32 v40, a0
    v_mfma_f32_16x16x32_bf16 a[112:115], a[240:243], v[24:27], a[112:115]
    v_accvgpr_read_b32 v41, a1
    v_accvgpr_read_b32 v42, a2
    v_mfma_f32_16x16x32_bf16 a[116:119], a[244:247], v[24:27], a[116:119]
    v_mfma_f32_16x16x32_bf16 a[120:123], a[248:251], v[24:27], a[120:123]
    v_mfma_f32_16x16x32_bf16 a[124:127], a[252:255], v[24:27], a[124:127]
    v_mfma_f32_16x16x32_bf16 v[72:75], v[228:231], v[24:27], v[72:75]
    v_mfma_f32_16x16x32_bf16 a[128:131], a[224:227], v[32:35], a[128:131]
    v_accvgpr_read_b32 v43, a3
    v_accvgpr_read_b32 v44, a4
    v_accvgpr_read_b32 v45, a5
    v_accvgpr_read_b32 v46, a6
    v_accvgpr_read_b32 v47, a7
    v_mfma_f32_16x16x32_bf16 a[132:135], a[228:231], v[32:35], a[132:135]
    v_mul_f32 v40, v40, v240
    v_mul_f32 v41, v41, v240
    v_mul_f32 v42, v42, v240
    v_mul_f32 v43, v43, v240
    v_mul_f32 v44, v44, v240
    v_mfma_f32_16x16x32_bf16 a[136:139], a[232:235], v[32:35], a[136:139]
    v_mul_f32 v45, v45, v240
    v_mul_f32 v46, v46, v240
    v_mul_f32 v47, v47, v240
    v_cvt_pk_bf16_f32 v40, v40, v41
    v_cvt_pk_bf16_f32 v41, v42, v43
    v_mfma_f32_16x16x32_bf16 a[140:143], a[236:239], v[32:35], a[140:143]
    v_cvt_pk_bf16_f32 v42, v44, v45
    v_cvt_pk_bf16_f32 v43, v46, v47
    buffer_store_dwordx4 v[40:43], v233, s[28:31], s66 offen offset:0
    v_accvgpr_read_b32 v48, a8
    v_accvgpr_read_b32 v49, a9
    v_mfma_f32_16x16x32_bf16 a[144:147], a[240:243], v[32:35], a[144:147]
    v_accvgpr_read_b32 v50, a10
    v_accvgpr_read_b32 v51, a11
    v_accvgpr_read_b32 v52, a12
    v_accvgpr_read_b32 v53, a13
    v_accvgpr_read_b32 v54, a14
    v_mfma_f32_16x16x32_bf16 a[148:151], a[244:247], v[32:35], a[148:151]
    v_accvgpr_read_b32 v55, a15
    v_mul_f32 v48, v48, v240
    v_mul_f32 v49, v49, v240
    v_mul_f32 v50, v50, v240
    v_mul_f32 v51, v51, v240
    v_mfma_f32_16x16x32_bf16 a[152:155], a[248:251], v[32:35], a[152:155]
    v_mul_f32 v52, v52, v240
    v_mul_f32 v53, v53, v240
    v_mul_f32 v54, v54, v240
    v_mul_f32 v55, v55, v240
    v_cvt_pk_bf16_f32 v48, v48, v49
    v_mfma_f32_16x16x32_bf16 a[156:159], a[252:255], v[32:35], a[156:159]
    v_cvt_pk_bf16_f32 v49, v50, v51
    v_cvt_pk_bf16_f32 v50, v52, v53
    v_cvt_pk_bf16_f32 v51, v54, v55
    buffer_store_dwordx4 v[48:51], v233, s[28:31], s66 offen offset:1024
    v_mfma_f32_16x16x32_bf16 v[76:79], v[228:231], v[32:35], v[76:79]
    v_accvgpr_read_b32 v40, a16
    v_accvgpr_read_b32 v41, a17
    v_accvgpr_read_b32 v42, a18
    v_accvgpr_read_b32 v43, a19
    v_accvgpr_read_b32 v44, a20
    v_accvgpr_read_b32 v45, a21
    v_accvgpr_read_b32 v46, a22
    v_accvgpr_read_b32 v47, a23
    v_pk_mul_f32 v[40:41], v[40:41], v[240:241]
    v_pk_mul_f32 v[42:43], v[42:43], v[240:241]
    v_pk_mul_f32 v[44:45], v[44:45], v[240:241]
    v_pk_mul_f32 v[46:47], v[46:47], v[240:241]
    v_cvt_pk_bf16_f32 v40, v40, v41
    v_cvt_pk_bf16_f32 v41, v42, v43
    v_cvt_pk_bf16_f32 v42, v44, v45
    v_cvt_pk_bf16_f32 v43, v46, v47
    buffer_store_dwordx4 v[40:43], v233, s[28:31], s66 offen offset:2048
    v_accvgpr_read_b32 v48, a24
    v_accvgpr_read_b32 v49, a25
    v_accvgpr_read_b32 v50, a26
    v_accvgpr_read_b32 v51, a27
    v_accvgpr_read_b32 v52, a28
    v_accvgpr_read_b32 v53, a29
    v_accvgpr_read_b32 v54, a30
    v_accvgpr_read_b32 v55, a31
    v_pk_mul_f32 v[48:49], v[48:49], v[240:241]
    v_pk_mul_f32 v[50:51], v[50:51], v[240:241]
    v_pk_mul_f32 v[52:53], v[52:53], v[240:241]
    v_pk_mul_f32 v[54:55], v[54:55], v[240:241]
    v_cvt_pk_bf16_f32 v48, v48, v49
    v_cvt_pk_bf16_f32 v49, v50, v51
    v_cvt_pk_bf16_f32 v50, v52, v53
    v_cvt_pk_bf16_f32 v51, v54, v55
    buffer_store_dwordx4 v[48:51], v233, s[28:31], s66 offen offset:3072
    v_rcp_f32 v240, v64
    s_add_u32 s66, s67, 131072
    v_mov_b32 v241, v240
    v_accvgpr_read_b32 v40, a32
    v_accvgpr_read_b32 v41, a33
    v_accvgpr_read_b32 v42, a34
    v_accvgpr_read_b32 v43, a35
    v_accvgpr_read_b32 v44, a36
    v_accvgpr_read_b32 v45, a37
    v_accvgpr_read_b32 v46, a38
    v_accvgpr_read_b32 v47, a39
    v_pk_mul_f32 v[40:41], v[40:41], v[240:241]
    v_pk_mul_f32 v[42:43], v[42:43], v[240:241]
    v_pk_mul_f32 v[44:45], v[44:45], v[240:241]
    v_pk_mul_f32 v[46:47], v[46:47], v[240:241]
    v_cvt_pk_bf16_f32 v40, v40, v41
    v_cvt_pk_bf16_f32 v41, v42, v43
    v_cvt_pk_bf16_f32 v42, v44, v45
    v_cvt_pk_bf16_f32 v43, v46, v47
    buffer_store_dwordx4 v[40:43], v233, s[28:31], s66 offen offset:0
    v_accvgpr_read_b32 v48, a40
    v_accvgpr_read_b32 v49, a41
    v_accvgpr_read_b32 v50, a42
    v_accvgpr_read_b32 v51, a43
    v_accvgpr_read_b32 v52, a44
    v_accvgpr_read_b32 v53, a45
    v_accvgpr_read_b32 v54, a46
    v_accvgpr_read_b32 v55, a47
    v_pk_mul_f32 v[48:49], v[48:49], v[240:241]
    v_pk_mul_f32 v[50:51], v[50:51], v[240:241]
    v_pk_mul_f32 v[52:53], v[52:53], v[240:241]
    v_pk_mul_f32 v[54:55], v[54:55], v[240:241]
    v_cvt_pk_bf16_f32 v48, v48, v49
    v_cvt_pk_bf16_f32 v49, v50, v51
    v_cvt_pk_bf16_f32 v50, v52, v53
    v_cvt_pk_bf16_f32 v51, v54, v55
    buffer_store_dwordx4 v[48:51], v233, s[28:31], s66 offen offset:1024
    v_accvgpr_read_b32 v40, a48
    v_accvgpr_read_b32 v41, a49
    v_accvgpr_read_b32 v42, a50
    v_accvgpr_read_b32 v43, a51
    v_accvgpr_read_b32 v44, a52
    v_accvgpr_read_b32 v45, a53
    v_accvgpr_read_b32 v46, a54
    v_accvgpr_read_b32 v47, a55
    v_pk_mul_f32 v[40:41], v[40:41], v[240:241]
    v_pk_mul_f32 v[42:43], v[42:43], v[240:241]
    v_pk_mul_f32 v[44:45], v[44:45], v[240:241]
    v_pk_mul_f32 v[46:47], v[46:47], v[240:241]
    v_cvt_pk_bf16_f32 v40, v40, v41
    v_cvt_pk_bf16_f32 v41, v42, v43
    v_cvt_pk_bf16_f32 v42, v44, v45
    v_cvt_pk_bf16_f32 v43, v46, v47
    buffer_store_dwordx4 v[40:43], v233, s[28:31], s66 offen offset:2048
    v_accvgpr_read_b32 v48, a56
    v_accvgpr_read_b32 v49, a57
    v_accvgpr_read_b32 v50, a58
    v_accvgpr_read_b32 v51, a59
    v_accvgpr_read_b32 v52, a60
    v_accvgpr_read_b32 v53, a61
    v_accvgpr_read_b32 v54, a62
    v_accvgpr_read_b32 v55, a63
    v_pk_mul_f32 v[48:49], v[48:49], v[240:241]
    v_pk_mul_f32 v[50:51], v[50:51], v[240:241]
    v_pk_mul_f32 v[52:53], v[52:53], v[240:241]
    v_pk_mul_f32 v[54:55], v[54:55], v[240:241]
    v_cvt_pk_bf16_f32 v48, v48, v49
    v_cvt_pk_bf16_f32 v49, v50, v51
    v_cvt_pk_bf16_f32 v50, v52, v53
    v_cvt_pk_bf16_f32 v51, v54, v55
    buffer_store_dwordx4 v[48:51], v233, s[28:31], s66 offen offset:3072
    v_add_f32 v246, v60, v64
    v_add_f32 v247, v68, v72
    v_mov_b32 v244, v56
    v_mov_b32 v245, v76
    v_add_f32 v246, v246, v247
    s_lshl_b32 s60, s36, 10
    s_add_u32 s60, s60, s74
    v_add_f32 v246, v246, v76
    v_add_u32 v242, s60, v233
    s_add_u32 s60, s47, s74
    v_add_u32 v243, s60, v233
    s_waitcnt lgkmcnt(0)
    s_barrier
    ds_write_b128 v242, v[244:247]
    ds_write_b128 v243, a[128:131] offset:4096
    ds_write_b128 v243, a[132:135] offset:5120
    ds_write_b128 v243, a[136:139] offset:6144
    ds_write_b128 v243, a[140:143] offset:7168
    v_rcp_f32 v240, v68
    s_add_u32 s66, s67, 262144
    v_mov_b32 v241, v240
    v_accvgpr_read_b32 v40, a64
    v_accvgpr_read_b32 v41, a65
    v_accvgpr_read_b32 v42, a66
    v_accvgpr_read_b32 v43, a67
    v_accvgpr_read_b32 v44, a68
    v_accvgpr_read_b32 v45, a69
    v_accvgpr_read_b32 v46, a70
    v_accvgpr_read_b32 v47, a71
    v_pk_mul_f32 v[40:41], v[40:41], v[240:241]
    v_pk_mul_f32 v[42:43], v[42:43], v[240:241]
    v_pk_mul_f32 v[44:45], v[44:45], v[240:241]
    v_pk_mul_f32 v[46:47], v[46:47], v[240:241]
    v_cvt_pk_bf16_f32 v40, v40, v41
    v_cvt_pk_bf16_f32 v41, v42, v43
    v_cvt_pk_bf16_f32 v42, v44, v45
    v_cvt_pk_bf16_f32 v43, v46, v47
    buffer_store_dwordx4 v[40:43], v233, s[28:31], s66 offen offset:0
    v_accvgpr_read_b32 v48, a72
    v_accvgpr_read_b32 v49, a73
    v_accvgpr_read_b32 v50, a74
    v_accvgpr_read_b32 v51, a75
    v_accvgpr_read_b32 v52, a76
    v_accvgpr_read_b32 v53, a77
    v_accvgpr_read_b32 v54, a78
    v_accvgpr_read_b32 v55, a79
    v_pk_mul_f32 v[48:49], v[48:49], v[240:241]
    v_pk_mul_f32 v[50:51], v[50:51], v[240:241]
    v_pk_mul_f32 v[52:53], v[52:53], v[240:241]
    v_pk_mul_f32 v[54:55], v[54:55], v[240:241]
    v_cvt_pk_bf16_f32 v48, v48, v49
    v_cvt_pk_bf16_f32 v49, v50, v51
    v_cvt_pk_bf16_f32 v50, v52, v53
    v_cvt_pk_bf16_f32 v51, v54, v55
    buffer_store_dwordx4 v[48:51], v233, s[28:31], s66 offen offset:1024
    v_accvgpr_read_b32 v40, a80
    v_accvgpr_read_b32 v41, a81
    v_accvgpr_read_b32 v42, a82
    v_accvgpr_read_b32 v43, a83
    v_accvgpr_read_b32 v44, a84
    v_accvgpr_read_b32 v45, a85
    v_accvgpr_read_b32 v46, a86
    v_accvgpr_read_b32 v47, a87
    v_pk_mul_f32 v[40:41], v[40:41], v[240:241]
    v_pk_mul_f32 v[42:43], v[42:43], v[240:241]
    v_pk_mul_f32 v[44:45], v[44:45], v[240:241]
    v_pk_mul_f32 v[46:47], v[46:47], v[240:241]
    v_cvt_pk_bf16_f32 v40, v40, v41
    v_cvt_pk_bf16_f32 v41, v42, v43
    v_cvt_pk_bf16_f32 v42, v44, v45
    v_cvt_pk_bf16_f32 v43, v46, v47
    buffer_store_dwordx4 v[40:43], v233, s[28:31], s66 offen offset:2048
    v_accvgpr_read_b32 v48, a88
    v_accvgpr_read_b32 v49, a89
    v_accvgpr_read_b32 v50, a90
    v_accvgpr_read_b32 v51, a91
    v_accvgpr_read_b32 v52, a92
    v_accvgpr_read_b32 v53, a93
    v_accvgpr_read_b32 v54, a94
    v_accvgpr_read_b32 v55, a95
    v_pk_mul_f32 v[48:49], v[48:49], v[240:241]
    v_pk_mul_f32 v[50:51], v[50:51], v[240:241]
    v_pk_mul_f32 v[52:53], v[52:53], v[240:241]
    v_pk_mul_f32 v[54:55], v[54:55], v[240:241]
    v_cvt_pk_bf16_f32 v48, v48, v49
    v_cvt_pk_bf16_f32 v49, v50, v51
    v_cvt_pk_bf16_f32 v50, v52, v53
    v_cvt_pk_bf16_f32 v51, v54, v55
    buffer_store_dwordx4 v[48:51], v233, s[28:31], s66 offen offset:3072
    v_xor_b32 v243, 4096, v243
    v_xor_b32 v242, 1024, v242
    s_waitcnt lgkmcnt(0)
    s_barrier
    ds_read_b128 v[248:251], v242
    v_xor_b32 v242, 2048, v242
    ds_read_b32 v0, v242 offset:8
    v_xor_b32 v242, 1024, v242
    ds_read_b32 v1, v242 offset:8
    ds_read_b128 v[8:11], v243 offset:4096
    ds_read_b128 v[12:15], v243 offset:5120
    ds_read_b128 v[16:19], v243 offset:6144
    ds_read_b128 v[20:23], v243 offset:7168
    v_rcp_f32 v240, v72
    s_add_u32 s66, s67, 393216
    v_mov_b32 v241, v240
    v_accvgpr_read_b32 v40, a96
    v_accvgpr_read_b32 v41, a97
    v_accvgpr_read_b32 v42, a98
    v_accvgpr_read_b32 v43, a99
    v_accvgpr_read_b32 v44, a100
    v_accvgpr_read_b32 v45, a101
    v_accvgpr_read_b32 v46, a102
    v_accvgpr_read_b32 v47, a103
    v_pk_mul_f32 v[40:41], v[40:41], v[240:241]
    v_pk_mul_f32 v[42:43], v[42:43], v[240:241]
    v_pk_mul_f32 v[44:45], v[44:45], v[240:241]
    v_pk_mul_f32 v[46:47], v[46:47], v[240:241]
    v_accvgpr_read_b32 v48, a104
    v_accvgpr_read_b32 v49, a105
    v_accvgpr_read_b32 v50, a106
    v_accvgpr_read_b32 v51, a107
    v_accvgpr_read_b32 v52, a108
    v_accvgpr_read_b32 v53, a109
    v_accvgpr_read_b32 v54, a110
    v_accvgpr_read_b32 v55, a111
    v_pk_mul_f32 v[48:49], v[48:49], v[240:241]
    v_pk_mul_f32 v[50:51], v[50:51], v[240:241]
    v_pk_mul_f32 v[52:53], v[52:53], v[240:241]
    v_pk_mul_f32 v[54:55], v[54:55], v[240:241]
    s_waitcnt lgkmcnt(4)
    v_add_f32 v0, v0, v1
    v_add_f32 v1, v246, v250
    v_add_f32 v0, v0, v1
    v_cmp_nge_f32 vcc, s43, v0
    s_cbranch_vccnz A1h1_redo
A1h1_ok:
    v_min_f32 v0, v244, v248
    v_sub_f32 v244, v0, v244
    v_sub_f32 v248, v0, v248
    v_exp_f32 v244, v244
    v_exp_f32 v248, v248
    s_nop 0
    v_mul_f32 v0, v244, v245
    v_fmac_f32 v0, v248, v249
    v_rcp_f32 v0, v0
    s_nop 0
    v_mul_f32 v244, v244, v0
    v_mul_f32 v248, v248, v0
    v_mov_b32 v245, v244
    v_mov_b32 v249, v248
    v_accvgpr_read_b32 v24, a144
    v_accvgpr_read_b32 v25, a145
    v_accvgpr_read_b32 v26, a146
    v_accvgpr_read_b32 v27, a147
    v_accvgpr_read_b32 v28, a148
    v_accvgpr_read_b32 v29, a149
    v_accvgpr_read_b32 v30, a150
    v_accvgpr_read_b32 v31, a151
    v_accvgpr_read_b32 v32, a152
    v_accvgpr_read_b32 v33, a153
    v_accvgpr_read_b32 v34, a154
    v_accvgpr_read_b32 v35, a155
    v_accvgpr_read_b32 v36, a156
    v_accvgpr_read_b32 v37, a157
    v_accvgpr_read_b32 v38, a158
    v_accvgpr_read_b32 v39, a159
    v_pk_mul_f32 v[24:25], v[24:25], v[244:245]
    v_pk_mul_f32 v[26:27], v[26:27], v[244:245]
    v_pk_mul_f32 v[28:29], v[28:29], v[244:245]
    v_pk_mul_f32 v[30:31], v[30:31], v[244:245]
    v_pk_mul_f32 v[32:33], v[32:33], v[244:245]
    v_pk_mul_f32 v[34:35], v[34:35], v[244:245]
    v_pk_mul_f32 v[36:37], v[36:37], v[244:245]
    v_pk_mul_f32 v[38:39], v[38:39], v[244:245]
    s_waitcnt lgkmcnt(0)
    v_pk_fma_f32 v[24:25], v[8:9], v[248:249], v[24:25]
    v_pk_fma_f32 v[26:27], v[10:11], v[248:249], v[26:27]
    v_pk_fma_f32 v[28:29], v[12:13], v[248:249], v[28:29]
    v_pk_fma_f32 v[30:31], v[14:15], v[248:249], v[30:31]
    v_pk_fma_f32 v[32:33], v[16:17], v[248:249], v[32:33]
    v_pk_fma_f32 v[34:35], v[18:19], v[248:249], v[34:35]
    v_pk_fma_f32 v[36:37], v[20:21], v[248:249], v[36:37]
    v_pk_fma_f32 v[38:39], v[22:23], v[248:249], v[38:39]
    v_cvt_pk_bf16_f32 v24, v24, v25
    v_cvt_pk_bf16_f32 v25, v26, v27
    v_cvt_pk_bf16_f32 v26, v28, v29
    v_cvt_pk_bf16_f32 v27, v30, v31
    v_cvt_pk_bf16_f32 v28, v32, v33
    v_cvt_pk_bf16_f32 v29, v34, v35
    v_cvt_pk_bf16_f32 v30, v36, v37
    v_cvt_pk_bf16_f32 v31, v38, v39
    s_lshr_b32 s60, s36, 1
    s_lshl_b32 s60, s60, 17
    s_add_u32 s60, s60, s70
    s_add_u32 s60, s60, 2101248
    buffer_store_dwordx4 v[24:27], v233, s[28:31], s60 offen offset:2048
    buffer_store_dwordx4 v[28:31], v233, s[28:31], s60 offen offset:3072
    v_cvt_pk_bf16_f32 v40, v40, v41
    v_cvt_pk_bf16_f32 v41, v42, v43
    v_cvt_pk_bf16_f32 v42, v44, v45
    v_cvt_pk_bf16_f32 v43, v46, v47
    buffer_store_dwordx4 v[40:43], v233, s[28:31], s66 offen offset:0
    v_cvt_pk_bf16_f32 v48, v48, v49
    v_cvt_pk_bf16_f32 v49, v50, v51
    v_cvt_pk_bf16_f32 v50, v52, v53
    v_cvt_pk_bf16_f32 v51, v54, v55
    buffer_store_dwordx4 v[48:51], v233, s[28:31], s66 offen offset:1024
    v_accvgpr_read_b32 v40, a112
    v_accvgpr_read_b32 v41, a113
    v_accvgpr_read_b32 v42, a114
    v_accvgpr_read_b32 v43, a115
    v_accvgpr_read_b32 v44, a116
    v_accvgpr_read_b32 v45, a117
    v_accvgpr_read_b32 v46, a118
    v_accvgpr_read_b32 v47, a119
    v_pk_mul_f32 v[40:41], v[40:41], v[240:241]
    v_pk_mul_f32 v[42:43], v[42:43], v[240:241]
    v_pk_mul_f32 v[44:45], v[44:45], v[240:241]
    v_pk_mul_f32 v[46:47], v[46:47], v[240:241]
    v_cvt_pk_bf16_f32 v40, v40, v41
    v_cvt_pk_bf16_f32 v41, v42, v43
    v_cvt_pk_bf16_f32 v42, v44, v45
    v_cvt_pk_bf16_f32 v43, v46, v47
    buffer_store_dwordx4 v[40:43], v233, s[28:31], s66 offen offset:2048
    v_accvgpr_read_b32 v48, a120
    v_accvgpr_read_b32 v49, a121
    v_accvgpr_read_b32 v50, a122
    v_accvgpr_read_b32 v51, a123
    v_accvgpr_read_b32 v52, a124
    v_accvgpr_read_b32 v53, a125
    v_accvgpr_read_b32 v54, a126
    v_accvgpr_read_b32 v55, a127
    v_pk_mul_f32 v[48:49], v[48:49], v[240:241]
    v_pk_mul_f32 v[50:51], v[50:51], v[240:241]
    v_pk_mul_f32 v[52:53], v[52:53], v[240:241]
    v_pk_mul_f32 v[54:55], v[54:55], v[240:241]
    v_cvt_pk_bf16_f32 v48, v48, v49
    v_cvt_pk_bf16_f32 v49, v50, v51
    v_cvt_pk_bf16_f32 v50, v52, v53
    v_cvt_pk_bf16_f32 v51, v54, v55
    buffer_store_dwordx4 v[48:51], v233, s[28:31], s66 offen offset:3072
    s_and_b32 s61, s50, 1
    s_lshl_b32 s61, s61, 2
    s_or_b32 s61, s61, s36
    s_lshl_b32 s61, s61, 5
    s_add_u32 s60, s81, 131072
    v_add_u32 v212, s60, v235
    v_xor_b32 v212, s61, v212
    v_xor_b32 v213, 32, v212
    v_xor_b32 v214, 64, v212
    v_xor_b32 v215, 96, v212
    v_xor_b32 v216, 128, v212
    v_xor_b32 v217, 160, v212
    v_xor_b32 v218, 192, v212
    v_xor_b32 v219, 224, v212
    s_cmp_lg_u32 s40, 0
    s_cbranch_scc1 OP_slow
    s_waitcnt vmcnt(18)
    s_branch OP_main
A1h1_redo:
    s_cmp_lg_u32 s41, 1
    s_cbranch_scc1 A1h1_ok
    s_mov_b32 s41, 2
    s_branch MP1
A1h1_enter:
    v_mov_b32 v24, 0
    v_mov_b32 v25, 0
    v_mov_b32 v26, 0
    v_mov_b32 v27, 0
    v_mov_b32 v28, 0
    v_mov_b32 v29, 0
    v_mov_b32 v30, 0
    v_mov_b32 v31, 0
    v_mov_b32 v32, 0
    v_mov_b32 v33, 0
    v_mov_b32 v34, 0
    v_mov_b32 v35, 0
    v_mov_b32 v36, 0
    v_mov_b32 v37, 0
    v_mov_b32 v38, 0xff800000
    v_mov_b32 v39, 0xff800000
    s_mov_b32 s39, 16
    s_mov_b32 s2, 3
    s_branch A1h1_loop
MP0:
    s_waitcnt vmcnt(0) lgkmcnt(0)
    s_barrier
    s_add_u32 s60, s74, s44
    v_subrev_u32 v208, s60, v208
    v_subrev_u32 v209, s60, v209
    v_subrev_u32 v210, s60, v210
    v_subrev_u32 v211, s60, v211
    v_subrev_u32 v212, s60, v212
    v_subrev_u32 v213, s60, v213
    v_subrev_u32 v214, s60, v214
    v_subrev_u32 v215, s60, v215
    v_subrev_u32 v216, s60, v216
    v_subrev_u32 v217, s60, v217
    v_subrev_u32 v218, s60, v218
    v_subrev_u32 v219, s60, v219
    v_mov_b32 v242, 0xff800000
    v_mov_b32 v243, 0xff800000
    v_mov_b32 v244, 0xff800000
    v_mov_b32 v245, 0xff800000
    v_mov_b32 v246, 0xff800000
    s_add_u32 s85, s3, 0
    s_mov_b32 s62, 16
MP0_loop:
    s_add_u32 m0, s3, 0
    s_xor_b32 s87, s85, s86
    s_add_u32 s85, s85, 4096
    buffer_load_dwordx4 v220, s[20:23], s87 offen nt lds
    s_add_u32 m0, s3, 4096
    s_xor_b32 s87, s85, s86
    s_add_u32 s85, s85, 4096
    buffer_load_dwordx4 v220, s[20:23], s87 offen nt lds
    s_add_u32 m0, s3, 8192
    s_xor_b32 s87, s85, s86
    s_add_u32 s85, s85, 4096
    buffer_load_dwordx4 v220, s[20:23], s87 offen nt lds
    s_add_u32 m0, s3, 12288
    s_xor_b32 s87, s85, s86
    s_add_u32 s85, s85, 4096
    buffer_load_dwordx4 v220, s[20:23], s87 offen nt lds
    s_waitcnt vmcnt(0)
    s_barrier
    ds_read_b128 a[192:195], v208 offset:0
    ds_read_b128 a[196:199], v209 offset:0
    ds_read_b128 a[200:203], v210 offset:0
    ds_read_b128 a[204:207], v211 offset:0
    ds_read_b128 a[208:211], v208 offset:4096
    ds_read_b128 a[212:215], v209 offset:4096
    ds_read_b128 a[216:219], v210 offset:4096
    ds_read_b128 a[220:223], v211 offset:4096
    s_waitcnt lgkmcnt(0)
    v_mfma_f32_16x16x32_bf16 v[0:3], a[192:195], v[80:83], 0
    v_mfma_f32_16x16x32_bf16 v[0:3], a[196:199], v[84:87], v[0:3]
    v_mfma_f32_16x16x32_bf16 v[0:3], a[200:203], v[88:91], v[0:3]
    v_mfma_f32_16x16x32_bf16 v[0:3], a[204:207], v[92:95], v[0:3]
    v_mfma_f32_16x16x32_bf16 v[4:7], a[208:211], v[80:83], 0
    v_mfma_f32_16x16x32_bf16 v[4:7], a[212:215], v[84:87], v[4:7]
    v_mfma_f32_16x16x32_bf16 v[4:7], a[216:219], v[88:91], v[4:7]
    v_mfma_f32_16x16x32_bf16 v[4:7], a[220:223], v[92:95], v[4:7]
    v_mfma_f32_16x16x32_bf16 v[8:11], a[192:195], v[96:99], 0
    v_mfma_f32_16x16x32_bf16 v[8:11], a[196:199], v[100:103], v[8:11]
    v_mfma_f32_16x16x32_bf16 v[8:11], a[200:203], v[104:107], v[8:11]
    v_mfma_f32_16x16x32_bf16 v[8:11], a[204:207], v[108:111], v[8:11]
    v_mfma_f32_16x16x32_bf16 v[12:15], a[208:211], v[96:99], 0
    v_mfma_f32_16x16x32_bf16 v[12:15], a[212:215], v[100:103], v[12:15]
    v_mfma_f32_16x16x32_bf16 v[12:15], a[216:219], v[104:107], v[12:15]
    v_mfma_f32_16x16x32_bf16 v[12:15], a[220:223], v[108:111], v[12:15]
    v_mfma_f32_16x16x32_bf16 v[16:19], a[192:195], v[112:115], 0
    v_mfma_f32_16x16x32_bf16 v[16:19], a[196:199], v[116:119], v[16:19]
    v_mfma_f32_16x16x32_bf16 v[16:19], a[200:203], v[120:123], v[16:19]
    v_mfma_f32_16x16x32_bf16 v[16:19], a[204:207], v[124:127], v[16:19]
    v_mfma_f32_16x16x32_bf16 v[20:23], a[208:211], v[112:115], 0
    v_mfma_f32_16x16x32_bf16 v[20:23], a[212:215], v[116:119], v[20:23]
    v_mfma_f32_16x16x32_bf16 v[20:23], a[216:219], v[120:123], v[20:23]
    v_mfma_f32_16x16x32_bf16 v[20:23], a[220:223], v[124:127], v[20:23]
    v_mfma_f32_16x16x32_bf16 v[24:27], a[192:195], v[128:131], 0
    v_mfma_f32_16x16x32_bf16 v[24:27], a[196:199], v[132:135], v[24:27]
    v_mfma_f32_16x16x32_bf16 v[24:27], a[200:203], v[136:139], v[24:27]
    v_mfma_f32_16x16x32_bf16 v[24:27], a[204:207], v[140:143], v[24:27]
    v_mfma_f32_16x16x32_bf16 v[28:31], a[208:211], v[128:131], 0
    v_mfma_f32_16x16x32_bf16 v[28:31], a[212:215], v[132:135], v[28:31]
    v_mfma_f32_16x16x32_bf16 v[28:31], a[216:219], v[136:139], v[28:31]
    v_mfma_f32_16x16x32_bf16 v[28:31], a[220:223], v[140:143], v[28:31]
    v_mfma_f32_16x16x32_bf16 v[32:35], a[192:195], v[144:147], 0
    v_mfma_f32_16x16x32_bf16 v[32:35], a[196:199], v[148:151], v[32:35]
    v_mfma_f32_16x16x32_bf16 v[32:35], a[200:203], v[152:155], v[32:35]
    v_mfma_f32_16x16x32_bf16 v[32:35], a[204:207], v[156:159], v[32:35]
    v_mfma_f32_16x16x32_bf16 v[36:39], a[208:211], v[144:147], 0
    v_mfma_f32_16x16x32_bf16 v[36:39], a[212:215], v[148:151], v[36:39]
    v_mfma_f32_16x16x32_bf16 v[36:39], a[216:219], v[152:155], v[36:39]
    v_mfma_f32_16x16x32_bf16 v[36:39], a[220:223], v[156:159], v[36:39]
    s_nop 15
    v_max3_f32 v242, v242, v0, v1
    v_max3_f32 v242, v242, v2, v3
    v_max3_f32 v242, v242, v4, v5
    v_max3_f32 v242, v242, v6, v7
    v_max3_f32 v243, v243, v8, v9
    v_max3_f32 v243, v243, v10, v11
    v_max3_f32 v243, v243, v12, v13
    v_max3_f32 v243, v243, v14, v15
    v_max3_f32 v244, v244, v16, v17
    v_max3_f32 v244, v244, v18, v19
    v_max3_f32 v244, v244, v20, v21
    v_max3_f32 v244, v244, v22, v23
    v_max3_f32 v245, v245, v24, v25
    v_max3_f32 v245, v245, v26, v27
    v_max3_f32 v245, v245, v28, v29
    v_max3_f32 v245, v245, v30, v31
    v_max3_f32 v246, v246, v32, v33
    v_max3_f32 v246, v246, v34, v35
    v_max3_f32 v246, v246, v36, v37
    v_max3_f32 v246, v246, v38, v39
    s_nop 7
    ds_read_b128 a[192:195], v208 offset:8192
    ds_read_b128 a[196:199], v209 offset:8192
    ds_read_b128 a[200:203], v210 offset:8192
    ds_read_b128 a[204:207], v211 offset:8192
    ds_read_b128 a[208:211], v208 offset:12288
    ds_read_b128 a[212:215], v209 offset:12288
    ds_read_b128 a[216:219], v210 offset:12288
    ds_read_b128 a[220:223], v211 offset:12288
    s_waitcnt lgkmcnt(0)
    v_mfma_f32_16x16x32_bf16 v[0:3], a[192:195], v[80:83], 0
    v_mfma_f32_16x16x32_bf16 v[0:3], a[196:199], v[84:87], v[0:3]
    v_mfma_f32_16x16x32_bf16 v[0:3], a[200:203], v[88:91], v[0:3]
    v_mfma_f32_16x16x32_bf16 v[0:3], a[204:207], v[92:95], v[0:3]
    v_mfma_f32_16x16x32_bf16 v[4:7], a[208:211], v[80:83], 0
    v_mfma_f32_16x16x32_bf16 v[4:7], a[212:215], v[84:87], v[4:7]
    v_mfma_f32_16x16x32_bf16 v[4:7], a[216:219], v[88:91], v[4:7]
    v_mfma_f32_16x16x32_bf16 v[4:7], a[220:223], v[92:95], v[4:7]
    v_mfma_f32_16x16x32_bf16 v[8:11], a[192:195], v[96:99], 0
    v_mfma_f32_16x16x32_bf16 v[8:11], a[196:199], v[100:103], v[8:11]
    v_mfma_f32_16x16x32_bf16 v[8:11], a[200:203], v[104:107], v[8:11]
    v_mfma_f32_16x16x32_bf16 v[8:11], a[204:207], v[108:111], v[8:11]
    v_mfma_f32_16x16x32_bf16 v[12:15], a[208:211], v[96:99], 0
    v_mfma_f32_16x16x32_bf16 v[12:15], a[212:215], v[100:103], v[12:15]
    v_mfma_f32_16x16x32_bf16 v[12:15], a[216:219], v[104:107], v[12:15]
    v_mfma_f32_16x16x32_bf16 v[12:15], a[220:223], v[108:111], v[12:15]
    v_mfma_f32_16x16x32_bf16 v[16:19], a[192:195], v[112:115], 0
    v_mfma_f32_16x16x32_bf16 v[16:19], a[196:199], v[116:119], v[16:19]
    v_mfma_f32_16x16x32_bf16 v[16:19], a[200:203], v[120:123], v[16:19]
    v_mfma_f32_16x16x32_bf16 v[16:19], a[204:207], v[124:127], v[16:19]
    v_mfma_f32_16x16x32_bf16 v[20:23], a[208:211], v[112:115], 0
    v_mfma_f32_16x16x32_bf16 v[20:23], a[212:215], v[116:119], v[20:23]
    v_mfma_f32_16x16x32_bf16 v[20:23], a[216:219], v[120:123], v[20:23]
    v_mfma_f32_16x16x32_bf16 v[20:23], a[220:223], v[124:127], v[20:23]
    v_mfma_f32_16x16x32_bf16 v[24:27], a[192:195], v[128:131], 0
    v_mfma_f32_16x16x32_bf16 v[24:27], a[196:199], v[132:135], v[24:27]
    v_mfma_f32_16x16x32_bf16 v[24:27], a[200:203], v[136:139], v[24:27]
    v_mfma_f32_16x16x32_bf16 v[24:27], a[204:207], v[140:143], v[24:27]
    v_mfma_f32_16x16x32_bf16 v[28:31], a[208:211], v[128:131], 0
    v_mfma_f32_16x16x32_bf16 v[28:31], a[212:215], v[132:135], v[28:31]
    v_mfma_f32_16x16x32_bf16 v[28:31], a[216:219], v[136:139], v[28:31]
    v_mfma_f32_16x16x32_bf16 v[28:31], a[220:223], v[140:143], v[28:31]
    v_mfma_f32_16x16x32_bf16 v[32:35], a[192:195], v[144:147], 0
    v_mfma_f32_16x16x32_bf16 v[32:35], a[196:199], v[148:151], v[32:35]
    v_mfma_f32_16x16x32_bf16 v[32:35], a[200:203], v[152:155], v[32:35]
    v_mfma_f32_16x16x32_bf16 v[32:35], a[204:207], v[156:159], v[32:35]
    v_mfma_f32_16x16x32_bf16 v[36:39], a[208:211], v[144:147], 0
    v_mfma_f32_16x16x32_bf16 v[36:39], a[212:215], v[148:151], v[36:39]
    v_mfma_f32_16x16x32_bf16 v[36:39], a[216:219], v[152:155], v[36:39]
    v_mfma_f32_16x16x32_bf16 v[36:39], a[220:223], v[156:159], v[36:39]
    s_nop 15
    v_max3_f32 v242, v242, v0, v1
    v_max3_f32 v242, v242, v2, v3
    v_max3_f32 v242, v242, v4, v5
    v_max3_f32 v242, v242, v6, v7
    v_max3_f32 v243, v243, v8, v9
    v_max3_f32 v243, v243, v10, v11
    v_max3_f32 v243, v243, v12, v13
    v_max3_f32 v243, v243, v14, v15
    v_max3_f32 v244, v244, v16, v17
    v_max3_f32 v244, v244, v18, v19
    v_max3_f32 v244, v244, v20, v21
    v_max3_f32 v244, v244, v22, v23
    v_max3_f32 v245, v245, v24, v25
    v_max3_f32 v245, v245, v26, v27
    v_max3_f32 v245, v245, v28, v29
    v_max3_f32 v245, v245, v30, v31
    v_max3_f32 v246, v246, v32, v33
    v_max3_f32 v246, v246, v34, v35
    v_max3_f32 v246, v246, v36, v37
    v_max3_f32 v246, v246, v38, v39
    s_nop 7
    s_barrier
    s_sub_u32 s62, s62, 1
    s_cmp_lg_u32 s62, 0
    s_cbranch_scc1 MP0_loop
    v_mov_b32 v240, v242
    s_nop 1
    v_permlane32_swap_b32 v242, v240
    v_max_f32 v242, v242, v240
    v_mov_b32 v240, v242
    s_nop 1
    v_permlane16_swap_b32 v242, v240
    v_max_f32 v242, v242, v240
    v_sub_f32 v40, 0, v242
    v_mov_b32 v60, 0
    v_sub_f32 v41, 0, v242
    v_mov_b32 v61, 0
    v_sub_f32 v42, 0, v242
    v_mov_b32 v62, 0
    v_sub_f32 v43, 0, v242
    v_mov_b32 v63, 0
    v_mov_b32 v240, v243
    s_nop 1
    v_permlane32_swap_b32 v243, v240
    v_max_f32 v243, v243, v240
    v_mov_b32 v240, v243
    s_nop 1
    v_permlane16_swap_b32 v243, v240
    v_max_f32 v243, v243, v240
    v_sub_f32 v44, 0, v243
    v_mov_b32 v64, 0
    v_sub_f32 v45, 0, v243
    v_mov_b32 v65, 0
    v_sub_f32 v46, 0, v243
    v_mov_b32 v66, 0
    v_sub_f32 v47, 0, v243
    v_mov_b32 v67, 0
    v_mov_b32 v240, v244
    s_nop 1
    v_permlane32_swap_b32 v244, v240
    v_max_f32 v244, v244, v240
    v_mov_b32 v240, v244
    s_nop 1
    v_permlane16_swap_b32 v244, v240
    v_max_f32 v244, v244, v240
    v_sub_f32 v48, 0, v244
    v_mov_b32 v68, 0
    v_sub_f32 v49, 0, v244
    v_mov_b32 v69, 0
    v_sub_f32 v50, 0, v244
    v_mov_b32 v70, 0
    v_sub_f32 v51, 0, v244
    v_mov_b32 v71, 0
    v_mov_b32 v240, v245
    s_nop 1
    v_permlane32_swap_b32 v245, v240
    v_max_f32 v245, v245, v240
    v_mov_b32 v240, v245
    s_nop 1
    v_permlane16_swap_b32 v245, v240
    v_max_f32 v245, v245, v240
    v_sub_f32 v52, 0, v245
    v_mov_b32 v72, 0
    v_sub_f32 v53, 0, v245
    v_mov_b32 v73, 0
    v_sub_f32 v54, 0, v245
    v_mov_b32 v74, 0
    v_sub_f32 v55, 0, v245
    v_mov_b32 v75, 0
    v_mov_b32 v240, v246
    s_nop 1
    v_permlane32_swap_b32 v246, v240
    v_max_f32 v246, v246, v240
    v_mov_b32 v240, v246
    s_nop 1
    v_permlane16_swap_b32 v246, v240
    v_max_f32 v246, v246, v240
    v_sub_f32 v56, 0, v246
    v_mov_b32 v76, 0
    v_sub_f32 v57, 0, v246
    v_mov_b32 v77, 0
    v_sub_f32 v58, 0, v246
    v_mov_b32 v78, 0
    v_sub_f32 v59, 0, v246
    v_mov_b32 v79, 0
    s_add_u32 s37, s3, 0
    s_mov_b32 s85, s37
    s_add_u32 m0, s3, 0
    s_xor_b32 s87, s85, s86
    s_add_u32 s85, s85, 4096
    buffer_load_dwordx4 v220, s[20:23], s87 offen nt lds
    s_add_u32 m0, s3, 4096
    s_xor_b32 s87, s85, s86
    s_add_u32 s85, s85, 4096
    buffer_load_dwordx4 v220, s[20:23], s87 offen nt lds
    s_waitcnt vmcnt(0)
    s_barrier
    ds_read_b128 a[192:195], v208 offset:0
    ds_read_b128 a[196:199], v209 offset:0
    ds_read_b128 a[200:203], v210 offset:0
    ds_read_b128 a[204:207], v211 offset:0
    ds_read_b128 a[208:211], v208 offset:4096
    ds_read_b128 a[212:215], v209 offset:4096
    ds_read_b128 a[216:219], v210 offset:4096
    ds_read_b128 a[220:223], v211 offset:4096
    s_waitcnt lgkmcnt(0)
    s_barrier
    s_add_u32 m0, s3, 0
    s_xor_b32 s87, s85, s86
    s_add_u32 s85, s85, 4096
    buffer_load_dwordx4 v220, s[20:23], s87 offen nt lds
    s_add_u32 m0, s3, 4096
    s_xor_b32 s87, s85, s86
    s_add_u32 s85, s85, 4096
    buffer_load_dwordx4 v220, s[20:23], s87 offen nt lds
    s_add_u32 m0, s3, 8192
    s_xor_b32 s87, s85, s86
    s_add_u32 s85, s85, 4096
    buffer_load_dwordx4 v220, s[20:23], s87 offen nt lds
    s_add_u32 m0, s3, 12288
    s_xor_b32 s87, s85, s86
    s_add_u32 s85, s85, 4096
    buffer_load_dwordx4 v220, s[20:23], s87 offen nt lds
    s_add_u32 m0, s3, 16384
    s_xor_b32 s87, s37, s86
    s_add_u32 s37, s37, 4096
    buffer_load_dwordx4 v224, s[24:27], s87 offen nt lds
    s_add_u32 m0, s3, 20480
    s_xor_b32 s87, s37, s86
    s_add_u32 s37, s37, 4096
    buffer_load_dwordx4 v224, s[24:27], s87 offen nt lds
    s_add_u32 m0, s3, 24576
    s_xor_b32 s87, s37, s86
    s_add_u32 s37, s37, 4096
    buffer_load_dwordx4 v224, s[24:27], s87 offen nt lds
    s_add_u32 m0, s3, 28672
    s_xor_b32 s87, s37, s86
    s_add_u32 s37, s37, 4096
    buffer_load_dwordx4 v224, s[24:27], s87 offen nt lds
    s_add_u32 m0, s3, 32768
    s_xor_b32 s87, s85, s86
    s_add_u32 s85, s85, 4096
    buffer_load_dwordx4 v220, s[20:23], s87 offen nt lds
    s_add_u32 m0, s3, 36864
    s_xor_b32 s87, s85, s86
    s_add_u32 s85, s85, 4096
    buffer_load_dwordx4 v220, s[20:23], s87 offen nt lds
    s_add_u32 m0, s3, 40960
    s_xor_b32 s87, s85, s86
    s_add_u32 s85, s85, 4096
    buffer_load_dwordx4 v220, s[20:23], s87 offen nt lds
    s_add_u32 m0, s3, 45056
    s_xor_b32 s87, s85, s86
    s_add_u32 s85, s85, 4096
    buffer_load_dwordx4 v220, s[20:23], s87 offen nt lds
    s_add_u32 m0, s3, 49152
    s_xor_b32 s87, s37, s86
    s_add_u32 s37, s37, 4096
    buffer_load_dwordx4 v224, s[24:27], s87 offen nt lds
    s_add_u32 m0, s3, 53248
    s_xor_b32 s87, s37, s86
    s_add_u32 s37, s37, 4096
    buffer_load_dwordx4 v224, s[24:27], s87 offen nt lds
    s_add_u32 m0, s3, 57344
    s_xor_b32 s87, s37, s86
    s_add_u32 s37, s37, 4096
    buffer_load_dwordx4 v224, s[24:27], s87 offen nt lds
    s_add_u32 m0, s3, 61440
    s_xor_b32 s87, s37, s86
    s_add_u32 s37, s37, 4096
    buffer_load_dwordx4 v224, s[24:27], s87 offen nt lds
    s_mov_b32 s74, 0x18000
    s_mov_b32 s44, s45
    v_accvgpr_write_b32 a0, 0
    v_accvgpr_write_b32 a1, 0
    v_accvgpr_write_b32 a2, 0
    v_accvgpr_write_b32 a3, 0
    v_accvgpr_write_b32 a4, 0
    v_accvgpr_write_b32 a5, 0
    v_accvgpr_write_b32 a6, 0
    v_accvgpr_write_b32 a7, 0
    v_accvgpr_write_b32 a8, 0
    v_accvgpr_write_b32 a9, 0
    v_accvgpr_write_b32 a10, 0
    v_accvgpr_write_b32 a11, 0
    v_accvgpr_write_b32 a12, 0
    v_accvgpr_write_b32 a13, 0
    v_accvgpr_write_b32 a14, 0
    v_accvgpr_write_b32 a15, 0
    v_accvgpr_write_b32 a16, 0
    v_accvgpr_write_b32 a17, 0
    v_accvgpr_write_b32 a18, 0
    v_accvgpr_write_b32 a19, 0
    v_accvgpr_write_b32 a20, 0
    v_accvgpr_write_b32 a21, 0
    v_accvgpr_write_b32 a22, 0
    v_accvgpr_write_b32 a23, 0
    v_accvgpr_write_b32 a24, 0
    v_accvgpr_write_b32 a25, 0
    v_accvgpr_write_b32 a26, 0
    v_accvgpr_write_b32 a27, 0
    v_accvgpr_write_b32 a28, 0
    v_accvgpr_write_b32 a29, 0
    v_accvgpr_write_b32 a30, 0
    v_accvgpr_write_b32 a31, 0
    v_accvgpr_write_b32 a32, 0
    v_accvgpr_write_b32 a33, 0
    v_accvgpr_write_b32 a34, 0
    v_accvgpr_write_b32 a35, 0
    v_accvgpr_write_b32 a36, 0
    v_accvgpr_write_b32 a37, 0
    v_accvgpr_write_b32 a38, 0
    v_accvgpr_write_b32 a39, 0
    v_accvgpr_write_b32 a40, 0
    v_accvgpr_write_b32 a41, 0
    v_accvgpr_write_b32 a42, 0
    v_accvgpr_write_b32 a43, 0
    v_accvgpr_write_b32 a44, 0
    v_accvgpr_write_b32 a45, 0
    v_accvgpr_write_b32 a46, 0
    v_accvgpr_write_b32 a47, 0
    v_accvgpr_write_b32 a48, 0
    v_accvgpr_write_b32 a49, 0
    v_accvgpr_write_b32 a50, 0
    v_accvgpr_write_b32 a51, 0
    v_accvgpr_write_b32 a52, 0
    v_accvgpr_write_b32 a53, 0
    v_accvgpr_write_b32 a54, 0
    v_accvgpr_write_b32 a55, 0
    v_accvgpr_write_b32 a56, 0
    v_accvgpr_write_b32 a57, 0
    v_accvgpr_write_b32 a58, 0
    v_accvgpr_write_b32 a59, 0
    v_accvgpr_write_b32 a60, 0
    v_accvgpr_write_b32 a61, 0
    v_accvgpr_write_b32 a62, 0
    v_accvgpr_write_b32 a63, 0
    v_accvgpr_write_b32 a64, 0
    v_accvgpr_write_b32 a65, 0
    v_accvgpr_write_b32 a66, 0
    v_accvgpr_write_b32 a67, 0
    v_accvgpr_write_b32 a68, 0
    v_accvgpr_write_b32 a69, 0
    v_accvgpr_write_b32 a70, 0
    v_accvgpr_write_b32 a71, 0
    v_accvgpr_write_b32 a72, 0
    v_accvgpr_write_b32 a73, 0
    v_accvgpr_write_b32 a74, 0
    v_accvgpr_write_b32 a75, 0
    v_accvgpr_write_b32 a76, 0
    v_accvgpr_write_b32 a77, 0
    v_accvgpr_write_b32 a78, 0
    v_accvgpr_write_b32 a79, 0
    v_accvgpr_write_b32 a80, 0
    v_accvgpr_write_b32 a81, 0
    v_accvgpr_write_b32 a82, 0
    v_accvgpr_write_b32 a83, 0
    v_accvgpr_write_b32 a84, 0
    v_accvgpr_write_b32 a85, 0
    v_accvgpr_write_b32 a86, 0
    v_accvgpr_write_b32 a87, 0
    v_accvgpr_write_b32 a88, 0
    v_accvgpr_write_b32 a89, 0
    v_accvgpr_write_b32 a90, 0
    v_accvgpr_write_b32 a91, 0
    v_accvgpr_write_b32 a92, 0
    v_accvgpr_write_b32 a93, 0
    v_accvgpr_write_b32 a94, 0
    v_accvgpr_write_b32 a95, 0
    v_accvgpr_write_b32 a96, 0
    v_accvgpr_write_b32 a97, 0
    v_accvgpr_write_b32 a98, 0
    v_accvgpr_write_b32 a99, 0
    v_accvgpr_write_b32 a100, 0
    v_accvgpr_write_b32 a101, 0
    v_accvgpr_write_b32 a102, 0
    v_accvgpr_write_b32 a103, 0
    v_accvgpr_write_b32 a104, 0
    v_accvgpr_write_b32 a105, 0
    v_accvgpr_write_b32 a106, 0
    v_accvgpr_write_b32 a107, 0
    v_accvgpr_write_b32 a108, 0
    v_accvgpr_write_b32 a109, 0
    v_accvgpr_write_b32 a110, 0
    v_accvgpr_write_b32 a111, 0
    v_accvgpr_write_b32 a112, 0
    v_accvgpr_write_b32 a113, 0
    v_accvgpr_write_b32 a114, 0
    v_accvgpr_write_b32 a115, 0
    v_accvgpr_write_b32 a116, 0
    v_accvgpr_write_b32 a117, 0
    v_accvgpr_write_b32 a118, 0
    v_accvgpr_write_b32 a119, 0
    v_accvgpr_write_b32 a120, 0
    v_accvgpr_write_b32 a121, 0
    v_accvgpr_write_b32 a122, 0
    v_accvgpr_write_b32 a123, 0
    v_accvgpr_write_b32 a124, 0
    v_accvgpr_write_b32 a125, 0
    v_accvgpr_write_b32 a126, 0
    v_accvgpr_write_b32 a127, 0
    v_accvgpr_write_b32 a128, 0
    v_accvgpr_write_b32 a129, 0
    v_accvgpr_write_b32 a130, 0
    v_accvgpr_write_b32 a131, 0
    v_accvgpr_write_b32 a132, 0
    v_accvgpr_write_b32 a133, 0
    v_accvgpr_write_b32 a134, 0
    v_accvgpr_write_b32 a135, 0
    v_accvgpr_write_b32 a136, 0
    v_accvgpr_write_b32 a137, 0
    v_accvgpr_write_b32 a138, 0
    v_accvgpr_write_b32 a139, 0
    v_accvgpr_write_b32 a140, 0
    v_accvgpr_write_b32 a141, 0
    v_accvgpr_write_b32 a142, 0
    v_accvgpr_write_b32 a143, 0
    v_accvgpr_write_b32 a144, 0
    v_accvgpr_write_b32 a145, 0
    v_accvgpr_write_b32 a146, 0
    v_accvgpr_write_b32 a147, 0
    v_accvgpr_write_b32 a148, 0
    v_accvgpr_write_b32 a149, 0
    v_accvgpr_write_b32 a150, 0
    v_accvgpr_write_b32 a151, 0
    v_accvgpr_write_b32 a152, 0
    v_accvgpr_write_b32 a153, 0
    v_accvgpr_write_b32 a154, 0
    v_accvgpr_write_b32 a155, 0
    v_accvgpr_write_b32 a156, 0
    v_accvgpr_write_b32 a157, 0
    v_accvgpr_write_b32 a158, 0
    v_accvgpr_write_b32 a159, 0
    v_accvgpr_write_b32 a224, 0
    v_accvgpr_write_b32 a225, 0
    v_accvgpr_write_b32 a226, 0
    v_accvgpr_write_b32 a227, 0
    v_accvgpr_write_b32 a228, 0
    v_accvgpr_write_b32 a229, 0
    v_accvgpr_write_b32 a230, 0
    v_accvgpr_write_b32 a231, 0
    v_accvgpr_write_b32 a232, 0
    v_accvgpr_write_b32 a233, 0
    v_accvgpr_write_b32 a234, 0
    v_accvgpr_write_b32 a235, 0
    v_accvgpr_write_b32 a236, 0
    v_accvgpr_write_b32 a237, 0
    v_accvgpr_write_b32 a238, 0
    v_accvgpr_write_b32 a239, 0
    v_accvgpr_write_b32 a240, 0
    v_accvgpr_write_b32 a241, 0
    v_accvgpr_write_b32 a242, 0
    v_accvgpr_write_b32 a243, 0
    v_accvgpr_write_b32 a244, 0
    v_accvgpr_write_b32 a245, 0
    v_accvgpr_write_b32 a246, 0
    v_accvgpr_write_b32 a247, 0
    v_accvgpr_write_b32 a248, 0
    v_accvgpr_write_b32 a249, 0
    v_accvgpr_write_b32 a250, 0
    v_accvgpr_write_b32 a251, 0
    v_accvgpr_write_b32 a252, 0
    v_accvgpr_write_b32 a253, 0
    v_accvgpr_write_b32 a254, 0
    v_accvgpr_write_b32 a255, 0
    s_waitcnt vmcnt(0)
    s_bitcmp1_b32 s36, 0
    s_cbranch_scc1 A1h0_enter
    s_branch A0h0_enter
MP1:
    s_waitcnt vmcnt(0) lgkmcnt(0)
    s_barrier
    s_add_u32 s60, s74, s44
    v_subrev_u32 v208, s60, v208
    v_subrev_u32 v209, s60, v209
    v_subrev_u32 v210, s60, v210
    v_subrev_u32 v211, s60, v211
    v_subrev_u32 v212, s60, v212
    v_subrev_u32 v213, s60, v213
    v_subrev_u32 v214, s60, v214
    v_subrev_u32 v215, s60, v215
    v_subrev_u32 v216, s60, v216
    v_subrev_u32 v217, s60, v217
    v_subrev_u32 v218, s60, v218
    v_subrev_u32 v219, s60, v219
    v_mov_b32 v242, 0xff800000
    v_mov_b32 v243, 0xff800000
    v_mov_b32 v244, 0xff800000
    v_mov_b32 v245, 0xff800000
    v_mov_b32 v246, 0xff800000
    s_add_u32 s85, s3, 262144
    s_mov_b32 s62, 16
MP1_loop:
    s_add_u32 m0, s3, 0
    s_xor_b32 s87, s85, s86
    s_add_u32 s85, s85, 4096
    buffer_load_dwordx4 v220, s[20:23], s87 offen nt lds
    s_add_u32 m0, s3, 4096
    s_xor_b32 s87, s85, s86
    s_add_u32 s85, s85, 4096
    buffer_load_dwordx4 v220, s[20:23], s87 offen nt lds
    s_add_u32 m0, s3, 8192
    s_xor_b32 s87, s85, s86
    s_add_u32 s85, s85, 4096
    buffer_load_dwordx4 v220, s[20:23], s87 offen nt lds
    s_add_u32 m0, s3, 12288
    s_xor_b32 s87, s85, s86
    s_add_u32 s85, s85, 4096
    buffer_load_dwordx4 v220, s[20:23], s87 offen nt lds
    s_waitcnt vmcnt(0)
    s_barrier
    ds_read_b128 a[192:195], v208 offset:0
    ds_read_b128 a[196:199], v209 offset:0
    ds_read_b128 a[200:203], v210 offset:0
    ds_read_b128 a[204:207], v211 offset:0
    ds_read_b128 a[208:211], v208 offset:4096
    ds_read_b128 a[212:215], v209 offset:4096
    ds_read_b128 a[216:219], v210 offset:4096
    ds_read_b128 a[220:223], v211 offset:4096
    s_waitcnt lgkmcnt(0)
    v_mfma_f32_16x16x32_bf16 v[0:3], a[192:195], v[160:163], 0
    v_mfma_f32_16x16x32_bf16 v[0:3], a[196:199], v[164:167], v[0:3]
    v_mfma_f32_16x16x32_bf16 v[0:3], a[200:203], v[168:171], v[0:3]
    v_mfma_f32_16x16x32_bf16 v[0:3], a[204:207], v[172:175], v[0:3]
    v_mfma_f32_16x16x32_bf16 v[4:7], a[208:211], v[160:163], 0
    v_mfma_f32_16x16x32_bf16 v[4:7], a[212:215], v[164:167], v[4:7]
    v_mfma_f32_16x16x32_bf16 v[4:7], a[216:219], v[168:171], v[4:7]
    v_mfma_f32_16x16x32_bf16 v[4:7], a[220:223], v[172:175], v[4:7]
    v_mfma_f32_16x16x32_bf16 v[8:11], a[192:195], v[176:179], 0
    v_mfma_f32_16x16x32_bf16 v[8:11], a[196:199], v[180:183], v[8:11]
    v_mfma_f32_16x16x32_bf16 v[8:11], a[200:203], v[184:187], v[8:11]
    v_mfma_f32_16x16x32_bf16 v[8:11], a[204:207], v[188:191], v[8:11]
    v_mfma_f32_16x16x32_bf16 v[12:15], a[208:211], v[176:179], 0
    v_mfma_f32_16x16x32_bf16 v[12:15], a[212:215], v[180:183], v[12:15]
    v_mfma_f32_16x16x32_bf16 v[12:15], a[216:219], v[184:187], v[12:15]
    v_mfma_f32_16x16x32_bf16 v[12:15], a[220:223], v[188:191], v[12:15]
    v_mfma_f32_16x16x32_bf16 v[16:19], a[192:195], v[192:195], 0
    v_mfma_f32_16x16x32_bf16 v[16:19], a[196:199], v[196:199], v[16:19]
    v_mfma_f32_16x16x32_bf16 v[16:19], a[200:203], v[200:203], v[16:19]
    v_mfma_f32_16x16x32_bf16 v[16:19], a[204:207], v[204:207], v[16:19]
    v_mfma_f32_16x16x32_bf16 v[20:23], a[208:211], v[192:195], 0
    v_mfma_f32_16x16x32_bf16 v[20:23], a[212:215], v[196:199], v[20:23]
    v_mfma_f32_16x16x32_bf16 v[20:23], a[216:219], v[200:203], v[20:23]
    v_mfma_f32_16x16x32_bf16 v[20:23], a[220:223], v[204:207], v[20:23]
    v_mfma_f32_16x16x32_bf16 v[24:27], a[192:195], a[160:163], 0
    v_mfma_f32_16x16x32_bf16 v[24:27], a[196:199], a[164:167], v[24:27]
    v_mfma_f32_16x16x32_bf16 v[24:27], a[200:203], a[168:171], v[24:27]
    v_mfma_f32_16x16x32_bf16 v[24:27], a[204:207], a[172:175], v[24:27]
    v_mfma_f32_16x16x32_bf16 v[28:31], a[208:211], a[160:163], 0
    v_mfma_f32_16x16x32_bf16 v[28:31], a[212:215], a[164:167], v[28:31]
    v_mfma_f32_16x16x32_bf16 v[28:31], a[216:219], a[168:171], v[28:31]
    v_mfma_f32_16x16x32_bf16 v[28:31], a[220:223], a[172:175], v[28:31]
    v_mfma_f32_16x16x32_bf16 v[32:35], a[192:195], a[176:179], 0
    v_mfma_f32_16x16x32_bf16 v[32:35], a[196:199], a[180:183], v[32:35]
    v_mfma_f32_16x16x32_bf16 v[32:35], a[200:203], a[184:187], v[32:35]
    v_mfma_f32_16x16x32_bf16 v[32:35], a[204:207], a[188:191], v[32:35]
    v_mfma_f32_16x16x32_bf16 v[36:39], a[208:211], a[176:179], 0
    v_mfma_f32_16x16x32_bf16 v[36:39], a[212:215], a[180:183], v[36:39]
    v_mfma_f32_16x16x32_bf16 v[36:39], a[216:219], a[184:187], v[36:39]
    v_mfma_f32_16x16x32_bf16 v[36:39], a[220:223], a[188:191], v[36:39]
    s_nop 15
    v_max3_f32 v242, v242, v0, v1
    v_max3_f32 v242, v242, v2, v3
    v_max3_f32 v242, v242, v4, v5
    v_max3_f32 v242, v242, v6, v7
    v_max3_f32 v243, v243, v8, v9
    v_max3_f32 v243, v243, v10, v11
    v_max3_f32 v243, v243, v12, v13
    v_max3_f32 v243, v243, v14, v15
    v_max3_f32 v244, v244, v16, v17
    v_max3_f32 v244, v244, v18, v19
    v_max3_f32 v244, v244, v20, v21
    v_max3_f32 v244, v244, v22, v23
    v_max3_f32 v245, v245, v24, v25
    v_max3_f32 v245, v245, v26, v27
    v_max3_f32 v245, v245, v28, v29
    v_max3_f32 v245, v245, v30, v31
    v_max3_f32 v246, v246, v32, v33
    v_max3_f32 v246, v246, v34, v35
    v_max3_f32 v246, v246, v36, v37
    v_max3_f32 v246, v246, v38, v39
    s_nop 7
    ds_read_b128 a[192:195], v208 offset:8192
    ds_read_b128 a[196:199], v209 offset:8192
    ds_read_b128 a[200:203], v210 offset:8192
    ds_read_b128 a[204:207], v211 offset:8192
    ds_read_b128 a[208:211], v208 offset:12288
    ds_read_b128 a[212:215], v209 offset:12288
    ds_read_b128 a[216:219], v210 offset:12288
    ds_read_b128 a[220:223], v211 offset:12288
    s_waitcnt lgkmcnt(0)
    v_mfma_f32_16x16x32_bf16 v[0:3], a[192:195], v[160:163], 0
    v_mfma_f32_16x16x32_bf16 v[0:3], a[196:199], v[164:167], v[0:3]
    v_mfma_f32_16x16x32_bf16 v[0:3], a[200:203], v[168:171], v[0:3]
    v_mfma_f32_16x16x32_bf16 v[0:3], a[204:207], v[172:175], v[0:3]
    v_mfma_f32_16x16x32_bf16 v[4:7], a[208:211], v[160:163], 0
    v_mfma_f32_16x16x32_bf16 v[4:7], a[212:215], v[164:167], v[4:7]
    v_mfma_f32_16x16x32_bf16 v[4:7], a[216:219], v[168:171], v[4:7]
    v_mfma_f32_16x16x32_bf16 v[4:7], a[220:223], v[172:175], v[4:7]
    v_mfma_f32_16x16x32_bf16 v[8:11], a[192:195], v[176:179], 0
    v_mfma_f32_16x16x32_bf16 v[8:11], a[196:199], v[180:183], v[8:11]
    v_mfma_f32_16x16x32_bf16 v[8:11], a[200:203], v[184:187], v[8:11]
    v_mfma_f32_16x16x32_bf16 v[8:11], a[204:207], v[188:191], v[8:11]
    v_mfma_f32_16x16x32_bf16 v[12:15], a[208:211], v[176:179], 0
    v_mfma_f32_16x16x32_bf16 v[12:15], a[212:215], v[180:183], v[12:15]
    v_mfma_f32_16x16x32_bf16 v[12:15], a[216:219], v[184:187], v[12:15]
    v_mfma_f32_16x16x32_bf16 v[12:15], a[220:223], v[188:191], v[12:15]
    v_mfma_f32_16x16x32_bf16 v[16:19], a[192:195], v[192:195], 0
    v_mfma_f32_16x16x32_bf16 v[16:19], a[196:199], v[196:199], v[16:19]
    v_mfma_f32_16x16x32_bf16 v[16:19], a[200:203], v[200:203], v[16:19]
    v_mfma_f32_16x16x32_bf16 v[16:19], a[204:207], v[204:207], v[16:19]
    v_mfma_f32_16x16x32_bf16 v[20:23], a[208:211], v[192:195], 0
    v_mfma_f32_16x16x32_bf16 v[20:23], a[212:215], v[196:199], v[20:23]
    v_mfma_f32_16x16x32_bf16 v[20:23], a[216:219], v[200:203], v[20:23]
    v_mfma_f32_16x16x32_bf16 v[20:23], a[220:223], v[204:207], v[20:23]
    v_mfma_f32_16x16x32_bf16 v[24:27], a[192:195], a[160:163], 0
    v_mfma_f32_16x16x32_bf16 v[24:27], a[196:199], a[164:167], v[24:27]
    v_mfma_f32_16x16x32_bf16 v[24:27], a[200:203], a[168:171], v[24:27]
    v_mfma_f32_16x16x32_bf16 v[24:27], a[204:207], a[172:175], v[24:27]
    v_mfma_f32_16x16x32_bf16 v[28:31], a[208:211], a[160:163], 0
    v_mfma_f32_16x16x32_bf16 v[28:31], a[212:215], a[164:167], v[28:31]
    v_mfma_f32_16x16x32_bf16 v[28:31], a[216:219], a[168:171], v[28:31]
    v_mfma_f32_16x16x32_bf16 v[28:31], a[220:223], a[172:175], v[28:31]
    v_mfma_f32_16x16x32_bf16 v[32:35], a[192:195], a[176:179], 0
    v_mfma_f32_16x16x32_bf16 v[32:35], a[196:199], a[180:183], v[32:35]
    v_mfma_f32_16x16x32_bf16 v[32:35], a[200:203], a[184:187], v[32:35]
    v_mfma_f32_16x16x32_bf16 v[32:35], a[204:207], a[188:191], v[32:35]
    v_mfma_f32_16x16x32_bf16 v[36:39], a[208:211], a[176:179], 0
    v_mfma_f32_16x16x32_bf16 v[36:39], a[212:215], a[180:183], v[36:39]
    v_mfma_f32_16x16x32_bf16 v[36:39], a[216:219], a[184:187], v[36:39]
    v_mfma_f32_16x16x32_bf16 v[36:39], a[220:223], a[188:191], v[36:39]
    s_nop 15
    v_max3_f32 v242, v242, v0, v1
    v_max3_f32 v242, v242, v2, v3
    v_max3_f32 v242, v242, v4, v5
    v_max3_f32 v242, v242, v6, v7
    v_max3_f32 v243, v243, v8, v9
    v_max3_f32 v243, v243, v10, v11
    v_max3_f32 v243, v243, v12, v13
    v_max3_f32 v243, v243, v14, v15
    v_max3_f32 v244, v244, v16, v17
    v_max3_f32 v244, v244, v18, v19
    v_max3_f32 v244, v244, v20, v21
    v_max3_f32 v244, v244, v22, v23
    v_max3_f32 v245, v245, v24, v25
    v_max3_f32 v245, v245, v26, v27
    v_max3_f32 v245, v245, v28, v29
    v_max3_f32 v245, v245, v30, v31
    v_max3_f32 v246, v246, v32, v33
    v_max3_f32 v246, v246, v34, v35
    v_max3_f32 v246, v246, v36, v37
    v_max3_f32 v246, v246, v38, v39
    s_nop 7
    s_barrier
    s_sub_u32 s62, s62, 1
    s_cmp_lg_u32 s62, 0
    s_cbranch_scc1 MP1_loop
    v_mov_b32 v240, v242
    s_nop 1
    v_permlane32_swap_b32 v242, v240
    v_max_f32 v242, v242, v240
    v_mov_b32 v240, v242
    s_nop 1
    v_permlane16_swap_b32 v242, v240
    v_max_f32 v242, v242, v240
    v_sub_f32 v40, 0, v242
    v_mov_b32 v60, 0
    v_sub_f32 v41, 0, v242
    v_mov_b32 v61, 0
    v_sub_f32 v42, 0, v242
    v_mov_b32 v62, 0
    v_sub_f32 v43, 0, v242
    v_mov_b32 v63, 0
    v_mov_b32 v240, v243
    s_nop 1
    v_permlane32_swap_b32 v243, v240
    v_max_f32 v243, v243, v240
    v_mov_b32 v240, v243
    s_nop 1
    v_permlane16_swap_b32 v243, v240
    v_max_f32 v243, v243, v240
    v_sub_f32 v44, 0, v243
    v_mov_b32 v64, 0
    v_sub_f32 v45, 0, v243
    v_mov_b32 v65, 0
    v_sub_f32 v46, 0, v243
    v_mov_b32 v66, 0
    v_sub_f32 v47, 0, v243
    v_mov_b32 v67, 0
    v_mov_b32 v240, v244
    s_nop 1
    v_permlane32_swap_b32 v244, v240
    v_max_f32 v244, v244, v240
    v_mov_b32 v240, v244
    s_nop 1
    v_permlane16_swap_b32 v244, v240
    v_max_f32 v244, v244, v240
    v_sub_f32 v48, 0, v244
    v_mov_b32 v68, 0
    v_sub_f32 v49, 0, v244
    v_mov_b32 v69, 0
    v_sub_f32 v50, 0, v244
    v_mov_b32 v70, 0
    v_sub_f32 v51, 0, v244
    v_mov_b32 v71, 0
    v_mov_b32 v240, v245
    s_nop 1
    v_permlane32_swap_b32 v245, v240
    v_max_f32 v245, v245, v240
    v_mov_b32 v240, v245
    s_nop 1
    v_permlane16_swap_b32 v245, v240
    v_max_f32 v245, v245, v240
    v_sub_f32 v52, 0, v245
    v_mov_b32 v72, 0
    v_sub_f32 v53, 0, v245
    v_mov_b32 v73, 0
    v_sub_f32 v54, 0, v245
    v_mov_b32 v74, 0
    v_sub_f32 v55, 0, v245
    v_mov_b32 v75, 0
    v_mov_b32 v240, v246
    s_nop 1
    v_permlane32_swap_b32 v246, v240
    v_max_f32 v246, v246, v240
    v_mov_b32 v240, v246
    s_nop 1
    v_permlane16_swap_b32 v246, v240
    v_max_f32 v246, v246, v240
    v_sub_f32 v56, 0, v246
    v_mov_b32 v76, 0
    v_sub_f32 v57, 0, v246
    v_mov_b32 v77, 0
    v_sub_f32 v58, 0, v246
    v_mov_b32 v78, 0
    v_sub_f32 v59, 0, v246
    v_mov_b32 v79, 0
    s_add_u32 s37, s3, 262144
    s_mov_b32 s85, s37
    s_add_u32 m0, s3, 0
    s_xor_b32 s87, s85, s86
    s_add_u32 s85, s85, 4096
    buffer_load_dwordx4 v220, s[20:23], s87 offen nt lds
    s_add_u32 m0, s3, 4096
    s_xor_b32 s87, s85, s86
    s_add_u32 s85, s85, 4096
    buffer_load_dwordx4 v220, s[20:23], s87 offen nt lds
    s_waitcnt vmcnt(0)
    s_barrier
    ds_read_b128 a[192:195], v208 offset:0
    ds_read_b128 a[196:199], v209 offset:0
    ds_read_b128 a[200:203], v210 offset:0
    ds_read_b128 a[204:207], v211 offset:0
    ds_read_b128 a[208:211], v208 offset:4096
    ds_read_b128 a[212:215], v209 offset:4096
    ds_read_b128 a[216:219], v210 offset:4096
    ds_read_b128 a[220:223], v211 offset:4096
    s_waitcnt lgkmcnt(0)
    s_barrier
    s_add_u32 m0, s3, 0
    s_xor_b32 s87, s85, s86
    s_add_u32 s85, s85, 4096
    buffer_load_dwordx4 v220, s[20:23], s87 offen nt lds
    s_add_u32 m0, s3, 4096
    s_xor_b32 s87, s85, s86
    s_add_u32 s85, s85, 4096
    buffer_load_dwordx4 v220, s[20:23], s87 offen nt lds
    s_add_u32 m0, s3, 8192
    s_xor_b32 s87, s85, s86
    s_add_u32 s85, s85, 4096
    buffer_load_dwordx4 v220, s[20:23], s87 offen nt lds
    s_add_u32 m0, s3, 12288
    s_xor_b32 s87, s85, s86
    s_add_u32 s85, s85, 4096
    buffer_load_dwordx4 v220, s[20:23], s87 offen nt lds
    s_add_u32 m0, s3, 16384
    s_xor_b32 s87, s37, s86
    s_add_u32 s37, s37, 4096
    buffer_load_dwordx4 v224, s[24:27], s87 offen nt lds
    s_add_u32 m0, s3, 20480
    s_xor_b32 s87, s37, s86
    s_add_u32 s37, s37, 4096
    buffer_load_dwordx4 v224, s[24:27], s87 offen nt lds
    s_add_u32 m0, s3, 24576
    s_xor_b32 s87, s37, s86
    s_add_u32 s37, s37, 4096
    buffer_load_dwordx4 v224, s[24:27], s87 offen nt lds
    s_add_u32 m0, s3, 28672
    s_xor_b32 s87, s37, s86
    s_add_u32 s37, s37, 4096
    buffer_load_dwordx4 v224, s[24:27], s87 offen nt lds
    s_add_u32 m0, s3, 32768
    s_xor_b32 s87, s85, s86
    s_add_u32 s85, s85, 4096
    buffer_load_dwordx4 v220, s[20:23], s87 offen nt lds
    s_add_u32 m0, s3, 36864
    s_xor_b32 s87, s85, s86
    s_add_u32 s85, s85, 4096
    buffer_load_dwordx4 v220, s[20:23], s87 offen nt lds
    s_add_u32 m0, s3, 40960
    s_xor_b32 s87, s85, s86
    s_add_u32 s85, s85, 4096
    buffer_load_dwordx4 v220, s[20:23], s87 offen nt lds
    s_add_u32 m0, s3, 45056
    s_xor_b32 s87, s85, s86
    s_add_u32 s85, s85, 4096
    buffer_load_dwordx4 v220, s[20:23], s87 offen nt lds
    s_add_u32 m0, s3, 49152
    s_xor_b32 s87, s37, s86
    s_add_u32 s37, s37, 4096
    buffer_load_dwordx4 v224, s[24:27], s87 offen nt lds
    s_add_u32 m0, s3, 53248
    s_xor_b32 s87, s37, s86
    s_add_u32 s37, s37, 4096
    buffer_load_dwordx4 v224, s[24:27], s87 offen nt lds
    s_add_u32 m0, s3, 57344
    s_xor_b32 s87, s37, s86
    s_add_u32 s37, s37, 4096
    buffer_load_dwordx4 v224, s[24:27], s87 offen nt lds
    s_add_u32 m0, s3, 61440
    s_xor_b32 s87, s37, s86
    s_add_u32 s37, s37, 4096
    buffer_load_dwordx4 v224, s[24:27], s87 offen nt lds
    s_add_u32 m0, s3, 65536
    s_xor_b32 s87, s85, s86
    s_add_u32 s85, s85, 4096
    buffer_load_dwordx4 v220, s[20:23], s87 offen nt lds
    s_add_u32 m0, s3, 69632
    s_xor_b32 s87, s85, s86
    s_add_u32 s85, s85, 4096
    buffer_load_dwordx4 v220, s[20:23], s87 offen nt lds
    s_add_u32 m0, s3, 73728
    s_xor_b32 s87, s85, s86
    s_add_u32 s85, s85, 4096
    buffer_load_dwordx4 v220, s[20:23], s87 offen nt lds
    s_add_u32 m0, s3, 77824
    s_xor_b32 s87, s85, s86
    s_add_u32 s85, s85, 4096
    buffer_load_dwordx4 v220, s[20:23], s87 offen nt lds
    s_add_u32 m0, s3, 81920
    s_xor_b32 s87, s37, s86
    s_add_u32 s37, s37, 4096
    buffer_load_dwordx4 v224, s[24:27], s87 offen nt lds
    s_add_u32 m0, s3, 86016
    s_xor_b32 s87, s37, s86
    s_add_u32 s37, s37, 4096
    buffer_load_dwordx4 v224, s[24:27], s87 offen nt lds
    s_add_u32 m0, s3, 90112
    s_xor_b32 s87, s37, s86
    s_add_u32 s37, s37, 4096
    buffer_load_dwordx4 v224, s[24:27], s87 offen nt lds
    s_add_u32 m0, s3, 94208
    s_xor_b32 s87, s37, s86
    s_add_u32 s37, s37, 4096
    buffer_load_dwordx4 v224, s[24:27], s87 offen nt lds
    s_mov_b32 s74, 0x18000
    s_mov_b32 s44, s45
    v_accvgpr_write_b32 a0, 0
    v_accvgpr_write_b32 a1, 0
    v_accvgpr_write_b32 a2, 0
    v_accvgpr_write_b32 a3, 0
    v_accvgpr_write_b32 a4, 0
    v_accvgpr_write_b32 a5, 0
    v_accvgpr_write_b32 a6, 0
    v_accvgpr_write_b32 a7, 0
    v_accvgpr_write_b32 a8, 0
    v_accvgpr_write_b32 a9, 0
    v_accvgpr_write_b32 a10, 0
    v_accvgpr_write_b32 a11, 0
    v_accvgpr_write_b32 a12, 0
    v_accvgpr_write_b32 a13, 0
    v_accvgpr_write_b32 a14, 0
    v_accvgpr_write_b32 a15, 0
    v_accvgpr_write_b32 a16, 0
    v_accvgpr_write_b32 a17, 0
    v_accvgpr_write_b32 a18, 0
    v_accvgpr_write_b32 a19, 0
    v_accvgpr_write_b32 a20, 0
    v_accvgpr_write_b32 a21, 0
    v_accvgpr_write_b32 a22, 0
    v_accvgpr_write_b32 a23, 0
    v_accvgpr_write_b32 a24, 0
    v_accvgpr_write_b32 a25, 0
    v_accvgpr_write_b32 a26, 0
    v_accvgpr_write_b32 a27, 0
    v_accvgpr_write_b32 a28, 0
    v_accvgpr_write_b32 a29, 0
    v_accvgpr_write_b32 a30, 0
    v_accvgpr_write_b32 a31, 0
    v_accvgpr_write_b32 a32, 0
    v_accvgpr_write_b32 a33, 0
    v_accvgpr_write_b32 a34, 0
    v_accvgpr_write_b32 a35, 0
    v_accvgpr_write_b32 a36, 0
    v_accvgpr_write_b32 a37, 0
    v_accvgpr_write_b32 a38, 0
    v_accvgpr_write_b32 a39, 0
    v_accvgpr_write_b32 a40, 0
    v_accvgpr_write_b32 a41, 0
    v_accvgpr_write_b32 a42, 0
    v_accvgpr_write_b32 a43, 0
    v_accvgpr_write_b32 a44, 0
    v_accvgpr_write_b32 a45, 0
    v_accvgpr_write_b32 a46, 0
    v_accvgpr_write_b32 a47, 0
    v_accvgpr_write_b32 a48, 0
    v_accvgpr_write_b32 a49, 0
    v_accvgpr_write_b32 a50, 0
    v_accvgpr_write_b32 a51, 0
    v_accvgpr_write_b32 a52, 0
    v_accvgpr_write_b32 a53, 0
    v_accvgpr_write_b32 a54, 0
    v_accvgpr_write_b32 a55, 0
    v_accvgpr_write_b32 a56, 0
    v_accvgpr_write_b32 a57, 0
    v_accvgpr_write_b32 a58, 0
    v_accvgpr_write_b32 a59, 0
    v_accvgpr_write_b32 a60, 0
    v_accvgpr_write_b32 a61, 0
    v_accvgpr_write_b32 a62, 0
    v_accvgpr_write_b32 a63, 0
    v_accvgpr_write_b32 a64, 0
    v_accvgpr_write_b32 a65, 0
    v_accvgpr_write_b32 a66, 0
    v_accvgpr_write_b32 a67, 0
    v_accvgpr_write_b32 a68, 0
    v_accvgpr_write_b32 a69, 0
    v_accvgpr_write_b32 a70, 0
    v_accvgpr_write_b32 a71, 0
    v_accvgpr_write_b32 a72, 0
    v_accvgpr_write_b32 a73, 0
    v_accvgpr_write_b32 a74, 0
    v_accvgpr_write_b32 a75, 0
    v_accvgpr_write_b32 a76, 0
    v_accvgpr_write_b32 a77, 0
    v_accvgpr_write_b32 a78, 0
    v_accvgpr_write_b32 a79, 0
    v_accvgpr_write_b32 a80, 0
    v_accvgpr_write_b32 a81, 0
    v_accvgpr_write_b32 a82, 0
    v_accvgpr_write_b32 a83, 0
    v_accvgpr_write_b32 a84, 0
    v_accvgpr_write_b32 a85, 0
    v_accvgpr_write_b32 a86, 0
    v_accvgpr_write_b32 a87, 0
    v_accvgpr_write_b32 a88, 0
    v_accvgpr_write_b32 a89, 0
    v_accvgpr_write_b32 a90, 0
    v_accvgpr_write_b32 a91, 0
    v_accvgpr_write_b32 a92, 0
    v_accvgpr_write_b32 a93, 0
    v_accvgpr_write_b32 a94, 0
    v_accvgpr_write_b32 a95, 0
    v_accvgpr_write_b32 a96, 0
    v_accvgpr_write_b32 a97, 0
    v_accvgpr_write_b32 a98, 0
    v_accvgpr_write_b32 a99, 0
    v_accvgpr_write_b32 a100, 0
    v_accvgpr_write_b32 a101, 0
    v_accvgpr_write_b32 a102, 0
    v_accvgpr_write_b32 a103, 0
    v_accvgpr_write_b32 a104, 0
    v_accvgpr_write_b32 a105, 0
    v_accvgpr_write_b32 a106, 0
    v_accvgpr_write_b32 a107, 0
    v_accvgpr_write_b32 a108, 0
    v_accvgpr_write_b32 a109, 0
    v_accvgpr_write_b32 a110, 0
    v_accvgpr_write_b32 a111, 0
    v_accvgpr_write_b32 a112, 0
    v_accvgpr_write_b32 a113, 0
    v_accvgpr_write_b32 a114, 0
    v_accvgpr_write_b32 a115, 0
    v_accvgpr_write_b32 a116, 0
    v_accvgpr_write_b32 a117, 0
    v_accvgpr_write_b32 a118, 0
    v_accvgpr_write_b32 a119, 0
    v_accvgpr_write_b32 a120, 0
    v_accvgpr_write_b32 a121, 0
    v_accvgpr_write_b32 a122, 0
    v_accvgpr_write_b32 a123, 0
    v_accvgpr_write_b32 a124, 0
    v_accvgpr_write_b32 a125, 0
    v_accvgpr_write_b32 a126, 0
    v_accvgpr_write_b32 a127, 0
    v_accvgpr_write_b32 a128, 0
    v_accvgpr_write_b32 a129, 0
    v_accvgpr_write_b32 a130, 0
    v_accvgpr_write_b32 a131, 0
    v_accvgpr_write_b32 a132, 0
    v_accvgpr_write_b32 a133, 0
    v_accvgpr_write_b32 a134, 0
    v_accvgpr_write_b32 a135, 0
    v_accvgpr_write_b32 a136, 0
    v_accvgpr_write_b32 a137, 0
    v_accvgpr_write_b32 a138, 0
    v_accvgpr_write_b32 a139, 0
    v_accvgpr_write_b32 a140, 0
    v_accvgpr_write_b32 a141, 0
    v_accvgpr_write_b32 a142, 0
    v_accvgpr_write_b32 a143, 0
    v_accvgpr_write_b32 a144, 0
    v_accvgpr_write_b32 a145, 0
    v_accvgpr_write_b32 a146, 0
    v_accvgpr_write_b32 a147, 0
    v_accvgpr_write_b32 a148, 0
    v_accvgpr_write_b32 a149, 0
    v_accvgpr_write_b32 a150, 0
    v_accvgpr_write_b32 a151, 0
    v_accvgpr_write_b32 a152, 0
    v_accvgpr_write_b32 a153, 0
    v_accvgpr_write_b32 a154, 0
    v_accvgpr_write_b32 a155, 0
    v_accvgpr_write_b32 a156, 0
    v_accvgpr_write_b32 a157, 0
    v_accvgpr_write_b32 a158, 0
    v_accvgpr_write_b32 a159, 0
    v_accvgpr_write_b32 a224, 0
    v_accvgpr_write_b32 a225, 0
    v_accvgpr_write_b32 a226, 0
    v_accvgpr_write_b32 a227, 0
    v_accvgpr_write_b32 a228, 0
    v_accvgpr_write_b32 a229, 0
    v_accvgpr_write_b32 a230, 0
    v_accvgpr_write_b32 a231, 0
    v_accvgpr_write_b32 a232, 0
    v_accvgpr_write_b32 a233, 0
    v_accvgpr_write_b32 a234, 0
    v_accvgpr_write_b32 a235, 0
    v_accvgpr_write_b32 a236, 0
    v_accvgpr_write_b32 a237, 0
    v_accvgpr_write_b32 a238, 0
    v_accvgpr_write_b32 a239, 0
    v_accvgpr_write_b32 a240, 0
    v_accvgpr_write_b32 a241, 0
    v_accvgpr_write_b32 a242, 0
    v_accvgpr_write_b32 a243, 0
    v_accvgpr_write_b32 a244, 0
    v_accvgpr_write_b32 a245, 0
    v_accvgpr_write_b32 a246, 0
    v_accvgpr_write_b32 a247, 0
    v_accvgpr_write_b32 a248, 0
    v_accvgpr_write_b32 a249, 0
    v_accvgpr_write_b32 a250, 0
    v_accvgpr_write_b32 a251, 0
    v_accvgpr_write_b32 a252, 0
    v_accvgpr_write_b32 a253, 0
    v_accvgpr_write_b32 a254, 0
    v_accvgpr_write_b32 a255, 0
    s_waitcnt vmcnt(0)
    s_bitcmp1_b32 s36, 0
    s_cbranch_scc1 A1h1_enter
    s_branch A0h1_enter
OP_slow:
    s_waitcnt vmcnt(0) lgkmcnt(0)
    s_barrier
    s_cmp_lg_u32 s36, 0
    s_cbranch_scc1 OP_s1
    buffer_wbl2 sc1
    s_waitcnt vmcnt(0)
    v_mov_b32 v226, 0x10000
    s_mov_b64 exec, 1
    global_atomic_add v239, v226, s[48:49] offset:4
    s_mov_b64 exec, -1
    s_mov_b32 s65, 0x20000
OP_s0:
    global_load_dword v226, v239, s[48:49] offset:4 sc1
    s_waitcnt vmcnt(0)
    v_readfirstlane_b32 s62, v226
    s_lshr_b32 s62, s62, 16
    s_cmp_ge_u32 s62, 16
    s_cbranch_scc1 OP_s2
    s_sub_u32 s65, s65, 1
    s_cmp_eq_u32 s65, 0
    s_cbranch_scc1 OP_s2
    s_sleep 8
    s_branch OP_s0
OP_s2:
    buffer_inv sc1
    s_waitcnt vmcnt(0)
OP_s1:
    s_barrier
    v_xor_b32 v252, 0, v238
    buffer_load_dwordx4 v[80:83], v252, s[28:31], s51 offen sc1
    buffer_load_dwordx4 v[84:87], v252, s[28:31], s52 offen sc1
    buffer_load_dwordx4 v[88:91], v252, s[28:31], s53 offen sc1
    buffer_load_dwordx4 v[92:95], v252, s[28:31], s54 offen sc1
    buffer_load_dwordx4 v[96:99], v252, s[28:31], s55 offen sc1
    buffer_load_dwordx4 v[100:103], v252, s[28:31], s56 offen sc1
    buffer_load_dwordx4 v[104:107], v252, s[28:31], s57 offen sc1
    buffer_load_dwordx4 v[108:111], v252, s[28:31], s58 offen sc1
    buffer_load_dwordx4 v[112:115], v252, s[28:31], s59 offen sc1
    v_xor_b32 v253, 1024, v238
    buffer_load_dwordx4 v[116:119], v253, s[28:31], s51 offen sc1
    buffer_load_dwordx4 v[120:123], v253, s[28:31], s52 offen sc1
    buffer_load_dwordx4 v[124:127], v253, s[28:31], s53 offen sc1
    buffer_load_dwordx4 v[128:131], v253, s[28:31], s54 offen sc1
    buffer_load_dwordx4 v[132:135], v253, s[28:31], s55 offen sc1
    buffer_load_dwordx4 v[136:139], v253, s[28:31], s56 offen sc1
    buffer_load_dwordx4 v[140:143], v253, s[28:31], s57 offen sc1
    buffer_load_dwordx4 v[144:147], v253, s[28:31], s58 offen sc1
    buffer_load_dwordx4 v[148:151], v253, s[28:31], s59 offen sc1
    s_waitcnt vmcnt(0)
OP_main:
    ds_read_b64_tr_b16 v[0:1], v212 offset:0
    ds_read_b64_tr_b16 v[2:3], v212 offset:4096
    ds_read_b64_tr_b16 v[4:5], v213 offset:0
    ds_read_b64_tr_b16 v[6:7], v213 offset:4096
    ds_read_b64_tr_b16 v[8:9], v214 offset:0
    ds_read_b64_tr_b16 v[10:11], v214 offset:4096
    ds_read_b64_tr_b16 v[12:13], v215 offset:0
    ds_read_b64_tr_b16 v[14:15], v215 offset:4096
    ds_read_b64_tr_b16 v[16:17], v216 offset:0
    ds_read_b64_tr_b16 v[18:19], v216 offset:4096
    ds_read_b64_tr_b16 v[20:21], v217 offset:0
    ds_read_b64_tr_b16 v[22:23], v217 offset:4096
    ds_read_b64_tr_b16 v[24:25], v218 offset:0
    ds_read_b64_tr_b16 v[26:27], v218 offset:4096
    ds_read_b64_tr_b16 v[28:29], v219 offset:0
    ds_read_b64_tr_b16 v[30:31], v219 offset:4096
    s_waitcnt lgkmcnt(0)
    v_mfma_f32_16x16x32_bf16 a[0:3], v[0:3], v[80:83], 0
    v_mfma_f32_16x16x32_bf16 a[36:39], v[4:7], v[80:83], 0
    v_xor_b32 v252, 2048, v238
    v_mfma_f32_16x16x32_bf16 a[72:75], v[8:11], v[80:83], 0
    buffer_load_dwordx4 v[152:155], v252, s[28:31], s51 offen sc1
    v_mfma_f32_16x16x32_bf16 a[108:111], v[12:15], v[80:83], 0
    v_add_u32 v212, 0xfffe0000, v212
    v_add_u32 v213, 0xfffe0000, v213
    v_mfma_f32_16x16x32_bf16 v[64:67], v[16:19], v[80:83], 0
    v_add_u32 v214, 0xfffe0000, v214
    v_add_u32 v215, 0xfffe0000, v215
    v_mfma_f32_16x16x32_bf16 a[144:147], v[20:23], v[80:83], 0
    buffer_load_dwordx4 v[156:159], v252, s[28:31], s52 offen sc1
    v_mfma_f32_16x16x32_bf16 a[180:183], v[24:27], v[80:83], 0
    v_add_u32 v216, 0xfffe0000, v216
    v_add_u32 v217, 0xfffe0000, v217
    v_mfma_f32_16x16x32_bf16 a[216:219], v[28:31], v[80:83], 0
    v_add_u32 v218, 0xfffe0000, v218
    v_add_u32 v219, 0xfffe0000, v219
    v_mfma_f32_16x16x32_bf16 a[4:7], v[0:3], v[84:87], 0
    buffer_load_dwordx4 v[160:163], v252, s[28:31], s53 offen sc1
    v_mfma_f32_16x16x32_bf16 a[40:43], v[4:7], v[84:87], 0
    ds_read_b64_tr_b16 v[32:33], v212 offset:0
    ds_read_b64_tr_b16 v[34:35], v212 offset:4096
    v_mfma_f32_16x16x32_bf16 a[76:79], v[8:11], v[84:87], 0
    v_mfma_f32_16x16x32_bf16 a[112:115], v[12:15], v[84:87], 0
    buffer_load_dwordx4 v[164:167], v252, s[28:31], s54 offen sc1
    v_mfma_f32_16x16x32_bf16 v[68:71], v[16:19], v[84:87], 0
    ds_read_b64_tr_b16 v[36:37], v213 offset:0
    ds_read_b64_tr_b16 v[38:39], v213 offset:4096
    v_mfma_f32_16x16x32_bf16 a[148:151], v[20:23], v[84:87], 0
    v_mfma_f32_16x16x32_bf16 a[184:187], v[24:27], v[84:87], 0
    buffer_load_dwordx4 v[168:171], v252, s[28:31], s55 offen sc1
    v_mfma_f32_16x16x32_bf16 a[220:223], v[28:31], v[84:87], 0
    ds_read_b64_tr_b16 v[40:41], v214 offset:0
    ds_read_b64_tr_b16 v[42:43], v214 offset:4096
    v_mfma_f32_16x16x32_bf16 a[8:11], v[0:3], v[88:91], 0
    v_mfma_f32_16x16x32_bf16 a[44:47], v[4:7], v[88:91], 0
    buffer_load_dwordx4 v[172:175], v252, s[28:31], s56 offen sc1
    v_mfma_f32_16x16x32_bf16 a[80:83], v[8:11], v[88:91], 0
    ds_read_b64_tr_b16 v[44:45], v215 offset:0
    ds_read_b64_tr_b16 v[46:47], v215 offset:4096
    v_mfma_f32_16x16x32_bf16 a[116:119], v[12:15], v[88:91], 0
    v_mfma_f32_16x16x32_bf16 v[72:75], v[16:19], v[88:91], 0
    buffer_load_dwordx4 v[176:179], v252, s[28:31], s57 offen sc1
    v_mfma_f32_16x16x32_bf16 a[152:155], v[20:23], v[88:91], 0
    ds_read_b64_tr_b16 v[48:49], v216 offset:0
    ds_read_b64_tr_b16 v[50:51], v216 offset:4096
    v_mfma_f32_16x16x32_bf16 a[188:191], v[24:27], v[88:91], 0
    v_mfma_f32_16x16x32_bf16 a[224:227], v[28:31], v[88:91], 0
    buffer_load_dwordx4 v[180:183], v252, s[28:31], s58 offen sc1
    v_mfma_f32_16x16x32_bf16 a[12:15], v[0:3], v[92:95], 0
    ds_read_b64_tr_b16 v[52:53], v217 offset:0
    ds_read_b64_tr_b16 v[54:55], v217 offset:4096
    v_mfma_f32_16x16x32_bf16 a[48:51], v[4:7], v[92:95], 0
    v_mfma_f32_16x16x32_bf16 a[84:87], v[8:11], v[92:95], 0
    buffer_load_dwordx4 v[184:187], v252, s[28:31], s59 offen sc1
    v_mfma_f32_16x16x32_bf16 a[120:123], v[12:15], v[92:95], 0
    s_add_u32 m0, s81, 131072
    s_xor_b32 s87, s80, 262144
    ds_read_b64_tr_b16 v[56:57], v218 offset:0
    v_mfma_f32_16x16x32_bf16 v[76:79], v[16:19], v[92:95], 0
    ds_read_b64_tr_b16 v[58:59], v218 offset:4096
    v_mfma_f32_16x16x32_bf16 a[156:159], v[20:23], v[92:95], 0
    buffer_load_dwordx4 v221, s[32:35], s87 offen offset:0  lds
    v_mfma_f32_16x16x32_bf16 a[192:195], v[24:27], v[92:95], 0
    ds_read_b64_tr_b16 v[60:61], v219 offset:0
    ds_read_b64_tr_b16 v[62:63], v219 offset:4096
    v_mfma_f32_16x16x32_bf16 a[228:231], v[28:31], v[92:95], 0
    v_mfma_f32_16x16x32_bf16 a[16:19], v[0:3], v[96:99], 0
    buffer_load_dwordx4 v222, s[32:35], s87 offen offset:1024  lds
    v_mfma_f32_16x16x32_bf16 a[52:55], v[4:7], v[96:99], 0
    v_mfma_f32_16x16x32_bf16 a[88:91], v[8:11], v[96:99], 0
    v_mfma_f32_16x16x32_bf16 a[124:127], v[12:15], v[96:99], 0
    buffer_load_dwordx4 v223, s[32:35], s87 offen offset:2048  lds
    v_mfma_f32_16x16x32_bf16 v[188:191], v[16:19], v[96:99], 0
    v_mfma_f32_16x16x32_bf16 a[160:163], v[20:23], v[96:99], 0
    v_mfma_f32_16x16x32_bf16 a[196:199], v[24:27], v[96:99], 0
    buffer_load_dwordx4 v225, s[32:35], s87 offen offset:3072  lds
    v_mfma_f32_16x16x32_bf16 a[232:235], v[28:31], v[96:99], 0
    v_mfma_f32_16x16x32_bf16 a[20:23], v[0:3], v[100:103], 0
    v_mfma_f32_16x16x32_bf16 a[56:59], v[4:7], v[100:103], 0
    v_mfma_f32_16x16x32_bf16 a[92:95], v[8:11], v[100:103], 0
    v_mfma_f32_16x16x32_bf16 a[128:131], v[12:15], v[100:103], 0
    v_mfma_f32_16x16x32_bf16 v[192:195], v[16:19], v[100:103], 0
    v_mfma_f32_16x16x32_bf16 a[164:167], v[20:23], v[100:103], 0
    v_mfma_f32_16x16x32_bf16 a[200:203], v[24:27], v[100:103], 0
    v_mfma_f32_16x16x32_bf16 a[236:239], v[28:31], v[100:103], 0
    v_mfma_f32_16x16x32_bf16 a[24:27], v[0:3], v[104:107], 0
    v_mfma_f32_16x16x32_bf16 a[60:63], v[4:7], v[104:107], 0
    v_mfma_f32_16x16x32_bf16 a[96:99], v[8:11], v[104:107], 0
    v_mfma_f32_16x16x32_bf16 a[132:135], v[12:15], v[104:107], 0
    v_mfma_f32_16x16x32_bf16 v[196:199], v[16:19], v[104:107], 0
    v_mfma_f32_16x16x32_bf16 a[168:171], v[20:23], v[104:107], 0
    v_mfma_f32_16x16x32_bf16 a[204:207], v[24:27], v[104:107], 0
    v_mfma_f32_16x16x32_bf16 a[240:243], v[28:31], v[104:107], 0
    v_mfma_f32_16x16x32_bf16 a[28:31], v[0:3], v[108:111], 0
    v_mfma_f32_16x16x32_bf16 a[64:67], v[4:7], v[108:111], 0
    v_mfma_f32_16x16x32_bf16 a[100:103], v[8:11], v[108:111], 0
    v_mfma_f32_16x16x32_bf16 a[136:139], v[12:15], v[108:111], 0
    v_mfma_f32_16x16x32_bf16 v[200:203], v[16:19], v[108:111], 0
    v_mfma_f32_16x16x32_bf16 a[172:175], v[20:23], v[108:111], 0
    v_mfma_f32_16x16x32_bf16 a[208:211], v[24:27], v[108:111], 0
    v_mfma_f32_16x16x32_bf16 a[244:247], v[28:31], v[108:111], 0
    v_mfma_f32_16x16x32_bf16 a[32:35], v[0:3], v[112:115], 0
    v_mfma_f32_16x16x32_bf16 a[68:71], v[4:7], v[112:115], 0
    v_mfma_f32_16x16x32_bf16 a[104:107], v[8:11], v[112:115], 0
    v_mfma_f32_16x16x32_bf16 a[140:143], v[12:15], v[112:115], 0
    v_mfma_f32_16x16x32_bf16 v[204:207], v[16:19], v[112:115], 0
    v_mfma_f32_16x16x32_bf16 a[176:179], v[20:23], v[112:115], 0
    v_mfma_f32_16x16x32_bf16 a[212:215], v[24:27], v[112:115], 0
    v_mfma_f32_16x16x32_bf16 a[248:251], v[28:31], v[112:115], 0
    s_waitcnt lgkmcnt(0)
    s_waitcnt vmcnt(13)
    v_mfma_f32_16x16x32_bf16 a[0:3], v[32:35], v[116:119], a[0:3]
    s_barrier
    s_cmp_lg_u32 s36, 0
    s_cbranch_scc1 OP_a1
    v_mov_b32 v226, 1
    s_mov_b64 exec, 1
    global_atomic_add v239, v226, s[48:49] offset:4
    s_mov_b64 exec, -1
OP_a1:
    v_mfma_f32_16x16x32_bf16 a[36:39], v[36:39], v[116:119], a[36:39]
    v_xor_b32 v253, 3072, v238
    v_mfma_f32_16x16x32_bf16 a[72:75], v[40:43], v[116:119], a[72:75]
    buffer_load_dwordx4 v[80:83], v253, s[28:31], s51 offen sc1
    v_mfma_f32_16x16x32_bf16 a[108:111], v[44:47], v[116:119], a[108:111]
    v_mfma_f32_16x16x32_bf16 v[64:67], v[48:51], v[116:119], v[64:67]
    v_mfma_f32_16x16x32_bf16 a[144:147], v[52:55], v[116:119], a[144:147]
    buffer_load_dwordx4 v[84:87], v253, s[28:31], s52 offen sc1
    v_mfma_f32_16x16x32_bf16 a[180:183], v[56:59], v[116:119], a[180:183]
    v_mfma_f32_16x16x32_bf16 a[216:219], v[60:63], v[116:119], a[216:219]
    v_mfma_f32_16x16x32_bf16 a[4:7], v[32:35], v[120:123], a[4:7]
    buffer_load_dwordx4 v[88:91], v253, s[28:31], s53 offen sc1
    v_mfma_f32_16x16x32_bf16 a[40:43], v[36:39], v[120:123], a[40:43]
    ds_read_b64_tr_b16 v[0:1], v212 offset:32768
    ds_read_b64_tr_b16 v[2:3], v212 offset:36864
    v_mfma_f32_16x16x32_bf16 a[76:79], v[40:43], v[120:123], a[76:79]
    v_mfma_f32_16x16x32_bf16 a[112:115], v[44:47], v[120:123], a[112:115]
    buffer_load_dwordx4 v[92:95], v253, s[28:31], s54 offen sc1
    v_mfma_f32_16x16x32_bf16 v[68:71], v[48:51], v[120:123], v[68:71]
    ds_read_b64_tr_b16 v[4:5], v213 offset:32768
    ds_read_b64_tr_b16 v[6:7], v213 offset:36864
    v_mfma_f32_16x16x32_bf16 a[148:151], v[52:55], v[120:123], a[148:151]
    v_mfma_f32_16x16x32_bf16 a[184:187], v[56:59], v[120:123], a[184:187]
    buffer_load_dwordx4 v[96:99], v253, s[28:31], s55 offen sc1
    v_mfma_f32_16x16x32_bf16 a[220:223], v[60:63], v[120:123], a[220:223]
    ds_read_b64_tr_b16 v[8:9], v214 offset:32768
    ds_read_b64_tr_b16 v[10:11], v214 offset:36864
    v_mfma_f32_16x16x32_bf16 a[8:11], v[32:35], v[124:127], a[8:11]
    v_mfma_f32_16x16x32_bf16 a[44:47], v[36:39], v[124:127], a[44:47]
    buffer_load_dwordx4 v[100:103], v253, s[28:31], s56 offen sc1
    v_mfma_f32_16x16x32_bf16 a[80:83], v[40:43], v[124:127], a[80:83]
    ds_read_b64_tr_b16 v[12:13], v215 offset:32768
    ds_read_b64_tr_b16 v[14:15], v215 offset:36864
    v_mfma_f32_16x16x32_bf16 a[116:119], v[44:47], v[124:127], a[116:119]
    v_mfma_f32_16x16x32_bf16 v[72:75], v[48:51], v[124:127], v[72:75]
    buffer_load_dwordx4 v[104:107], v253, s[28:31], s57 offen sc1
    v_mfma_f32_16x16x32_bf16 a[152:155], v[52:55], v[124:127], a[152:155]
    ds_read_b64_tr_b16 v[16:17], v216 offset:32768
    ds_read_b64_tr_b16 v[18:19], v216 offset:36864
    v_mfma_f32_16x16x32_bf16 a[188:191], v[56:59], v[124:127], a[188:191]
    v_mfma_f32_16x16x32_bf16 a[224:227], v[60:63], v[124:127], a[224:227]
    buffer_load_dwordx4 v[108:111], v253, s[28:31], s58 offen sc1
    v_mfma_f32_16x16x32_bf16 a[12:15], v[32:35], v[128:131], a[12:15]
    ds_read_b64_tr_b16 v[20:21], v217 offset:32768
    ds_read_b64_tr_b16 v[22:23], v217 offset:36864
    v_mfma_f32_16x16x32_bf16 a[48:51], v[36:39], v[128:131], a[48:51]
    v_mfma_f32_16x16x32_bf16 a[84:87], v[40:43], v[128:131], a[84:87]
    buffer_load_dwordx4 v[112:115], v253, s[28:31], s59 offen sc1
    v_mfma_f32_16x16x32_bf16 a[120:123], v[44:47], v[128:131], a[120:123]
    s_add_u32 m0, s81, 135168
    s_xor_b32 s87, s80, 278528
    ds_read_b64_tr_b16 v[24:25], v218 offset:32768
    v_mfma_f32_16x16x32_bf16 v[76:79], v[48:51], v[128:131], v[76:79]
    ds_read_b64_tr_b16 v[26:27], v218 offset:36864
    v_mfma_f32_16x16x32_bf16 a[156:159], v[52:55], v[128:131], a[156:159]
    buffer_load_dwordx4 v221, s[32:35], s87 offen offset:0  lds
    v_mfma_f32_16x16x32_bf16 a[192:195], v[56:59], v[128:131], a[192:195]
    ds_read_b64_tr_b16 v[28:29], v219 offset:32768
    ds_read_b64_tr_b16 v[30:31], v219 offset:36864
    v_mfma_f32_16x16x32_bf16 a[228:231], v[60:63], v[128:131], a[228:231]
    v_mfma_f32_16x16x32_bf16 a[16:19], v[32:35], v[132:135], a[16:19]
    buffer_load_dwordx4 v222, s[32:35], s87 offen offset:1024  lds
    v_mfma_f32_16x16x32_bf16 a[52:55], v[36:39], v[132:135], a[52:55]
    v_mfma_f32_16x16x32_bf16 a[88:91], v[40:43], v[132:135], a[88:91]
    v_mfma_f32_16x16x32_bf16 a[124:127], v[44:47], v[132:135], a[124:127]
    buffer_load_dwordx4 v223, s[32:35], s87 offen offset:2048  lds
    v_mfma_f32_16x16x32_bf16 v[188:191], v[48:51], v[132:135], v[188:191]
    v_mfma_f32_16x16x32_bf16 a[160:163], v[52:55], v[132:135], a[160:163]
    v_mfma_f32_16x16x32_bf16 a[196:199], v[56:59], v[132:135], a[196:199]
    buffer_load_dwordx4 v225, s[32:35], s87 offen offset:3072  lds
    v_mfma_f32_16x16x32_bf16 a[232:235], v[60:63], v[132:135], a[232:235]
    s_add_u32 m0, s81, 0
    s_xor_b32 s87, s80, 294912
    v_mfma_f32_16x16x32_bf16 a[20:23], v[32:35], v[136:139], a[20:23]
    v_mfma_f32_16x16x32_bf16 a[56:59], v[36:39], v[136:139], a[56:59]
    buffer_load_dwordx4 v221, s[32:35], s87 offen offset:0  lds
    v_mfma_f32_16x16x32_bf16 a[92:95], v[40:43], v[136:139], a[92:95]
    v_mfma_f32_16x16x32_bf16 a[128:131], v[44:47], v[136:139], a[128:131]
    v_mfma_f32_16x16x32_bf16 v[192:195], v[48:51], v[136:139], v[192:195]
    buffer_load_dwordx4 v222, s[32:35], s87 offen offset:1024  lds
    v_mfma_f32_16x16x32_bf16 a[164:167], v[52:55], v[136:139], a[164:167]
    v_mfma_f32_16x16x32_bf16 a[200:203], v[56:59], v[136:139], a[200:203]
    v_mfma_f32_16x16x32_bf16 a[236:239], v[60:63], v[136:139], a[236:239]
    buffer_load_dwordx4 v223, s[32:35], s87 offen offset:2048  lds
    v_mfma_f32_16x16x32_bf16 a[24:27], v[32:35], v[140:143], a[24:27]
    v_mfma_f32_16x16x32_bf16 a[60:63], v[36:39], v[140:143], a[60:63]
    v_mfma_f32_16x16x32_bf16 a[96:99], v[40:43], v[140:143], a[96:99]
    buffer_load_dwordx4 v225, s[32:35], s87 offen offset:3072  lds
    v_mfma_f32_16x16x32_bf16 a[132:135], v[44:47], v[140:143], a[132:135]
    v_mfma_f32_16x16x32_bf16 v[196:199], v[48:51], v[140:143], v[196:199]
    v_mfma_f32_16x16x32_bf16 a[168:171], v[52:55], v[140:143], a[168:171]
    v_mfma_f32_16x16x32_bf16 a[204:207], v[56:59], v[140:143], a[204:207]
    v_mfma_f32_16x16x32_bf16 a[240:243], v[60:63], v[140:143], a[240:243]
    v_mfma_f32_16x16x32_bf16 a[28:31], v[32:35], v[144:147], a[28:31]
    v_mfma_f32_16x16x32_bf16 a[64:67], v[36:39], v[144:147], a[64:67]
    v_mfma_f32_16x16x32_bf16 a[100:103], v[40:43], v[144:147], a[100:103]
    v_mfma_f32_16x16x32_bf16 a[136:139], v[44:47], v[144:147], a[136:139]
    v_mfma_f32_16x16x32_bf16 v[200:203], v[48:51], v[144:147], v[200:203]
    v_mfma_f32_16x16x32_bf16 a[172:175], v[52:55], v[144:147], a[172:175]
    v_mfma_f32_16x16x32_bf16 a[208:211], v[56:59], v[144:147], a[208:211]
    v_mfma_f32_16x16x32_bf16 a[244:247], v[60:63], v[144:147], a[244:247]
    v_mfma_f32_16x16x32_bf16 a[32:35], v[32:35], v[148:151], a[32:35]
    v_mfma_f32_16x16x32_bf16 a[68:71], v[36:39], v[148:151], a[68:71]
    v_mfma_f32_16x16x32_bf16 a[104:107], v[40:43], v[148:151], a[104:107]
    v_mfma_f32_16x16x32_bf16 a[140:143], v[44:47], v[148:151], a[140:143]
    v_mfma_f32_16x16x32_bf16 v[204:207], v[48:51], v[148:151], v[204:207]
    v_mfma_f32_16x16x32_bf16 a[176:179], v[52:55], v[148:151], a[176:179]
    v_mfma_f32_16x16x32_bf16 a[212:215], v[56:59], v[148:151], a[212:215]
    v_mfma_f32_16x16x32_bf16 a[248:251], v[60:63], v[148:151], a[248:251]
    s_waitcnt lgkmcnt(0)
    s_waitcnt vmcnt(17)
    v_mfma_f32_16x16x32_bf16 a[0:3], v[0:3], v[152:155], a[0:3]
    v_mfma_f32_16x16x32_bf16 a[36:39], v[4:7], v[152:155], a[36:39]
    v_xor_b32 v252, 8192, v238
    v_mfma_f32_16x16x32_bf16 a[72:75], v[8:11], v[152:155], a[72:75]
    buffer_load_dwordx4 v[116:119], v252, s[28:31], s51 offen sc1
    v_mfma_f32_16x16x32_bf16 a[108:111], v[12:15], v[152:155], a[108:111]
    v_add_u32 v212, 0x10000, v212
    v_add_u32 v213, 0x10000, v213
    v_mfma_f32_16x16x32_bf16 v[64:67], v[16:19], v[152:155], v[64:67]
    v_add_u32 v214, 0x10000, v214
    v_add_u32 v215, 0x10000, v215
    v_mfma_f32_16x16x32_bf16 a[144:147], v[20:23], v[152:155], a[144:147]
    buffer_load_dwordx4 v[120:123], v252, s[28:31], s52 offen sc1
    v_mfma_f32_16x16x32_bf16 a[180:183], v[24:27], v[152:155], a[180:183]
    v_add_u32 v216, 0x10000, v216
    v_add_u32 v217, 0x10000, v217
    v_mfma_f32_16x16x32_bf16 a[216:219], v[28:31], v[152:155], a[216:219]
    v_add_u32 v218, 0x10000, v218
    v_add_u32 v219, 0x10000, v219
    v_mfma_f32_16x16x32_bf16 a[4:7], v[0:3], v[156:159], a[4:7]
    buffer_load_dwordx4 v[124:127], v252, s[28:31], s53 offen sc1
    v_mfma_f32_16x16x32_bf16 a[40:43], v[4:7], v[156:159], a[40:43]
    ds_read_b64_tr_b16 v[32:33], v212 offset:0
    ds_read_b64_tr_b16 v[34:35], v212 offset:4096
    v_mfma_f32_16x16x32_bf16 a[76:79], v[8:11], v[156:159], a[76:79]
    v_mfma_f32_16x16x32_bf16 a[112:115], v[12:15], v[156:159], a[112:115]
    buffer_load_dwordx4 v[128:131], v252, s[28:31], s54 offen sc1
    v_mfma_f32_16x16x32_bf16 v[68:71], v[16:19], v[156:159], v[68:71]
    ds_read_b64_tr_b16 v[36:37], v213 offset:0
    ds_read_b64_tr_b16 v[38:39], v213 offset:4096
    v_mfma_f32_16x16x32_bf16 a[148:151], v[20:23], v[156:159], a[148:151]
    v_mfma_f32_16x16x32_bf16 a[184:187], v[24:27], v[156:159], a[184:187]
    buffer_load_dwordx4 v[132:135], v252, s[28:31], s55 offen sc1
    v_mfma_f32_16x16x32_bf16 a[220:223], v[28:31], v[156:159], a[220:223]
    ds_read_b64_tr_b16 v[40:41], v214 offset:0
    ds_read_b64_tr_b16 v[42:43], v214 offset:4096
    v_mfma_f32_16x16x32_bf16 a[8:11], v[0:3], v[160:163], a[8:11]
    v_mfma_f32_16x16x32_bf16 a[44:47], v[4:7], v[160:163], a[44:47]
    buffer_load_dwordx4 v[136:139], v252, s[28:31], s56 offen sc1
    v_mfma_f32_16x16x32_bf16 a[80:83], v[8:11], v[160:163], a[80:83]
    ds_read_b64_tr_b16 v[44:45], v215 offset:0
    ds_read_b64_tr_b16 v[46:47], v215 offset:4096
    v_mfma_f32_16x16x32_bf16 a[116:119], v[12:15], v[160:163], a[116:119]
    v_mfma_f32_16x16x32_bf16 v[72:75], v[16:19], v[160:163], v[72:75]
    buffer_load_dwordx4 v[140:143], v252, s[28:31], s57 offen sc1
    v_mfma_f32_16x16x32_bf16 a[152:155], v[20:23], v[160:163], a[152:155]
    ds_read_b64_tr_b16 v[48:49], v216 offset:0
    ds_read_b64_tr_b16 v[50:51], v216 offset:4096
    v_mfma_f32_16x16x32_bf16 a[188:191], v[24:27], v[160:163], a[188:191]
    v_mfma_f32_16x16x32_bf16 a[224:227], v[28:31], v[160:163], a[224:227]
    buffer_load_dwordx4 v[144:147], v252, s[28:31], s58 offen sc1
    v_mfma_f32_16x16x32_bf16 a[12:15], v[0:3], v[164:167], a[12:15]
    ds_read_b64_tr_b16 v[52:53], v217 offset:0
    ds_read_b64_tr_b16 v[54:55], v217 offset:4096
    v_mfma_f32_16x16x32_bf16 a[48:51], v[4:7], v[164:167], a[48:51]
    v_mfma_f32_16x16x32_bf16 a[84:87], v[8:11], v[164:167], a[84:87]
    buffer_load_dwordx4 v[148:151], v252, s[28:31], s59 offen sc1
    v_mfma_f32_16x16x32_bf16 a[120:123], v[12:15], v[164:167], a[120:123]
    s_add_u32 m0, s81, 4096
    s_xor_b32 s87, s80, 311296
    ds_read_b64_tr_b16 v[56:57], v218 offset:0
    v_mfma_f32_16x16x32_bf16 v[76:79], v[16:19], v[164:167], v[76:79]
    ds_read_b64_tr_b16 v[58:59], v218 offset:4096
    v_mfma_f32_16x16x32_bf16 a[156:159], v[20:23], v[164:167], a[156:159]
    buffer_load_dwordx4 v221, s[32:35], s87 offen offset:0  lds
    v_mfma_f32_16x16x32_bf16 a[192:195], v[24:27], v[164:167], a[192:195]
    ds_read_b64_tr_b16 v[60:61], v219 offset:0
    ds_read_b64_tr_b16 v[62:63], v219 offset:4096
    v_mfma_f32_16x16x32_bf16 a[228:231], v[28:31], v[164:167], a[228:231]
    v_mfma_f32_16x16x32_bf16 a[16:19], v[0:3], v[168:171], a[16:19]
    buffer_load_dwordx4 v222, s[32:35], s87 offen offset:1024  lds
    v_mfma_f32_16x16x32_bf16 a[52:55], v[4:7], v[168:171], a[52:55]
    v_mfma_f32_16x16x32_bf16 a[88:91], v[8:11], v[168:171], a[88:91]
    v_mfma_f32_16x16x32_bf16 a[124:127], v[12:15], v[168:171], a[124:127]
    buffer_load_dwordx4 v223, s[32:35], s87 offen offset:2048  lds
    v_mfma_f32_16x16x32_bf16 v[188:191], v[16:19], v[168:171], v[188:191]
    v_mfma_f32_16x16x32_bf16 a[160:163], v[20:23], v[168:171], a[160:163]
    v_mfma_f32_16x16x32_bf16 a[196:199], v[24:27], v[168:171], a[196:199]
    buffer_load_dwordx4 v225, s[32:35], s87 offen offset:3072  lds
    v_mfma_f32_16x16x32_bf16 a[232:235], v[28:31], v[168:171], a[232:235]
    s_add_u32 m0, s81, 32768
    s_xor_b32 s87, s80, 327680
    v_mfma_f32_16x16x32_bf16 a[20:23], v[0:3], v[172:175], a[20:23]
    v_mfma_f32_16x16x32_bf16 a[56:59], v[4:7], v[172:175], a[56:59]
    buffer_load_dwordx4 v221, s[32:35], s87 offen offset:0  lds
    v_mfma_f32_16x16x32_bf16 a[92:95], v[8:11], v[172:175], a[92:95]
    v_mfma_f32_16x16x32_bf16 a[128:131], v[12:15], v[172:175], a[128:131]
    v_mfma_f32_16x16x32_bf16 v[192:195], v[16:19], v[172:175], v[192:195]
    buffer_load_dwordx4 v222, s[32:35], s87 offen offset:1024  lds
    v_mfma_f32_16x16x32_bf16 a[164:167], v[20:23], v[172:175], a[164:167]
    v_mfma_f32_16x16x32_bf16 a[200:203], v[24:27], v[172:175], a[200:203]
    v_mfma_f32_16x16x32_bf16 a[236:239], v[28:31], v[172:175], a[236:239]
    buffer_load_dwordx4 v223, s[32:35], s87 offen offset:2048  lds
    v_mfma_f32_16x16x32_bf16 a[24:27], v[0:3], v[176:179], a[24:27]
    v_mfma_f32_16x16x32_bf16 a[60:63], v[4:7], v[176:179], a[60:63]
    v_mfma_f32_16x16x32_bf16 a[96:99], v[8:11], v[176:179], a[96:99]
    buffer_load_dwordx4 v225, s[32:35], s87 offen offset:3072  lds
    v_mfma_f32_16x16x32_bf16 a[132:135], v[12:15], v[176:179], a[132:135]
    v_mfma_f32_16x16x32_bf16 v[196:199], v[16:19], v[176:179], v[196:199]
    v_mfma_f32_16x16x32_bf16 a[168:171], v[20:23], v[176:179], a[168:171]
    v_mfma_f32_16x16x32_bf16 a[204:207], v[24:27], v[176:179], a[204:207]
    v_mfma_f32_16x16x32_bf16 a[240:243], v[28:31], v[176:179], a[240:243]
    v_mfma_f32_16x16x32_bf16 a[28:31], v[0:3], v[180:183], a[28:31]
    v_mfma_f32_16x16x32_bf16 a[64:67], v[4:7], v[180:183], a[64:67]
    v_mfma_f32_16x16x32_bf16 a[100:103], v[8:11], v[180:183], a[100:103]
    v_mfma_f32_16x16x32_bf16 a[136:139], v[12:15], v[180:183], a[136:139]
    v_mfma_f32_16x16x32_bf16 v[200:203], v[16:19], v[180:183], v[200:203]
    v_mfma_f32_16x16x32_bf16 a[172:175], v[20:23], v[180:183], a[172:175]
    v_mfma_f32_16x16x32_bf16 a[208:211], v[24:27], v[180:183], a[208:211]
    v_mfma_f32_16x16x32_bf16 a[244:247], v[28:31], v[180:183], a[244:247]
    v_mfma_f32_16x16x32_bf16 a[32:35], v[0:3], v[184:187], a[32:35]
    v_mfma_f32_16x16x32_bf16 a[68:71], v[4:7], v[184:187], a[68:71]
    v_mfma_f32_16x16x32_bf16 a[104:107], v[8:11], v[184:187], a[104:107]
    v_mfma_f32_16x16x32_bf16 a[140:143], v[12:15], v[184:187], a[140:143]
    v_mfma_f32_16x16x32_bf16 v[204:207], v[16:19], v[184:187], v[204:207]
    v_mfma_f32_16x16x32_bf16 a[176:179], v[20:23], v[184:187], a[176:179]
    v_mfma_f32_16x16x32_bf16 a[212:215], v[24:27], v[184:187], a[212:215]
    v_mfma_f32_16x16x32_bf16 a[248:251], v[28:31], v[184:187], a[248:251]
    s_waitcnt lgkmcnt(0)
    s_waitcnt vmcnt(17)
    v_mfma_f32_16x16x32_bf16 a[0:3], v[32:35], v[80:83], a[0:3]
    v_mfma_f32_16x16x32_bf16 a[36:39], v[36:39], v[80:83], a[36:39]
    v_xor_b32 v253, 9216, v238
    v_mfma_f32_16x16x32_bf16 a[72:75], v[40:43], v[80:83], a[72:75]
    buffer_load_dwordx4 v[152:155], v253, s[28:31], s51 offen sc1
    v_mfma_f32_16x16x32_bf16 a[108:111], v[44:47], v[80:83], a[108:111]
    v_add_u32 v212, 0x10000, v212
    v_add_u32 v213, 0x10000, v213
    v_mfma_f32_16x16x32_bf16 v[64:67], v[48:51], v[80:83], v[64:67]
    v_add_u32 v214, 0x10000, v214
    v_add_u32 v215, 0x10000, v215
    v_mfma_f32_16x16x32_bf16 a[144:147], v[52:55], v[80:83], a[144:147]
    buffer_load_dwordx4 v[156:159], v253, s[28:31], s52 offen sc1
    v_mfma_f32_16x16x32_bf16 a[180:183], v[56:59], v[80:83], a[180:183]
    v_add_u32 v216, 0x10000, v216
    v_add_u32 v217, 0x10000, v217
    v_mfma_f32_16x16x32_bf16 a[216:219], v[60:63], v[80:83], a[216:219]
    v_add_u32 v218, 0x10000, v218
    v_add_u32 v219, 0x10000, v219
    v_mfma_f32_16x16x32_bf16 a[4:7], v[32:35], v[84:87], a[4:7]
    buffer_load_dwordx4 v[160:163], v253, s[28:31], s53 offen sc1
    v_mfma_f32_16x16x32_bf16 a[40:43], v[36:39], v[84:87], a[40:43]
    ds_read_b64_tr_b16 v[0:1], v212 offset:0
    ds_read_b64_tr_b16 v[2:3], v212 offset:4096
    v_mfma_f32_16x16x32_bf16 a[76:79], v[40:43], v[84:87], a[76:79]
    v_mfma_f32_16x16x32_bf16 a[112:115], v[44:47], v[84:87], a[112:115]
    buffer_load_dwordx4 v[164:167], v253, s[28:31], s54 offen sc1
    v_mfma_f32_16x16x32_bf16 v[68:71], v[48:51], v[84:87], v[68:71]
    ds_read_b64_tr_b16 v[4:5], v213 offset:0
    ds_read_b64_tr_b16 v[6:7], v213 offset:4096
    v_mfma_f32_16x16x32_bf16 a[148:151], v[52:55], v[84:87], a[148:151]
    v_mfma_f32_16x16x32_bf16 a[184:187], v[56:59], v[84:87], a[184:187]
    buffer_load_dwordx4 v[168:171], v253, s[28:31], s55 offen sc1
    v_mfma_f32_16x16x32_bf16 a[220:223], v[60:63], v[84:87], a[220:223]
    ds_read_b64_tr_b16 v[8:9], v214 offset:0
    ds_read_b64_tr_b16 v[10:11], v214 offset:4096
    v_mfma_f32_16x16x32_bf16 a[8:11], v[32:35], v[88:91], a[8:11]
    v_mfma_f32_16x16x32_bf16 a[44:47], v[36:39], v[88:91], a[44:47]
    buffer_load_dwordx4 v[172:175], v253, s[28:31], s56 offen sc1
    v_mfma_f32_16x16x32_bf16 a[80:83], v[40:43], v[88:91], a[80:83]
    ds_read_b64_tr_b16 v[12:13], v215 offset:0
    ds_read_b64_tr_b16 v[14:15], v215 offset:4096
    v_mfma_f32_16x16x32_bf16 a[116:119], v[44:47], v[88:91], a[116:119]
    v_mfma_f32_16x16x32_bf16 v[72:75], v[48:51], v[88:91], v[72:75]
    buffer_load_dwordx4 v[176:179], v253, s[28:31], s57 offen sc1
    v_mfma_f32_16x16x32_bf16 a[152:155], v[52:55], v[88:91], a[152:155]
    ds_read_b64_tr_b16 v[16:17], v216 offset:0
    ds_read_b64_tr_b16 v[18:19], v216 offset:4096
    v_mfma_f32_16x16x32_bf16 a[188:191], v[56:59], v[88:91], a[188:191]
    v_mfma_f32_16x16x32_bf16 a[224:227], v[60:63], v[88:91], a[224:227]
    buffer_load_dwordx4 v[180:183], v253, s[28:31], s58 offen sc1
    v_mfma_f32_16x16x32_bf16 a[12:15], v[32:35], v[92:95], a[12:15]
    ds_read_b64_tr_b16 v[20:21], v217 offset:0
    ds_read_b64_tr_b16 v[22:23], v217 offset:4096
    v_mfma_f32_16x16x32_bf16 a[48:51], v[36:39], v[92:95], a[48:51]
    v_mfma_f32_16x16x32_bf16 a[84:87], v[40:43], v[92:95], a[84:87]
    buffer_load_dwordx4 v[184:187], v253, s[28:31], s59 offen sc1
    v_mfma_f32_16x16x32_bf16 a[120:123], v[44:47], v[92:95], a[120:123]
    s_add_u32 m0, s81, 36864
    s_xor_b32 s87, s80, 344064
    ds_read_b64_tr_b16 v[24:25], v218 offset:0
    v_mfma_f32_16x16x32_bf16 v[76:79], v[48:51], v[92:95], v[76:79]
    ds_read_b64_tr_b16 v[26:27], v218 offset:4096
    v_mfma_f32_16x16x32_bf16 a[156:159], v[52:55], v[92:95], a[156:159]
    buffer_load_dwordx4 v221, s[32:35], s87 offen offset:0  lds
    v_mfma_f32_16x16x32_bf16 a[192:195], v[56:59], v[92:95], a[192:195]
    ds_read_b64_tr_b16 v[28:29], v219 offset:0
    ds_read_b64_tr_b16 v[30:31], v219 offset:4096
    v_mfma_f32_16x16x32_bf16 a[228:231], v[60:63], v[92:95], a[228:231]
    v_mfma_f32_16x16x32_bf16 a[16:19], v[32:35], v[96:99], a[16:19]
    buffer_load_dwordx4 v222, s[32:35], s87 offen offset:1024  lds
    v_mfma_f32_16x16x32_bf16 a[52:55], v[36:39], v[96:99], a[52:55]
    v_mfma_f32_16x16x32_bf16 a[88:91], v[40:43], v[96:99], a[88:91]
    v_mfma_f32_16x16x32_bf16 a[124:127], v[44:47], v[96:99], a[124:127]
    buffer_load_dwordx4 v223, s[32:35], s87 offen offset:2048  lds
    v_mfma_f32_16x16x32_bf16 v[188:191], v[48:51], v[96:99], v[188:191]
    v_mfma_f32_16x16x32_bf16 a[160:163], v[52:55], v[96:99], a[160:163]
    v_mfma_f32_16x16x32_bf16 a[196:199], v[56:59], v[96:99], a[196:199]
    buffer_load_dwordx4 v225, s[32:35], s87 offen offset:3072  lds
    v_mfma_f32_16x16x32_bf16 a[232:235], v[60:63], v[96:99], a[232:235]
    s_add_u32 m0, s81, 65536
    s_xor_b32 s87, s80, 360448
    v_mfma_f32_16x16x32_bf16 a[20:23], v[32:35], v[100:103], a[20:23]
    v_mfma_f32_16x16x32_bf16 a[56:59], v[36:39], v[100:103], a[56:59]
    buffer_load_dwordx4 v221, s[32:35], s87 offen offset:0  lds
    v_mfma_f32_16x16x32_bf16 a[92:95], v[40:43], v[100:103], a[92:95]
    v_mfma_f32_16x16x32_bf16 a[128:131], v[44:47], v[100:103], a[128:131]
    v_mfma_f32_16x16x32_bf16 v[192:195], v[48:51], v[100:103], v[192:195]
    buffer_load_dwordx4 v222, s[32:35], s87 offen offset:1024  lds
    v_mfma_f32_16x16x32_bf16 a[164:167], v[52:55], v[100:103], a[164:167]
    v_mfma_f32_16x16x32_bf16 a[200:203], v[56:59], v[100:103], a[200:203]
    v_mfma_f32_16x16x32_bf16 a[236:239], v[60:63], v[100:103], a[236:239]
    buffer_load_dwordx4 v223, s[32:35], s87 offen offset:2048  lds
    v_mfma_f32_16x16x32_bf16 a[24:27], v[32:35], v[104:107], a[24:27]
    v_mfma_f32_16x16x32_bf16 a[60:63], v[36:39], v[104:107], a[60:63]
    v_mfma_f32_16x16x32_bf16 a[96:99], v[40:43], v[104:107], a[96:99]
    buffer_load_dwordx4 v225, s[32:35], s87 offen offset:3072  lds
    v_mfma_f32_16x16x32_bf16 a[132:135], v[44:47], v[104:107], a[132:135]
    v_mfma_f32_16x16x32_bf16 v[196:199], v[48:51], v[104:107], v[196:199]
    v_mfma_f32_16x16x32_bf16 a[168:171], v[52:55], v[104:107], a[168:171]
    v_mfma_f32_16x16x32_bf16 a[204:207], v[56:59], v[104:107], a[204:207]
    v_mfma_f32_16x16x32_bf16 a[240:243], v[60:63], v[104:107], a[240:243]
    v_mfma_f32_16x16x32_bf16 a[28:31], v[32:35], v[108:111], a[28:31]
    v_mfma_f32_16x16x32_bf16 a[64:67], v[36:39], v[108:111], a[64:67]
    v_mfma_f32_16x16x32_bf16 a[100:103], v[40:43], v[108:111], a[100:103]
    v_mfma_f32_16x16x32_bf16 a[136:139], v[44:47], v[108:111], a[136:139]
    v_mfma_f32_16x16x32_bf16 v[200:203], v[48:51], v[108:111], v[200:203]
    v_mfma_f32_16x16x32_bf16 a[172:175], v[52:55], v[108:111], a[172:175]
    v_mfma_f32_16x16x32_bf16 a[208:211], v[56:59], v[108:111], a[208:211]
    v_mfma_f32_16x16x32_bf16 a[244:247], v[60:63], v[108:111], a[244:247]
    v_mfma_f32_16x16x32_bf16 a[32:35], v[32:35], v[112:115], a[32:35]
    v_mfma_f32_16x16x32_bf16 a[68:71], v[36:39], v[112:115], a[68:71]
    v_mfma_f32_16x16x32_bf16 a[104:107], v[40:43], v[112:115], a[104:107]
    v_mfma_f32_16x16x32_bf16 a[140:143], v[44:47], v[112:115], a[140:143]
    v_mfma_f32_16x16x32_bf16 v[204:207], v[48:51], v[112:115], v[204:207]
    v_mfma_f32_16x16x32_bf16 a[176:179], v[52:55], v[112:115], a[176:179]
    v_mfma_f32_16x16x32_bf16 a[212:215], v[56:59], v[112:115], a[212:215]
    v_mfma_f32_16x16x32_bf16 a[248:251], v[60:63], v[112:115], a[248:251]
    s_waitcnt lgkmcnt(0)
    s_waitcnt vmcnt(17)
    v_mfma_f32_16x16x32_bf16 a[0:3], v[0:3], v[116:119], a[0:3]
    v_mfma_f32_16x16x32_bf16 a[36:39], v[4:7], v[116:119], a[36:39]
    v_xor_b32 v252, 10240, v238
    v_mfma_f32_16x16x32_bf16 a[72:75], v[8:11], v[116:119], a[72:75]
    buffer_load_dwordx4 v[80:83], v252, s[28:31], s51 offen sc1
    v_mfma_f32_16x16x32_bf16 a[108:111], v[12:15], v[116:119], a[108:111]
    v_add_u32 v212, 0xfffe0000, v212
    v_add_u32 v213, 0xfffe0000, v213
    v_mfma_f32_16x16x32_bf16 v[64:67], v[16:19], v[116:119], v[64:67]
    v_add_u32 v214, 0xfffe0000, v214
    v_add_u32 v215, 0xfffe0000, v215
    v_mfma_f32_16x16x32_bf16 a[144:147], v[20:23], v[116:119], a[144:147]
    buffer_load_dwordx4 v[84:87], v252, s[28:31], s52 offen sc1
    v_mfma_f32_16x16x32_bf16 a[180:183], v[24:27], v[116:119], a[180:183]
    v_add_u32 v216, 0xfffe0000, v216
    v_add_u32 v217, 0xfffe0000, v217
    v_mfma_f32_16x16x32_bf16 a[216:219], v[28:31], v[116:119], a[216:219]
    v_add_u32 v218, 0xfffe0000, v218
    v_add_u32 v219, 0xfffe0000, v219
    v_mfma_f32_16x16x32_bf16 a[4:7], v[0:3], v[120:123], a[4:7]
    buffer_load_dwordx4 v[88:91], v252, s[28:31], s53 offen sc1
    v_mfma_f32_16x16x32_bf16 a[40:43], v[4:7], v[120:123], a[40:43]
    ds_read_b64_tr_b16 v[32:33], v212 offset:0
    ds_read_b64_tr_b16 v[34:35], v212 offset:4096
    v_mfma_f32_16x16x32_bf16 a[76:79], v[8:11], v[120:123], a[76:79]
    v_mfma_f32_16x16x32_bf16 a[112:115], v[12:15], v[120:123], a[112:115]
    buffer_load_dwordx4 v[92:95], v252, s[28:31], s54 offen sc1
    v_mfma_f32_16x16x32_bf16 v[68:71], v[16:19], v[120:123], v[68:71]
    ds_read_b64_tr_b16 v[36:37], v213 offset:0
    ds_read_b64_tr_b16 v[38:39], v213 offset:4096
    v_mfma_f32_16x16x32_bf16 a[148:151], v[20:23], v[120:123], a[148:151]
    v_mfma_f32_16x16x32_bf16 a[184:187], v[24:27], v[120:123], a[184:187]
    buffer_load_dwordx4 v[96:99], v252, s[28:31], s55 offen sc1
    v_mfma_f32_16x16x32_bf16 a[220:223], v[28:31], v[120:123], a[220:223]
    ds_read_b64_tr_b16 v[40:41], v214 offset:0
    ds_read_b64_tr_b16 v[42:43], v214 offset:4096
    v_mfma_f32_16x16x32_bf16 a[8:11], v[0:3], v[124:127], a[8:11]
    v_mfma_f32_16x16x32_bf16 a[44:47], v[4:7], v[124:127], a[44:47]
    buffer_load_dwordx4 v[100:103], v252, s[28:31], s56 offen sc1
    v_mfma_f32_16x16x32_bf16 a[80:83], v[8:11], v[124:127], a[80:83]
    ds_read_b64_tr_b16 v[44:45], v215 offset:0
    ds_read_b64_tr_b16 v[46:47], v215 offset:4096
    v_mfma_f32_16x16x32_bf16 a[116:119], v[12:15], v[124:127], a[116:119]
    v_mfma_f32_16x16x32_bf16 v[72:75], v[16:19], v[124:127], v[72:75]
    buffer_load_dwordx4 v[104:107], v252, s[28:31], s57 offen sc1
    v_mfma_f32_16x16x32_bf16 a[152:155], v[20:23], v[124:127], a[152:155]
    ds_read_b64_tr_b16 v[48:49], v216 offset:0
    ds_read_b64_tr_b16 v[50:51], v216 offset:4096
    v_mfma_f32_16x16x32_bf16 a[188:191], v[24:27], v[124:127], a[188:191]
    v_mfma_f32_16x16x32_bf16 a[224:227], v[28:31], v[124:127], a[224:227]
    buffer_load_dwordx4 v[108:111], v252, s[28:31], s58 offen sc1
    v_mfma_f32_16x16x32_bf16 a[12:15], v[0:3], v[128:131], a[12:15]
    ds_read_b64_tr_b16 v[52:53], v217 offset:0
    ds_read_b64_tr_b16 v[54:55], v217 offset:4096
    v_mfma_f32_16x16x32_bf16 a[48:51], v[4:7], v[128:131], a[48:51]
    v_mfma_f32_16x16x32_bf16 a[84:87], v[8:11], v[128:131], a[84:87]
    buffer_load_dwordx4 v[112:115], v252, s[28:31], s59 offen sc1
    v_mfma_f32_16x16x32_bf16 a[120:123], v[12:15], v[128:131], a[120:123]
    s_add_u32 m0, s81, 69632
    s_xor_b32 s87, s80, 376832
    ds_read_b64_tr_b16 v[56:57], v218 offset:0
    v_mfma_f32_16x16x32_bf16 v[76:79], v[16:19], v[128:131], v[76:79]
    ds_read_b64_tr_b16 v[58:59], v218 offset:4096
    v_mfma_f32_16x16x32_bf16 a[156:159], v[20:23], v[128:131], a[156:159]
    buffer_load_dwordx4 v221, s[32:35], s87 offen offset:0  lds
    v_mfma_f32_16x16x32_bf16 a[192:195], v[24:27], v[128:131], a[192:195]
    ds_read_b64_tr_b16 v[60:61], v219 offset:0
    ds_read_b64_tr_b16 v[62:63], v219 offset:4096
    v_mfma_f32_16x16x32_bf16 a[228:231], v[28:31], v[128:131], a[228:231]
    v_mfma_f32_16x16x32_bf16 a[16:19], v[0:3], v[132:135], a[16:19]
    buffer_load_dwordx4 v222, s[32:35], s87 offen offset:1024  lds
    v_mfma_f32_16x16x32_bf16 a[52:55], v[4:7], v[132:135], a[52:55]
    v_mfma_f32_16x16x32_bf16 a[88:91], v[8:11], v[132:135], a[88:91]
    v_mfma_f32_16x16x32_bf16 a[124:127], v[12:15], v[132:135], a[124:127]
    buffer_load_dwordx4 v223, s[32:35], s87 offen offset:2048  lds
    v_mfma_f32_16x16x32_bf16 v[188:191], v[16:19], v[132:135], v[188:191]
    v_mfma_f32_16x16x32_bf16 a[160:163], v[20:23], v[132:135], a[160:163]
    v_mfma_f32_16x16x32_bf16 a[196:199], v[24:27], v[132:135], a[196:199]
    buffer_load_dwordx4 v225, s[32:35], s87 offen offset:3072  lds
    v_mfma_f32_16x16x32_bf16 a[232:235], v[28:31], v[132:135], a[232:235]
    s_add_u32 m0, s81, 131072
    s_xor_b32 s87, s80, 131072
    v_mfma_f32_16x16x32_bf16 a[20:23], v[0:3], v[136:139], a[20:23]
    v_mfma_f32_16x16x32_bf16 a[56:59], v[4:7], v[136:139], a[56:59]
    buffer_load_dwordx4 v221, s[32:35], s87 offen offset:0  lds
    v_mfma_f32_16x16x32_bf16 a[92:95], v[8:11], v[136:139], a[92:95]
    v_mfma_f32_16x16x32_bf16 a[128:131], v[12:15], v[136:139], a[128:131]
    v_mfma_f32_16x16x32_bf16 v[192:195], v[16:19], v[136:139], v[192:195]
    buffer_load_dwordx4 v222, s[32:35], s87 offen offset:1024  lds
    v_mfma_f32_16x16x32_bf16 a[164:167], v[20:23], v[136:139], a[164:167]
    v_mfma_f32_16x16x32_bf16 a[200:203], v[24:27], v[136:139], a[200:203]
    v_mfma_f32_16x16x32_bf16 a[236:239], v[28:31], v[136:139], a[236:239]
    buffer_load_dwordx4 v223, s[32:35], s87 offen offset:2048  lds
    v_mfma_f32_16x16x32_bf16 a[24:27], v[0:3], v[140:143], a[24:27]
    v_mfma_f32_16x16x32_bf16 a[60:63], v[4:7], v[140:143], a[60:63]
    v_mfma_f32_16x16x32_bf16 a[96:99], v[8:11], v[140:143], a[96:99]
    buffer_load_dwordx4 v225, s[32:35], s87 offen offset:3072  lds
    v_mfma_f32_16x16x32_bf16 a[132:135], v[12:15], v[140:143], a[132:135]
    v_mfma_f32_16x16x32_bf16 v[196:199], v[16:19], v[140:143], v[196:199]
    v_mfma_f32_16x16x32_bf16 a[168:171], v[20:23], v[140:143], a[168:171]
    v_mfma_f32_16x16x32_bf16 a[204:207], v[24:27], v[140:143], a[204:207]
    v_mfma_f32_16x16x32_bf16 a[240:243], v[28:31], v[140:143], a[240:243]
    v_mfma_f32_16x16x32_bf16 a[28:31], v[0:3], v[144:147], a[28:31]
    v_mfma_f32_16x16x32_bf16 a[64:67], v[4:7], v[144:147], a[64:67]
    v_mfma_f32_16x16x32_bf16 a[100:103], v[8:11], v[144:147], a[100:103]
    v_mfma_f32_16x16x32_bf16 a[136:139], v[12:15], v[144:147], a[136:139]
    v_mfma_f32_16x16x32_bf16 v[200:203], v[16:19], v[144:147], v[200:203]
    v_mfma_f32_16x16x32_bf16 a[172:175], v[20:23], v[144:147], a[172:175]
    v_mfma_f32_16x16x32_bf16 a[208:211], v[24:27], v[144:147], a[208:211]
    v_mfma_f32_16x16x32_bf16 a[244:247], v[28:31], v[144:147], a[244:247]
    v_mfma_f32_16x16x32_bf16 a[32:35], v[0:3], v[148:151], a[32:35]
    v_mfma_f32_16x16x32_bf16 a[68:71], v[4:7], v[148:151], a[68:71]
    v_mfma_f32_16x16x32_bf16 a[104:107], v[8:11], v[148:151], a[104:107]
    v_mfma_f32_16x16x32_bf16 a[140:143], v[12:15], v[148:151], a[140:143]
    v_mfma_f32_16x16x32_bf16 v[204:207], v[16:19], v[148:151], v[204:207]
    global_load_dword v226, v239, s[48:49] offset:4 sc1
    v_mfma_f32_16x16x32_bf16 a[176:179], v[20:23], v[148:151], a[176:179]
    v_mfma_f32_16x16x32_bf16 a[212:215], v[24:27], v[148:151], a[212:215]
    v_mfma_f32_16x16x32_bf16 a[248:251], v[28:31], v[148:151], a[248:251]
    s_waitcnt lgkmcnt(0)
    s_waitcnt vmcnt(17)
    v_mfma_f32_16x16x32_bf16 a[0:3], v[32:35], v[152:155], a[0:3]
    v_mfma_f32_16x16x32_bf16 a[36:39], v[36:39], v[152:155], a[36:39]
    v_xor_b32 v253, 11264, v238
    v_mfma_f32_16x16x32_bf16 a[72:75], v[40:43], v[152:155], a[72:75]
    buffer_load_dwordx4 v[116:119], v253, s[28:31], s51 offen sc1
    v_mfma_f32_16x16x32_bf16 a[108:111], v[44:47], v[152:155], a[108:111]
    v_mfma_f32_16x16x32_bf16 v[64:67], v[48:51], v[152:155], v[64:67]
    v_mfma_f32_16x16x32_bf16 a[144:147], v[52:55], v[152:155], a[144:147]
    buffer_load_dwordx4 v[120:123], v253, s[28:31], s52 offen sc1
    v_mfma_f32_16x16x32_bf16 a[180:183], v[56:59], v[152:155], a[180:183]
    v_mfma_f32_16x16x32_bf16 a[216:219], v[60:63], v[152:155], a[216:219]
    v_mfma_f32_16x16x32_bf16 a[4:7], v[32:35], v[156:159], a[4:7]
    buffer_load_dwordx4 v[124:127], v253, s[28:31], s53 offen sc1
    v_mfma_f32_16x16x32_bf16 a[40:43], v[36:39], v[156:159], a[40:43]
    ds_read_b64_tr_b16 v[0:1], v212 offset:32768
    ds_read_b64_tr_b16 v[2:3], v212 offset:36864
    v_mfma_f32_16x16x32_bf16 a[76:79], v[40:43], v[156:159], a[76:79]
    v_mfma_f32_16x16x32_bf16 a[112:115], v[44:47], v[156:159], a[112:115]
    buffer_load_dwordx4 v[128:131], v253, s[28:31], s54 offen sc1
    v_mfma_f32_16x16x32_bf16 v[68:71], v[48:51], v[156:159], v[68:71]
    ds_read_b64_tr_b16 v[4:5], v213 offset:32768
    ds_read_b64_tr_b16 v[6:7], v213 offset:36864
    v_mfma_f32_16x16x32_bf16 a[148:151], v[52:55], v[156:159], a[148:151]
    v_mfma_f32_16x16x32_bf16 a[184:187], v[56:59], v[156:159], a[184:187]
    buffer_load_dwordx4 v[132:135], v253, s[28:31], s55 offen sc1
    v_mfma_f32_16x16x32_bf16 a[220:223], v[60:63], v[156:159], a[220:223]
    ds_read_b64_tr_b16 v[8:9], v214 offset:32768
    ds_read_b64_tr_b16 v[10:11], v214 offset:36864
    v_mfma_f32_16x16x32_bf16 a[8:11], v[32:35], v[160:163], a[8:11]
    v_mfma_f32_16x16x32_bf16 a[44:47], v[36:39], v[160:163], a[44:47]
    buffer_load_dwordx4 v[136:139], v253, s[28:31], s56 offen sc1
    v_mfma_f32_16x16x32_bf16 a[80:83], v[40:43], v[160:163], a[80:83]
    ds_read_b64_tr_b16 v[12:13], v215 offset:32768
    ds_read_b64_tr_b16 v[14:15], v215 offset:36864
    v_mfma_f32_16x16x32_bf16 a[116:119], v[44:47], v[160:163], a[116:119]
    v_mfma_f32_16x16x32_bf16 v[72:75], v[48:51], v[160:163], v[72:75]
    buffer_load_dwordx4 v[140:143], v253, s[28:31], s57 offen sc1
    v_mfma_f32_16x16x32_bf16 a[152:155], v[52:55], v[160:163], a[152:155]
    ds_read_b64_tr_b16 v[16:17], v216 offset:32768
    ds_read_b64_tr_b16 v[18:19], v216 offset:36864
    v_mfma_f32_16x16x32_bf16 a[188:191], v[56:59], v[160:163], a[188:191]
    v_mfma_f32_16x16x32_bf16 a[224:227], v[60:63], v[160:163], a[224:227]
    buffer_load_dwordx4 v[144:147], v253, s[28:31], s58 offen sc1
    v_mfma_f32_16x16x32_bf16 a[12:15], v[32:35], v[164:167], a[12:15]
    ds_read_b64_tr_b16 v[20:21], v217 offset:32768
    ds_read_b64_tr_b16 v[22:23], v217 offset:36864
    v_mfma_f32_16x16x32_bf16 a[48:51], v[36:39], v[164:167], a[48:51]
    v_mfma_f32_16x16x32_bf16 a[84:87], v[40:43], v[164:167], a[84:87]
    buffer_load_dwordx4 v[148:151], v253, s[28:31], s59 offen sc1
    v_mfma_f32_16x16x32_bf16 a[120:123], v[44:47], v[164:167], a[120:123]
    s_add_u32 m0, s81, 135168
    s_xor_b32 s87, s80, 147456
    ds_read_b64_tr_b16 v[24:25], v218 offset:32768
    v_mfma_f32_16x16x32_bf16 v[76:79], v[48:51], v[164:167], v[76:79]
    ds_read_b64_tr_b16 v[26:27], v218 offset:36864
    v_mfma_f32_16x16x32_bf16 a[156:159], v[52:55], v[164:167], a[156:159]
    buffer_load_dwordx4 v221, s[32:35], s87 offen offset:0  lds
    v_mfma_f32_16x16x32_bf16 a[192:195], v[56:59], v[164:167], a[192:195]
    ds_read_b64_tr_b16 v[28:29], v219 offset:32768
    ds_read_b64_tr_b16 v[30:31], v219 offset:36864
    v_mfma_f32_16x16x32_bf16 a[228:231], v[60:63], v[164:167], a[228:231]
    v_mfma_f32_16x16x32_bf16 a[16:19], v[32:35], v[168:171], a[16:19]
    buffer_load_dwordx4 v222, s[32:35], s87 offen offset:1024  lds
    v_mfma_f32_16x16x32_bf16 a[52:55], v[36:39], v[168:171], a[52:55]
    v_mfma_f32_16x16x32_bf16 a[88:91], v[40:43], v[168:171], a[88:91]
    v_mfma_f32_16x16x32_bf16 a[124:127], v[44:47], v[168:171], a[124:127]
    buffer_load_dwordx4 v223, s[32:35], s87 offen offset:2048  lds
    v_mfma_f32_16x16x32_bf16 v[188:191], v[48:51], v[168:171], v[188:191]
    v_mfma_f32_16x16x32_bf16 a[160:163], v[52:55], v[168:171], a[160:163]
    v_mfma_f32_16x16x32_bf16 a[196:199], v[56:59], v[168:171], a[196:199]
    buffer_load_dwordx4 v225, s[32:35], s87 offen offset:3072  lds
    v_mfma_f32_16x16x32_bf16 a[232:235], v[60:63], v[168:171], a[232:235]
    s_add_u32 m0, s81, 0
    s_xor_b32 s87, s80, 163840
    v_mfma_f32_16x16x32_bf16 a[20:23], v[32:35], v[172:175], a[20:23]
    v_mfma_f32_16x16x32_bf16 a[56:59], v[36:39], v[172:175], a[56:59]
    buffer_load_dwordx4 v221, s[32:35], s87 offen offset:0  lds
    v_mfma_f32_16x16x32_bf16 a[92:95], v[40:43], v[172:175], a[92:95]
    v_mfma_f32_16x16x32_bf16 a[128:131], v[44:47], v[172:175], a[128:131]
    v_mfma_f32_16x16x32_bf16 v[192:195], v[48:51], v[172:175], v[192:195]
    buffer_load_dwordx4 v222, s[32:35], s87 offen offset:1024  lds
    v_mfma_f32_16x16x32_bf16 a[164:167], v[52:55], v[172:175], a[164:167]
    v_mfma_f32_16x16x32_bf16 a[200:203], v[56:59], v[172:175], a[200:203]
    v_mfma_f32_16x16x32_bf16 a[236:239], v[60:63], v[172:175], a[236:239]
    buffer_load_dwordx4 v223, s[32:35], s87 offen offset:2048  lds
    v_mfma_f32_16x16x32_bf16 a[24:27], v[32:35], v[176:179], a[24:27]
    v_mfma_f32_16x16x32_bf16 a[60:63], v[36:39], v[176:179], a[60:63]
    v_mfma_f32_16x16x32_bf16 a[96:99], v[40:43], v[176:179], a[96:99]
    buffer_load_dwordx4 v225, s[32:35], s87 offen offset:3072  lds
    v_mfma_f32_16x16x32_bf16 a[132:135], v[44:47], v[176:179], a[132:135]
    v_mfma_f32_16x16x32_bf16 v[196:199], v[48:51], v[176:179], v[196:199]
    v_mfma_f32_16x16x32_bf16 a[168:171], v[52:55], v[176:179], a[168:171]
    v_mfma_f32_16x16x32_bf16 a[204:207], v[56:59], v[176:179], a[204:207]
    v_mfma_f32_16x16x32_bf16 a[240:243], v[60:63], v[176:179], a[240:243]
    v_mfma_f32_16x16x32_bf16 a[28:31], v[32:35], v[180:183], a[28:31]
    v_mfma_f32_16x16x32_bf16 a[64:67], v[36:39], v[180:183], a[64:67]
    v_mfma_f32_16x16x32_bf16 a[100:103], v[40:43], v[180:183], a[100:103]
    v_mfma_f32_16x16x32_bf16 a[136:139], v[44:47], v[180:183], a[136:139]
    v_mfma_f32_16x16x32_bf16 v[200:203], v[48:51], v[180:183], v[200:203]
    v_mfma_f32_16x16x32_bf16 a[172:175], v[52:55], v[180:183], a[172:175]
    v_mfma_f32_16x16x32_bf16 a[208:211], v[56:59], v[180:183], a[208:211]
    v_mfma_f32_16x16x32_bf16 a[244:247], v[60:63], v[180:183], a[244:247]
    v_mfma_f32_16x16x32_bf16 a[32:35], v[32:35], v[184:187], a[32:35]
    v_mfma_f32_16x16x32_bf16 a[68:71], v[36:39], v[184:187], a[68:71]
    v_mfma_f32_16x16x32_bf16 a[104:107], v[40:43], v[184:187], a[104:107]
    v_mfma_f32_16x16x32_bf16 a[140:143], v[44:47], v[184:187], a[140:143]
    v_mfma_f32_16x16x32_bf16 v[204:207], v[48:51], v[184:187], v[204:207]
    v_mfma_f32_16x16x32_bf16 a[176:179], v[52:55], v[184:187], a[176:179]
    v_mfma_f32_16x16x32_bf16 a[212:215], v[56:59], v[184:187], a[212:215]
    v_mfma_f32_16x16x32_bf16 a[248:251], v[60:63], v[184:187], a[248:251]
    s_waitcnt lgkmcnt(0)
    s_waitcnt vmcnt(17)
    v_mfma_f32_16x16x32_bf16 a[0:3], v[0:3], v[80:83], a[0:3]
    s_mov_b32 s65, 0x20000
OP_c0:
    v_readfirstlane_b32 s62, v226
    s_and_b32 s62, s62, 0xffff
    s_cmp_ge_u32 s62, 16
    s_cbranch_scc0 OP_wait
OP_c1:
    v_mfma_f32_16x16x32_bf16 a[36:39], v[4:7], v[80:83], a[36:39]
    v_xor_b32 v252, 4096, v238
    v_mfma_f32_16x16x32_bf16 a[72:75], v[8:11], v[80:83], a[72:75]
    buffer_load_dwordx4 v[152:155], v252, s[28:31], s51 offen sc1
    v_mfma_f32_16x16x32_bf16 a[108:111], v[12:15], v[80:83], a[108:111]
    v_add_u32 v212, 0x10000, v212
    v_add_u32 v213, 0x10000, v213
    v_mfma_f32_16x16x32_bf16 v[64:67], v[16:19], v[80:83], v[64:67]
    v_add_u32 v214, 0x10000, v214
    v_add_u32 v215, 0x10000, v215
    v_mfma_f32_16x16x32_bf16 a[144:147], v[20:23], v[80:83], a[144:147]
    buffer_load_dwordx4 v[156:159], v252, s[28:31], s52 offen sc1
    v_mfma_f32_16x16x32_bf16 a[180:183], v[24:27], v[80:83], a[180:183]
    v_add_u32 v216, 0x10000, v216
    v_add_u32 v217, 0x10000, v217
    v_mfma_f32_16x16x32_bf16 a[216:219], v[28:31], v[80:83], a[216:219]
    v_add_u32 v218, 0x10000, v218
    v_add_u32 v219, 0x10000, v219
    v_mfma_f32_16x16x32_bf16 a[4:7], v[0:3], v[84:87], a[4:7]
    buffer_load_dwordx4 v[160:163], v252, s[28:31], s53 offen sc1
    v_mfma_f32_16x16x32_bf16 a[40:43], v[4:7], v[84:87], a[40:43]
    ds_read_b64_tr_b16 v[32:33], v212 offset:0
    ds_read_b64_tr_b16 v[34:35], v212 offset:4096
    v_mfma_f32_16x16x32_bf16 a[76:79], v[8:11], v[84:87], a[76:79]
    v_mfma_f32_16x16x32_bf16 a[112:115], v[12:15], v[84:87], a[112:115]
    buffer_load_dwordx4 v[164:167], v252, s[28:31], s54 offen sc1
    v_mfma_f32_16x16x32_bf16 v[68:71], v[16:19], v[84:87], v[68:71]
    ds_read_b64_tr_b16 v[36:37], v213 offset:0
    ds_read_b64_tr_b16 v[38:39], v213 offset:4096
    v_mfma_f32_16x16x32_bf16 a[148:151], v[20:23], v[84:87], a[148:151]
    v_mfma_f32_16x16x32_bf16 a[184:187], v[24:27], v[84:87], a[184:187]
    buffer_load_dwordx4 v[168:171], v252, s[28:31], s55 offen sc1
    v_mfma_f32_16x16x32_bf16 a[220:223], v[28:31], v[84:87], a[220:223]
    ds_read_b64_tr_b16 v[40:41], v214 offset:0
    ds_read_b64_tr_b16 v[42:43], v214 offset:4096
    v_mfma_f32_16x16x32_bf16 a[8:11], v[0:3], v[88:91], a[8:11]
    v_mfma_f32_16x16x32_bf16 a[44:47], v[4:7], v[88:91], a[44:47]
    buffer_load_dwordx4 v[172:175], v252, s[28:31], s56 offen sc1
    v_mfma_f32_16x16x32_bf16 a[80:83], v[8:11], v[88:91], a[80:83]
    ds_read_b64_tr_b16 v[44:45], v215 offset:0
    ds_read_b64_tr_b16 v[46:47], v215 offset:4096
    v_mfma_f32_16x16x32_bf16 a[116:119], v[12:15], v[88:91], a[116:119]
    v_mfma_f32_16x16x32_bf16 v[72:75], v[16:19], v[88:91], v[72:75]
    buffer_load_dwordx4 v[176:179], v252, s[28:31], s57 offen sc1
    v_mfma_f32_16x16x32_bf16 a[152:155], v[20:23], v[88:91], a[152:155]
    ds_read_b64_tr_b16 v[48:49], v216 offset:0
    ds_read_b64_tr_b16 v[50:51], v216 offset:4096
    v_mfma_f32_16x16x32_bf16 a[188:191], v[24:27], v[88:91], a[188:191]
    v_mfma_f32_16x16x32_bf16 a[224:227], v[28:31], v[88:91], a[224:227]
    buffer_load_dwordx4 v[180:183], v252, s[28:31], s58 offen sc1
    v_mfma_f32_16x16x32_bf16 a[12:15], v[0:3], v[92:95], a[12:15]
    ds_read_b64_tr_b16 v[52:53], v217 offset:0
    ds_read_b64_tr_b16 v[54:55], v217 offset:4096
    v_mfma_f32_16x16x32_bf16 a[48:51], v[4:7], v[92:95], a[48:51]
    v_mfma_f32_16x16x32_bf16 a[84:87], v[8:11], v[92:95], a[84:87]
    buffer_load_dwordx4 v[184:187], v252, s[28:31], s59 offen sc1
    v_mfma_f32_16x16x32_bf16 a[120:123], v[12:15], v[92:95], a[120:123]
    s_add_u32 m0, s81, 4096
    s_xor_b32 s87, s80, 180224
    ds_read_b64_tr_b16 v[56:57], v218 offset:0
    v_mfma_f32_16x16x32_bf16 v[76:79], v[16:19], v[92:95], v[76:79]
    ds_read_b64_tr_b16 v[58:59], v218 offset:4096
    v_mfma_f32_16x16x32_bf16 a[156:159], v[20:23], v[92:95], a[156:159]
    buffer_load_dwordx4 v221, s[32:35], s87 offen offset:0  lds
    v_mfma_f32_16x16x32_bf16 a[192:195], v[24:27], v[92:95], a[192:195]
    ds_read_b64_tr_b16 v[60:61], v219 offset:0
    ds_read_b64_tr_b16 v[62:63], v219 offset:4096
    v_mfma_f32_16x16x32_bf16 a[228:231], v[28:31], v[92:95], a[228:231]
    v_mfma_f32_16x16x32_bf16 a[16:19], v[0:3], v[96:99], a[16:19]
    buffer_load_dwordx4 v222, s[32:35], s87 offen offset:1024  lds
    v_mfma_f32_16x16x32_bf16 a[52:55], v[4:7], v[96:99], a[52:55]
    v_mfma_f32_16x16x32_bf16 a[88:91], v[8:11], v[96:99], a[88:91]
    v_mfma_f32_16x16x32_bf16 a[124:127], v[12:15], v[96:99], a[124:127]
    buffer_load_dwordx4 v223, s[32:35], s87 offen offset:2048  lds
    v_mfma_f32_16x16x32_bf16 v[188:191], v[16:19], v[96:99], v[188:191]
    v_mfma_f32_16x16x32_bf16 a[160:163], v[20:23], v[96:99], a[160:163]
    v_mfma_f32_16x16x32_bf16 a[196:199], v[24:27], v[96:99], a[196:199]
    buffer_load_dwordx4 v225, s[32:35], s87 offen offset:3072  lds
    v_mfma_f32_16x16x32_bf16 a[232:235], v[28:31], v[96:99], a[232:235]
    s_add_u32 m0, s81, 32768
    s_xor_b32 s87, s80, 196608
    v_mfma_f32_16x16x32_bf16 a[20:23], v[0:3], v[100:103], a[20:23]
    v_mfma_f32_16x16x32_bf16 a[56:59], v[4:7], v[100:103], a[56:59]
    buffer_load_dwordx4 v221, s[32:35], s87 offen offset:0  lds
    v_mfma_f32_16x16x32_bf16 a[92:95], v[8:11], v[100:103], a[92:95]
    v_mfma_f32_16x16x32_bf16 a[128:131], v[12:15], v[100:103], a[128:131]
    v_mfma_f32_16x16x32_bf16 v[192:195], v[16:19], v[100:103], v[192:195]
    buffer_load_dwordx4 v222, s[32:35], s87 offen offset:1024  lds
    v_mfma_f32_16x16x32_bf16 a[164:167], v[20:23], v[100:103], a[164:167]
    v_mfma_f32_16x16x32_bf16 a[200:203], v[24:27], v[100:103], a[200:203]
    v_mfma_f32_16x16x32_bf16 a[236:239], v[28:31], v[100:103], a[236:239]
    buffer_load_dwordx4 v223, s[32:35], s87 offen offset:2048  lds
    v_mfma_f32_16x16x32_bf16 a[24:27], v[0:3], v[104:107], a[24:27]
    v_mfma_f32_16x16x32_bf16 a[60:63], v[4:7], v[104:107], a[60:63]
    v_mfma_f32_16x16x32_bf16 a[96:99], v[8:11], v[104:107], a[96:99]
    buffer_load_dwordx4 v225, s[32:35], s87 offen offset:3072  lds
    v_mfma_f32_16x16x32_bf16 a[132:135], v[12:15], v[104:107], a[132:135]
    v_mfma_f32_16x16x32_bf16 v[196:199], v[16:19], v[104:107], v[196:199]
    v_mfma_f32_16x16x32_bf16 a[168:171], v[20:23], v[104:107], a[168:171]
    v_mfma_f32_16x16x32_bf16 a[204:207], v[24:27], v[104:107], a[204:207]
    v_mfma_f32_16x16x32_bf16 a[240:243], v[28:31], v[104:107], a[240:243]
    v_mfma_f32_16x16x32_bf16 a[28:31], v[0:3], v[108:111], a[28:31]
    v_mfma_f32_16x16x32_bf16 a[64:67], v[4:7], v[108:111], a[64:67]
    v_mfma_f32_16x16x32_bf16 a[100:103], v[8:11], v[108:111], a[100:103]
    v_mfma_f32_16x16x32_bf16 a[136:139], v[12:15], v[108:111], a[136:139]
    v_mfma_f32_16x16x32_bf16 v[200:203], v[16:19], v[108:111], v[200:203]
    v_mfma_f32_16x16x32_bf16 a[172:175], v[20:23], v[108:111], a[172:175]
    v_mfma_f32_16x16x32_bf16 a[208:211], v[24:27], v[108:111], a[208:211]
    v_mfma_f32_16x16x32_bf16 a[244:247], v[28:31], v[108:111], a[244:247]
    v_mfma_f32_16x16x32_bf16 a[32:35], v[0:3], v[112:115], a[32:35]
    v_mfma_f32_16x16x32_bf16 a[68:71], v[4:7], v[112:115], a[68:71]
    v_mfma_f32_16x16x32_bf16 a[104:107], v[8:11], v[112:115], a[104:107]
    v_mfma_f32_16x16x32_bf16 a[140:143], v[12:15], v[112:115], a[140:143]
    v_mfma_f32_16x16x32_bf16 v[204:207], v[16:19], v[112:115], v[204:207]
    v_mfma_f32_16x16x32_bf16 a[176:179], v[20:23], v[112:115], a[176:179]
    v_mfma_f32_16x16x32_bf16 a[212:215], v[24:27], v[112:115], a[212:215]
    v_mfma_f32_16x16x32_bf16 a[248:251], v[28:31], v[112:115], a[248:251]
    s_waitcnt lgkmcnt(0)
    s_waitcnt vmcnt(17)
    v_mfma_f32_16x16x32_bf16 a[0:3], v[32:35], v[116:119], a[0:3]
    v_mfma_f32_16x16x32_bf16 a[36:39], v[36:39], v[116:119], a[36:39]
    v_xor_b32 v253, 5120, v238
    v_mfma_f32_16x16x32_bf16 a[72:75], v[40:43], v[116:119], a[72:75]
    buffer_load_dwordx4 v[80:83], v253, s[28:31], s51 offen sc1
    v_mfma_f32_16x16x32_bf16 a[108:111], v[44:47], v[116:119], a[108:111]
    v_add_u32 v212, 0x10000, v212
    v_add_u32 v213, 0x10000, v213
    v_mfma_f32_16x16x32_bf16 v[64:67], v[48:51], v[116:119], v[64:67]
    v_add_u32 v214, 0x10000, v214
    v_add_u32 v215, 0x10000, v215
    v_mfma_f32_16x16x32_bf16 a[144:147], v[52:55], v[116:119], a[144:147]
    buffer_load_dwordx4 v[84:87], v253, s[28:31], s52 offen sc1
    v_mfma_f32_16x16x32_bf16 a[180:183], v[56:59], v[116:119], a[180:183]
    v_add_u32 v216, 0x10000, v216
    v_add_u32 v217, 0x10000, v217
    v_mfma_f32_16x16x32_bf16 a[216:219], v[60:63], v[116:119], a[216:219]
    v_add_u32 v218, 0x10000, v218
    v_add_u32 v219, 0x10000, v219
    v_mfma_f32_16x16x32_bf16 a[4:7], v[32:35], v[120:123], a[4:7]
    buffer_load_dwordx4 v[88:91], v253, s[28:31], s53 offen sc1
    v_mfma_f32_16x16x32_bf16 a[40:43], v[36:39], v[120:123], a[40:43]
    ds_read_b64_tr_b16 v[0:1], v212 offset:0
    ds_read_b64_tr_b16 v[2:3], v212 offset:4096
    v_mfma_f32_16x16x32_bf16 a[76:79], v[40:43], v[120:123], a[76:79]
    v_mfma_f32_16x16x32_bf16 a[112:115], v[44:47], v[120:123], a[112:115]
    buffer_load_dwordx4 v[92:95], v253, s[28:31], s54 offen sc1
    v_mfma_f32_16x16x32_bf16 v[68:71], v[48:51], v[120:123], v[68:71]
    ds_read_b64_tr_b16 v[4:5], v213 offset:0
    ds_read_b64_tr_b16 v[6:7], v213 offset:4096
    v_mfma_f32_16x16x32_bf16 a[148:151], v[52:55], v[120:123], a[148:151]
    v_mfma_f32_16x16x32_bf16 a[184:187], v[56:59], v[120:123], a[184:187]
    buffer_load_dwordx4 v[96:99], v253, s[28:31], s55 offen sc1
    v_mfma_f32_16x16x32_bf16 a[220:223], v[60:63], v[120:123], a[220:223]
    ds_read_b64_tr_b16 v[8:9], v214 offset:0
    ds_read_b64_tr_b16 v[10:11], v214 offset:4096
    v_mfma_f32_16x16x32_bf16 a[8:11], v[32:35], v[124:127], a[8:11]
    v_mfma_f32_16x16x32_bf16 a[44:47], v[36:39], v[124:127], a[44:47]
    buffer_load_dwordx4 v[100:103], v253, s[28:31], s56 offen sc1
    v_mfma_f32_16x16x32_bf16 a[80:83], v[40:43], v[124:127], a[80:83]
    ds_read_b64_tr_b16 v[12:13], v215 offset:0
    ds_read_b64_tr_b16 v[14:15], v215 offset:4096
    v_mfma_f32_16x16x32_bf16 a[116:119], v[44:47], v[124:127], a[116:119]
    v_mfma_f32_16x16x32_bf16 v[72:75], v[48:51], v[124:127], v[72:75]
    buffer_load_dwordx4 v[104:107], v253, s[28:31], s57 offen sc1
    v_mfma_f32_16x16x32_bf16 a[152:155], v[52:55], v[124:127], a[152:155]
    ds_read_b64_tr_b16 v[16:17], v216 offset:0
    ds_read_b64_tr_b16 v[18:19], v216 offset:4096
    v_mfma_f32_16x16x32_bf16 a[188:191], v[56:59], v[124:127], a[188:191]
    v_mfma_f32_16x16x32_bf16 a[224:227], v[60:63], v[124:127], a[224:227]
    buffer_load_dwordx4 v[108:111], v253, s[28:31], s58 offen sc1
    v_mfma_f32_16x16x32_bf16 a[12:15], v[32:35], v[128:131], a[12:15]
    ds_read_b64_tr_b16 v[20:21], v217 offset:0
    ds_read_b64_tr_b16 v[22:23], v217 offset:4096
    v_mfma_f32_16x16x32_bf16 a[48:51], v[36:39], v[128:131], a[48:51]
    v_mfma_f32_16x16x32_bf16 a[84:87], v[40:43], v[128:131], a[84:87]
    buffer_load_dwordx4 v[112:115], v253, s[28:31], s59 offen sc1
    v_mfma_f32_16x16x32_bf16 a[120:123], v[44:47], v[128:131], a[120:123]
    s_add_u32 m0, s81, 36864
    s_xor_b32 s87, s80, 212992
    ds_read_b64_tr_b16 v[24:25], v218 offset:0
    v_mfma_f32_16x16x32_bf16 v[76:79], v[48:51], v[128:131], v[76:79]
    ds_read_b64_tr_b16 v[26:27], v218 offset:4096
    v_mfma_f32_16x16x32_bf16 a[156:159], v[52:55], v[128:131], a[156:159]
    buffer_load_dwordx4 v221, s[32:35], s87 offen offset:0  lds
    v_mfma_f32_16x16x32_bf16 a[192:195], v[56:59], v[128:131], a[192:195]
    ds_read_b64_tr_b16 v[28:29], v219 offset:0
    ds_read_b64_tr_b16 v[30:31], v219 offset:4096
    v_mfma_f32_16x16x32_bf16 a[228:231], v[60:63], v[128:131], a[228:231]
    v_mfma_f32_16x16x32_bf16 a[16:19], v[32:35], v[132:135], a[16:19]
    buffer_load_dwordx4 v222, s[32:35], s87 offen offset:1024  lds
    v_mfma_f32_16x16x32_bf16 a[52:55], v[36:39], v[132:135], a[52:55]
    v_mfma_f32_16x16x32_bf16 a[88:91], v[40:43], v[132:135], a[88:91]
    v_mfma_f32_16x16x32_bf16 a[124:127], v[44:47], v[132:135], a[124:127]
    buffer_load_dwordx4 v223, s[32:35], s87 offen offset:2048  lds
    v_mfma_f32_16x16x32_bf16 v[188:191], v[48:51], v[132:135], v[188:191]
    v_mfma_f32_16x16x32_bf16 a[160:163], v[52:55], v[132:135], a[160:163]
    v_mfma_f32_16x16x32_bf16 a[196:199], v[56:59], v[132:135], a[196:199]
    buffer_load_dwordx4 v225, s[32:35], s87 offen offset:3072  lds
    v_mfma_f32_16x16x32_bf16 a[232:235], v[60:63], v[132:135], a[232:235]
    s_add_u32 m0, s81, 65536
    s_xor_b32 s87, s80, 229376
    v_mfma_f32_16x16x32_bf16 a[20:23], v[32:35], v[136:139], a[20:23]
    v_mfma_f32_16x16x32_bf16 a[56:59], v[36:39], v[136:139], a[56:59]
    buffer_load_dwordx4 v221, s[32:35], s87 offen offset:0  lds
    v_mfma_f32_16x16x32_bf16 a[92:95], v[40:43], v[136:139], a[92:95]
    v_mfma_f32_16x16x32_bf16 a[128:131], v[44:47], v[136:139], a[128:131]
    v_mfma_f32_16x16x32_bf16 v[192:195], v[48:51], v[136:139], v[192:195]
    buffer_load_dwordx4 v222, s[32:35], s87 offen offset:1024  lds
    v_mfma_f32_16x16x32_bf16 a[164:167], v[52:55], v[136:139], a[164:167]
    v_mfma_f32_16x16x32_bf16 a[200:203], v[56:59], v[136:139], a[200:203]
    v_mfma_f32_16x16x32_bf16 a[236:239], v[60:63], v[136:139], a[236:239]
    buffer_load_dwordx4 v223, s[32:35], s87 offen offset:2048  lds
    v_mfma_f32_16x16x32_bf16 a[24:27], v[32:35], v[140:143], a[24:27]
    v_mfma_f32_16x16x32_bf16 a[60:63], v[36:39], v[140:143], a[60:63]
    v_mfma_f32_16x16x32_bf16 a[96:99], v[40:43], v[140:143], a[96:99]
    buffer_load_dwordx4 v225, s[32:35], s87 offen offset:3072  lds
    v_mfma_f32_16x16x32_bf16 a[132:135], v[44:47], v[140:143], a[132:135]
    v_mfma_f32_16x16x32_bf16 v[196:199], v[48:51], v[140:143], v[196:199]
    v_mfma_f32_16x16x32_bf16 a[168:171], v[52:55], v[140:143], a[168:171]
    v_mfma_f32_16x16x32_bf16 a[204:207], v[56:59], v[140:143], a[204:207]
    v_mfma_f32_16x16x32_bf16 a[240:243], v[60:63], v[140:143], a[240:243]
    v_mfma_f32_16x16x32_bf16 a[28:31], v[32:35], v[144:147], a[28:31]
    v_mfma_f32_16x16x32_bf16 a[64:67], v[36:39], v[144:147], a[64:67]
    v_mfma_f32_16x16x32_bf16 a[100:103], v[40:43], v[144:147], a[100:103]
    v_mfma_f32_16x16x32_bf16 a[136:139], v[44:47], v[144:147], a[136:139]
    v_mfma_f32_16x16x32_bf16 v[200:203], v[48:51], v[144:147], v[200:203]
    v_mfma_f32_16x16x32_bf16 a[172:175], v[52:55], v[144:147], a[172:175]
    v_mfma_f32_16x16x32_bf16 a[208:211], v[56:59], v[144:147], a[208:211]
    v_mfma_f32_16x16x32_bf16 a[244:247], v[60:63], v[144:147], a[244:247]
    v_mfma_f32_16x16x32_bf16 a[32:35], v[32:35], v[148:151], a[32:35]
    v_mfma_f32_16x16x32_bf16 a[68:71], v[36:39], v[148:151], a[68:71]
    v_mfma_f32_16x16x32_bf16 a[104:107], v[40:43], v[148:151], a[104:107]
    v_mfma_f32_16x16x32_bf16 a[140:143], v[44:47], v[148:151], a[140:143]
    v_mfma_f32_16x16x32_bf16 v[204:207], v[48:51], v[148:151], v[204:207]
    v_mfma_f32_16x16x32_bf16 a[176:179], v[52:55], v[148:151], a[176:179]
    v_mfma_f32_16x16x32_bf16 a[212:215], v[56:59], v[148:151], a[212:215]
    v_mfma_f32_16x16x32_bf16 a[248:251], v[60:63], v[148:151], a[248:251]
    s_waitcnt lgkmcnt(0)
    s_waitcnt vmcnt(17)
    v_mfma_f32_16x16x32_bf16 a[0:3], v[0:3], v[152:155], a[0:3]
    v_mfma_f32_16x16x32_bf16 a[36:39], v[4:7], v[152:155], a[36:39]
    v_xor_b32 v252, 6144, v238
    v_mfma_f32_16x16x32_bf16 a[72:75], v[8:11], v[152:155], a[72:75]
    buffer_load_dwordx4 v[116:119], v252, s[28:31], s51 offen sc1
    v_mfma_f32_16x16x32_bf16 a[108:111], v[12:15], v[152:155], a[108:111]
    v_add_u32 v212, 0xfffe0000, v212
    v_add_u32 v213, 0xfffe0000, v213
    v_mfma_f32_16x16x32_bf16 v[64:67], v[16:19], v[152:155], v[64:67]
    v_add_u32 v214, 0xfffe0000, v214
    v_add_u32 v215, 0xfffe0000, v215
    v_mfma_f32_16x16x32_bf16 a[144:147], v[20:23], v[152:155], a[144:147]
    buffer_load_dwordx4 v[120:123], v252, s[28:31], s52 offen sc1
    v_mfma_f32_16x16x32_bf16 a[180:183], v[24:27], v[152:155], a[180:183]
    v_add_u32 v216, 0xfffe0000, v216
    v_add_u32 v217, 0xfffe0000, v217
    v_mfma_f32_16x16x32_bf16 a[216:219], v[28:31], v[152:155], a[216:219]
    v_add_u32 v218, 0xfffe0000, v218
    v_add_u32 v219, 0xfffe0000, v219
    v_mfma_f32_16x16x32_bf16 a[4:7], v[0:3], v[156:159], a[4:7]
    buffer_load_dwordx4 v[124:127], v252, s[28:31], s53 offen sc1
    v_mfma_f32_16x16x32_bf16 a[40:43], v[4:7], v[156:159], a[40:43]
    ds_read_b64_tr_b16 v[32:33], v212 offset:0
    ds_read_b64_tr_b16 v[34:35], v212 offset:4096
    v_mfma_f32_16x16x32_bf16 a[76:79], v[8:11], v[156:159], a[76:79]
    v_mfma_f32_16x16x32_bf16 a[112:115], v[12:15], v[156:159], a[112:115]
    buffer_load_dwordx4 v[128:131], v252, s[28:31], s54 offen sc1
    v_mfma_f32_16x16x32_bf16 v[68:71], v[16:19], v[156:159], v[68:71]
    ds_read_b64_tr_b16 v[36:37], v213 offset:0
    ds_read_b64_tr_b16 v[38:39], v213 offset:4096
    v_mfma_f32_16x16x32_bf16 a[148:151], v[20:23], v[156:159], a[148:151]
    v_mfma_f32_16x16x32_bf16 a[184:187], v[24:27], v[156:159], a[184:187]
    buffer_load_dwordx4 v[132:135], v252, s[28:31], s55 offen sc1
    v_mfma_f32_16x16x32_bf16 a[220:223], v[28:31], v[156:159], a[220:223]
    ds_read_b64_tr_b16 v[40:41], v214 offset:0
    ds_read_b64_tr_b16 v[42:43], v214 offset:4096
    v_mfma_f32_16x16x32_bf16 a[8:11], v[0:3], v[160:163], a[8:11]
    v_mfma_f32_16x16x32_bf16 a[44:47], v[4:7], v[160:163], a[44:47]
    buffer_load_dwordx4 v[136:139], v252, s[28:31], s56 offen sc1
    v_mfma_f32_16x16x32_bf16 a[80:83], v[8:11], v[160:163], a[80:83]
    ds_read_b64_tr_b16 v[44:45], v215 offset:0
    ds_read_b64_tr_b16 v[46:47], v215 offset:4096
    v_mfma_f32_16x16x32_bf16 a[116:119], v[12:15], v[160:163], a[116:119]
    v_mfma_f32_16x16x32_bf16 v[72:75], v[16:19], v[160:163], v[72:75]
    buffer_load_dwordx4 v[140:143], v252, s[28:31], s57 offen sc1
    v_mfma_f32_16x16x32_bf16 a[152:155], v[20:23], v[160:163], a[152:155]
    ds_read_b64_tr_b16 v[48:49], v216 offset:0
    ds_read_b64_tr_b16 v[50:51], v216 offset:4096
    v_mfma_f32_16x16x32_bf16 a[188:191], v[24:27], v[160:163], a[188:191]
    v_mfma_f32_16x16x32_bf16 a[224:227], v[28:31], v[160:163], a[224:227]
    buffer_load_dwordx4 v[144:147], v252, s[28:31], s58 offen sc1
    v_mfma_f32_16x16x32_bf16 a[12:15], v[0:3], v[164:167], a[12:15]
    ds_read_b64_tr_b16 v[52:53], v217 offset:0
    ds_read_b64_tr_b16 v[54:55], v217 offset:4096
    v_mfma_f32_16x16x32_bf16 a[48:51], v[4:7], v[164:167], a[48:51]
    v_mfma_f32_16x16x32_bf16 a[84:87], v[8:11], v[164:167], a[84:87]
    buffer_load_dwordx4 v[148:151], v252, s[28:31], s59 offen sc1
    v_mfma_f32_16x16x32_bf16 a[120:123], v[12:15], v[164:167], a[120:123]
    s_add_u32 m0, s81, 69632
    s_xor_b32 s87, s80, 245760
    ds_read_b64_tr_b16 v[56:57], v218 offset:0
    v_mfma_f32_16x16x32_bf16 v[76:79], v[16:19], v[164:167], v[76:79]
    ds_read_b64_tr_b16 v[58:59], v218 offset:4096
    v_mfma_f32_16x16x32_bf16 a[156:159], v[20:23], v[164:167], a[156:159]
    buffer_load_dwordx4 v221, s[32:35], s87 offen offset:0  lds
    v_mfma_f32_16x16x32_bf16 a[192:195], v[24:27], v[164:167], a[192:195]
    ds_read_b64_tr_b16 v[60:61], v219 offset:0
    ds_read_b64_tr_b16 v[62:63], v219 offset:4096
    v_mfma_f32_16x16x32_bf16 a[228:231], v[28:31], v[164:167], a[228:231]
    v_mfma_f32_16x16x32_bf16 a[16:19], v[0:3], v[168:171], a[16:19]
    buffer_load_dwordx4 v222, s[32:35], s87 offen offset:1024  lds
    v_mfma_f32_16x16x32_bf16 a[52:55], v[4:7], v[168:171], a[52:55]
    v_mfma_f32_16x16x32_bf16 a[88:91], v[8:11], v[168:171], a[88:91]
    v_mfma_f32_16x16x32_bf16 a[124:127], v[12:15], v[168:171], a[124:127]
    buffer_load_dwordx4 v223, s[32:35], s87 offen offset:2048  lds
    v_mfma_f32_16x16x32_bf16 v[188:191], v[16:19], v[168:171], v[188:191]
    v_mfma_f32_16x16x32_bf16 a[160:163], v[20:23], v[168:171], a[160:163]
    v_mfma_f32_16x16x32_bf16 a[196:199], v[24:27], v[168:171], a[196:199]
    buffer_load_dwordx4 v225, s[32:35], s87 offen offset:3072  lds
    v_mfma_f32_16x16x32_bf16 a[232:235], v[28:31], v[168:171], a[232:235]
    s_add_u32 m0, s81, 131072
    s_xor_b32 s87, s80, 393216
    v_mfma_f32_16x16x32_bf16 a[20:23], v[0:3], v[172:175], a[20:23]
    v_mfma_f32_16x16x32_bf16 a[56:59], v[4:7], v[172:175], a[56:59]
    buffer_load_dwordx4 v221, s[32:35], s87 offen offset:0  lds
    v_mfma_f32_16x16x32_bf16 a[92:95], v[8:11], v[172:175], a[92:95]
    v_mfma_f32_16x16x32_bf16 a[128:131], v[12:15], v[172:175], a[128:131]
    v_mfma_f32_16x16x32_bf16 v[192:195], v[16:19], v[172:175], v[192:195]
    buffer_load_dwordx4 v222, s[32:35], s87 offen offset:1024  lds
    v_mfma_f32_16x16x32_bf16 a[164:167], v[20:23], v[172:175], a[164:167]
    v_mfma_f32_16x16x32_bf16 a[200:203], v[24:27], v[172:175], a[200:203]
    v_mfma_f32_16x16x32_bf16 a[236:239], v[28:31], v[172:175], a[236:239]
    buffer_load_dwordx4 v223, s[32:35], s87 offen offset:2048  lds
    v_mfma_f32_16x16x32_bf16 a[24:27], v[0:3], v[176:179], a[24:27]
    v_mfma_f32_16x16x32_bf16 a[60:63], v[4:7], v[176:179], a[60:63]
    v_mfma_f32_16x16x32_bf16 a[96:99], v[8:11], v[176:179], a[96:99]
    buffer_load_dwordx4 v225, s[32:35], s87 offen offset:3072  lds
    v_mfma_f32_16x16x32_bf16 a[132:135], v[12:15], v[176:179], a[132:135]
    v_mfma_f32_16x16x32_bf16 v[196:199], v[16:19], v[176:179], v[196:199]
    v_mfma_f32_16x16x32_bf16 a[168:171], v[20:23], v[176:179], a[168:171]
    v_mfma_f32_16x16x32_bf16 a[204:207], v[24:27], v[176:179], a[204:207]
    v_mfma_f32_16x16x32_bf16 a[240:243], v[28:31], v[176:179], a[240:243]
    v_mfma_f32_16x16x32_bf16 a[28:31], v[0:3], v[180:183], a[28:31]
    v_mfma_f32_16x16x32_bf16 a[64:67], v[4:7], v[180:183], a[64:67]
    v_mfma_f32_16x16x32_bf16 a[100:103], v[8:11], v[180:183], a[100:103]
    v_mfma_f32_16x16x32_bf16 a[136:139], v[12:15], v[180:183], a[136:139]
    v_mfma_f32_16x16x32_bf16 v[200:203], v[16:19], v[180:183], v[200:203]
    v_mfma_f32_16x16x32_bf16 a[172:175], v[20:23], v[180:183], a[172:175]
    v_mfma_f32_16x16x32_bf16 a[208:211], v[24:27], v[180:183], a[208:211]
    v_mfma_f32_16x16x32_bf16 a[244:247], v[28:31], v[180:183], a[244:247]
    v_mfma_f32_16x16x32_bf16 a[32:35], v[0:3], v[184:187], a[32:35]
    v_mfma_f32_16x16x32_bf16 a[68:71], v[4:7], v[184:187], a[68:71]
    v_mfma_f32_16x16x32_bf16 a[104:107], v[8:11], v[184:187], a[104:107]
    v_mfma_f32_16x16x32_bf16 a[140:143], v[12:15], v[184:187], a[140:143]
    v_mfma_f32_16x16x32_bf16 v[204:207], v[16:19], v[184:187], v[204:207]
    v_mfma_f32_16x16x32_bf16 a[176:179], v[20:23], v[184:187], a[176:179]
    v_mfma_f32_16x16x32_bf16 a[212:215], v[24:27], v[184:187], a[212:215]
    v_mfma_f32_16x16x32_bf16 a[248:251], v[28:31], v[184:187], a[248:251]
    s_waitcnt lgkmcnt(0)
    s_waitcnt vmcnt(17)
    v_mfma_f32_16x16x32_bf16 a[0:3], v[32:35], v[80:83], a[0:3]
    v_mfma_f32_16x16x32_bf16 a[36:39], v[36:39], v[80:83], a[36:39]
    v_xor_b32 v253, 7168, v238
    v_mfma_f32_16x16x32_bf16 a[72:75], v[40:43], v[80:83], a[72:75]
    buffer_load_dwordx4 v[152:155], v253, s[28:31], s51 offen sc1
    v_mfma_f32_16x16x32_bf16 a[108:111], v[44:47], v[80:83], a[108:111]
    v_mfma_f32_16x16x32_bf16 v[64:67], v[48:51], v[80:83], v[64:67]
    v_mfma_f32_16x16x32_bf16 a[144:147], v[52:55], v[80:83], a[144:147]
    buffer_load_dwordx4 v[156:159], v253, s[28:31], s52 offen sc1
    v_mfma_f32_16x16x32_bf16 a[180:183], v[56:59], v[80:83], a[180:183]
    v_mfma_f32_16x16x32_bf16 a[216:219], v[60:63], v[80:83], a[216:219]
    v_mfma_f32_16x16x32_bf16 a[4:7], v[32:35], v[84:87], a[4:7]
    buffer_load_dwordx4 v[160:163], v253, s[28:31], s53 offen sc1
    v_mfma_f32_16x16x32_bf16 a[40:43], v[36:39], v[84:87], a[40:43]
    ds_read_b64_tr_b16 v[0:1], v212 offset:32768
    ds_read_b64_tr_b16 v[2:3], v212 offset:36864
    v_mfma_f32_16x16x32_bf16 a[76:79], v[40:43], v[84:87], a[76:79]
    v_mfma_f32_16x16x32_bf16 a[112:115], v[44:47], v[84:87], a[112:115]
    buffer_load_dwordx4 v[164:167], v253, s[28:31], s54 offen sc1
    v_mfma_f32_16x16x32_bf16 v[68:71], v[48:51], v[84:87], v[68:71]
    ds_read_b64_tr_b16 v[4:5], v213 offset:32768
    ds_read_b64_tr_b16 v[6:7], v213 offset:36864
    v_mfma_f32_16x16x32_bf16 a[148:151], v[52:55], v[84:87], a[148:151]
    v_mfma_f32_16x16x32_bf16 a[184:187], v[56:59], v[84:87], a[184:187]
    buffer_load_dwordx4 v[168:171], v253, s[28:31], s55 offen sc1
    v_mfma_f32_16x16x32_bf16 a[220:223], v[60:63], v[84:87], a[220:223]
    ds_read_b64_tr_b16 v[8:9], v214 offset:32768
    ds_read_b64_tr_b16 v[10:11], v214 offset:36864
    v_mfma_f32_16x16x32_bf16 a[8:11], v[32:35], v[88:91], a[8:11]
    v_mfma_f32_16x16x32_bf16 a[44:47], v[36:39], v[88:91], a[44:47]
    buffer_load_dwordx4 v[172:175], v253, s[28:31], s56 offen sc1
    v_mfma_f32_16x16x32_bf16 a[80:83], v[40:43], v[88:91], a[80:83]
    ds_read_b64_tr_b16 v[12:13], v215 offset:32768
    ds_read_b64_tr_b16 v[14:15], v215 offset:36864
    v_mfma_f32_16x16x32_bf16 a[116:119], v[44:47], v[88:91], a[116:119]
    v_mfma_f32_16x16x32_bf16 v[72:75], v[48:51], v[88:91], v[72:75]
    buffer_load_dwordx4 v[176:179], v253, s[28:31], s57 offen sc1
    v_mfma_f32_16x16x32_bf16 a[152:155], v[52:55], v[88:91], a[152:155]
    ds_read_b64_tr_b16 v[16:17], v216 offset:32768
    ds_read_b64_tr_b16 v[18:19], v216 offset:36864
    v_mfma_f32_16x16x32_bf16 a[188:191], v[56:59], v[88:91], a[188:191]
    v_mfma_f32_16x16x32_bf16 a[224:227], v[60:63], v[88:91], a[224:227]
    buffer_load_dwordx4 v[180:183], v253, s[28:31], s58 offen sc1
    v_mfma_f32_16x16x32_bf16 a[12:15], v[32:35], v[92:95], a[12:15]
    ds_read_b64_tr_b16 v[20:21], v217 offset:32768
    ds_read_b64_tr_b16 v[22:23], v217 offset:36864
    v_mfma_f32_16x16x32_bf16 a[48:51], v[36:39], v[92:95], a[48:51]
    v_mfma_f32_16x16x32_bf16 a[84:87], v[40:43], v[92:95], a[84:87]
    buffer_load_dwordx4 v[184:187], v253, s[28:31], s59 offen sc1
    v_mfma_f32_16x16x32_bf16 a[120:123], v[44:47], v[92:95], a[120:123]
    s_add_u32 m0, s81, 135168
    s_xor_b32 s87, s80, 409600
    ds_read_b64_tr_b16 v[24:25], v218 offset:32768
    v_mfma_f32_16x16x32_bf16 v[76:79], v[48:51], v[92:95], v[76:79]
    ds_read_b64_tr_b16 v[26:27], v218 offset:36864
    v_mfma_f32_16x16x32_bf16 a[156:159], v[52:55], v[92:95], a[156:159]
    buffer_load_dwordx4 v221, s[32:35], s87 offen offset:0  lds
    v_mfma_f32_16x16x32_bf16 a[192:195], v[56:59], v[92:95], a[192:195]
    ds_read_b64_tr_b16 v[28:29], v219 offset:32768
    ds_read_b64_tr_b16 v[30:31], v219 offset:36864
    v_mfma_f32_16x16x32_bf16 a[228:231], v[60:63], v[92:95], a[228:231]
    v_and_b32 v248, 15, v232
    v_lshrrev_b32 v249, 5, v232
    v_mfma_f32_16x16x32_bf16 a[16:19], v[32:35], v[96:99], a[16:19]
    buffer_load_dwordx4 v222, s[32:35], s87 offen offset:1024  lds
    v_mfma_f32_16x16x32_bf16 a[52:55], v[36:39], v[96:99], a[52:55]
    s_lshl_b32 s60, s36, 1
    v_or_b32 v249, s60, v249
    v_mfma_f32_16x16x32_bf16 a[88:91], v[40:43], v[96:99], a[88:91]
    v_and_b32 v250, 7, v232
    v_xor_b32 v249, v249, v250
    v_mfma_f32_16x16x32_bf16 a[124:127], v[44:47], v[96:99], a[124:127]
    buffer_load_dwordx4 v223, s[32:35], s87 offen offset:2048  lds
    v_mfma_f32_16x16x32_bf16 v[188:191], v[48:51], v[96:99], v[188:191]
    v_lshlrev_b32 v249, 4, v249
    v_lshl_add_u32 v249, v248, 7, v249
    v_mfma_f32_16x16x32_bf16 a[160:163], v[52:55], v[96:99], a[160:163]
    v_bfe_u32 v250, v232, 4, 1
    v_lshl_add_u32 v249, v250, 3, v249
    v_mfma_f32_16x16x32_bf16 a[196:199], v[56:59], v[96:99], a[196:199]
    buffer_load_dwordx4 v225, s[32:35], s87 offen offset:3072  lds
    v_mfma_f32_16x16x32_bf16 a[232:235], v[60:63], v[96:99], a[232:235]
    s_add_u32 m0, s81, 0
    s_xor_b32 s87, s80, 425984
    v_add_u32 v208, 114688, v249
    v_mfma_f32_16x16x32_bf16 a[20:23], v[32:35], v[100:103], a[20:23]
    s_mul_i32 s60, s36, 27648
    v_add_u32 v240, s60, v233
    v_mfma_f32_16x16x32_bf16 a[56:59], v[36:39], v[100:103], a[56:59]
    buffer_load_dwordx4 v221, s[32:35], s87 offen offset:0  lds
    v_mfma_f32_16x16x32_bf16 a[92:95], v[40:43], v[100:103], a[92:95]
    s_xor_b32 s60, s36, 1
    s_mul_i32 s60, s60, 27648
    s_add_u32 s60, s60, 0
    v_add_u32 v241, s60, v233
    v_mfma_f32_16x16x32_bf16 a[128:131], v[44:47], v[100:103], a[128:131]
    s_xor_b32 s60, s36, 2
    s_mul_i32 s60, s60, 27648
    s_add_u32 s60, s60, 9216
    v_add_u32 v242, s60, v233
    v_mfma_f32_16x16x32_bf16 v[192:195], v[48:51], v[100:103], v[192:195]
    buffer_load_dwordx4 v222, s[32:35], s87 offen offset:1024  lds
    v_mfma_f32_16x16x32_bf16 a[164:167], v[52:55], v[100:103], a[164:167]
    s_xor_b32 s60, s36, 3
    s_mul_i32 s60, s60, 27648
    s_add_u32 s60, s60, 18432
    v_add_u32 v243, s60, v233
    v_mfma_f32_16x16x32_bf16 a[200:203], v[56:59], v[100:103], a[200:203]
    s_and_b32 s68, s78, 7
    s_mul_i32 s68, s68, 589824
    s_bfe_u32 s61, s50, 0x10003
    v_mfma_f32_16x16x32_bf16 a[236:239], v[60:63], v[100:103], a[236:239]
    buffer_load_dwordx4 v223, s[32:35], s87 offen offset:2048  lds
    v_mfma_f32_16x16x32_bf16 a[24:27], v[32:35], v[104:107], a[24:27]
    s_mul_i32 s61, s61, 294912
    s_add_u32 s68, s68, s61
    s_lshr_b32 s61, s78, 3
    v_mfma_f32_16x16x32_bf16 a[60:63], v[36:39], v[104:107], a[60:63]
    s_lshl_b32 s61, s61, 10
    s_add_u32 s68, s68, s61
    s_and_b32 s61, s50, 7
    v_mfma_f32_16x16x32_bf16 a[96:99], v[40:43], v[104:107], a[96:99]
    buffer_load_dwordx4 v225, s[32:35], s87 offen offset:3072  lds
    v_mfma_f32_16x16x32_bf16 a[132:135], v[44:47], v[104:107], a[132:135]
    s_lshl_b32 s61, s61, 7
    s_add_u32 s68, s68, s61
    v_mfma_f32_16x16x32_bf16 v[196:199], v[48:51], v[104:107], v[196:199]
    v_mfma_f32_16x16x32_bf16 a[168:171], v[52:55], v[104:107], a[168:171]
    v_mfma_f32_16x16x32_bf16 a[204:207], v[56:59], v[104:107], a[204:207]
    v_mfma_f32_16x16x32_bf16 a[240:243], v[60:63], v[104:107], a[240:243]
    v_mfma_f32_16x16x32_bf16 a[28:31], v[32:35], v[108:111], a[28:31]
    v_mfma_f32_16x16x32_bf16 a[64:67], v[36:39], v[108:111], a[64:67]
    v_mfma_f32_16x16x32_bf16 a[100:103], v[40:43], v[108:111], a[100:103]
    v_mfma_f32_16x16x32_bf16 a[136:139], v[44:47], v[108:111], a[136:139]
    v_mfma_f32_16x16x32_bf16 v[200:203], v[48:51], v[108:111], v[200:203]
    v_mfma_f32_16x16x32_bf16 a[172:175], v[52:55], v[108:111], a[172:175]
    v_mfma_f32_16x16x32_bf16 a[208:211], v[56:59], v[108:111], a[208:211]
    v_mfma_f32_16x16x32_bf16 a[244:247], v[60:63], v[108:111], a[244:247]
    v_mfma_f32_16x16x32_bf16 a[32:35], v[32:35], v[112:115], a[32:35]
    v_mfma_f32_16x16x32_bf16 a[68:71], v[36:39], v[112:115], a[68:71]
    v_mfma_f32_16x16x32_bf16 a[104:107], v[40:43], v[112:115], a[104:107]
    v_mfma_f32_16x16x32_bf16 a[140:143], v[44:47], v[112:115], a[140:143]
    v_mfma_f32_16x16x32_bf16 v[204:207], v[48:51], v[112:115], v[204:207]
    v_mfma_f32_16x16x32_bf16 a[176:179], v[52:55], v[112:115], a[176:179]
    v_mfma_f32_16x16x32_bf16 a[212:215], v[56:59], v[112:115], a[212:215]
    v_mfma_f32_16x16x32_bf16 a[248:251], v[60:63], v[112:115], a[248:251]
    s_waitcnt lgkmcnt(0)
    s_waitcnt vmcnt(17)
    v_mfma_f32_16x16x32_bf16 a[0:3], v[0:3], v[116:119], a[0:3]
    v_mfma_f32_16x16x32_bf16 a[36:39], v[4:7], v[116:119], a[36:39]
    v_xor_b32 v252, 12288, v238
    v_mfma_f32_16x16x32_bf16 a[72:75], v[8:11], v[116:119], a[72:75]
    buffer_load_dwordx4 v[80:83], v252, s[28:31], s51 offen sc1
    v_mfma_f32_16x16x32_bf16 a[108:111], v[12:15], v[116:119], a[108:111]
    v_add_u32 v212, 0x10000, v212
    v_add_u32 v213, 0x10000, v213
    v_mfma_f32_16x16x32_bf16 v[64:67], v[16:19], v[116:119], v[64:67]
    v_add_u32 v214, 0x10000, v214
    v_add_u32 v215, 0x10000, v215
    v_mfma_f32_16x16x32_bf16 a[144:147], v[20:23], v[116:119], a[144:147]
    buffer_load_dwordx4 v[84:87], v252, s[28:31], s52 offen sc1
    v_mfma_f32_16x16x32_bf16 a[180:183], v[24:27], v[116:119], a[180:183]
    v_add_u32 v216, 0x10000, v216
    v_add_u32 v217, 0x10000, v217
    v_mfma_f32_16x16x32_bf16 a[216:219], v[28:31], v[116:119], a[216:219]
    v_add_u32 v218, 0x10000, v218
    v_add_u32 v219, 0x10000, v219
    v_mfma_f32_16x16x32_bf16 a[4:7], v[0:3], v[120:123], a[4:7]
    buffer_load_dwordx4 v[88:91], v252, s[28:31], s53 offen sc1
    v_mfma_f32_16x16x32_bf16 a[40:43], v[4:7], v[120:123], a[40:43]
    ds_read_b64_tr_b16 v[32:33], v212 offset:0
    ds_read_b64_tr_b16 v[34:35], v212 offset:4096
    v_mfma_f32_16x16x32_bf16 a[76:79], v[8:11], v[120:123], a[76:79]
    v_mfma_f32_16x16x32_bf16 a[112:115], v[12:15], v[120:123], a[112:115]
    buffer_load_dwordx4 v[92:95], v252, s[28:31], s54 offen sc1
    v_mfma_f32_16x16x32_bf16 v[68:71], v[16:19], v[120:123], v[68:71]
    ds_read_b64_tr_b16 v[36:37], v213 offset:0
    ds_read_b64_tr_b16 v[38:39], v213 offset:4096
    v_mfma_f32_16x16x32_bf16 a[148:151], v[20:23], v[120:123], a[148:151]
    v_mfma_f32_16x16x32_bf16 a[184:187], v[24:27], v[120:123], a[184:187]
    buffer_load_dwordx4 v[96:99], v252, s[28:31], s55 offen sc1
    v_mfma_f32_16x16x32_bf16 a[220:223], v[28:31], v[120:123], a[220:223]
    ds_read_b64_tr_b16 v[40:41], v214 offset:0
    ds_read_b64_tr_b16 v[42:43], v214 offset:4096
    v_mfma_f32_16x16x32_bf16 a[8:11], v[0:3], v[124:127], a[8:11]
    v_mfma_f32_16x16x32_bf16 a[44:47], v[4:7], v[124:127], a[44:47]
    buffer_load_dwordx4 v[100:103], v252, s[28:31], s56 offen sc1
    v_mfma_f32_16x16x32_bf16 a[80:83], v[8:11], v[124:127], a[80:83]
    ds_read_b64_tr_b16 v[44:45], v215 offset:0
    ds_read_b64_tr_b16 v[46:47], v215 offset:4096
    v_mfma_f32_16x16x32_bf16 a[116:119], v[12:15], v[124:127], a[116:119]
    v_mfma_f32_16x16x32_bf16 v[72:75], v[16:19], v[124:127], v[72:75]
    buffer_load_dwordx4 v[104:107], v252, s[28:31], s57 offen sc1
    v_mfma_f32_16x16x32_bf16 a[152:155], v[20:23], v[124:127], a[152:155]
    ds_read_b64_tr_b16 v[48:49], v216 offset:0
    ds_read_b64_tr_b16 v[50:51], v216 offset:4096
    v_mfma_f32_16x16x32_bf16 a[188:191], v[24:27], v[124:127], a[188:191]
    v_mfma_f32_16x16x32_bf16 a[224:227], v[28:31], v[124:127], a[224:227]
    buffer_load_dwordx4 v[108:111], v252, s[28:31], s58 offen sc1
    v_mfma_f32_16x16x32_bf16 a[12:15], v[0:3], v[128:131], a[12:15]
    ds_read_b64_tr_b16 v[52:53], v217 offset:0
    ds_read_b64_tr_b16 v[54:55], v217 offset:4096
    v_mfma_f32_16x16x32_bf16 a[48:51], v[4:7], v[128:131], a[48:51]
    v_mfma_f32_16x16x32_bf16 a[84:87], v[8:11], v[128:131], a[84:87]
    buffer_load_dwordx4 v[112:115], v252, s[28:31], s59 offen sc1
    v_mfma_f32_16x16x32_bf16 a[120:123], v[12:15], v[128:131], a[120:123]
    s_add_u32 m0, s81, 4096
    s_xor_b32 s87, s80, 442368
    ds_read_b64_tr_b16 v[56:57], v218 offset:0
    v_mfma_f32_16x16x32_bf16 v[76:79], v[16:19], v[128:131], v[76:79]
    ds_read_b64_tr_b16 v[58:59], v218 offset:4096
    v_mfma_f32_16x16x32_bf16 a[156:159], v[20:23], v[128:131], a[156:159]
    buffer_load_dwordx4 v221, s[32:35], s87 offen offset:0  lds
    v_mfma_f32_16x16x32_bf16 a[192:195], v[24:27], v[128:131], a[192:195]
    ds_read_b64_tr_b16 v[60:61], v219 offset:0
    ds_read_b64_tr_b16 v[62:63], v219 offset:4096
    v_mfma_f32_16x16x32_bf16 a[228:231], v[28:31], v[128:131], a[228:231]
    v_and_b32 v248, 7, v236
    v_lshrrev_b32 v249, 3, v236
    v_mfma_f32_16x16x32_bf16 a[16:19], v[0:3], v[132:135], a[16:19]
    buffer_load_dwordx4 v222, s[32:35], s87 offen offset:1024  lds
    v_mfma_f32_16x16x32_bf16 a[52:55], v[4:7], v[132:135], a[52:55]
    v_and_b32 v250, 7, v249
    v_xor_b32 v250, v250, v248
    v_mfma_f32_16x16x32_bf16 a[88:91], v[8:11], v[132:135], a[88:91]
    v_lshlrev_b32 v250, 4, v250
    v_lshl_add_u32 v244, v249, 7, v250
    v_mfma_f32_16x16x32_bf16 a[124:127], v[12:15], v[132:135], a[124:127]
    buffer_load_dwordx4 v223, s[32:35], s87 offen offset:2048  lds
    v_mfma_f32_16x16x32_bf16 v[188:191], v[16:19], v[132:135], v[188:191]
    v_add_u32 v244, 114688, v244
    v_mfma_f32_16x16x32_bf16 a[160:163], v[20:23], v[132:135], a[160:163]
    v_lshlrev_b32 v247, 11, v249
    v_lshl_add_u32 v247, v248, 4, v247
    v_mfma_f32_16x16x32_bf16 a[196:199], v[24:27], v[132:135], a[196:199]
    buffer_load_dwordx4 v225, s[32:35], s87 offen offset:3072  lds
    v_mfma_f32_16x16x32_bf16 a[232:235], v[28:31], v[132:135], a[232:235]
    s_add_u32 m0, s81, 32768
    s_xor_b32 s87, s80, 458752
    v_mfma_f32_16x16x32_bf16 a[20:23], v[0:3], v[136:139], a[20:23]
    s_and_b32 s69, s50, 1
    s_mul_i32 s69, s69, 40960
    s_sub_u32 s71, 40960, s69
    v_mfma_f32_16x16x32_bf16 a[56:59], v[4:7], v[136:139], a[56:59]
    buffer_load_dwordx4 v221, s[32:35], s87 offen offset:0  lds
    v_mfma_f32_16x16x32_bf16 a[92:95], v[8:11], v[136:139], a[92:95]
    s_mul_i32 s60, s36, 9216
    s_add_u32 s72, s71, s60
    s_lshl_b32 s61, s36, 2
    v_mfma_f32_16x16x32_bf16 a[128:131], v[12:15], v[136:139], a[128:131]
    s_add_u32 s61, s61, 36864
    s_add_u32 s71, s71, s61
    s_add_u32 s73, s69, s61
    v_mfma_f32_16x16x32_bf16 v[192:195], v[16:19], v[136:139], v[192:195]
    buffer_load_dwordx4 v222, s[32:35], s87 offen offset:1024  lds
    v_mfma_f32_16x16x32_bf16 a[164:167], v[20:23], v[136:139], a[164:167]
    v_mov_b32 v209, 0
    v_mov_b32 v210, 1
    v_mfma_f32_16x16x32_bf16 a[200:203], v[24:27], v[136:139], a[200:203]
    s_add_u32 s69, s69, s60
    s_add_u32 s66, s69, 4096
    s_add_u32 s67, s69, 8192
    v_mfma_f32_16x16x32_bf16 a[236:239], v[28:31], v[136:139], a[236:239]
    buffer_load_dwordx4 v223, s[32:35], s87 offen offset:2048  lds
    v_mfma_f32_16x16x32_bf16 a[24:27], v[0:3], v[140:143], a[24:27]
    buffer_load_dword v211, v209, s[4:7], s73 offen sc1
    v_mfma_f32_16x16x32_bf16 a[60:63], v[4:7], v[140:143], a[60:63]
    v_mfma_f32_16x16x32_bf16 a[96:99], v[8:11], v[140:143], a[96:99]
    buffer_load_dwordx4 v225, s[32:35], s87 offen offset:3072  lds
    v_mfma_f32_16x16x32_bf16 a[132:135], v[12:15], v[140:143], a[132:135]
    v_mfma_f32_16x16x32_bf16 v[196:199], v[16:19], v[140:143], v[196:199]
    v_mfma_f32_16x16x32_bf16 a[168:171], v[20:23], v[140:143], a[168:171]
    v_mfma_f32_16x16x32_bf16 a[204:207], v[24:27], v[140:143], a[204:207]
    v_mfma_f32_16x16x32_bf16 a[240:243], v[28:31], v[140:143], a[240:243]
    v_mfma_f32_16x16x32_bf16 a[28:31], v[0:3], v[144:147], a[28:31]
    v_mfma_f32_16x16x32_bf16 a[64:67], v[4:7], v[144:147], a[64:67]
    v_mfma_f32_16x16x32_bf16 a[100:103], v[8:11], v[144:147], a[100:103]
    v_mfma_f32_16x16x32_bf16 a[136:139], v[12:15], v[144:147], a[136:139]
    v_mfma_f32_16x16x32_bf16 v[200:203], v[16:19], v[144:147], v[200:203]
    v_mfma_f32_16x16x32_bf16 a[172:175], v[20:23], v[144:147], a[172:175]
    v_mfma_f32_16x16x32_bf16 a[208:211], v[24:27], v[144:147], a[208:211]
    v_mfma_f32_16x16x32_bf16 a[244:247], v[28:31], v[144:147], a[244:247]
    v_mfma_f32_16x16x32_bf16 a[32:35], v[0:3], v[148:151], a[32:35]
    v_mfma_f32_16x16x32_bf16 a[68:71], v[4:7], v[148:151], a[68:71]
    v_mfma_f32_16x16x32_bf16 a[104:107], v[8:11], v[148:151], a[104:107]
    v_mfma_f32_16x16x32_bf16 a[140:143], v[12:15], v[148:151], a[140:143]
    v_mfma_f32_16x16x32_bf16 v[204:207], v[16:19], v[148:151], v[204:207]
    v_mfma_f32_16x16x32_bf16 a[176:179], v[20:23], v[148:151], a[176:179]
    v_mfma_f32_16x16x32_bf16 a[212:215], v[24:27], v[148:151], a[212:215]
    v_mfma_f32_16x16x32_bf16 a[248:251], v[28:31], v[148:151], a[248:251]
    s_waitcnt lgkmcnt(0)
    s_waitcnt vmcnt(17)
    v_mfma_f32_16x16x32_bf16 a[0:3], v[32:35], v[152:155], a[0:3]
    v_mfma_f32_16x16x32_bf16 a[36:39], v[36:39], v[152:155], a[36:39]
    v_xor_b32 v253, 13312, v238
    v_mfma_f32_16x16x32_bf16 a[72:75], v[40:43], v[152:155], a[72:75]
    buffer_load_dwordx4 v[116:119], v253, s[28:31], s51 offen sc1
    v_mfma_f32_16x16x32_bf16 a[108:111], v[44:47], v[152:155], a[108:111]
    v_add_u32 v212, 0x10000, v212
    v_add_u32 v213, 0x10000, v213
    v_mfma_f32_16x16x32_bf16 v[64:67], v[48:51], v[152:155], v[64:67]
    v_add_u32 v214, 0x10000, v214
    v_add_u32 v215, 0x10000, v215
    v_mfma_f32_16x16x32_bf16 a[144:147], v[52:55], v[152:155], a[144:147]
    buffer_load_dwordx4 v[120:123], v253, s[28:31], s52 offen sc1
    v_mfma_f32_16x16x32_bf16 a[180:183], v[56:59], v[152:155], a[180:183]
    v_add_u32 v216, 0x10000, v216
    v_add_u32 v217, 0x10000, v217
    v_mfma_f32_16x16x32_bf16 a[216:219], v[60:63], v[152:155], a[216:219]
    v_add_u32 v218, 0x10000, v218
    v_add_u32 v219, 0x10000, v219
    v_mfma_f32_16x16x32_bf16 a[4:7], v[32:35], v[156:159], a[4:7]
    buffer_load_dwordx4 v[124:127], v253, s[28:31], s53 offen sc1
    v_mfma_f32_16x16x32_bf16 a[40:43], v[36:39], v[156:159], a[40:43]
    ds_read_b64_tr_b16 v[0:1], v212 offset:0
    ds_read_b64_tr_b16 v[2:3], v212 offset:4096
    v_mfma_f32_16x16x32_bf16 a[76:79], v[40:43], v[156:159], a[76:79]
    v_mfma_f32_16x16x32_bf16 a[112:115], v[44:47], v[156:159], a[112:115]
    buffer_load_dwordx4 v[128:131], v253, s[28:31], s54 offen sc1
    v_mfma_f32_16x16x32_bf16 v[68:71], v[48:51], v[156:159], v[68:71]
    ds_read_b64_tr_b16 v[4:5], v213 offset:0
    ds_read_b64_tr_b16 v[6:7], v213 offset:4096
    v_mfma_f32_16x16x32_bf16 a[148:151], v[52:55], v[156:159], a[148:151]
    v_mfma_f32_16x16x32_bf16 a[184:187], v[56:59], v[156:159], a[184:187]
    buffer_load_dwordx4 v[132:135], v253, s[28:31], s55 offen sc1
    v_mfma_f32_16x16x32_bf16 a[220:223], v[60:63], v[156:159], a[220:223]
    ds_read_b64_tr_b16 v[8:9], v214 offset:0
    ds_read_b64_tr_b16 v[10:11], v214 offset:4096
    v_mfma_f32_16x16x32_bf16 a[8:11], v[32:35], v[160:163], a[8:11]
    v_mfma_f32_16x16x32_bf16 a[44:47], v[36:39], v[160:163], a[44:47]
    buffer_load_dwordx4 v[136:139], v253, s[28:31], s56 offen sc1
    v_mfma_f32_16x16x32_bf16 a[80:83], v[40:43], v[160:163], a[80:83]
    ds_read_b64_tr_b16 v[12:13], v215 offset:0
    ds_read_b64_tr_b16 v[14:15], v215 offset:4096
    v_mfma_f32_16x16x32_bf16 a[116:119], v[44:47], v[160:163], a[116:119]
    v_mfma_f32_16x16x32_bf16 v[72:75], v[48:51], v[160:163], v[72:75]
    buffer_load_dwordx4 v[140:143], v253, s[28:31], s57 offen sc1
    v_mfma_f32_16x16x32_bf16 a[152:155], v[52:55], v[160:163], a[152:155]
    ds_read_b64_tr_b16 v[16:17], v216 offset:0
    ds_read_b64_tr_b16 v[18:19], v216 offset:4096
    v_mfma_f32_16x16x32_bf16 a[188:191], v[56:59], v[160:163], a[188:191]
    v_mfma_f32_16x16x32_bf16 a[224:227], v[60:63], v[160:163], a[224:227]
    buffer_load_dwordx4 v[144:147], v253, s[28:31], s58 offen sc1
    v_mfma_f32_16x16x32_bf16 a[12:15], v[32:35], v[164:167], a[12:15]
    ds_read_b64_tr_b16 v[20:21], v217 offset:0
    ds_read_b64_tr_b16 v[22:23], v217 offset:4096
    v_mfma_f32_16x16x32_bf16 a[48:51], v[36:39], v[164:167], a[48:51]
    v_mfma_f32_16x16x32_bf16 a[84:87], v[40:43], v[164:167], a[84:87]
    buffer_load_dwordx4 v[148:151], v253, s[28:31], s59 offen sc1
    v_mfma_f32_16x16x32_bf16 a[120:123], v[44:47], v[164:167], a[120:123]
    s_add_u32 m0, s81, 36864
    s_xor_b32 s87, s80, 475136
    ds_read_b64_tr_b16 v[24:25], v218 offset:0
    v_mfma_f32_16x16x32_bf16 v[76:79], v[48:51], v[164:167], v[76:79]
    ds_read_b64_tr_b16 v[26:27], v218 offset:4096
    v_mfma_f32_16x16x32_bf16 a[156:159], v[52:55], v[164:167], a[156:159]
    buffer_load_dwordx4 v221, s[32:35], s87 offen offset:0  lds
    v_mfma_f32_16x16x32_bf16 a[192:195], v[56:59], v[164:167], a[192:195]
    ds_read_b64_tr_b16 v[28:29], v219 offset:0
    ds_read_b64_tr_b16 v[30:31], v219 offset:4096
    v_mfma_f32_16x16x32_bf16 a[228:231], v[60:63], v[164:167], a[228:231]
    v_mfma_f32_16x16x32_bf16 a[16:19], v[32:35], v[168:171], a[16:19]
    buffer_load_dwordx4 v222, s[32:35], s87 offen offset:1024  lds
    v_mfma_f32_16x16x32_bf16 a[52:55], v[36:39], v[168:171], a[52:55]
    v_mfma_f32_16x16x32_bf16 a[88:91], v[40:43], v[168:171], a[88:91]
    v_mfma_f32_16x16x32_bf16 a[124:127], v[44:47], v[168:171], a[124:127]
    buffer_load_dwordx4 v223, s[32:35], s87 offen offset:2048  lds
    v_mfma_f32_16x16x32_bf16 v[188:191], v[48:51], v[168:171], v[188:191]
    v_mfma_f32_16x16x32_bf16 a[160:163], v[52:55], v[168:171], a[160:163]
    v_mfma_f32_16x16x32_bf16 a[196:199], v[56:59], v[168:171], a[196:199]
    buffer_load_dwordx4 v225, s[32:35], s87 offen offset:3072  lds
    v_mfma_f32_16x16x32_bf16 a[232:235], v[60:63], v[168:171], a[232:235]
    s_add_u32 m0, s81, 65536
    s_xor_b32 s87, s80, 491520
    v_mfma_f32_16x16x32_bf16 a[20:23], v[32:35], v[172:175], a[20:23]
    v_mfma_f32_16x16x32_bf16 a[56:59], v[36:39], v[172:175], a[56:59]
    buffer_load_dwordx4 v221, s[32:35], s87 offen offset:0  lds
    v_mfma_f32_16x16x32_bf16 a[92:95], v[40:43], v[172:175], a[92:95]
    v_mfma_f32_16x16x32_bf16 a[128:131], v[44:47], v[172:175], a[128:131]
    v_mfma_f32_16x16x32_bf16 v[192:195], v[48:51], v[172:175], v[192:195]
    buffer_load_dwordx4 v222, s[32:35], s87 offen offset:1024  lds
    v_mfma_f32_16x16x32_bf16 a[164:167], v[52:55], v[172:175], a[164:167]
    v_mfma_f32_16x16x32_bf16 a[200:203], v[56:59], v[172:175], a[200:203]
    v_mfma_f32_16x16x32_bf16 a[236:239], v[60:63], v[172:175], a[236:239]
    buffer_load_dwordx4 v223, s[32:35], s87 offen offset:2048  lds
    v_mfma_f32_16x16x32_bf16 a[24:27], v[32:35], v[176:179], a[24:27]
    v_mfma_f32_16x16x32_bf16 a[60:63], v[36:39], v[176:179], a[60:63]
    v_mfma_f32_16x16x32_bf16 a[96:99], v[40:43], v[176:179], a[96:99]
    buffer_load_dwordx4 v225, s[32:35], s87 offen offset:3072  lds
    v_mfma_f32_16x16x32_bf16 a[132:135], v[44:47], v[176:179], a[132:135]
    v_mfma_f32_16x16x32_bf16 v[196:199], v[48:51], v[176:179], v[196:199]
    v_mfma_f32_16x16x32_bf16 a[168:171], v[52:55], v[176:179], a[168:171]
    v_mfma_f32_16x16x32_bf16 a[204:207], v[56:59], v[176:179], a[204:207]
    v_mfma_f32_16x16x32_bf16 a[240:243], v[60:63], v[176:179], a[240:243]
    v_mfma_f32_16x16x32_bf16 a[28:31], v[32:35], v[180:183], a[28:31]
    v_mfma_f32_16x16x32_bf16 a[64:67], v[36:39], v[180:183], a[64:67]
    v_mfma_f32_16x16x32_bf16 a[100:103], v[40:43], v[180:183], a[100:103]
    v_mfma_f32_16x16x32_bf16 a[136:139], v[44:47], v[180:183], a[136:139]
    v_mfma_f32_16x16x32_bf16 v[200:203], v[48:51], v[180:183], v[200:203]
    v_mfma_f32_16x16x32_bf16 a[172:175], v[52:55], v[180:183], a[172:175]
    v_mfma_f32_16x16x32_bf16 a[208:211], v[56:59], v[180:183], a[208:211]
    v_mfma_f32_16x16x32_bf16 a[244:247], v[60:63], v[180:183], a[244:247]
    v_mfma_f32_16x16x32_bf16 a[32:35], v[32:35], v[184:187], a[32:35]
    v_mfma_f32_16x16x32_bf16 a[68:71], v[36:39], v[184:187], a[68:71]
    v_mfma_f32_16x16x32_bf16 a[104:107], v[40:43], v[184:187], a[104:107]
    v_mfma_f32_16x16x32_bf16 a[140:143], v[44:47], v[184:187], a[140:143]
    v_mfma_f32_16x16x32_bf16 v[204:207], v[48:51], v[184:187], v[204:207]
    v_mfma_f32_16x16x32_bf16 a[176:179], v[52:55], v[184:187], a[176:179]
    v_mfma_f32_16x16x32_bf16 a[212:215], v[56:59], v[184:187], a[212:215]
    v_mfma_f32_16x16x32_bf16 a[248:251], v[60:63], v[184:187], a[248:251]
    s_waitcnt lgkmcnt(0)
    s_waitcnt vmcnt(17)
    v_mfma_f32_16x16x32_bf16 a[0:3], v[0:3], v[80:83], a[0:3]
    v_mfma_f32_16x16x32_bf16 a[36:39], v[4:7], v[80:83], a[36:39]
    v_xor_b32 v252, 14336, v238
    v_mfma_f32_16x16x32_bf16 a[72:75], v[8:11], v[80:83], a[72:75]
    buffer_load_dwordx4 v[152:155], v252, s[28:31], s51 offen sc1
    v_mfma_f32_16x16x32_bf16 a[108:111], v[12:15], v[80:83], a[108:111]
    v_add_u32 v212, 0xfffe0000, v212
    v_add_u32 v213, 0xfffe0000, v213
    v_mfma_f32_16x16x32_bf16 v[64:67], v[16:19], v[80:83], v[64:67]
    v_add_u32 v214, 0xfffe0000, v214
    v_add_u32 v215, 0xfffe0000, v215
    v_mfma_f32_16x16x32_bf16 a[144:147], v[20:23], v[80:83], a[144:147]
    buffer_load_dwordx4 v[156:159], v252, s[28:31], s52 offen sc1
    v_mfma_f32_16x16x32_bf16 a[180:183], v[24:27], v[80:83], a[180:183]
    v_add_u32 v216, 0xfffe0000, v216
    v_add_u32 v217, 0xfffe0000, v217
    v_mfma_f32_16x16x32_bf16 a[216:219], v[28:31], v[80:83], a[216:219]
    v_add_u32 v218, 0xfffe0000, v218
    v_add_u32 v219, 0xfffe0000, v219
    v_mfma_f32_16x16x32_bf16 a[4:7], v[0:3], v[84:87], a[4:7]
    buffer_load_dwordx4 v[160:163], v252, s[28:31], s53 offen sc1
    v_mfma_f32_16x16x32_bf16 a[40:43], v[4:7], v[84:87], a[40:43]
    ds_read_b64_tr_b16 v[32:33], v212 offset:0
    ds_read_b64_tr_b16 v[34:35], v212 offset:4096
    v_mfma_f32_16x16x32_bf16 a[76:79], v[8:11], v[84:87], a[76:79]
    v_mfma_f32_16x16x32_bf16 a[112:115], v[12:15], v[84:87], a[112:115]
    buffer_load_dwordx4 v[164:167], v252, s[28:31], s54 offen sc1
    v_mfma_f32_16x16x32_bf16 v[68:71], v[16:19], v[84:87], v[68:71]
    ds_read_b64_tr_b16 v[36:37], v213 offset:0
    ds_read_b64_tr_b16 v[38:39], v213 offset:4096
    v_mfma_f32_16x16x32_bf16 a[148:151], v[20:23], v[84:87], a[148:151]
    v_mfma_f32_16x16x32_bf16 a[184:187], v[24:27], v[84:87], a[184:187]
    buffer_load_dwordx4 v[168:171], v252, s[28:31], s55 offen sc1
    v_mfma_f32_16x16x32_bf16 a[220:223], v[28:31], v[84:87], a[220:223]
    ds_read_b64_tr_b16 v[40:41], v214 offset:0
    ds_read_b64_tr_b16 v[42:43], v214 offset:4096
    v_mfma_f32_16x16x32_bf16 a[8:11], v[0:3], v[88:91], a[8:11]
    v_mfma_f32_16x16x32_bf16 a[44:47], v[4:7], v[88:91], a[44:47]
    buffer_load_dwordx4 v[172:175], v252, s[28:31], s56 offen sc1
    v_mfma_f32_16x16x32_bf16 a[80:83], v[8:11], v[88:91], a[80:83]
    ds_read_b64_tr_b16 v[44:45], v215 offset:0
    ds_read_b64_tr_b16 v[46:47], v215 offset:4096
    v_mfma_f32_16x16x32_bf16 a[116:119], v[12:15], v[88:91], a[116:119]
    v_mfma_f32_16x16x32_bf16 v[72:75], v[16:19], v[88:91], v[72:75]
    buffer_load_dwordx4 v[176:179], v252, s[28:31], s57 offen sc1
    v_mfma_f32_16x16x32_bf16 a[152:155], v[20:23], v[88:91], a[152:155]
    ds_read_b64_tr_b16 v[48:49], v216 offset:0
    ds_read_b64_tr_b16 v[50:51], v216 offset:4096
    v_mfma_f32_16x16x32_bf16 a[188:191], v[24:27], v[88:91], a[188:191]
    v_mfma_f32_16x16x32_bf16 a[224:227], v[28:31], v[88:91], a[224:227]
    buffer_load_dwordx4 v[180:183], v252, s[28:31], s58 offen sc1
    v_mfma_f32_16x16x32_bf16 a[12:15], v[0:3], v[92:95], a[12:15]
    ds_read_b64_tr_b16 v[52:53], v217 offset:0
    ds_read_b64_tr_b16 v[54:55], v217 offset:4096
    v_mfma_f32_16x16x32_bf16 a[48:51], v[4:7], v[92:95], a[48:51]
    v_mfma_f32_16x16x32_bf16 a[84:87], v[8:11], v[92:95], a[84:87]
    buffer_load_dwordx4 v[184:187], v252, s[28:31], s59 offen sc1
    v_mfma_f32_16x16x32_bf16 a[120:123], v[12:15], v[92:95], a[120:123]
    s_add_u32 m0, s81, 69632
    s_xor_b32 s87, s80, 507904
    ds_read_b64_tr_b16 v[56:57], v218 offset:0
    v_mfma_f32_16x16x32_bf16 v[76:79], v[16:19], v[92:95], v[76:79]
    ds_read_b64_tr_b16 v[58:59], v218 offset:4096
    v_mfma_f32_16x16x32_bf16 a[156:159], v[20:23], v[92:95], a[156:159]
    buffer_load_dwordx4 v221, s[32:35], s87 offen offset:0  lds
    v_mfma_f32_16x16x32_bf16 a[192:195], v[24:27], v[92:95], a[192:195]
    ds_read_b64_tr_b16 v[60:61], v219 offset:0
    ds_read_b64_tr_b16 v[62:63], v219 offset:4096
    v_mfma_f32_16x16x32_bf16 a[228:231], v[28:31], v[92:95], a[228:231]
    v_mfma_f32_16x16x32_bf16 a[16:19], v[0:3], v[96:99], a[16:19]
    buffer_load_dwordx4 v222, s[32:35], s87 offen offset:1024  lds
    v_mfma_f32_16x16x32_bf16 a[52:55], v[4:7], v[96:99], a[52:55]
    v_mfma_f32_16x16x32_bf16 a[88:91], v[8:11], v[96:99], a[88:91]
    v_mfma_f32_16x16x32_bf16 a[124:127], v[12:15], v[96:99], a[124:127]
    buffer_load_dwordx4 v223, s[32:35], s87 offen offset:2048  lds
    v_mfma_f32_16x16x32_bf16 v[188:191], v[16:19], v[96:99], v[188:191]
    v_mfma_f32_16x16x32_bf16 a[160:163], v[20:23], v[96:99], a[160:163]
    v_mfma_f32_16x16x32_bf16 a[196:199], v[24:27], v[96:99], a[196:199]
    buffer_load_dwordx4 v225, s[32:35], s87 offen offset:3072  lds
    v_mfma_f32_16x16x32_bf16 a[232:235], v[28:31], v[96:99], a[232:235]
    v_mfma_f32_16x16x32_bf16 a[20:23], v[0:3], v[100:103], a[20:23]
    v_mfma_f32_16x16x32_bf16 a[56:59], v[4:7], v[100:103], a[56:59]
    v_mfma_f32_16x16x32_bf16 a[92:95], v[8:11], v[100:103], a[92:95]
    v_mfma_f32_16x16x32_bf16 a[128:131], v[12:15], v[100:103], a[128:131]
    v_mfma_f32_16x16x32_bf16 v[192:195], v[16:19], v[100:103], v[192:195]
    v_mfma_f32_16x16x32_bf16 a[164:167], v[20:23], v[100:103], a[164:167]
    v_mfma_f32_16x16x32_bf16 a[200:203], v[24:27], v[100:103], a[200:203]
    v_mfma_f32_16x16x32_bf16 a[236:239], v[28:31], v[100:103], a[236:239]
    v_mfma_f32_16x16x32_bf16 a[24:27], v[0:3], v[104:107], a[24:27]
    v_mfma_f32_16x16x32_bf16 a[60:63], v[4:7], v[104:107], a[60:63]
    v_mfma_f32_16x16x32_bf16 a[96:99], v[8:11], v[104:107], a[96:99]
    v_mfma_f32_16x16x32_bf16 a[132:135], v[12:15], v[104:107], a[132:135]
    v_mfma_f32_16x16x32_bf16 v[196:199], v[16:19], v[104:107], v[196:199]
    v_mfma_f32_16x16x32_bf16 a[168:171], v[20:23], v[104:107], a[168:171]
    v_mfma_f32_16x16x32_bf16 a[204:207], v[24:27], v[104:107], a[204:207]
    v_mfma_f32_16x16x32_bf16 a[240:243], v[28:31], v[104:107], a[240:243]
    v_mfma_f32_16x16x32_bf16 a[28:31], v[0:3], v[108:111], a[28:31]
    v_mfma_f32_16x16x32_bf16 a[64:67], v[4:7], v[108:111], a[64:67]
    v_mfma_f32_16x16x32_bf16 a[100:103], v[8:11], v[108:111], a[100:103]
    v_mfma_f32_16x16x32_bf16 a[136:139], v[12:15], v[108:111], a[136:139]
    v_mfma_f32_16x16x32_bf16 v[200:203], v[16:19], v[108:111], v[200:203]
    v_mfma_f32_16x16x32_bf16 a[172:175], v[20:23], v[108:111], a[172:175]
    v_mfma_f32_16x16x32_bf16 a[208:211], v[24:27], v[108:111], a[208:211]
    v_mfma_f32_16x16x32_bf16 a[244:247], v[28:31], v[108:111], a[244:247]
    v_mfma_f32_16x16x32_bf16 a[32:35], v[0:3], v[112:115], a[32:35]
    v_mfma_f32_16x16x32_bf16 a[68:71], v[4:7], v[112:115], a[68:71]
    v_mfma_f32_16x16x32_bf16 a[104:107], v[8:11], v[112:115], a[104:107]
    v_mfma_f32_16x16x32_bf16 a[140:143], v[12:15], v[112:115], a[140:143]
    v_mfma_f32_16x16x32_bf16 v[204:207], v[16:19], v[112:115], v[204:207]
    v_mfma_f32_16x16x32_bf16 a[176:179], v[20:23], v[112:115], a[176:179]
    v_mfma_f32_16x16x32_bf16 a[212:215], v[24:27], v[112:115], a[212:215]
    v_mfma_f32_16x16x32_bf16 a[248:251], v[28:31], v[112:115], a[248:251]
    s_waitcnt lgkmcnt(0)
    s_waitcnt vmcnt(13)
    v_mfma_f32_16x16x32_bf16 a[0:3], v[32:35], v[116:119], a[0:3]
    v_mfma_f32_16x16x32_bf16 a[36:39], v[36:39], v[116:119], a[36:39]
    v_xor_b32 v253, 15360, v238
    v_mfma_f32_16x16x32_bf16 a[72:75], v[40:43], v[116:119], a[72:75]
    buffer_load_dwordx4 v[80:83], v253, s[28:31], s51 offen sc1
    v_mfma_f32_16x16x32_bf16 a[108:111], v[44:47], v[116:119], a[108:111]
    v_mfma_f32_16x16x32_bf16 v[64:67], v[48:51], v[116:119], v[64:67]
    v_mfma_f32_16x16x32_bf16 a[144:147], v[52:55], v[116:119], a[144:147]
    buffer_load_dwordx4 v[84:87], v253, s[28:31], s52 offen sc1
    v_mfma_f32_16x16x32_bf16 a[180:183], v[56:59], v[116:119], a[180:183]
    v_mfma_f32_16x16x32_bf16 a[216:219], v[60:63], v[116:119], a[216:219]
    v_mfma_f32_16x16x32_bf16 a[4:7], v[32:35], v[120:123], a[4:7]
    buffer_load_dwordx4 v[88:91], v253, s[28:31], s53 offen sc1
    v_mfma_f32_16x16x32_bf16 a[40:43], v[36:39], v[120:123], a[40:43]
    ds_read_b64_tr_b16 v[0:1], v212 offset:32768
    ds_read_b64_tr_b16 v[2:3], v212 offset:36864
    v_mfma_f32_16x16x32_bf16 a[76:79], v[40:43], v[120:123], a[76:79]
    v_mfma_f32_16x16x32_bf16 a[112:115], v[44:47], v[120:123], a[112:115]
    buffer_load_dwordx4 v[92:95], v253, s[28:31], s54 offen sc1
    v_mfma_f32_16x16x32_bf16 v[68:71], v[48:51], v[120:123], v[68:71]
    ds_read_b64_tr_b16 v[4:5], v213 offset:32768
    ds_read_b64_tr_b16 v[6:7], v213 offset:36864
    v_mfma_f32_16x16x32_bf16 a[148:151], v[52:55], v[120:123], a[148:151]
    v_mfma_f32_16x16x32_bf16 a[184:187], v[56:59], v[120:123], a[184:187]
    buffer_load_dwordx4 v[96:99], v253, s[28:31], s55 offen sc1
    v_mfma_f32_16x16x32_bf16 a[220:223], v[60:63], v[120:123], a[220:223]
    ds_read_b64_tr_b16 v[8:9], v214 offset:32768
    ds_read_b64_tr_b16 v[10:11], v214 offset:36864
    v_mfma_f32_16x16x32_bf16 a[8:11], v[32:35], v[124:127], a[8:11]
    v_mfma_f32_16x16x32_bf16 a[44:47], v[36:39], v[124:127], a[44:47]
    buffer_load_dwordx4 v[100:103], v253, s[28:31], s56 offen sc1
    v_mfma_f32_16x16x32_bf16 a[80:83], v[40:43], v[124:127], a[80:83]
    ds_read_b64_tr_b16 v[12:13], v215 offset:32768
    ds_read_b64_tr_b16 v[14:15], v215 offset:36864
    v_mfma_f32_16x16x32_bf16 a[116:119], v[44:47], v[124:127], a[116:119]
    v_mfma_f32_16x16x32_bf16 v[72:75], v[48:51], v[124:127], v[72:75]
    buffer_load_dwordx4 v[104:107], v253, s[28:31], s57 offen sc1
    v_mfma_f32_16x16x32_bf16 a[152:155], v[52:55], v[124:127], a[152:155]
    ds_read_b64_tr_b16 v[16:17], v216 offset:32768
    ds_read_b64_tr_b16 v[18:19], v216 offset:36864
    v_mfma_f32_16x16x32_bf16 a[188:191], v[56:59], v[124:127], a[188:191]
    v_mfma_f32_16x16x32_bf16 a[224:227], v[60:63], v[124:127], a[224:227]
    buffer_load_dwordx4 v[108:111], v253, s[28:31], s58 offen sc1
    v_mfma_f32_16x16x32_bf16 a[12:15], v[32:35], v[128:131], a[12:15]
    ds_read_b64_tr_b16 v[20:21], v217 offset:32768
    ds_read_b64_tr_b16 v[22:23], v217 offset:36864
    v_mfma_f32_16x16x32_bf16 a[48:51], v[36:39], v[128:131], a[48:51]
    v_mfma_f32_16x16x32_bf16 a[84:87], v[40:43], v[128:131], a[84:87]
    buffer_load_dwordx4 v[112:115], v253, s[28:31], s59 offen sc1
    v_mfma_f32_16x16x32_bf16 a[120:123], v[44:47], v[128:131], a[120:123]
    ds_read_b64_tr_b16 v[24:25], v218 offset:32768
    ds_read_b64_tr_b16 v[26:27], v218 offset:36864
    v_mfma_f32_16x16x32_bf16 v[76:79], v[48:51], v[128:131], v[76:79]
    v_mfma_f32_16x16x32_bf16 a[156:159], v[52:55], v[128:131], a[156:159]
    ds_read_b64_tr_b16 v[28:29], v219 offset:32768
    ds_read_b64_tr_b16 v[30:31], v219 offset:36864
    v_mfma_f32_16x16x32_bf16 a[192:195], v[56:59], v[128:131], a[192:195]
    v_mfma_f32_16x16x32_bf16 a[228:231], v[60:63], v[128:131], a[228:231]
    v_mfma_f32_16x16x32_bf16 a[16:19], v[32:35], v[132:135], a[16:19]
    v_mfma_f32_16x16x32_bf16 a[52:55], v[36:39], v[132:135], a[52:55]
    v_mfma_f32_16x16x32_bf16 a[88:91], v[40:43], v[132:135], a[88:91]
    v_mfma_f32_16x16x32_bf16 a[124:127], v[44:47], v[132:135], a[124:127]
    v_mfma_f32_16x16x32_bf16 v[188:191], v[48:51], v[132:135], v[188:191]
    v_mfma_f32_16x16x32_bf16 a[160:163], v[52:55], v[132:135], a[160:163]
    v_mfma_f32_16x16x32_bf16 a[196:199], v[56:59], v[132:135], a[196:199]
    v_mfma_f32_16x16x32_bf16 a[232:235], v[60:63], v[132:135], a[232:235]
    v_mfma_f32_16x16x32_bf16 a[20:23], v[32:35], v[136:139], a[20:23]
    v_mfma_f32_16x16x32_bf16 a[56:59], v[36:39], v[136:139], a[56:59]
    v_mfma_f32_16x16x32_bf16 a[92:95], v[40:43], v[136:139], a[92:95]
    v_mfma_f32_16x16x32_bf16 a[128:131], v[44:47], v[136:139], a[128:131]
    v_mfma_f32_16x16x32_bf16 v[192:195], v[48:51], v[136:139], v[192:195]
    v_mfma_f32_16x16x32_bf16 a[164:167], v[52:55], v[136:139], a[164:167]
    v_mfma_f32_16x16x32_bf16 a[200:203], v[56:59], v[136:139], a[200:203]
    v_mfma_f32_16x16x32_bf16 a[236:239], v[60:63], v[136:139], a[236:239]
    v_mfma_f32_16x16x32_bf16 a[24:27], v[32:35], v[140:143], a[24:27]
    v_mfma_f32_16x16x32_bf16 a[60:63], v[36:39], v[140:143], a[60:63]
    v_mfma_f32_16x16x32_bf16 a[96:99], v[40:43], v[140:143], a[96:99]
    v_mfma_f32_16x16x32_bf16 a[132:135], v[44:47], v[140:143], a[132:135]
    v_mfma_f32_16x16x32_bf16 v[196:199], v[48:51], v[140:143], v[196:199]
    v_mfma_f32_16x16x32_bf16 a[168:171], v[52:55], v[140:143], a[168:171]
    v_mfma_f32_16x16x32_bf16 a[204:207], v[56:59], v[140:143], a[204:207]
    v_mfma_f32_16x16x32_bf16 a[240:243], v[60:63], v[140:143], a[240:243]
    v_mfma_f32_16x16x32_bf16 a[28:31], v[32:35], v[144:147], a[28:31]
    v_mfma_f32_16x16x32_bf16 a[64:67], v[36:39], v[144:147], a[64:67]
    v_mfma_f32_16x16x32_bf16 a[100:103], v[40:43], v[144:147], a[100:103]
    v_mfma_f32_16x16x32_bf16 a[136:139], v[44:47], v[144:147], a[136:139]
    v_mfma_f32_16x16x32_bf16 v[200:203], v[48:51], v[144:147], v[200:203]
    v_mfma_f32_16x16x32_bf16 a[172:175], v[52:55], v[144:147], a[172:175]
    v_mfma_f32_16x16x32_bf16 a[208:211], v[56:59], v[144:147], a[208:211]
    v_mfma_f32_16x16x32_bf16 a[244:247], v[60:63], v[144:147], a[244:247]
    v_add_u32 v212, 0x10000, v212
    v_add_u32 v213, 0x10000, v213
    v_mfma_f32_16x16x32_bf16 a[32:35], v[32:35], v[148:151], a[32:35]
    v_add_u32 v214, 0x10000, v214
    v_add_u32 v215, 0x10000, v215
    v_mfma_f32_16x16x32_bf16 a[68:71], v[36:39], v[148:151], a[68:71]
    v_add_u32 v216, 0x10000, v216
    v_add_u32 v217, 0x10000, v217
    v_mfma_f32_16x16x32_bf16 a[104:107], v[40:43], v[148:151], a[104:107]
    v_add_u32 v218, 0x10000, v218
    v_add_u32 v219, 0x10000, v219
    v_mfma_f32_16x16x32_bf16 a[140:143], v[44:47], v[148:151], a[140:143]
    v_mfma_f32_16x16x32_bf16 v[204:207], v[48:51], v[148:151], v[204:207]
    v_mfma_f32_16x16x32_bf16 a[176:179], v[52:55], v[148:151], a[176:179]
    v_mfma_f32_16x16x32_bf16 a[212:215], v[56:59], v[148:151], a[212:215]
    v_mfma_f32_16x16x32_bf16 a[248:251], v[60:63], v[148:151], a[248:251]
    s_waitcnt lgkmcnt(0)
    s_waitcnt vmcnt(9)
    v_mfma_f32_16x16x32_bf16 v[64:67], v[16:19], v[152:155], v[64:67]
    ds_read_b64_tr_b16 v[48:49], v216 offset:0
    ds_read_b64_tr_b16 v[50:51], v216 offset:4096
    v_mfma_f32_16x16x32_bf16 a[144:147], v[20:23], v[152:155], a[144:147]
    ds_read_b64_tr_b16 v[52:53], v217 offset:0
    ds_read_b64_tr_b16 v[54:55], v217 offset:4096
    v_mfma_f32_16x16x32_bf16 a[180:183], v[24:27], v[152:155], a[180:183]
    ds_read_b64_tr_b16 v[56:57], v218 offset:0
    ds_read_b64_tr_b16 v[58:59], v218 offset:4096
    v_mfma_f32_16x16x32_bf16 a[216:219], v[28:31], v[152:155], a[216:219]
    ds_read_b64_tr_b16 v[60:61], v219 offset:0
    ds_read_b64_tr_b16 v[62:63], v219 offset:4096
    v_mfma_f32_16x16x32_bf16 v[68:71], v[16:19], v[156:159], v[68:71]
    ds_read_b64_tr_b16 v[32:33], v212 offset:0
    ds_read_b64_tr_b16 v[34:35], v212 offset:4096
    v_mfma_f32_16x16x32_bf16 a[148:151], v[20:23], v[156:159], a[148:151]
    ds_read_b64_tr_b16 v[36:37], v213 offset:0
    ds_read_b64_tr_b16 v[38:39], v213 offset:4096
    v_mfma_f32_16x16x32_bf16 a[184:187], v[24:27], v[156:159], a[184:187]
    ds_read_b64_tr_b16 v[40:41], v214 offset:0
    ds_read_b64_tr_b16 v[42:43], v214 offset:4096
    v_mfma_f32_16x16x32_bf16 a[220:223], v[28:31], v[156:159], a[220:223]
    ds_read_b64_tr_b16 v[44:45], v215 offset:0
    ds_read_b64_tr_b16 v[46:47], v215 offset:4096
    v_mfma_f32_16x16x32_bf16 v[72:75], v[16:19], v[160:163], v[72:75]
    v_mfma_f32_16x16x32_bf16 a[152:155], v[20:23], v[160:163], a[152:155]
    v_mfma_f32_16x16x32_bf16 a[188:191], v[24:27], v[160:163], a[188:191]
    v_mfma_f32_16x16x32_bf16 a[224:227], v[28:31], v[160:163], a[224:227]
    v_mfma_f32_16x16x32_bf16 v[76:79], v[16:19], v[164:167], v[76:79]
    v_mfma_f32_16x16x32_bf16 a[156:159], v[20:23], v[164:167], a[156:159]
    v_mfma_f32_16x16x32_bf16 a[192:195], v[24:27], v[164:167], a[192:195]
    v_mfma_f32_16x16x32_bf16 a[228:231], v[28:31], v[164:167], a[228:231]
    s_waitcnt lgkmcnt(0)
    s_waitcnt vmcnt(8)
    v_mfma_f32_16x16x32_bf16 v[64:67], v[48:51], v[80:83], v[64:67]
    v_mfma_f32_16x16x32_bf16 a[144:147], v[52:55], v[80:83], a[144:147]
    v_mfma_f32_16x16x32_bf16 a[180:183], v[56:59], v[80:83], a[180:183]
    v_mfma_f32_16x16x32_bf16 a[216:219], v[60:63], v[80:83], a[216:219]
    s_waitcnt vmcnt(7)
    s_waitcnt lgkmcnt(0)
    s_barrier
    v_mfma_f32_16x16x32_bf16 v[68:71], v[48:51], v[84:87], v[68:71]
    v_mfma_f32_16x16x32_bf16 a[148:151], v[52:55], v[84:87], a[148:151]
    v_mfma_f32_16x16x32_bf16 a[184:187], v[56:59], v[84:87], a[184:187]
    ds_write_b128 v241, a[144:147] offset:0
    v_mfma_f32_16x16x32_bf16 a[220:223], v[60:63], v[84:87], a[220:223]
    s_waitcnt vmcnt(6)
    v_mfma_f32_16x16x32_bf16 v[72:75], v[48:51], v[88:91], v[72:75]
    ds_write_b128 v242, a[180:183] offset:0
    v_mfma_f32_16x16x32_bf16 a[152:155], v[52:55], v[88:91], a[152:155]
    v_mfma_f32_16x16x32_bf16 a[188:191], v[56:59], v[88:91], a[188:191]
    ds_write_b128 v243, a[216:219] offset:0
    v_mfma_f32_16x16x32_bf16 a[224:227], v[60:63], v[88:91], a[224:227]
    s_waitcnt vmcnt(5)
    v_mfma_f32_16x16x32_bf16 v[76:79], v[48:51], v[92:95], v[76:79]
    ds_write_b128 v241, a[148:151] offset:1024
    v_mfma_f32_16x16x32_bf16 a[156:159], v[52:55], v[92:95], a[156:159]
    v_mfma_f32_16x16x32_bf16 a[192:195], v[56:59], v[92:95], a[192:195]
    ds_write_b128 v242, a[184:187] offset:1024
    v_mfma_f32_16x16x32_bf16 a[228:231], v[60:63], v[92:95], a[228:231]
    v_mfma_f32_16x16x32_bf16 v[188:191], v[16:19], v[168:171], v[188:191]
    ds_write_b128 v243, a[220:223] offset:1024
    v_mfma_f32_16x16x32_bf16 a[160:163], v[20:23], v[168:171], a[160:163]
    v_mfma_f32_16x16x32_bf16 a[196:199], v[24:27], v[168:171], a[196:199]
    ds_write_b128 v241, a[152:155] offset:2048
    v_mfma_f32_16x16x32_bf16 a[232:235], v[28:31], v[168:171], a[232:235]
    s_waitcnt vmcnt(4)
    v_mfma_f32_16x16x32_bf16 v[188:191], v[48:51], v[96:99], v[188:191]
    ds_write_b128 v242, a[188:191] offset:2048
    v_mfma_f32_16x16x32_bf16 a[160:163], v[52:55], v[96:99], a[160:163]
    v_mfma_f32_16x16x32_bf16 a[196:199], v[56:59], v[96:99], a[196:199]
    ds_write_b128 v243, a[224:227] offset:2048
    v_mfma_f32_16x16x32_bf16 a[232:235], v[60:63], v[96:99], a[232:235]
    v_mfma_f32_16x16x32_bf16 v[192:195], v[16:19], v[172:175], v[192:195]
    ds_write_b128 v241, a[156:159] offset:3072
    v_mfma_f32_16x16x32_bf16 a[164:167], v[20:23], v[172:175], a[164:167]
    v_mfma_f32_16x16x32_bf16 a[200:203], v[24:27], v[172:175], a[200:203]
    ds_write_b128 v242, a[192:195] offset:3072
    v_mfma_f32_16x16x32_bf16 a[236:239], v[28:31], v[172:175], a[236:239]
    s_waitcnt vmcnt(3)
    v_mfma_f32_16x16x32_bf16 v[192:195], v[48:51], v[100:103], v[192:195]
    ds_write_b128 v243, a[228:231] offset:3072
    v_mfma_f32_16x16x32_bf16 a[164:167], v[52:55], v[100:103], a[164:167]
    v_mfma_f32_16x16x32_bf16 a[200:203], v[56:59], v[100:103], a[200:203]
    ds_write_b128 v241, a[160:163] offset:4096
    v_mfma_f32_16x16x32_bf16 a[236:239], v[60:63], v[100:103], a[236:239]
    v_mfma_f32_16x16x32_bf16 v[196:199], v[16:19], v[176:179], v[196:199]
    ds_write_b128 v242, a[196:199] offset:4096
    v_mfma_f32_16x16x32_bf16 a[168:171], v[20:23], v[176:179], a[168:171]
    v_mfma_f32_16x16x32_bf16 a[204:207], v[24:27], v[176:179], a[204:207]
    ds_write_b128 v243, a[232:235] offset:4096
    v_mfma_f32_16x16x32_bf16 a[240:243], v[28:31], v[176:179], a[240:243]
    s_waitcnt vmcnt(2)
    v_mfma_f32_16x16x32_bf16 v[196:199], v[48:51], v[104:107], v[196:199]
    ds_write_b128 v241, a[164:167] offset:5120
    v_mfma_f32_16x16x32_bf16 a[168:171], v[52:55], v[104:107], a[168:171]
    v_mfma_f32_16x16x32_bf16 a[204:207], v[56:59], v[104:107], a[204:207]
    ds_write_b128 v242, a[200:203] offset:5120
    v_mfma_f32_16x16x32_bf16 a[240:243], v[60:63], v[104:107], a[240:243]
    v_mfma_f32_16x16x32_bf16 v[200:203], v[16:19], v[180:183], v[200:203]
    ds_write_b128 v243, a[236:239] offset:5120
    v_mfma_f32_16x16x32_bf16 a[172:175], v[20:23], v[180:183], a[172:175]
    v_mfma_f32_16x16x32_bf16 a[208:211], v[24:27], v[180:183], a[208:211]
    ds_write_b128 v241, a[168:171] offset:6144
    v_mfma_f32_16x16x32_bf16 a[244:247], v[28:31], v[180:183], a[244:247]
    s_waitcnt vmcnt(1)
    v_mfma_f32_16x16x32_bf16 v[200:203], v[48:51], v[108:111], v[200:203]
    ds_write_b128 v242, a[204:207] offset:6144
    v_mfma_f32_16x16x32_bf16 a[172:175], v[52:55], v[108:111], a[172:175]
    v_mfma_f32_16x16x32_bf16 a[208:211], v[56:59], v[108:111], a[208:211]
    ds_write_b128 v243, a[240:243] offset:6144
    v_mfma_f32_16x16x32_bf16 a[244:247], v[60:63], v[108:111], a[244:247]
    v_mfma_f32_16x16x32_bf16 v[204:207], v[16:19], v[184:187], v[204:207]
    v_mfma_f32_16x16x32_bf16 a[176:179], v[20:23], v[184:187], a[176:179]
    v_mfma_f32_16x16x32_bf16 a[212:215], v[24:27], v[184:187], a[212:215]
    ds_write_b128 v241, a[172:175] offset:7168
    v_mfma_f32_16x16x32_bf16 a[248:251], v[28:31], v[184:187], a[248:251]
    s_waitcnt vmcnt(0)
    v_mfma_f32_16x16x32_bf16 v[204:207], v[48:51], v[112:115], v[204:207]
    ds_write_b128 v242, a[208:211] offset:7168
    v_mfma_f32_16x16x32_bf16 a[176:179], v[52:55], v[112:115], a[176:179]
    v_mfma_f32_16x16x32_bf16 a[212:215], v[56:59], v[112:115], a[212:215]
    ds_write_b128 v243, a[244:247] offset:7168
    v_mfma_f32_16x16x32_bf16 a[248:251], v[60:63], v[112:115], a[248:251]
    s_nop 7
    ds_write_b128 v241, a[176:179] offset:8192
    ds_write_b128 v242, a[212:215] offset:8192
    ds_write_b128 v243, a[248:251] offset:8192
    s_waitcnt lgkmcnt(0)
    s_barrier
    ds_read_b128 v[116:119], v240 offset:0
    ds_read_b128 v[120:123], v240 offset:9216
    ds_read_b128 v[124:127], v240 offset:18432
    ds_read_b128 v[128:131], v240 offset:1024
    ds_read_b128 v[132:135], v240 offset:10240
    ds_read_b128 v[136:139], v240 offset:19456
    ds_read_b128 v[140:143], v240 offset:2048
    ds_read_b128 v[144:147], v240 offset:11264
    ds_read_b128 v[148:151], v240 offset:20480
    s_waitcnt lgkmcnt(6)
    v_pk_add_f32 v[64:65], v[64:65], v[116:117]
    v_pk_add_f32 v[120:121], v[120:121], v[124:125]
    v_pk_add_f32 v[66:67], v[66:67], v[118:119]
    v_pk_add_f32 v[122:123], v[122:123], v[126:127]
    v_pk_add_f32 v[64:65], v[64:65], v[120:121]
    v_pk_add_f32 v[66:67], v[66:67], v[122:123]
    ds_read_b128 v[116:119], v240 offset:3072
    ds_read_b128 v[120:123], v240 offset:12288
    ds_read_b128 v[124:127], v240 offset:21504
    buffer_store_dwordx4 v[64:67], v233, s[4:7], s72 offen sc1
    s_add_u32 s72, s72, 1024
    s_waitcnt lgkmcnt(6)
    v_pk_add_f32 v[68:69], v[68:69], v[128:129]
    v_pk_add_f32 v[132:133], v[132:133], v[136:137]
    v_pk_add_f32 v[70:71], v[70:71], v[130:131]
    v_pk_add_f32 v[134:135], v[134:135], v[138:139]
    v_pk_add_f32 v[68:69], v[68:69], v[132:133]
    v_pk_add_f32 v[70:71], v[70:71], v[134:135]
    ds_read_b128 v[128:131], v240 offset:4096
    ds_read_b128 v[132:135], v240 offset:13312
    ds_read_b128 v[136:139], v240 offset:22528
    buffer_store_dwordx4 v[68:71], v233, s[4:7], s72 offen sc1
    s_add_u32 s72, s72, 1024
    s_waitcnt lgkmcnt(6)
    v_pk_add_f32 v[72:73], v[72:73], v[140:141]
    v_pk_add_f32 v[144:145], v[144:145], v[148:149]
    v_pk_add_f32 v[74:75], v[74:75], v[142:143]
    v_pk_add_f32 v[146:147], v[146:147], v[150:151]
    v_pk_add_f32 v[72:73], v[72:73], v[144:145]
    v_pk_add_f32 v[74:75], v[74:75], v[146:147]
    ds_read_b128 v[140:143], v240 offset:5120
    ds_read_b128 v[144:147], v240 offset:14336
    ds_read_b128 v[148:151], v240 offset:23552
    buffer_store_dwordx4 v[72:75], v233, s[4:7], s72 offen sc1
    s_add_u32 s72, s72, 1024
    s_waitcnt lgkmcnt(6)
    v_pk_add_f32 v[76:77], v[76:77], v[116:117]
    v_pk_add_f32 v[120:121], v[120:121], v[124:125]
    v_pk_add_f32 v[78:79], v[78:79], v[118:119]
    v_pk_add_f32 v[122:123], v[122:123], v[126:127]
    v_pk_add_f32 v[76:77], v[76:77], v[120:121]
    v_pk_add_f32 v[78:79], v[78:79], v[122:123]
    ds_read_b128 v[116:119], v240 offset:6144
    ds_read_b128 v[120:123], v240 offset:15360
    ds_read_b128 v[124:127], v240 offset:24576
    buffer_store_dwordx4 v[76:79], v233, s[4:7], s72 offen sc1
    s_add_u32 s72, s72, 1024
    s_waitcnt lgkmcnt(6)
    v_pk_add_f32 v[188:189], v[188:189], v[128:129]
    v_pk_add_f32 v[132:133], v[132:133], v[136:137]
    v_pk_add_f32 v[190:191], v[190:191], v[130:131]
    v_pk_add_f32 v[134:135], v[134:135], v[138:139]
    v_pk_add_f32 v[188:189], v[188:189], v[132:133]
    v_pk_add_f32 v[190:191], v[190:191], v[134:135]
    ds_read_b128 v[128:131], v240 offset:7168
    ds_read_b128 v[132:135], v240 offset:16384
    ds_read_b128 v[136:139], v240 offset:25600
    buffer_store_dwordx4 v[188:191], v233, s[4:7], s72 offen sc1
    s_add_u32 s72, s72, 1024
    s_waitcnt lgkmcnt(6)
    v_pk_add_f32 v[192:193], v[192:193], v[140:141]
    v_pk_add_f32 v[144:145], v[144:145], v[148:149]
    v_pk_add_f32 v[194:195], v[194:195], v[142:143]
    v_pk_add_f32 v[146:147], v[146:147], v[150:151]
    v_pk_add_f32 v[192:193], v[192:193], v[144:145]
    v_pk_add_f32 v[194:195], v[194:195], v[146:147]
    ds_read_b128 v[140:143], v240 offset:8192
    ds_read_b128 v[144:147], v240 offset:17408
    ds_read_b128 v[148:151], v240 offset:26624
    buffer_store_dwordx4 v[192:195], v233, s[4:7], s72 offen sc1
    s_add_u32 s72, s72, 1024
    s_waitcnt lgkmcnt(6)
    v_pk_add_f32 v[196:197], v[196:197], v[116:117]
    v_pk_add_f32 v[120:121], v[120:121], v[124:125]
    v_pk_add_f32 v[198:199], v[198:199], v[118:119]
    v_pk_add_f32 v[122:123], v[122:123], v[126:127]
    v_pk_add_f32 v[196:197], v[196:197], v[120:121]
    v_pk_add_f32 v[198:199], v[198:199], v[122:123]
    buffer_store_dwordx4 v[196:199], v233, s[4:7], s72 offen sc1
    s_add_u32 s72, s72, 1024
    s_waitcnt lgkmcnt(3)
    v_pk_add_f32 v[200:201], v[200:201], v[128:129]
    v_pk_add_f32 v[132:133], v[132:133], v[136:137]
    v_pk_add_f32 v[202:203], v[202:203], v[130:131]
    v_pk_add_f32 v[134:135], v[134:135], v[138:139]
    v_pk_add_f32 v[200:201], v[200:201], v[132:133]
    v_pk_add_f32 v[202:203], v[202:203], v[134:135]
    buffer_store_dwordx4 v[200:203], v233, s[4:7], s72 offen sc1
    s_add_u32 s72, s72, 1024
    s_waitcnt lgkmcnt(0)
    v_pk_add_f32 v[204:205], v[204:205], v[140:141]
    v_pk_add_f32 v[144:145], v[144:145], v[148:149]
    v_pk_add_f32 v[206:207], v[206:207], v[142:143]
    v_pk_add_f32 v[146:147], v[146:147], v[150:151]
    v_pk_add_f32 v[204:205], v[204:205], v[144:145]
    v_pk_add_f32 v[206:207], v[206:207], v[146:147]
    buffer_store_dwordx4 v[204:207], v233, s[4:7], s72 offen sc1
    s_add_u32 s72, s72, 1024
    s_barrier
    v_mfma_f32_16x16x32_bf16 a[0:3], v[0:3], v[152:155], a[0:3]
    v_mfma_f32_16x16x32_bf16 a[36:39], v[4:7], v[152:155], a[36:39]
    v_mfma_f32_16x16x32_bf16 a[72:75], v[8:11], v[152:155], a[72:75]
    v_mfma_f32_16x16x32_bf16 a[108:111], v[12:15], v[152:155], a[108:111]
    v_mfma_f32_16x16x32_bf16 a[0:3], v[32:35], v[80:83], a[0:3]
    v_mfma_f32_16x16x32_bf16 a[36:39], v[36:39], v[80:83], a[36:39]
    v_mfma_f32_16x16x32_bf16 a[72:75], v[40:43], v[80:83], a[72:75]
    v_mfma_f32_16x16x32_bf16 a[108:111], v[44:47], v[80:83], a[108:111]
    v_mfma_f32_16x16x32_bf16 a[4:7], v[0:3], v[156:159], a[4:7]
    v_mfma_f32_16x16x32_bf16 a[40:43], v[4:7], v[156:159], a[40:43]
    v_mfma_f32_16x16x32_bf16 a[76:79], v[8:11], v[156:159], a[76:79]
    ds_write_b128 v241, a[36:39] offset:0
    v_mfma_f32_16x16x32_bf16 a[112:115], v[12:15], v[156:159], a[112:115]
    v_accvgpr_read_b32 v116, a0
    v_accvgpr_read_b32 v117, a1
    v_mfma_f32_16x16x32_bf16 a[4:7], v[32:35], v[84:87], a[4:7]
    ds_write_b128 v242, a[72:75] offset:0
    v_mfma_f32_16x16x32_bf16 a[40:43], v[36:39], v[84:87], a[40:43]
    v_accvgpr_read_b32 v118, a2
    v_accvgpr_read_b32 v119, a3
    v_mfma_f32_16x16x32_bf16 a[76:79], v[40:43], v[84:87], a[76:79]
    ds_write_b128 v243, a[108:111] offset:0
    v_mfma_f32_16x16x32_bf16 a[112:115], v[44:47], v[84:87], a[112:115]
    v_mfma_f32_16x16x32_bf16 a[8:11], v[0:3], v[160:163], a[8:11]
    v_mfma_f32_16x16x32_bf16 a[44:47], v[4:7], v[160:163], a[44:47]
    v_mfma_f32_16x16x32_bf16 a[80:83], v[8:11], v[160:163], a[80:83]
    ds_write_b128 v241, a[40:43] offset:1024
    v_mfma_f32_16x16x32_bf16 a[116:119], v[12:15], v[160:163], a[116:119]
    v_accvgpr_read_b32 v120, a4
    v_accvgpr_read_b32 v121, a5
    v_mfma_f32_16x16x32_bf16 a[8:11], v[32:35], v[88:91], a[8:11]
    ds_write_b128 v242, a[76:79] offset:1024
    v_mfma_f32_16x16x32_bf16 a[44:47], v[36:39], v[88:91], a[44:47]
    v_accvgpr_read_b32 v122, a6
    v_accvgpr_read_b32 v123, a7
    v_mfma_f32_16x16x32_bf16 a[80:83], v[40:43], v[88:91], a[80:83]
    ds_write_b128 v243, a[112:115] offset:1024
    v_mfma_f32_16x16x32_bf16 a[116:119], v[44:47], v[88:91], a[116:119]
    v_mfma_f32_16x16x32_bf16 a[12:15], v[0:3], v[164:167], a[12:15]
    v_mfma_f32_16x16x32_bf16 a[48:51], v[4:7], v[164:167], a[48:51]
    v_mfma_f32_16x16x32_bf16 a[84:87], v[8:11], v[164:167], a[84:87]
    ds_write_b128 v241, a[44:47] offset:2048
    v_mfma_f32_16x16x32_bf16 a[120:123], v[12:15], v[164:167], a[120:123]
    v_accvgpr_read_b32 v124, a8
    v_accvgpr_read_b32 v125, a9
    v_mfma_f32_16x16x32_bf16 a[12:15], v[32:35], v[92:95], a[12:15]
    ds_write_b128 v242, a[80:83] offset:2048
    v_mfma_f32_16x16x32_bf16 a[48:51], v[36:39], v[92:95], a[48:51]
    v_accvgpr_read_b32 v126, a10
    v_accvgpr_read_b32 v127, a11
    v_mfma_f32_16x16x32_bf16 a[84:87], v[40:43], v[92:95], a[84:87]
    ds_write_b128 v243, a[116:119] offset:2048
    v_mfma_f32_16x16x32_bf16 a[120:123], v[44:47], v[92:95], a[120:123]
    v_mfma_f32_16x16x32_bf16 a[16:19], v[0:3], v[168:171], a[16:19]
    v_mfma_f32_16x16x32_bf16 a[52:55], v[4:7], v[168:171], a[52:55]
    v_mfma_f32_16x16x32_bf16 a[88:91], v[8:11], v[168:171], a[88:91]
    ds_write_b128 v241, a[48:51] offset:3072
    v_mfma_f32_16x16x32_bf16 a[124:127], v[12:15], v[168:171], a[124:127]
    v_accvgpr_read_b32 v128, a12
    v_accvgpr_read_b32 v129, a13
    v_mfma_f32_16x16x32_bf16 a[16:19], v[32:35], v[96:99], a[16:19]
    ds_write_b128 v242, a[84:87] offset:3072
    v_mfma_f32_16x16x32_bf16 a[52:55], v[36:39], v[96:99], a[52:55]
    v_accvgpr_read_b32 v130, a14
    v_accvgpr_read_b32 v131, a15
    v_mfma_f32_16x16x32_bf16 a[88:91], v[40:43], v[96:99], a[88:91]
    ds_write_b128 v243, a[120:123] offset:3072
    v_mfma_f32_16x16x32_bf16 a[124:127], v[44:47], v[96:99], a[124:127]
    v_mfma_f32_16x16x32_bf16 a[20:23], v[0:3], v[172:175], a[20:23]
    v_mfma_f32_16x16x32_bf16 a[56:59], v[4:7], v[172:175], a[56:59]
    v_mfma_f32_16x16x32_bf16 a[92:95], v[8:11], v[172:175], a[92:95]
    ds_write_b128 v241, a[52:55] offset:4096
    v_mfma_f32_16x16x32_bf16 a[128:131], v[12:15], v[172:175], a[128:131]
    v_accvgpr_read_b32 v132, a16
    v_accvgpr_read_b32 v133, a17
    v_mfma_f32_16x16x32_bf16 a[20:23], v[32:35], v[100:103], a[20:23]
    s_waitcnt vmcnt(0)
    s_mov_b64 exec, 1
    s_cmp_lg_u32 s40, 0
    s_cbranch_scc1 OP_rel
    buffer_store_dword v210, v209, s[4:7], s71 offen
OP_r1:
    s_mov_b64 exec, -1
    v_mfma_f32_16x16x32_bf16 a[56:59], v[36:39], v[100:103], a[56:59]
    ds_write_b128 v242, a[88:91] offset:4096
    v_mfma_f32_16x16x32_bf16 a[92:95], v[40:43], v[100:103], a[92:95]
    v_accvgpr_read_b32 v134, a18
    v_accvgpr_read_b32 v135, a19
    v_mfma_f32_16x16x32_bf16 a[128:131], v[44:47], v[100:103], a[128:131]
    ds_write_b128 v243, a[124:127] offset:4096
    v_mfma_f32_16x16x32_bf16 a[24:27], v[0:3], v[176:179], a[24:27]
    v_mfma_f32_16x16x32_bf16 a[60:63], v[4:7], v[176:179], a[60:63]
    v_mfma_f32_16x16x32_bf16 a[96:99], v[8:11], v[176:179], a[96:99]
    ds_write_b128 v241, a[56:59] offset:5120
    v_mfma_f32_16x16x32_bf16 a[132:135], v[12:15], v[176:179], a[132:135]
    v_accvgpr_read_b32 v136, a20
    v_accvgpr_read_b32 v137, a21
    v_mfma_f32_16x16x32_bf16 a[24:27], v[32:35], v[104:107], a[24:27]
    ds_write_b128 v242, a[92:95] offset:5120
    v_mfma_f32_16x16x32_bf16 a[60:63], v[36:39], v[104:107], a[60:63]
    v_accvgpr_read_b32 v138, a22
    v_accvgpr_read_b32 v139, a23
    v_mfma_f32_16x16x32_bf16 a[96:99], v[40:43], v[104:107], a[96:99]
    ds_write_b128 v243, a[128:131] offset:5120
    v_mfma_f32_16x16x32_bf16 a[132:135], v[44:47], v[104:107], a[132:135]
    v_mfma_f32_16x16x32_bf16 a[28:31], v[0:3], v[180:183], a[28:31]
    v_mfma_f32_16x16x32_bf16 a[64:67], v[4:7], v[180:183], a[64:67]
    v_mfma_f32_16x16x32_bf16 a[100:103], v[8:11], v[180:183], a[100:103]
    ds_write_b128 v241, a[60:63] offset:6144
    v_mfma_f32_16x16x32_bf16 a[136:139], v[12:15], v[180:183], a[136:139]
    v_accvgpr_read_b32 v140, a24
    v_accvgpr_read_b32 v141, a25
    v_mfma_f32_16x16x32_bf16 a[28:31], v[32:35], v[108:111], a[28:31]
    ds_write_b128 v242, a[96:99] offset:6144
    v_mfma_f32_16x16x32_bf16 a[64:67], v[36:39], v[108:111], a[64:67]
    v_accvgpr_read_b32 v142, a26
    v_accvgpr_read_b32 v143, a27
    v_mfma_f32_16x16x32_bf16 a[100:103], v[40:43], v[108:111], a[100:103]
    ds_write_b128 v243, a[132:135] offset:6144
    v_mfma_f32_16x16x32_bf16 a[136:139], v[44:47], v[108:111], a[136:139]
    v_mfma_f32_16x16x32_bf16 a[32:35], v[0:3], v[184:187], a[32:35]
    v_mfma_f32_16x16x32_bf16 a[68:71], v[4:7], v[184:187], a[68:71]
    v_mfma_f32_16x16x32_bf16 a[104:107], v[8:11], v[184:187], a[104:107]
    ds_write_b128 v241, a[64:67] offset:7168
    v_mfma_f32_16x16x32_bf16 a[140:143], v[12:15], v[184:187], a[140:143]
    v_accvgpr_read_b32 v144, a28
    v_accvgpr_read_b32 v145, a29
    v_mfma_f32_16x16x32_bf16 a[32:35], v[32:35], v[112:115], a[32:35]
    ds_write_b128 v242, a[100:103] offset:7168
    v_mfma_f32_16x16x32_bf16 a[68:71], v[36:39], v[112:115], a[68:71]
    v_accvgpr_read_b32 v146, a30
    v_accvgpr_read_b32 v147, a31
    v_mfma_f32_16x16x32_bf16 a[104:107], v[40:43], v[112:115], a[104:107]
    ds_write_b128 v243, a[136:139] offset:7168
    v_mfma_f32_16x16x32_bf16 a[140:143], v[44:47], v[112:115], a[140:143]
    s_nop 7
    ds_write_b128 v241, a[68:71] offset:8192
    ds_write_b128 v242, a[104:107] offset:8192
    ds_write_b128 v243, a[140:143] offset:8192
    buffer_load_dword v211, v209, s[4:7], s73 offen sc1
    v_accvgpr_read_b32 v148, a32
    v_accvgpr_read_b32 v149, a33
    v_accvgpr_read_b32 v150, a34
    v_accvgpr_read_b32 v151, a35
    s_waitcnt lgkmcnt(0)
    s_barrier
    ds_read_b128 v[80:83], v240 offset:0
    ds_read_b128 v[84:87], v240 offset:9216
    ds_read_b128 v[88:91], v240 offset:18432
    ds_read_b128 v[92:95], v240 offset:1024
    ds_read_b128 v[96:99], v240 offset:10240
    ds_read_b128 v[100:103], v240 offset:19456
    ds_read_b128 v[104:107], v240 offset:2048
    ds_read_b128 v[108:111], v240 offset:11264
    ds_read_b128 v[112:115], v240 offset:20480
    ds_read_b128 v[152:155], v240 offset:3072
    ds_read_b128 v[156:159], v240 offset:12288
    ds_read_b128 v[160:163], v240 offset:21504
    s_waitcnt lgkmcnt(9)
    ds_read_b128 v[164:167], v240 offset:4096
    ds_read_b128 v[168:171], v240 offset:13312
    ds_read_b128 v[172:175], v240 offset:22528
    v_pk_add_f32 v[116:117], v[116:117], v[80:81]
    v_pk_add_f32 v[84:85], v[84:85], v[88:89]
    v_pk_add_f32 v[118:119], v[118:119], v[82:83]
    v_pk_add_f32 v[86:87], v[86:87], v[90:91]
    v_pk_add_f32 v[116:117], v[116:117], v[84:85]
    v_pk_add_f32 v[118:119], v[118:119], v[86:87]
    s_waitcnt lgkmcnt(9)
    ds_read_b128 v[80:83], v240 offset:5120
    ds_read_b128 v[84:87], v240 offset:14336
    ds_read_b128 v[88:91], v240 offset:23552
    v_pk_add_f32 v[120:121], v[120:121], v[92:93]
    v_pk_add_f32 v[96:97], v[96:97], v[100:101]
    v_pk_add_f32 v[122:123], v[122:123], v[94:95]
    v_pk_add_f32 v[98:99], v[98:99], v[102:103]
    v_pk_add_f32 v[120:121], v[120:121], v[96:97]
    v_pk_add_f32 v[122:123], v[122:123], v[98:99]
    s_waitcnt lgkmcnt(9)
    ds_read_b128 v[92:95], v240 offset:6144
    ds_read_b128 v[96:99], v240 offset:15360
    ds_read_b128 v[100:103], v240 offset:24576
    v_pk_add_f32 v[124:125], v[124:125], v[104:105]
    v_pk_add_f32 v[108:109], v[108:109], v[112:113]
    v_pk_add_f32 v[126:127], v[126:127], v[106:107]
    v_pk_add_f32 v[110:111], v[110:111], v[114:115]
    v_pk_add_f32 v[124:125], v[124:125], v[108:109]
    v_pk_add_f32 v[126:127], v[126:127], v[110:111]
    s_mov_b32 s65, 0x20000
OP_f0:
    s_waitcnt vmcnt(0)
    v_readfirstlane_b32 s62, v211
    s_cmp_eq_u32 s62, 1
    s_cbranch_scc0 OP_fw
OP_f1:
    buffer_load_dwordx4 v[16:19], v233, s[4:7], s69 offen offset:0 sc1
    buffer_load_dwordx4 v[20:23], v233, s[4:7], s69 offen offset:1024 sc1
    buffer_load_dwordx4 v[24:27], v233, s[4:7], s69 offen offset:2048 sc1
    buffer_load_dwordx4 v[28:31], v233, s[4:7], s69 offen offset:3072 sc1
    buffer_load_dwordx4 v[48:51], v233, s[4:7], s66 offen offset:0 sc1
    buffer_load_dwordx4 v[52:55], v233, s[4:7], s66 offen offset:1024 sc1
    buffer_load_dwordx4 v[56:59], v233, s[4:7], s66 offen offset:2048 sc1
    buffer_load_dwordx4 v[60:63], v233, s[4:7], s66 offen offset:3072 sc1
    buffer_load_dwordx4 v[248:251], v233, s[4:7], s67 offen offset:0 sc1
    s_waitcnt lgkmcnt(9)
    ds_read_b128 v[104:107], v240 offset:7168
    ds_read_b128 v[108:111], v240 offset:16384
    ds_read_b128 v[112:115], v240 offset:25600
    v_pk_add_f32 v[128:129], v[128:129], v[152:153]
    v_pk_add_f32 v[156:157], v[156:157], v[160:161]
    v_pk_add_f32 v[130:131], v[130:131], v[154:155]
    v_pk_add_f32 v[158:159], v[158:159], v[162:163]
    v_pk_add_f32 v[128:129], v[128:129], v[156:157]
    v_pk_add_f32 v[130:131], v[130:131], v[158:159]
    s_waitcnt lgkmcnt(9)
    ds_read_b128 v[152:155], v240 offset:8192
    ds_read_b128 v[156:159], v240 offset:17408
    ds_read_b128 v[160:163], v240 offset:26624
    v_pk_add_f32 v[132:133], v[132:133], v[164:165]
    v_pk_add_f32 v[168:169], v[168:169], v[172:173]
    v_pk_add_f32 v[134:135], v[134:135], v[166:167]
    v_pk_add_f32 v[170:171], v[170:171], v[174:175]
    v_pk_add_f32 v[132:133], v[132:133], v[168:169]
    v_pk_add_f32 v[134:135], v[134:135], v[170:171]
    s_waitcnt lgkmcnt(9)
    v_pk_add_f32 v[136:137], v[136:137], v[80:81]
    v_pk_add_f32 v[84:85], v[84:85], v[88:89]
    v_pk_add_f32 v[138:139], v[138:139], v[82:83]
    v_pk_add_f32 v[86:87], v[86:87], v[90:91]
    v_pk_add_f32 v[136:137], v[136:137], v[84:85]
    v_pk_add_f32 v[138:139], v[138:139], v[86:87]
    s_waitcnt lgkmcnt(6)
    v_pk_add_f32 v[140:141], v[140:141], v[92:93]
    v_pk_add_f32 v[96:97], v[96:97], v[100:101]
    v_pk_add_f32 v[142:143], v[142:143], v[94:95]
    v_pk_add_f32 v[98:99], v[98:99], v[102:103]
    v_pk_add_f32 v[140:141], v[140:141], v[96:97]
    v_pk_add_f32 v[142:143], v[142:143], v[98:99]
    s_waitcnt lgkmcnt(3)
    v_pk_add_f32 v[144:145], v[144:145], v[104:105]
    v_pk_add_f32 v[108:109], v[108:109], v[112:113]
    v_pk_add_f32 v[146:147], v[146:147], v[106:107]
    v_pk_add_f32 v[110:111], v[110:111], v[114:115]
    v_pk_add_f32 v[144:145], v[144:145], v[108:109]
    v_pk_add_f32 v[146:147], v[146:147], v[110:111]
    s_waitcnt lgkmcnt(0)
    v_pk_add_f32 v[148:149], v[148:149], v[152:153]
    v_pk_add_f32 v[156:157], v[156:157], v[160:161]
    v_pk_add_f32 v[150:151], v[150:151], v[154:155]
    v_pk_add_f32 v[158:159], v[158:159], v[162:163]
    v_pk_add_f32 v[148:149], v[148:149], v[156:157]
    v_pk_add_f32 v[150:151], v[150:151], v[158:159]
    s_waitcnt vmcnt(8)
    v_pk_add_f32 v[116:117], v[116:117], v[16:17]
    v_pk_add_f32 v[118:119], v[118:119], v[18:19]
    v_cvt_pk_bf16_f32 v116, v116, v117
    v_cvt_pk_bf16_f32 v117, v118, v119
    ds_write_b64 v208, v[116:117] offset:0
    s_waitcnt vmcnt(7)
    v_pk_add_f32 v[120:121], v[120:121], v[20:21]
    v_pk_add_f32 v[122:123], v[122:123], v[22:23]
    v_cvt_pk_bf16_f32 v120, v120, v121
    v_cvt_pk_bf16_f32 v121, v122, v123
    ds_write_b64 v208, v[120:121] offset:2048
    s_waitcnt vmcnt(6)
    v_pk_add_f32 v[124:125], v[124:125], v[24:25]
    v_pk_add_f32 v[126:127], v[126:127], v[26:27]
    v_cvt_pk_bf16_f32 v124, v124, v125
    v_cvt_pk_bf16_f32 v125, v126, v127
    ds_write_b64 v208, v[124:125] offset:4096
    s_waitcnt vmcnt(5)
    v_pk_add_f32 v[128:129], v[128:129], v[28:29]
    v_pk_add_f32 v[130:131], v[130:131], v[30:31]
    v_cvt_pk_bf16_f32 v128, v128, v129
    v_cvt_pk_bf16_f32 v129, v130, v131
    ds_write_b64 v208, v[128:129] offset:6144
    s_waitcnt vmcnt(4)
    v_pk_add_f32 v[132:133], v[132:133], v[48:49]
    v_pk_add_f32 v[134:135], v[134:135], v[50:51]
    v_cvt_pk_bf16_f32 v132, v132, v133
    v_cvt_pk_bf16_f32 v133, v134, v135
    ds_write_b64 v208, v[132:133] offset:8192
    s_waitcnt vmcnt(3)
    v_pk_add_f32 v[136:137], v[136:137], v[52:53]
    v_pk_add_f32 v[138:139], v[138:139], v[54:55]
    v_cvt_pk_bf16_f32 v136, v136, v137
    v_cvt_pk_bf16_f32 v137, v138, v139
    ds_write_b64 v208, v[136:137] offset:10240
    s_waitcnt vmcnt(2)
    v_pk_add_f32 v[140:141], v[140:141], v[56:57]
    v_pk_add_f32 v[142:143], v[142:143], v[58:59]
    v_cvt_pk_bf16_f32 v140, v140, v141
    v_cvt_pk_bf16_f32 v141, v142, v143
    ds_write_b64 v208, v[140:141] offset:12288
    s_waitcnt vmcnt(1)
    v_pk_add_f32 v[144:145], v[144:145], v[60:61]
    v_pk_add_f32 v[146:147], v[146:147], v[62:63]
    v_cvt_pk_bf16_f32 v144, v144, v145
    v_cvt_pk_bf16_f32 v145, v146, v147
    ds_write_b64 v208, v[144:145] offset:14336
    s_waitcnt vmcnt(0)
    v_pk_add_f32 v[148:149], v[148:149], v[248:249]
    v_pk_add_f32 v[150:151], v[150:151], v[250:251]
    v_cvt_pk_bf16_f32 v148, v148, v149
    v_cvt_pk_bf16_f32 v149, v150, v151
    ds_write_b64 v208, v[148:149] offset:16384
    s_waitcnt lgkmcnt(0)
    s_barrier
    ds_read_b128 v[80:83], v244 offset:0
    ds_read_b128 v[84:87], v244 offset:4096
    ds_read_b128 v[88:91], v244 offset:8192
    ds_read_b128 v[92:95], v244 offset:12288
    ds_read_b128 v[96:99], v244 offset:16384
    s_waitcnt lgkmcnt(4)
    buffer_store_dwordx4 v[80:83], v247, s[88:91], s68 offen sc1
    s_add_u32 s68, s68, 65536
    s_waitcnt lgkmcnt(3)
    buffer_store_dwordx4 v[84:87], v247, s[88:91], s68 offen sc1
    s_add_u32 s68, s68, 65536
    s_waitcnt lgkmcnt(2)
    buffer_store_dwordx4 v[88:91], v247, s[88:91], s68 offen sc1
    s_add_u32 s68, s68, 65536
    s_waitcnt lgkmcnt(1)
    buffer_store_dwordx4 v[92:95], v247, s[88:91], s68 offen sc1
    s_add_u32 s68, s68, 65536
    s_cmp_ge_u32 s36, 2
    s_cbranch_scc1 K1_end
    s_waitcnt lgkmcnt(0)
    buffer_store_dwordx4 v[96:99], v247, s[88:91], s68 offen sc1
    s_add_u32 s68, s68, 65536
    s_branch K1_end
OP_rel:
    buffer_store_dword v210, v209, s[4:7], s71 offen sc1
    s_branch OP_r1
OP_fw:
    s_sub_u32 s65, s65, 1
    s_cmp_eq_u32 s65, 0
    s_cbranch_scc1 OP_f1
    buffer_load_dword v211, v209, s[4:7], s73 offen sc1
    s_branch OP_f0
OP_wait:
    s_sub_u32 s65, s65, 1
    s_cmp_eq_u32 s65, 0
    s_cbranch_scc1 OP_c1
    s_sleep 4
    global_load_dword v226, v239, s[48:49] offset:4 sc1
    s_waitcnt vmcnt(0)
    s_branch OP_c0
K1_end:
K1_exit:
    s_endpgm
.section .rodata,"a"
.p2align 6
.amdhsa_kernel concat_heads__mha_block_cached__gqa_block_cached__near_ridge_kernel
  .amdhsa_next_free_vgpr 512
  .amdhsa_next_free_sgpr 102
  .amdhsa_accum_offset 256
  .amdhsa_group_segment_fixed_size 0
  .amdhsa_kernarg_size 104
  .amdhsa_user_sgpr_count 2
  .amdhsa_user_sgpr_kernarg_segment_ptr 1
  .amdhsa_system_sgpr_workgroup_id_x 1
  .amdhsa_float_denorm_mode_32 3
.end_amdhsa_kernel
```
